```python
import torch

def _softmax(x, axis=-1):
    return torch.softmax(x, dim=axis)

def _gelu(x):
    return torch.nn.functional.gelu(x, approximate='tanh')

def _silu(x):
    return torch.nn.functional.silu(x)

def _sigmoid(x):
    return torch.sigmoid(x)

def _layernorm(x, axis=-1, eps=1e-05):
    m = x.mean(dim=axis, keepdim=True)
    v = x.var(dim=axis, keepdim=True, unbiased=False)
    return (x - m) / torch.sqrt(v + eps)

def _scatter_add(tgt, idx, src, axis=0):
    return tgt.clone().index_add_(axis, idx, src)

def _segment_sum(src, seg, n):
    out = torch.zeros((n,) + src.shape[1:], dtype=src.dtype)
    return out.index_add_(0, seg, src)

def _pad(x, pw):
    flat = tuple((v for pair in reversed(pw) for v in pair))
    return torch.nn.functional.pad(x, flat)
kernel_name = 'parallel_sum__memory_aug_recurrent_mem_tr__swiglu_ffn__prompt'

def setup_inputs():

    _w = lambda a: (lambda t: t.to(torch.bfloat16) if t.is_floating_point() else t)(torch.as_tensor(a))

    def _A_setup():
        B, S, Dm = (1, 2048, 640)
        H, Dh = (32, 192)
        M, seg = (8, 32)
        seg = min(seg, S)
        S = S // seg * seg
        return {'x': _w((lambda *s: torch.randn(*s, dtype=torch.bfloat16) * 0.05)(B, S, Dm)), 'mem0': _w((lambda *s: torch.randn(*s, dtype=torch.bfloat16) * 1.6)(B, M, Dm)), 'Wq': _w((lambda *s: torch.randn(*s, dtype=torch.bfloat16) * 0.8)(Dm, H, Dh) * Dm ** (-0.5)), 'Wk': _w((lambda *s: torch.randn(*s, dtype=torch.bfloat16) * 0.8)(Dm, H, Dh) * Dm ** (-0.5)), 'Wv': _w((lambda *s: torch.randn(*s, dtype=torch.bfloat16) * 1.6)(Dm, H, Dh) * Dm ** (-0.5)), 'Wo': _w((lambda *s: torch.randn(*s, dtype=torch.bfloat16) * 1.6)(H, Dh, Dm) * (H * Dh) ** (-0.5)), 'seg_len': seg}
    _A_in = _A_setup()

    def _B_setup():
        B, S, D, F = (1, 2048, 640, 1536)
        return {'x': _w((lambda *s: torch.randn(*s, dtype=torch.bfloat16) * 0.05)(B, S, D)), 'w_gate': _w((lambda *s: torch.randn(*s, dtype=torch.bfloat16) * 0.05)(D, F)), 'w_up': _w((lambda *s: torch.randn(*s, dtype=torch.bfloat16) * 0.05)(D, F)), 'w_down': _w((lambda *s: torch.randn(*s, dtype=torch.bfloat16) * 0.05)(F, D))}
    _B_in = _B_setup()
    return {'A_x': _A_in['x'], 'A_mem0': _A_in['mem0'], 'A_Wq': _A_in['Wq'], 'A_Wk': _A_in['Wk'], 'A_Wv': _A_in['Wv'], 'A_Wo': _A_in['Wo'], 'A_seg_len': _A_in['seg_len'], 'B_x': _B_in['x'], 'B_w_gate': _B_in['w_gate'], 'B_w_up': _B_in['w_up'], 'B_w_down': _B_in['w_down']}

def reference(A_x, A_mem0, A_Wq, A_Wk, A_Wv, A_Wo, A_seg_len, B_x, B_w_gate, B_w_up, B_w_down):

    def _A_ref(x, mem0, Wq, Wk, Wv, Wo, seg_len):
        B, S, Dm = x.shape
        H, Dh = (Wq.shape[1], Wq.shape[2])
        M = mem0.shape[1]
        scale = Dh ** (-0.5)
        n_seg = S // seg_len
        L = M + seg_len
        idx = torch.arange(L)
        mask = (idx[:, None] < M) | (idx[:, None] >= idx[None, :])
        mem = mem0
        outs = []
        for s in range(n_seg):
            xs = x[:, s * seg_len:(s + 1) * seg_len, :].clone()
            h = torch.concatenate([mem, xs], axis=1)
            q = torch.einsum('btd,dhe->bhte', h, Wq)
            k = torch.einsum('btd,dhe->bhte', h, Wk)
            v = torch.einsum('btd,dhe->bhte', h, Wv)
            scores = torch.einsum('bhqe,bhke->bhqk', q, k) * scale
            scores = torch.where(mask[None, None], scores, -1000000000.0)
            p = _softmax(scores, axis=-1)
            o = torch.einsum('bhqk,bhke->bhqe', p, v)
            o = torch.einsum('bhte,hed->btd', o, Wo)
            mem = o[:, :M, :].clone()
            outs.append(o[:, M:, :])
        return torch.concatenate(outs, axis=1)

    def _B_ref(x, w_gate, w_up, w_down):
        g = _silu(x @ w_gate)
        u = x @ w_up
        return g * u @ w_down
    x = A_x
    xn = _layernorm(x, axis=-1)
    return x + _A_ref(xn, A_mem0, A_Wq, A_Wk, A_Wv, A_Wo, A_seg_len) + _B_ref(xn, B_w_gate, B_w_up, B_w_down)
```

```asm
; @launch kernel=parallel_sum__memory_aug_recurrent_mem_tr__swiglu_ffn__prompt_kernel grid=(256,1,1) block=(256,1,1) lds=163840
.amdgcn_target "amdgcn-amd-amdhsa--gfx950"
.text
.globl parallel_sum__memory_aug_recurrent_mem_tr__swiglu_ffn__prompt_kernel
.p2align 8
.type parallel_sum__memory_aug_recurrent_mem_tr__swiglu_ffn__prompt_kernel,@function
parallel_sum__memory_aug_recurrent_mem_tr__swiglu_ffn__prompt_kernel:
  s_cmp_ge_u32 s2, 256
  s_cbranch_scc1 K2_exit
  s_getpc_b64 s[96:97]
PC_1:
  v_lshlrev_b32 v5, 7, v0
  v_min_u32 v6, K2_last-PC_1-4, v5
  global_load_dword v252, v6, s[96:97]
  v_add_u32 v5, 32768, v5
  v_min_u32 v6, K2_last-PC_1-4, v5
  global_load_dword v252, v6, s[96:97]
  v_add_u32 v5, 32768, v5
  v_min_u32 v6, K2_last-PC_1-4, v5
  global_load_dword v252, v6, s[96:97]
  s_load_dwordx2 s[6:7], s[0:1], 96
  s_load_dwordx2 s[4:5], s[0:1], 104
  v_and_b32 v1, 63, v0
  v_lshrrev_b32 v2, 6, v0
  s_nop 0
  v_readfirstlane_b32 s3, v2
  s_waitcnt lgkmcnt(0)
  s_mov_b32 s66, 0
  s_mov_b32 s95, 0xffff0000
  s_cmp_lg_u32 s3, 0
  s_cbranch_scc1 CL_wait
  s_getreg_b32 s40, hwreg(HW_REG_XCC_ID)
  s_and_b32 s40, s40, 7
  s_lshr_b32 s41, s2, 3
  s_lshl_b32 s48, 1, s41
  s_and_b32 s49, s40, 3
  s_lshl_b32 s49, s49, 2
  s_lshr_b32 s50, s40, 2
  s_lshl_b32 s50, s50, 7
  s_add_u32 s49, s49, s50
  s_mov_b64 exec, 1
  v_mov_b32 v8, s49
  v_mov_b32 v9, s48
  v_mov_b32 v10, 0
  v_mov_b32 v11, 1
  global_atomic_or v12, v8, v9, s[6:7] offset:96 sc0 sc1
  s_waitcnt vmcnt(0)
  v_readfirstlane_b32 s49, v12
  s_and_b32 s49, s49, s48
  s_cbranch_scc0 CL_won
  global_atomic_add v12, v10, v11, s[6:7] offset:132 sc0 sc1
  s_waitcnt vmcnt(0)
  v_readfirstlane_b32 s50, v12
CL_all:
  global_load_dword v20, v10, s[6:7] offset:132 sc1
  s_waitcnt vmcnt(0)
  global_load_dwordx4 v[12:15], v10, s[6:7] offset:96 sc1
  global_load_dwordx4 v[16:19], v10, s[6:7] offset:224 sc1
  s_waitcnt vmcnt(0)
  v_bcnt_u32_b32 v20, v12, v20
  v_bcnt_u32_b32 v20, v13, v20
  v_bcnt_u32_b32 v20, v14, v20
  v_bcnt_u32_b32 v20, v15, v20
  v_bcnt_u32_b32 v20, v16, v20
  v_bcnt_u32_b32 v20, v17, v20
  v_bcnt_u32_b32 v20, v18, v20
  v_bcnt_u32_b32 v20, v19, v20
  s_nop 0
  v_readfirstlane_b32 s49, v20
  s_cmp_ge_u32 s49, 256
  s_cbranch_scc1 CL_pick
  s_sleep 4
  s_add_u32 s66, s66, 1
  s_cmp_lt_u32 s66, 2097152
  s_cbranch_scc1 CL_all
  s_branch K2_abort
CL_pick:
  v_readfirstlane_b32 s48, v12
  s_mov_b32 s40, 0
  s_not_b32 s48, s48
  s_bcnt1_i32_b32 s49, s48
  s_cmp_lt_u32 s50, s49
  s_cbranch_scc1 CL_bit
  s_sub_u32 s50, s50, s49
  v_readfirstlane_b32 s48, v13
  s_mov_b32 s40, 1
  s_not_b32 s48, s48
  s_bcnt1_i32_b32 s49, s48
  s_cmp_lt_u32 s50, s49
  s_cbranch_scc1 CL_bit
  s_sub_u32 s50, s50, s49
  v_readfirstlane_b32 s48, v14
  s_mov_b32 s40, 2
  s_not_b32 s48, s48
  s_bcnt1_i32_b32 s49, s48
  s_cmp_lt_u32 s50, s49
  s_cbranch_scc1 CL_bit
  s_sub_u32 s50, s50, s49
  v_readfirstlane_b32 s48, v15
  s_mov_b32 s40, 3
  s_not_b32 s48, s48
  s_bcnt1_i32_b32 s49, s48
  s_cmp_lt_u32 s50, s49
  s_cbranch_scc1 CL_bit
  s_sub_u32 s50, s50, s49
  v_readfirstlane_b32 s48, v16
  s_mov_b32 s40, 4
  s_not_b32 s48, s48
  s_bcnt1_i32_b32 s49, s48
  s_cmp_lt_u32 s50, s49
  s_cbranch_scc1 CL_bit
  s_sub_u32 s50, s50, s49
  v_readfirstlane_b32 s48, v17
  s_mov_b32 s40, 5
  s_not_b32 s48, s48
  s_bcnt1_i32_b32 s49, s48
  s_cmp_lt_u32 s50, s49
  s_cbranch_scc1 CL_bit
  s_sub_u32 s50, s50, s49
  v_readfirstlane_b32 s48, v18
  s_mov_b32 s40, 6
  s_not_b32 s48, s48
  s_bcnt1_i32_b32 s49, s48
  s_cmp_lt_u32 s50, s49
  s_cbranch_scc1 CL_bit
  s_sub_u32 s50, s50, s49
  v_readfirstlane_b32 s48, v19
  s_mov_b32 s40, 7
  s_not_b32 s48, s48
  s_bcnt1_i32_b32 s49, s48
  s_cmp_lt_u32 s50, s49
  s_cbranch_scc1 CL_bit
  s_sub_u32 s50, s50, s49
  s_branch K2_abort
CL_bit:
  s_ff1_i32_b32 s41, s48
  s_cmp_eq_u32 s50, 0
  s_cbranch_scc1 CL_won
  s_bitset0_b32 s48, s41
  s_sub_u32 s50, s50, 1
  s_branch CL_bit
CL_won:
  s_lshl_b32 s48, s41, 3
  s_add_u32 s48, s48, s40
  v_mov_b32 v9, s48
  ds_write_b32 v10, v9
  s_mov_b64 exec, -1
  s_waitcnt lgkmcnt(0)
CL_wait:
  s_barrier
  v_mov_b32 v10, 0
  ds_read_b32 v9, v10
  s_waitcnt lgkmcnt(0)
  v_readfirstlane_b32 s2, v9
  s_and_b32 s2, s2, 255
  s_and_b32 s40, s2, 7
  s_lshr_b32 s41, s2, 3
  s_waitcnt vmcnt(0)
  s_barrier
  s_cmp_ge_u32 s40, 4
  s_cbranch_scc1 K2_bulk
  s_cmp_ge_u32 s41, 16
  s_cbranch_scc1 K2_init
  s_cmp_ge_u32 s41, 8
  s_cbranch_scc1 K2_vo
  s_load_dwordx4 s[8:11], s[0:1], 16
  s_load_dwordx2 s[6:7], s[0:1], 96
  s_getreg_b32 s48, hwreg(HW_REG_XCC_ID)
  s_and_b32 s48, s48, 7
  s_mul_i32 s49, s48, s48
  s_lshl_b32 s49, s49, 16
  s_lshl_b32 s48, s48, 8
  s_add_u32 s48, s48, s49
  s_add_u32 s48, s48, 1
  s_lshl_b32 s49, s40, 2
  v_mov_b32 v20, s49
  v_mov_b32 v21, s48
  s_waitcnt lgkmcnt(0)
  s_cmp_lg_u32 s3, 0
  s_cbranch_scc1 HS_10
  s_mov_b64 exec, 1
  global_atomic_add v20, v21, s[6:7] sc1
  s_mov_b64 exec, -1
HS_10:
  s_lshl_b32 s42, s40, 3
  s_add_u32 s42, s42, s41
  v_add_u32 v20, 0, v0
  v_mul_u32_u24 v21, 2731, v20
  v_lshrrev_b32 v21, 16, v21
  v_mul_u32_u24 v22, 24, v21
  v_sub_u32 v22, v20, v22
  v_bfe_u32 v23, v21, 1, 2
  v_lshlrev_b32 v23, 1, v23
  v_xor_b32 v22, v22, v23
  s_mov_b32 s90, 12288
  v_mul_lo_u32 v21, v21, s90
  v_lshl_add_u32 v24, v22, 4, v21
  v_add_u32 v20, 256, v0
  v_mul_u32_u24 v21, 2731, v20
  v_lshrrev_b32 v21, 16, v21
  v_mul_u32_u24 v22, 24, v21
  v_sub_u32 v22, v20, v22
  v_bfe_u32 v23, v21, 1, 2
  v_lshlrev_b32 v23, 1, v23
  v_xor_b32 v22, v22, v23
  s_mov_b32 s90, 12288
  v_mul_lo_u32 v21, v21, s90
  v_lshl_add_u32 v25, v22, 4, v21
  v_add_u32 v20, 512, v0
  v_mul_u32_u24 v21, 2731, v20
  v_lshrrev_b32 v21, 16, v21
  v_mul_u32_u24 v22, 24, v21
  v_sub_u32 v22, v20, v22
  v_bfe_u32 v23, v21, 1, 2
  v_lshlrev_b32 v23, 1, v23
  v_xor_b32 v22, v22, v23
  s_mov_b32 s90, 12288
  v_mul_lo_u32 v21, v21, s90
  v_lshl_add_u32 v26, v22, 4, v21
  s_mov_b32 s91, 384
  s_mul_i32 s56, s3, 3
  v_lshrrev_b32 v20, 2, v1
  v_bfe_u32 v21, v20, 1, 2
  v_xor_b32 v21, s56, v21
  v_lshlrev_b32 v21, 5, v21
  v_mad_u32_u24 v21, v20, s91, v21
  v_and_b32 v20, 3, v1
  v_lshl_add_u32 v8, v20, 3, v21
  s_add_u32 s56, s56, 1
  v_lshrrev_b32 v20, 2, v1
  v_bfe_u32 v21, v20, 1, 2
  v_xor_b32 v21, s56, v21
  v_lshlrev_b32 v21, 5, v21
  v_mad_u32_u24 v21, v20, s91, v21
  v_and_b32 v20, 3, v1
  v_lshl_add_u32 v9, v20, 3, v21
  s_add_u32 s56, s56, 1
  v_lshrrev_b32 v20, 2, v1
  v_bfe_u32 v21, v20, 1, 2
  v_xor_b32 v21, s56, v21
  v_lshlrev_b32 v21, 5, v21
  v_mad_u32_u24 v21, v20, s91, v21
  v_and_b32 v20, 3, v1
  v_lshl_add_u32 v10, v20, 3, v21
  s_add_u32 s56, s56, 1
  s_mul_i32 s48, s42, 384
  s_add_u32 s8, s8, s48
  s_addc_u32 s9, s9, 0
  s_add_u32 s10, s10, s48
  s_addc_u32 s11, s11, 0
  s_mov_b64 s[34:35], s[8:9]
  s_mov_b64 s[36:37], s[10:11]
  s_lshl_b32 s92, s3, 10
  s_add_u32 m0, s92, 86016
  s_nop 0
  global_load_lds_dwordx4 v24, s[10:11]
  s_add_u32 m0, s92, 90112
  s_nop 0
  global_load_lds_dwordx4 v25, s[10:11]
  s_add_u32 m0, s92, 94208
  s_nop 0
  global_load_lds_dwordx4 v26, s[10:11]
  s_add_u32 s10, s10, 393216
  s_addc_u32 s11, s11, 0
  s_add_u32 m0, s92, 98304
  s_nop 0
  global_load_lds_dwordx4 v24, s[10:11]
  s_add_u32 m0, s92, 102400
  s_nop 0
  global_load_lds_dwordx4 v25, s[10:11]
  s_add_u32 m0, s92, 106496
  s_nop 0
  global_load_lds_dwordx4 v26, s[10:11]
  s_add_u32 s10, s10, 393216
  s_addc_u32 s11, s11, 0
  s_add_u32 m0, s92, 110592
  s_nop 0
  global_load_lds_dwordx4 v24, s[10:11]
  s_add_u32 m0, s92, 114688
  s_nop 0
  global_load_lds_dwordx4 v25, s[10:11]
  s_add_u32 m0, s92, 118784
  s_nop 0
  global_load_lds_dwordx4 v26, s[10:11]
  s_add_u32 s10, s10, 393216
  s_addc_u32 s11, s11, 0
  s_add_u32 m0, s92, 122880
  s_nop 0
  global_load_lds_dwordx4 v24, s[10:11]
  s_add_u32 m0, s92, 126976
  s_nop 0
  global_load_lds_dwordx4 v25, s[10:11]
  s_add_u32 m0, s92, 131072
  s_nop 0
  global_load_lds_dwordx4 v26, s[10:11]
  s_add_u32 s10, s10, 393216
  s_addc_u32 s11, s11, 0
  s_add_u32 m0, s92, 135168
  s_nop 0
  global_load_lds_dwordx4 v24, s[10:11]
  s_add_u32 m0, s92, 139264
  s_nop 0
  global_load_lds_dwordx4 v25, s[10:11]
  s_add_u32 m0, s92, 143360
  s_nop 0
  global_load_lds_dwordx4 v26, s[10:11]
  s_add_u32 s10, s10, 393216
  s_addc_u32 s11, s11, 0
  s_add_u32 m0, s92, 147456
  s_nop 0
  global_load_lds_dwordx4 v24, s[10:11]
  s_add_u32 m0, s92, 151552
  s_nop 0
  global_load_lds_dwordx4 v25, s[10:11]
  s_add_u32 m0, s92, 155648
  s_nop 0
  global_load_lds_dwordx4 v26, s[10:11]
  s_add_u32 s10, s10, 393216
  s_addc_u32 s11, s11, 0
  s_add_u32 m0, s92, 0
  s_nop 0
  global_load_lds_dwordx4 v24, s[10:11]
  s_add_u32 m0, s92, 4096
  s_nop 0
  global_load_lds_dwordx4 v25, s[10:11]
  s_add_u32 m0, s92, 8192
  s_nop 0
  global_load_lds_dwordx4 v26, s[10:11]
  s_add_u32 s10, s10, 393216
  s_addc_u32 s11, s11, 0
  s_add_u32 m0, s92, 12288
  s_nop 0
  global_load_lds_dwordx4 v24, s[10:11]
  s_add_u32 m0, s92, 16384
  s_nop 0
  global_load_lds_dwordx4 v25, s[10:11]
  s_add_u32 m0, s92, 20480
  s_nop 0
  global_load_lds_dwordx4 v26, s[10:11]
  s_add_u32 s10, s10, 393216
  s_addc_u32 s11, s11, 0
  s_add_u32 m0, s92, 24576
  s_nop 0
  global_load_lds_dwordx4 v24, s[10:11]
  s_add_u32 m0, s92, 28672
  s_nop 0
  global_load_lds_dwordx4 v25, s[10:11]
  s_add_u32 m0, s92, 32768
  s_nop 0
  global_load_lds_dwordx4 v26, s[10:11]
  s_add_u32 s10, s10, 393216
  s_addc_u32 s11, s11, 0
  s_add_u32 m0, s92, 36864
  s_nop 0
  global_load_lds_dwordx4 v24, s[10:11]
  s_add_u32 m0, s92, 40960
  s_nop 0
  global_load_lds_dwordx4 v25, s[10:11]
  s_add_u32 m0, s92, 45056
  s_nop 0
  global_load_lds_dwordx4 v26, s[10:11]
  s_add_u32 s10, s10, 393216
  s_addc_u32 s11, s11, 0
  s_add_u32 m0, s92, 49152
  s_nop 0
  global_load_lds_dwordx4 v24, s[10:11]
  s_add_u32 m0, s92, 53248
  s_nop 0
  global_load_lds_dwordx4 v25, s[10:11]
  s_add_u32 m0, s92, 57344
  s_nop 0
  global_load_lds_dwordx4 v26, s[10:11]
  s_add_u32 s10, s10, 393216
  s_addc_u32 s11, s11, 0
  s_add_u32 m0, s92, 61440
  s_nop 0
  global_load_lds_dwordx4 v24, s[10:11]
  s_add_u32 m0, s92, 65536
  s_nop 0
  global_load_lds_dwordx4 v25, s[10:11]
  s_add_u32 m0, s92, 69632
  s_nop 0
  global_load_lds_dwordx4 v26, s[10:11]
  s_add_u32 s10, s10, 393216
  s_addc_u32 s11, s11, 0
  s_add_u32 m0, s92, 73728
  s_nop 0
  global_load_lds_dwordx4 v24, s[10:11]
  s_add_u32 m0, s92, 77824
  s_nop 0
  global_load_lds_dwordx4 v25, s[10:11]
  s_add_u32 m0, s92, 81920
  s_nop 0
  global_load_lds_dwordx4 v26, s[10:11]
  s_add_u32 s10, s10, 393216
  s_addc_u32 s11, s11, 0
  s_waitcnt vmcnt(33)
  s_waitcnt lgkmcnt(0)
  s_barrier
  v_add_u32 v28, 86016, v8
  ds_read_b64_tr_b16 v[128:129], v28
  ds_read_b64_tr_b16 v[130:131], v28 offset:6144
  v_add_u32 v29, 86016, v9
  ds_read_b64_tr_b16 a[0:1], v29
  ds_read_b64_tr_b16 a[2:3], v29 offset:6144
  v_add_u32 v30, 86016, v10
  ds_read_b64_tr_b16 a[128:129], v30
  ds_read_b64_tr_b16 a[130:131], v30 offset:6144
  v_add_u32 v31, 98304, v8
  ds_read_b64_tr_b16 v[132:133], v31
  ds_read_b64_tr_b16 v[134:135], v31 offset:6144
  v_add_u32 v28, 98304, v9
  ds_read_b64_tr_b16 a[4:5], v28
  ds_read_b64_tr_b16 a[6:7], v28 offset:6144
  v_add_u32 v29, 98304, v10
  ds_read_b64_tr_b16 a[132:133], v29
  ds_read_b64_tr_b16 a[134:135], v29 offset:6144
  s_waitcnt vmcnt(27)
  s_waitcnt lgkmcnt(0)
  s_barrier
  s_add_u32 m0, s92, 86016
  s_nop 0
  global_load_lds_dwordx4 v24, s[10:11]
  s_add_u32 m0, s92, 90112
  s_nop 0
  global_load_lds_dwordx4 v25, s[10:11]
  s_add_u32 m0, s92, 94208
  s_nop 0
  global_load_lds_dwordx4 v26, s[10:11]
  s_add_u32 s10, s10, 393216
  s_addc_u32 s11, s11, 0
  s_add_u32 m0, s92, 98304
  s_nop 0
  global_load_lds_dwordx4 v24, s[10:11]
  s_add_u32 m0, s92, 102400
  s_nop 0
  global_load_lds_dwordx4 v25, s[10:11]
  s_add_u32 m0, s92, 106496
  s_nop 0
  global_load_lds_dwordx4 v26, s[10:11]
  s_add_u32 s10, s10, 393216
  s_addc_u32 s11, s11, 0
  v_add_u32 v28, 110592, v8
  ds_read_b64_tr_b16 v[136:137], v28
  ds_read_b64_tr_b16 v[138:139], v28 offset:6144
  v_add_u32 v29, 110592, v9
  ds_read_b64_tr_b16 a[8:9], v29
  ds_read_b64_tr_b16 a[10:11], v29 offset:6144
  v_add_u32 v30, 110592, v10
  ds_read_b64_tr_b16 a[136:137], v30
  ds_read_b64_tr_b16 a[138:139], v30 offset:6144
  v_add_u32 v31, 122880, v8
  ds_read_b64_tr_b16 v[140:141], v31
  ds_read_b64_tr_b16 v[142:143], v31 offset:6144
  v_add_u32 v28, 122880, v9
  ds_read_b64_tr_b16 a[12:13], v28
  ds_read_b64_tr_b16 a[14:15], v28 offset:6144
  v_add_u32 v29, 122880, v10
  ds_read_b64_tr_b16 a[140:141], v29
  ds_read_b64_tr_b16 a[142:143], v29 offset:6144
  s_waitcnt vmcnt(27)
  s_waitcnt lgkmcnt(0)
  s_barrier
  s_add_u32 m0, s92, 110592
  s_nop 0
  global_load_lds_dwordx4 v24, s[10:11]
  s_add_u32 m0, s92, 114688
  s_nop 0
  global_load_lds_dwordx4 v25, s[10:11]
  s_add_u32 m0, s92, 118784
  s_nop 0
  global_load_lds_dwordx4 v26, s[10:11]
  s_add_u32 s10, s10, 393216
  s_addc_u32 s11, s11, 0
  s_add_u32 m0, s92, 122880
  s_nop 0
  global_load_lds_dwordx4 v24, s[10:11]
  s_add_u32 m0, s92, 126976
  s_nop 0
  global_load_lds_dwordx4 v25, s[10:11]
  s_add_u32 m0, s92, 131072
  s_nop 0
  global_load_lds_dwordx4 v26, s[10:11]
  s_add_u32 s10, s10, 393216
  s_addc_u32 s11, s11, 0
  v_add_u32 v28, 135168, v8
  ds_read_b64_tr_b16 v[144:145], v28
  ds_read_b64_tr_b16 v[146:147], v28 offset:6144
  v_add_u32 v29, 135168, v9
  ds_read_b64_tr_b16 a[16:17], v29
  ds_read_b64_tr_b16 a[18:19], v29 offset:6144
  v_add_u32 v30, 135168, v10
  ds_read_b64_tr_b16 a[144:145], v30
  ds_read_b64_tr_b16 a[146:147], v30 offset:6144
  v_add_u32 v31, 147456, v8
  ds_read_b64_tr_b16 v[148:149], v31
  ds_read_b64_tr_b16 v[150:151], v31 offset:6144
  v_add_u32 v28, 147456, v9
  ds_read_b64_tr_b16 a[20:21], v28
  ds_read_b64_tr_b16 a[22:23], v28 offset:6144
  v_add_u32 v29, 147456, v10
  ds_read_b64_tr_b16 a[148:149], v29
  ds_read_b64_tr_b16 a[150:151], v29 offset:6144
  s_waitcnt vmcnt(27)
  s_waitcnt lgkmcnt(0)
  s_barrier
  s_add_u32 m0, s92, 135168
  s_nop 0
  global_load_lds_dwordx4 v24, s[10:11]
  s_add_u32 m0, s92, 139264
  s_nop 0
  global_load_lds_dwordx4 v25, s[10:11]
  s_add_u32 m0, s92, 143360
  s_nop 0
  global_load_lds_dwordx4 v26, s[10:11]
  s_add_u32 s10, s10, 393216
  s_addc_u32 s11, s11, 0
  s_add_u32 m0, s92, 147456
  s_nop 0
  global_load_lds_dwordx4 v24, s[10:11]
  s_add_u32 m0, s92, 151552
  s_nop 0
  global_load_lds_dwordx4 v25, s[10:11]
  s_add_u32 m0, s92, 155648
  s_nop 0
  global_load_lds_dwordx4 v26, s[10:11]
  s_add_u32 s10, s10, 393216
  s_addc_u32 s11, s11, 0
  v_add_u32 v28, 0, v8
  ds_read_b64_tr_b16 v[152:153], v28
  ds_read_b64_tr_b16 v[154:155], v28 offset:6144
  v_add_u32 v29, 0, v9
  ds_read_b64_tr_b16 a[24:25], v29
  ds_read_b64_tr_b16 a[26:27], v29 offset:6144
  v_add_u32 v30, 0, v10
  ds_read_b64_tr_b16 a[152:153], v30
  ds_read_b64_tr_b16 a[154:155], v30 offset:6144
  v_add_u32 v31, 12288, v8
  ds_read_b64_tr_b16 v[156:157], v31
  ds_read_b64_tr_b16 v[158:159], v31 offset:6144
  v_add_u32 v28, 12288, v9
  ds_read_b64_tr_b16 a[28:29], v28
  ds_read_b64_tr_b16 a[30:31], v28 offset:6144
  v_add_u32 v29, 12288, v10
  ds_read_b64_tr_b16 a[156:157], v29
  ds_read_b64_tr_b16 a[158:159], v29 offset:6144
  s_waitcnt vmcnt(27)
  s_waitcnt lgkmcnt(0)
  s_barrier
  s_add_u32 m0, s92, 0
  s_nop 0
  global_load_lds_dwordx4 v24, s[10:11]
  s_add_u32 m0, s92, 4096
  s_nop 0
  global_load_lds_dwordx4 v25, s[10:11]
  s_add_u32 m0, s92, 8192
  s_nop 0
  global_load_lds_dwordx4 v26, s[10:11]
  s_add_u32 s10, s10, 393216
  s_addc_u32 s11, s11, 0
  s_add_u32 m0, s92, 12288
  s_nop 0
  global_load_lds_dwordx4 v24, s[8:9]
  s_add_u32 m0, s92, 16384
  s_nop 0
  global_load_lds_dwordx4 v25, s[8:9]
  s_add_u32 m0, s92, 20480
  s_nop 0
  global_load_lds_dwordx4 v26, s[8:9]
  s_add_u32 s8, s8, 393216
  s_addc_u32 s9, s9, 0
  v_add_u32 v28, 24576, v8
  ds_read_b64_tr_b16 v[160:161], v28
  ds_read_b64_tr_b16 v[162:163], v28 offset:6144
  v_add_u32 v29, 24576, v9
  ds_read_b64_tr_b16 a[32:33], v29
  ds_read_b64_tr_b16 a[34:35], v29 offset:6144
  v_add_u32 v30, 24576, v10
  ds_read_b64_tr_b16 a[160:161], v30
  ds_read_b64_tr_b16 a[162:163], v30 offset:6144
  v_add_u32 v31, 36864, v8
  ds_read_b64_tr_b16 v[164:165], v31
  ds_read_b64_tr_b16 v[166:167], v31 offset:6144
  v_add_u32 v28, 36864, v9
  ds_read_b64_tr_b16 a[36:37], v28
  ds_read_b64_tr_b16 a[38:39], v28 offset:6144
  v_add_u32 v29, 36864, v10
  ds_read_b64_tr_b16 a[164:165], v29
  ds_read_b64_tr_b16 a[166:167], v29 offset:6144
  s_waitcnt vmcnt(27)
  s_waitcnt lgkmcnt(0)
  s_barrier
  s_add_u32 m0, s92, 24576
  s_nop 0
  global_load_lds_dwordx4 v24, s[8:9]
  s_add_u32 m0, s92, 28672
  s_nop 0
  global_load_lds_dwordx4 v25, s[8:9]
  s_add_u32 m0, s92, 32768
  s_nop 0
  global_load_lds_dwordx4 v26, s[8:9]
  s_add_u32 s8, s8, 393216
  s_addc_u32 s9, s9, 0
  s_add_u32 m0, s92, 36864
  s_nop 0
  global_load_lds_dwordx4 v24, s[8:9]
  s_add_u32 m0, s92, 40960
  s_nop 0
  global_load_lds_dwordx4 v25, s[8:9]
  s_add_u32 m0, s92, 45056
  s_nop 0
  global_load_lds_dwordx4 v26, s[8:9]
  s_add_u32 s8, s8, 393216
  s_addc_u32 s9, s9, 0
  v_add_u32 v28, 49152, v8
  ds_read_b64_tr_b16 v[168:169], v28
  ds_read_b64_tr_b16 v[170:171], v28 offset:6144
  v_add_u32 v29, 49152, v9
  ds_read_b64_tr_b16 a[40:41], v29
  ds_read_b64_tr_b16 a[42:43], v29 offset:6144
  v_add_u32 v30, 49152, v10
  ds_read_b64_tr_b16 a[168:169], v30
  ds_read_b64_tr_b16 a[170:171], v30 offset:6144
  v_add_u32 v31, 61440, v8
  ds_read_b64_tr_b16 v[172:173], v31
  ds_read_b64_tr_b16 v[174:175], v31 offset:6144
  v_add_u32 v28, 61440, v9
  ds_read_b64_tr_b16 a[44:45], v28
  ds_read_b64_tr_b16 a[46:47], v28 offset:6144
  v_add_u32 v29, 61440, v10
  ds_read_b64_tr_b16 a[172:173], v29
  ds_read_b64_tr_b16 a[174:175], v29 offset:6144
  s_waitcnt vmcnt(27)
  s_waitcnt lgkmcnt(0)
  s_barrier
  s_add_u32 m0, s92, 49152
  s_nop 0
  global_load_lds_dwordx4 v24, s[8:9]
  s_add_u32 m0, s92, 53248
  s_nop 0
  global_load_lds_dwordx4 v25, s[8:9]
  s_add_u32 m0, s92, 57344
  s_nop 0
  global_load_lds_dwordx4 v26, s[8:9]
  s_add_u32 s8, s8, 393216
  s_addc_u32 s9, s9, 0
  s_add_u32 m0, s92, 61440
  s_nop 0
  global_load_lds_dwordx4 v24, s[8:9]
  s_add_u32 m0, s92, 65536
  s_nop 0
  global_load_lds_dwordx4 v25, s[8:9]
  s_add_u32 m0, s92, 69632
  s_nop 0
  global_load_lds_dwordx4 v26, s[8:9]
  s_add_u32 s8, s8, 393216
  s_addc_u32 s9, s9, 0
  v_add_u32 v28, 73728, v8
  ds_read_b64_tr_b16 v[176:177], v28
  ds_read_b64_tr_b16 v[178:179], v28 offset:6144
  v_add_u32 v29, 73728, v9
  ds_read_b64_tr_b16 a[48:49], v29
  ds_read_b64_tr_b16 a[50:51], v29 offset:6144
  v_add_u32 v30, 73728, v10
  ds_read_b64_tr_b16 a[176:177], v30
  ds_read_b64_tr_b16 a[178:179], v30 offset:6144
  v_add_u32 v31, 86016, v8
  ds_read_b64_tr_b16 v[180:181], v31
  ds_read_b64_tr_b16 v[182:183], v31 offset:6144
  v_add_u32 v28, 86016, v9
  ds_read_b64_tr_b16 a[52:53], v28
  ds_read_b64_tr_b16 a[54:55], v28 offset:6144
  v_add_u32 v29, 86016, v10
  ds_read_b64_tr_b16 a[180:181], v29
  ds_read_b64_tr_b16 a[182:183], v29 offset:6144
  s_waitcnt vmcnt(27)
  s_waitcnt lgkmcnt(0)
  s_barrier
  s_add_u32 m0, s92, 73728
  s_nop 0
  global_load_lds_dwordx4 v24, s[8:9]
  s_add_u32 m0, s92, 77824
  s_nop 0
  global_load_lds_dwordx4 v25, s[8:9]
  s_add_u32 m0, s92, 81920
  s_nop 0
  global_load_lds_dwordx4 v26, s[8:9]
  s_add_u32 s8, s8, 393216
  s_addc_u32 s9, s9, 0
  s_add_u32 m0, s92, 86016
  s_nop 0
  global_load_lds_dwordx4 v24, s[8:9]
  s_add_u32 m0, s92, 90112
  s_nop 0
  global_load_lds_dwordx4 v25, s[8:9]
  s_add_u32 m0, s92, 94208
  s_nop 0
  global_load_lds_dwordx4 v26, s[8:9]
  s_add_u32 s8, s8, 393216
  s_addc_u32 s9, s9, 0
  v_add_u32 v28, 98304, v8
  ds_read_b64_tr_b16 v[184:185], v28
  ds_read_b64_tr_b16 v[186:187], v28 offset:6144
  v_add_u32 v29, 98304, v9
  ds_read_b64_tr_b16 a[56:57], v29
  ds_read_b64_tr_b16 a[58:59], v29 offset:6144
  v_add_u32 v30, 98304, v10
  ds_read_b64_tr_b16 a[184:185], v30
  ds_read_b64_tr_b16 a[186:187], v30 offset:6144
  v_add_u32 v31, 110592, v8
  ds_read_b64_tr_b16 v[188:189], v31
  ds_read_b64_tr_b16 v[190:191], v31 offset:6144
  v_add_u32 v28, 110592, v9
  ds_read_b64_tr_b16 a[60:61], v28
  ds_read_b64_tr_b16 a[62:63], v28 offset:6144
  v_add_u32 v29, 110592, v10
  ds_read_b64_tr_b16 a[188:189], v29
  ds_read_b64_tr_b16 a[190:191], v29 offset:6144
  s_waitcnt vmcnt(27)
  s_waitcnt lgkmcnt(0)
  s_barrier
  s_add_u32 m0, s92, 98304
  s_nop 0
  global_load_lds_dwordx4 v24, s[8:9]
  s_add_u32 m0, s92, 102400
  s_nop 0
  global_load_lds_dwordx4 v25, s[8:9]
  s_add_u32 m0, s92, 106496
  s_nop 0
  global_load_lds_dwordx4 v26, s[8:9]
  s_add_u32 s8, s8, 393216
  s_addc_u32 s9, s9, 0
  s_add_u32 m0, s92, 110592
  s_nop 0
  global_load_lds_dwordx4 v24, s[8:9]
  s_add_u32 m0, s92, 114688
  s_nop 0
  global_load_lds_dwordx4 v25, s[8:9]
  s_add_u32 m0, s92, 118784
  s_nop 0
  global_load_lds_dwordx4 v26, s[8:9]
  s_add_u32 s8, s8, 393216
  s_addc_u32 s9, s9, 0
  v_add_u32 v28, 122880, v8
  ds_read_b64_tr_b16 v[192:193], v28
  ds_read_b64_tr_b16 v[194:195], v28 offset:6144
  v_add_u32 v29, 122880, v9
  ds_read_b64_tr_b16 a[64:65], v29
  ds_read_b64_tr_b16 a[66:67], v29 offset:6144
  v_add_u32 v30, 122880, v10
  ds_read_b64_tr_b16 a[192:193], v30
  ds_read_b64_tr_b16 a[194:195], v30 offset:6144
  v_add_u32 v31, 135168, v8
  ds_read_b64_tr_b16 v[196:197], v31
  ds_read_b64_tr_b16 v[198:199], v31 offset:6144
  v_add_u32 v28, 135168, v9
  ds_read_b64_tr_b16 a[68:69], v28
  ds_read_b64_tr_b16 a[70:71], v28 offset:6144
  v_add_u32 v29, 135168, v10
  ds_read_b64_tr_b16 a[196:197], v29
  ds_read_b64_tr_b16 a[198:199], v29 offset:6144
  s_waitcnt vmcnt(27)
  s_waitcnt lgkmcnt(0)
  s_barrier
  s_add_u32 m0, s92, 122880
  s_nop 0
  global_load_lds_dwordx4 v24, s[8:9]
  s_add_u32 m0, s92, 126976
  s_nop 0
  global_load_lds_dwordx4 v25, s[8:9]
  s_add_u32 m0, s92, 131072
  s_nop 0
  global_load_lds_dwordx4 v26, s[8:9]
  s_add_u32 s8, s8, 393216
  s_addc_u32 s9, s9, 0
  s_add_u32 m0, s92, 135168
  s_nop 0
  global_load_lds_dwordx4 v24, s[8:9]
  s_add_u32 m0, s92, 139264
  s_nop 0
  global_load_lds_dwordx4 v25, s[8:9]
  s_add_u32 m0, s92, 143360
  s_nop 0
  global_load_lds_dwordx4 v26, s[8:9]
  s_add_u32 s8, s8, 393216
  s_addc_u32 s9, s9, 0
  v_add_u32 v28, 147456, v8
  ds_read_b64_tr_b16 v[200:201], v28
  ds_read_b64_tr_b16 v[202:203], v28 offset:6144
  v_add_u32 v29, 147456, v9
  ds_read_b64_tr_b16 a[72:73], v29
  ds_read_b64_tr_b16 a[74:75], v29 offset:6144
  v_add_u32 v30, 147456, v10
  ds_read_b64_tr_b16 a[200:201], v30
  ds_read_b64_tr_b16 a[202:203], v30 offset:6144
  v_add_u32 v31, 0, v8
  ds_read_b64_tr_b16 v[204:205], v31
  ds_read_b64_tr_b16 v[206:207], v31 offset:6144
  v_add_u32 v28, 0, v9
  ds_read_b64_tr_b16 a[76:77], v28
  ds_read_b64_tr_b16 a[78:79], v28 offset:6144
  v_add_u32 v29, 0, v10
  ds_read_b64_tr_b16 a[204:205], v29
  ds_read_b64_tr_b16 a[206:207], v29 offset:6144
  s_waitcnt vmcnt(27)
  s_waitcnt lgkmcnt(0)
  s_barrier
  s_add_u32 m0, s92, 147456
  s_nop 0
  global_load_lds_dwordx4 v24, s[8:9]
  s_add_u32 m0, s92, 151552
  s_nop 0
  global_load_lds_dwordx4 v25, s[8:9]
  s_add_u32 m0, s92, 155648
  s_nop 0
  global_load_lds_dwordx4 v26, s[8:9]
  s_add_u32 s8, s8, 393216
  s_addc_u32 s9, s9, 0
  s_add_u32 m0, s92, 0
  s_nop 0
  global_load_lds_dwordx4 v24, s[8:9]
  s_add_u32 m0, s92, 4096
  s_nop 0
  global_load_lds_dwordx4 v25, s[8:9]
  s_add_u32 m0, s92, 8192
  s_nop 0
  global_load_lds_dwordx4 v26, s[8:9]
  s_add_u32 s8, s8, 393216
  s_addc_u32 s9, s9, 0
  v_add_u32 v28, 12288, v8
  ds_read_b64_tr_b16 v[208:209], v28
  ds_read_b64_tr_b16 v[210:211], v28 offset:6144
  v_add_u32 v29, 12288, v9
  ds_read_b64_tr_b16 a[80:81], v29
  ds_read_b64_tr_b16 a[82:83], v29 offset:6144
  v_add_u32 v30, 12288, v10
  ds_read_b64_tr_b16 a[208:209], v30
  ds_read_b64_tr_b16 a[210:211], v30 offset:6144
  v_add_u32 v31, 24576, v8
  ds_read_b64_tr_b16 v[212:213], v31
  ds_read_b64_tr_b16 v[214:215], v31 offset:6144
  v_add_u32 v28, 24576, v9
  ds_read_b64_tr_b16 a[84:85], v28
  ds_read_b64_tr_b16 a[86:87], v28 offset:6144
  v_add_u32 v29, 24576, v10
  ds_read_b64_tr_b16 a[212:213], v29
  ds_read_b64_tr_b16 a[214:215], v29 offset:6144
  s_waitcnt vmcnt(27)
  s_waitcnt lgkmcnt(0)
  s_barrier
  s_add_u32 m0, s92, 12288
  s_nop 0
  global_load_lds_dwordx4 v24, s[8:9]
  s_add_u32 m0, s92, 16384
  s_nop 0
  global_load_lds_dwordx4 v25, s[8:9]
  s_add_u32 m0, s92, 20480
  s_nop 0
  global_load_lds_dwordx4 v26, s[8:9]
  s_add_u32 s8, s8, 393216
  s_addc_u32 s9, s9, 0
  s_add_u32 m0, s92, 24576
  s_nop 0
  global_load_lds_dwordx4 v24, s[8:9]
  s_add_u32 m0, s92, 28672
  s_nop 0
  global_load_lds_dwordx4 v25, s[8:9]
  s_add_u32 m0, s92, 32768
  s_nop 0
  global_load_lds_dwordx4 v26, s[8:9]
  s_add_u32 s8, s8, 393216
  s_addc_u32 s9, s9, 0
  v_add_u32 v28, 36864, v8
  ds_read_b64_tr_b16 v[216:217], v28
  ds_read_b64_tr_b16 v[218:219], v28 offset:6144
  v_add_u32 v29, 36864, v9
  ds_read_b64_tr_b16 a[88:89], v29
  ds_read_b64_tr_b16 a[90:91], v29 offset:6144
  v_add_u32 v30, 36864, v10
  ds_read_b64_tr_b16 a[216:217], v30
  ds_read_b64_tr_b16 a[218:219], v30 offset:6144
  v_add_u32 v31, 49152, v8
  ds_read_b64_tr_b16 v[220:221], v31
  ds_read_b64_tr_b16 v[222:223], v31 offset:6144
  v_add_u32 v28, 49152, v9
  ds_read_b64_tr_b16 a[92:93], v28
  ds_read_b64_tr_b16 a[94:95], v28 offset:6144
  v_add_u32 v29, 49152, v10
  ds_read_b64_tr_b16 a[220:221], v29
  ds_read_b64_tr_b16 a[222:223], v29 offset:6144
  s_waitcnt vmcnt(27)
  s_waitcnt lgkmcnt(0)
  s_barrier
  s_add_u32 m0, s92, 36864
  s_nop 0
  global_load_lds_dwordx4 v24, s[8:9]
  s_add_u32 m0, s92, 40960
  s_nop 0
  global_load_lds_dwordx4 v25, s[8:9]
  s_add_u32 m0, s92, 45056
  s_nop 0
  global_load_lds_dwordx4 v26, s[8:9]
  s_add_u32 s8, s8, 393216
  s_addc_u32 s9, s9, 0
  s_add_u32 m0, s92, 49152
  s_nop 0
  global_load_lds_dwordx4 v24, s[8:9]
  s_add_u32 m0, s92, 53248
  s_nop 0
  global_load_lds_dwordx4 v25, s[8:9]
  s_add_u32 m0, s92, 57344
  s_nop 0
  global_load_lds_dwordx4 v26, s[8:9]
  s_add_u32 s8, s8, 393216
  s_addc_u32 s9, s9, 0
  v_add_u32 v28, 61440, v8
  ds_read_b64_tr_b16 v[224:225], v28
  ds_read_b64_tr_b16 v[226:227], v28 offset:6144
  v_add_u32 v29, 61440, v9
  ds_read_b64_tr_b16 a[96:97], v29
  ds_read_b64_tr_b16 a[98:99], v29 offset:6144
  v_add_u32 v30, 61440, v10
  ds_read_b64_tr_b16 a[224:225], v30
  ds_read_b64_tr_b16 a[226:227], v30 offset:6144
  v_add_u32 v31, 73728, v8
  ds_read_b64_tr_b16 v[228:229], v31
  ds_read_b64_tr_b16 v[230:231], v31 offset:6144
  v_add_u32 v28, 73728, v9
  ds_read_b64_tr_b16 a[100:101], v28
  ds_read_b64_tr_b16 a[102:103], v28 offset:6144
  v_add_u32 v29, 73728, v10
  ds_read_b64_tr_b16 a[228:229], v29
  ds_read_b64_tr_b16 a[230:231], v29 offset:6144
  s_waitcnt vmcnt(27)
  s_waitcnt lgkmcnt(0)
  s_barrier
  s_add_u32 m0, s92, 61440
  s_nop 0
  global_load_lds_dwordx4 v24, s[8:9]
  s_add_u32 m0, s92, 65536
  s_nop 0
  global_load_lds_dwordx4 v25, s[8:9]
  s_add_u32 m0, s92, 69632
  s_nop 0
  global_load_lds_dwordx4 v26, s[8:9]
  s_add_u32 s8, s8, 393216
  s_addc_u32 s9, s9, 0
  s_add_u32 m0, s92, 73728
  s_nop 0
  global_load_lds_dwordx4 v24, s[8:9]
  s_add_u32 m0, s92, 77824
  s_nop 0
  global_load_lds_dwordx4 v25, s[8:9]
  s_add_u32 m0, s92, 81920
  s_nop 0
  global_load_lds_dwordx4 v26, s[8:9]
  s_add_u32 s8, s8, 393216
  s_addc_u32 s9, s9, 0
  v_add_u32 v28, 86016, v8
  ds_read_b64_tr_b16 v[232:233], v28
  ds_read_b64_tr_b16 v[234:235], v28 offset:6144
  v_add_u32 v29, 86016, v9
  ds_read_b64_tr_b16 a[104:105], v29
  ds_read_b64_tr_b16 a[106:107], v29 offset:6144
  v_add_u32 v30, 86016, v10
  ds_read_b64_tr_b16 a[232:233], v30
  ds_read_b64_tr_b16 a[234:235], v30 offset:6144
  v_add_u32 v31, 98304, v8
  ds_read_b64_tr_b16 v[236:237], v31
  ds_read_b64_tr_b16 v[238:239], v31 offset:6144
  v_add_u32 v28, 98304, v9
  ds_read_b64_tr_b16 a[108:109], v28
  ds_read_b64_tr_b16 a[110:111], v28 offset:6144
  v_add_u32 v29, 98304, v10
  ds_read_b64_tr_b16 a[236:237], v29
  ds_read_b64_tr_b16 a[238:239], v29 offset:6144
  s_waitcnt vmcnt(27)
  s_waitcnt lgkmcnt(0)
  s_barrier
  s_add_u32 m0, s92, 86016
  s_nop 0
  global_load_lds_dwordx4 v24, s[8:9]
  s_add_u32 m0, s92, 90112
  s_nop 0
  global_load_lds_dwordx4 v25, s[8:9]
  s_add_u32 m0, s92, 94208
  s_nop 0
  global_load_lds_dwordx4 v26, s[8:9]
  s_add_u32 s8, s8, 393216
  s_addc_u32 s9, s9, 0
  v_add_u32 v28, 110592, v8
  ds_read_b64_tr_b16 v[240:241], v28
  ds_read_b64_tr_b16 v[242:243], v28 offset:6144
  v_add_u32 v29, 110592, v9
  ds_read_b64_tr_b16 a[112:113], v29
  ds_read_b64_tr_b16 a[114:115], v29 offset:6144
  v_add_u32 v30, 110592, v10
  ds_read_b64_tr_b16 a[240:241], v30
  ds_read_b64_tr_b16 a[242:243], v30 offset:6144
  v_add_u32 v31, 122880, v8
  ds_read_b64_tr_b16 v[244:245], v31
  ds_read_b64_tr_b16 v[246:247], v31 offset:6144
  v_add_u32 v28, 122880, v9
  ds_read_b64_tr_b16 a[116:117], v28
  ds_read_b64_tr_b16 a[118:119], v28 offset:6144
  v_add_u32 v29, 122880, v10
  ds_read_b64_tr_b16 a[244:245], v29
  ds_read_b64_tr_b16 a[246:247], v29 offset:6144
  s_waitcnt vmcnt(24)
  s_waitcnt lgkmcnt(0)
  s_barrier
  v_add_u32 v28, 135168, v8
  ds_read_b64_tr_b16 v[248:249], v28
  ds_read_b64_tr_b16 v[250:251], v28 offset:6144
  v_add_u32 v29, 135168, v9
  ds_read_b64_tr_b16 a[120:121], v29
  ds_read_b64_tr_b16 a[122:123], v29 offset:6144
  v_add_u32 v30, 135168, v10
  ds_read_b64_tr_b16 a[248:249], v30
  ds_read_b64_tr_b16 a[250:251], v30 offset:6144
  v_add_u32 v31, 147456, v8
  ds_read_b64_tr_b16 v[252:253], v31
  ds_read_b64_tr_b16 v[254:255], v31 offset:6144
  v_add_u32 v28, 147456, v9
  ds_read_b64_tr_b16 a[124:125], v28
  ds_read_b64_tr_b16 a[126:127], v28 offset:6144
  v_add_u32 v29, 147456, v10
  ds_read_b64_tr_b16 a[252:253], v29
  ds_read_b64_tr_b16 a[254:255], v29 offset:6144
  s_waitcnt lgkmcnt(0)
  s_barrier
  v_add_u32 v11, 49152, v8
  v_add_u32 v12, 49152, v9
  v_add_u32 v13, 49152, v10
  v_mov_b32 v3, 0x4444
  v_mov_b32 v20, 0xeeee
  v_and_b32 v21, 2, v1
  v_cmp_ne_u32 vcc, 0, v21
  s_nop 1
  v_cndmask_b32 v3, v3, v20, vcc
  s_mul_i32 s67, s3, 3072
  s_cmp_eq_u32 s3, 3
  s_cselect_b32 s67, 8192, s67
  s_mul_i32 s48, s3, 10
  v_min_u32 v2, 9, v1
  v_add_u32 v2, s48, v2
  v_lshlrev_b32 v2, 8, v2
  v_lshlrev_b32 v4, 4, v1
  v_add_u32 v4, s67, v4
  v_bfe_u32 v20, v1, 5, 1
  v_lshlrev_b32 v5, 9, v20
  v_bfe_u32 v20, v1, 3, 1
  v_lshl_add_u32 v5, v20, 8, v5
  v_bfe_u32 v20, v1, 3, 1
  v_lshl_add_u32 v5, v20, 4, v5
  v_bfe_u32 v20, v1, 0, 1
  v_lshl_add_u32 v5, v20, 6, v5
  v_bfe_u32 v20, v1, 1, 1
  v_lshl_add_u32 v5, v20, 7, v5
  v_bfe_u32 v20, v1, 4, 1
  v_lshl_add_u32 v5, v20, 5, v5
  v_bfe_u32 v20, v1, 2, 1
  v_lshl_add_u32 v5, v20, 3, v5
  v_add_u32 v5, 135168, v5
  v_xor_b32 v119, 16, v5
  v_bfe_u32 v20, v1, 1, 4
  v_lshlrev_b32 v20, 2, v20
  v_lshl_add_u32 v6, v1, 6, v20
  v_add_u32 v6, 135168, v6
  v_add_u32 v7, 4096, v6
  v_and_b32 v21, 31, v1
  v_lshl_add_u32 v127, v21, 6, v20
  v_add_u32 v127, 143360, v127
  v_lshlrev_b32 v125, 4, v1
  v_add_u32 v125, 135168, v125
  s_mul_i32 s48, s3, 1536
  s_add_u32 s48, s48, 155648
  v_and_b32 v20, 15, v1
  v_lshlrev_b32 v14, 5, v20
  v_lshrrev_b32 v21, 4, v1
  v_lshl_add_u32 v14, v21, 2, v14
  v_add_u32 v14, s48, v14
  v_add_u32 v117, 1024, v14
  v_lshlrev_b32 v15, 3, v1
  v_add_u32 v15, 155648, v15
  v_mul_u32_u24 v113, 48, v20
  v_add_u32 v113, 161792, v113
  s_lshl_b32 s48, s3, 4
  v_lshl_add_u32 v114, v21, 2, v113
  v_add_u32 v114, s48, v114
  v_lshlrev_b32 v16, 4, v1
  v_add_u32 v16, 98304, v16
  s_cmp_eq_u32 s3, 2
  s_cselect_b32 s48, 6144, 0
  v_add_u32 v115, s48, v16
  s_lshr_b32 s57, s3, 1
  s_mul_i32 s48, s57, 6144
  s_add_u32 s48, s48, 122880
  v_lshlrev_b32 v17, 4, v1
  v_add_u32 v17, s48, v17
  s_lshr_b32 s54, s41, 2
  s_lshl_b32 s48, s40, 1
  s_add_u32 s54, s54, s48
  s_and_b32 s55, s41, 1
  s_bfe_u32 s56, s41, 0x10001
  s_mul_i32 s48, s54, 3072
  s_and_b32 s51, s41, 3
  s_lshl_b32 s51, s51, 2
  s_lshl_b32 s49, s56, 10
  s_add_u32 s49, s49, s48
  s_lshl_b32 s50, s55, 9
  s_add_u32 s49, s49, s50
  s_lshl_b32 s50, s57, 2
  s_add_u32 s49, s49, s50
  s_add_u32 s49, s49, 0x1300000
  v_bfe_u32 v22, v1, 0, 1
  v_lshlrev_b32 v18, 4, v22
  v_bfe_u32 v22, v1, 1, 1
  v_lshl_add_u32 v18, v22, 6, v18
  v_bfe_u32 v22, v1, 2, 1
  v_lshl_add_u32 v18, v22, 7, v18
  v_bfe_u32 v22, v1, 5, 1
  v_lshl_add_u32 v18, v22, 8, v18
  v_bfe_u32 v22, v1, 4, 1
  v_lshl_add_u32 v18, v22, 3, v18
  v_add_u32 v18, s49, v18
  s_add_u32 s49, s48, s51
  s_add_u32 s49, s49, 0x1300800
  v_bfe_u32 v22, v1, 0, 1
  v_lshlrev_b32 v19, 4, v22
  v_bfe_u32 v22, v1, 1, 1
  v_lshl_add_u32 v19, v22, 6, v19
  v_bfe_u32 v22, v1, 2, 1
  v_lshl_add_u32 v19, v22, 7, v19
  v_bfe_u32 v22, v1, 4, 1
  v_lshl_add_u32 v19, v22, 9, v19
  v_add_u32 v19, s49, v19
  s_cmp_eq_u32 s3, 0
  s_cselect_b64 vcc, -1, 0
  s_cselect_b32 s49, 256, 32
  s_cselect_b32 s74, 0, 0x00ff00ff
  s_mov_b32 s75, 0x00ff00ff
  v_cndmask_b32 v18, v18, v19, vcc
  v_add_u32 v118, s49, v18
  s_mul_i32 s48, s54, 10240
  s_mul_i32 s49, s57, 5120
  s_add_u32 s48, s48, s49
  s_add_u32 s48, s48, 0x1310000
  s_lshl_b32 s49, s51, 8
  s_add_u32 s49, s49, s48
  v_lshlrev_b32 v19, 4, v1
  v_add_u32 v19, s49, v19
  s_add_u32 s49, s48, s51
  s_add_u32 s49, s49, 4096
  v_bfe_u32 v22, v1, 4, 1
  v_lshlrev_b32 v112, 4, v20
  v_lshl_add_u32 v112, v22, 9, v112
  v_add_u32 v112, s49, v112
  v_lshlrev_b32 v21, 2, v21
  v_add_u32 v22, 0, v21
  v_cmp_le_u32 s[24:25], v22, v20
  v_add_u32 v22, 1, v21
  v_cmp_le_u32 s[26:27], v22, v20
  v_add_u32 v22, 2, v21
  v_cmp_le_u32 s[28:29], v22, v20
  v_add_u32 v22, 3, v21
  v_cmp_le_u32 s[30:31], v22, v20
  s_nop 1
  s_cmp_eq_u32 s3, 3
  s_cselect_b64 s[32:33], s[24:25], 0
  s_cselect_b64 s[24:25], -1, s[24:25]
  s_cselect_b64 s[34:35], s[26:27], 0
  s_cselect_b64 s[26:27], -1, s[26:27]
  s_cselect_b64 s[36:37], s[28:29], 0
  s_cselect_b64 s[28:29], -1, s[28:29]
  s_cselect_b64 s[38:39], s[30:31], 0
  s_cselect_b64 s[30:31], -1, s[30:31]
  s_mov_b32 s70, 0x3dd53b95
  s_mov_b32 s71, s70
  s_mov_b32 s72, 0
  s_mov_b32 s73, -1
  v_mov_b32 v120, 0xff800000
  v_mov_b32 v121, 0x7fff7fff
  v_mov_b32 v126, 0x7ffffffe
  s_mov_b64 s[84:85], 0
  s_lshl_b32 s48, s42, 8
  s_add_u32 s48, s48, 0x1360000
  v_lshlrev_b32 v122, 2, v1
  v_add_u32 v122, s48, v122
  v_add_u32 v123, 0x2000, v122
  v_mov_b32 v24, -1
  v_mov_b32 v25, -1
  v_mov_b32 v26, -1
  v_mov_b32 v27, -1
  v_lshlrev_b32 v28, 4, v0
  v_add_u32 v28, 135168, v28
  ds_write_b128 v28, v[24:27] offset:0
  ds_write_b128 v28, v[24:27] offset:4096
  ds_write_b128 v28, v[24:27] offset:8192
  ds_write_b128 v28, v[24:27] offset:12288
  ds_write_b128 v28, v[24:27] offset:16384
  v_mov_b32 v24, 0
  s_cmp_eq_u32 s3, 3
  s_cbranch_scc1 QK_noex
  ds_write_b32 v114, v24
QK_noex:
  s_cmp_lg_u32 s3, 0
  s_cbranch_scc1 OW_11
  s_lshl_b32 s49, s40, 2
  v_mov_b32 v20, s49
  v_mov_b32 v21, 32
HR_12:
  global_load_dword v22, v20, s[6:7] sc1
  global_load_dwordx2 v[24:25], v21, s[6:7] sc1
  s_waitcnt vmcnt(0)
  v_readfirstlane_b32 s48, v22
  v_readfirstlane_b32 s50, v24
  v_readfirstlane_b32 s57, v25
  s_and_b32 s49, s48, 0xff
  s_cmp_lg_u32 s49, 31
  s_cbranch_scc1 HS_14
  s_cmp_eq_u32 s50, 64
  s_cbranch_scc1 HD_13
HS_14:
  s_sleep 24
  s_add_u32 s66, s66, 1
  s_cmp_lt_u32 s66, 2097152
  s_cbranch_scc1 HR_12
  s_branch K2_abort
HD_13:
  s_bfe_u32 s49, s48, 0x80008
  s_mul_i32 s49, s49, s49
  s_lshr_b32 s48, s48, 16
  s_mul_i32 s48, s48, 31
  s_cmp_eq_u32 s48, s49
  s_cselect_b32 s43, 1, 0
OW_11:
  s_barrier
  s_lshl_b32 s49, s40, 2
  v_mov_b32 v20, s49
  v_mov_b32 v21, 32
HR_15:
  global_load_dword v22, v20, s[6:7] sc1
  global_load_dwordx2 v[24:25], v21, s[6:7] sc1
  s_waitcnt vmcnt(0)
  v_readfirstlane_b32 s48, v22
  v_readfirstlane_b32 s50, v24
  v_readfirstlane_b32 s57, v25
  s_and_b32 s49, s48, 0xff
  s_cmp_lg_u32 s49, 31
  s_cbranch_scc1 HS_17
  s_cmp_eq_u32 s50, 64
  s_cbranch_scc1 HD_16
HS_17:
  s_sleep 8
  s_add_u32 s66, s66, 1
  s_cmp_lt_u32 s66, 2097152
  s_cbranch_scc1 HR_15
  s_branch K2_abort
HD_16:
  s_bfe_u32 s49, s48, 0x80008
  s_mul_i32 s49, s49, s49
  s_lshr_b32 s48, s48, 16
  s_mul_i32 s48, s48, 31
  s_cmp_eq_u32 s48, s49
  s_cselect_b32 s43, 1, 0
  s_mul_i32 s59, s40, 10240
  s_add_u32 s59, s59, 0x1000000
  s_add_u32 s60, s4, s59
  s_addc_u32 s61, s5, 0
  s_mov_b32 s45, 0
  s_mov_b32 s44, 0
  s_mov_b32 s68, 0x80008000
  s_mov_b32 s69, 0x80008000
  s_mov_b64 s[62:63], s[4:5]
  s_mul_i32 s86, s3, 3072
  v_lshlrev_b32 v124, 4, v1
  v_add_u32 v124, s86, v124
  s_waitcnt vmcnt(0) lgkmcnt(0)
  s_barrier
  s_mov_b32 s47, 1
  s_mov_b32 s87, 98304
  s_mov_b32 s88, 110592
  s_mov_b32 s89, 122880
  s_cmp_lg_u32 s3, 0
  s_cbranch_scc1 OW_18
MW_19:
  s_bitcmp1_b64 s[84:85], s44
  s_cbranch_scc1 MD_20
  global_load_dword v20, v122, s[4:5] offset:0 sc1
  global_load_dword v21, v123, s[4:5] offset:0 sc1
  s_waitcnt vmcnt(0)
  v_and_b32 v20, v20, v21
  v_cmp_eq_u32 s[84:85], 1, v20
  s_nop 1
  s_bitcmp1_b64 s[84:85], s44
  s_cbranch_scc1 MD_20
  s_sleep 16
  s_add_u32 s66, s66, 1
  s_cmp_lt_u32 s66, 0x200000
  s_cbranch_scc1 MW_19
  s_endpgm
MD_20:
OW_18:
  s_barrier
MW_21:
  s_bitcmp1_b64 s[84:85], s44
  s_cbranch_scc1 MD_22
  global_load_dword v20, v122, s[4:5] offset:0 sc1
  global_load_dword v21, v123, s[4:5] offset:0 sc1
  s_waitcnt vmcnt(0)
  v_and_b32 v20, v20, v21
  v_cmp_eq_u32 s[84:85], 1, v20
  s_nop 1
  s_bitcmp1_b64 s[84:85], s44
  s_cbranch_scc1 MD_22
  s_sleep 8
  s_add_u32 s66, s66, 1
  s_cmp_lt_u32 s66, 0x200000
  s_cbranch_scc1 MW_21
  s_endpgm
MD_22:
  s_lshl_b32 s48, s44, 5
  s_add_u32 s48, s48, s42
  s_mul_i32 s48, s48, 12288
  s_add_u32 s48, s48, 0x3400000
  s_add_u32 s50, s4, s48
  s_addc_u32 s51, s5, 0
  s_add_u32 m0, s86, s87
  s_nop 0
  global_load_lds_dwordx4 v124, s[50:51] offset:0 sc1
  s_nop 0
  s_nop 0
  s_nop 0
  global_load_lds_dwordx4 v124, s[50:51] offset:1024 sc1
  s_nop 0
  s_nop 0
  s_nop 0
  global_load_lds_dwordx4 v124, s[50:51] offset:2048 sc1
  s_nop 0
  s_nop 0
  s_nop 0
  s_waitcnt vmcnt(0)
  s_barrier
  s_add_u32 s47, s44, 1
  s_min_u32 s47, s47, 63
  s_bitcmp1_b64 s[84:85], s47
  s_cselect_b32 s65, 1, 0
  s_cselect_b32 s47, s47, s44
  s_lshl_b32 s48, s47, 5
  s_add_u32 s48, s48, s42
  s_mul_i32 s48, s48, 12288
  s_add_u32 s48, s48, 0x3400000
  s_add_u32 s96, s4, s48
  s_addc_u32 s97, s5, 0
  s_lshl_b32 s48, s44, 5
  s_add_u32 s48, s48, s42
  s_mul_i32 s48, s48, 12288
  s_add_u32 s48, s48, 0x4c00000
  s_add_u32 s98, s4, s48
  s_addc_u32 s99, s5, 0
  v_cndmask_b32 v88, v120, 0, s[72:73]
  v_cndmask_b32 v89, v120, 0, s[72:73]
  v_cndmask_b32 v90, v120, 0, s[72:73]
  v_cndmask_b32 v91, v120, 0, s[72:73]
QK_step:
  s_cmp_eq_u32 s3, 0
  s_cbranch_scc1 QK_nokp
  ds_read_b128 v[88:91], v115 offset:0
  ds_read_b128 v[92:95], v115 offset:1024
  ds_read_b128 v[96:99], v115 offset:2048
  ds_read_b128 v[100:103], v115 offset:3072
  ds_read_b128 v[104:107], v115 offset:4096
  ds_read_b128 v[108:111], v115 offset:5120
QK_nokp:
  v_mov_b32 v40, 0
  v_mov_b32 v41, 0
  v_mov_b32 v42, 0
  v_mov_b32 v43, 0
  v_mov_b32 v44, 0
  v_mov_b32 v45, 0
  v_mov_b32 v46, 0
  v_mov_b32 v47, 0
  v_mov_b32 v48, 0
  v_mov_b32 v49, 0
  v_mov_b32 v50, 0
  v_mov_b32 v51, 0
  v_mov_b32 v52, 0
  v_mov_b32 v53, 0
  v_mov_b32 v54, 0
  v_mov_b32 v55, 0
  v_mov_b32 v56, 0
  v_mov_b32 v57, 0
  v_mov_b32 v58, 0
  v_mov_b32 v59, 0
  v_mov_b32 v60, 0
  v_mov_b32 v61, 0
  v_mov_b32 v62, 0
  v_mov_b32 v63, 0
  ds_read_b64_tr_b16 v[64:65], v8 offset:0
  ds_read_b64_tr_b16 v[66:67], v8 offset:6144
  ds_read_b64_tr_b16 v[68:69], v8 offset:12288
  ds_read_b64_tr_b16 v[70:71], v8 offset:18432
  ds_read_b64_tr_b16 v[72:73], v9 offset:0
  ds_read_b64_tr_b16 v[74:75], v9 offset:6144
  ds_read_b64_tr_b16 v[76:77], v9 offset:12288
  ds_read_b64_tr_b16 v[78:79], v9 offset:18432
  ds_read_b64_tr_b16 v[80:81], v10 offset:0
  ds_read_b64_tr_b16 v[82:83], v10 offset:6144
  ds_read_b64_tr_b16 v[84:85], v10 offset:12288
  ds_read_b64_tr_b16 v[86:87], v10 offset:18432
  s_add_u32 s48, s45, s67
  s_add_u32 m0, s48, 135168
  s_and_b32 s64, s68, 0x80000000
  s_cmp_ge_u32 s44, 2
  s_cbranch_scc1 QK_lg
QK_lp:
  global_load_dword v116, v2, s[60:61] sc1
  s_waitcnt vmcnt(0)
  v_cmp_ne_u32 vcc, -1, v116
  s_cbranch_vccnz QK_lg
  s_sleep 8
  s_add_u32 s66, s66, 1
  s_cmp_lt_u32 s66, 2097152
  s_cbranch_scc1 QK_lp
  s_branch K2_abort
QK_lg:
QK_poll:
  global_load_lds_dwordx4 v4, s[60:61] sc1
  global_load_lds_dwordx4 v4, s[60:61] offset:1024 sc1
  s_cmp_ge_u32 s3, 2
  s_cbranch_scc1 QK_n3
  global_load_lds_dwordx4 v4, s[60:61] offset:2048 sc1
QK_n3:
  ds_read_b32 v20, v6
  ds_read_b32 v21, v7
  ds_read_b32 v22, v127
  ds_read_b64_tr_b16 v[24:25], v5 offset:0
  ds_read_b64_tr_b16 v[26:27], v119 offset:0
  ds_read_b64_tr_b16 v[28:29], v5 offset:6144
  ds_read_b64_tr_b16 v[30:31], v119 offset:6144
  ds_read_b64_tr_b16 v[32:33], v5 offset:1024
  ds_read_b64_tr_b16 v[34:35], v119 offset:1024
  s_waitcnt lgkmcnt(6)
  v_max3_u32 v20, v20, v21, v22
  v_cmp_eq_u32 vcc, -1, v20
  s_cbranch_vccz QK_go
  s_waitcnt vmcnt(3)
  s_add_u32 s66, s66, 1
  s_cmp_lt_u32 s66, 2097152
  s_cbranch_scc1 QK_poll
  s_branch K2_abort
QK_go:
  s_waitcnt lgkmcnt(4)
  v_smfmac_f32_16x16x64_bf16 v[44:47], v[24:27], v[128:135], v3
  ds_read_b64_tr_b16 v[36:37], v5 offset:2048
  v_smfmac_f32_16x16x64_bf16 v[40:43], v[24:27], v[208:215], v3
  ds_read_b64_tr_b16 v[38:39], v119 offset:2048
  v_smfmac_f32_16x16x64_bf16 v[52:55], v[24:27], a[0:7], v3
  s_add_u32 m0, s86, s89
  v_smfmac_f32_16x16x64_bf16 v[48:51], v[24:27], a[80:87], v3
  global_load_lds_dwordx4 v124, s[98:99] offset:0 sc1
  v_smfmac_f32_16x16x64_bf16 v[60:63], v[24:27], a[128:135], v3
  v_smfmac_f32_16x16x64_bf16 v[56:59], v[24:27], a[208:215], v3
  s_waitcnt lgkmcnt(4)
  v_smfmac_f32_16x16x64_bf16 v[44:47], v[28:31], v[176:183], v3
  ds_read_b64_tr_b16 v[24:25], v5 offset:7168
  v_smfmac_f32_16x16x64_bf16 v[40:43], v[28:31], v[64:71], v3
  ds_read_b64_tr_b16 v[26:27], v119 offset:7168
  global_load_lds_dwordx4 v124, s[98:99] offset:1024 sc1
  v_smfmac_f32_16x16x64_bf16 v[52:55], v[28:31], a[48:55], v3
  ds_read_b64_tr_b16 v[64:65], v8 offset:24576
  v_smfmac_f32_16x16x64_bf16 v[48:51], v[28:31], v[72:79], v3
  ds_read_b64_tr_b16 v[66:67], v8 offset:30720
  v_smfmac_f32_16x16x64_bf16 v[60:63], v[28:31], a[176:183], v3
  ds_read_b64_tr_b16 v[68:69], v8 offset:36864
  v_smfmac_f32_16x16x64_bf16 v[56:59], v[28:31], v[80:87], v3
  ds_read_b64_tr_b16 v[70:71], v8 offset:43008
  global_load_lds_dwordx4 v124, s[98:99] offset:2048 sc1
  s_waitcnt lgkmcnt(8)
  v_smfmac_f32_16x16x64_bf16 v[44:47], v[32:35], v[136:143], v3
  ds_read_b64_tr_b16 v[28:29], v5 offset:3072
  v_smfmac_f32_16x16x64_bf16 v[40:43], v[32:35], v[216:223], v3
  ds_read_b64_tr_b16 v[30:31], v119 offset:3072
  v_smfmac_f32_16x16x64_bf16 v[52:55], v[32:35], a[8:15], v3
  ds_read_b64_tr_b16 v[72:73], v9 offset:24576
  v_smfmac_f32_16x16x64_bf16 v[48:51], v[32:35], a[88:95], v3
  ds_read_b64_tr_b16 v[74:75], v9 offset:30720
  s_add_u32 m0, s86, s88
  v_smfmac_f32_16x16x64_bf16 v[60:63], v[32:35], a[136:143], v3
  ds_read_b64_tr_b16 v[76:77], v9 offset:36864
  global_load_lds_dwordx4 v124, s[96:97] offset:0 sc1
  v_smfmac_f32_16x16x64_bf16 v[56:59], v[32:35], a[216:223], v3
  ds_read_b64_tr_b16 v[78:79], v9 offset:43008
  s_waitcnt lgkmcnt(12)
  v_smfmac_f32_16x16x64_bf16 v[44:47], v[36:39], v[144:151], v3
  ds_read_b64_tr_b16 v[32:33], v5 offset:4096
  v_smfmac_f32_16x16x64_bf16 v[40:43], v[36:39], v[224:231], v3
  ds_read_b64_tr_b16 v[34:35], v119 offset:4096
  v_smfmac_f32_16x16x64_bf16 v[52:55], v[36:39], a[16:23], v3
  ds_read_b64_tr_b16 v[80:81], v10 offset:24576
  global_load_lds_dwordx4 v124, s[96:97] offset:1024 sc1
  v_smfmac_f32_16x16x64_bf16 v[48:51], v[36:39], a[96:103], v3
  ds_read_b64_tr_b16 v[82:83], v10 offset:30720
  v_smfmac_f32_16x16x64_bf16 v[60:63], v[36:39], a[144:151], v3
  ds_read_b64_tr_b16 v[84:85], v10 offset:36864
  v_smfmac_f32_16x16x64_bf16 v[56:59], v[36:39], a[224:231], v3
  ds_read_b64_tr_b16 v[86:87], v10 offset:43008
  s_waitcnt lgkmcnt(15)
  v_smfmac_f32_16x16x64_bf16 v[44:47], v[24:27], v[184:191], v3
  ds_read_b64_tr_b16 v[36:37], v5 offset:8192
  global_load_lds_dwordx4 v124, s[96:97] offset:2048 sc1
  s_waitcnt lgkmcnt(13)
  v_smfmac_f32_16x16x64_bf16 v[40:43], v[24:27], v[64:71], v3
  ds_read_b64_tr_b16 v[38:39], v119 offset:8192
  v_smfmac_f32_16x16x64_bf16 v[52:55], v[24:27], a[56:63], v3
  ds_read_b64_tr_b16 v[64:65], v11 offset:0
  s_waitcnt lgkmcnt(9)
  v_smfmac_f32_16x16x64_bf16 v[48:51], v[24:27], v[72:79], v3
  ds_read_b64_tr_b16 v[66:67], v11 offset:6144
  v_smfmac_f32_16x16x64_bf16 v[60:63], v[24:27], a[184:191], v3
  ds_read_b64_tr_b16 v[68:69], v11 offset:12288
  s_waitcnt lgkmcnt(5)
  v_smfmac_f32_16x16x64_bf16 v[56:59], v[24:27], v[80:87], v3
  ds_read_b64_tr_b16 v[70:71], v11 offset:18432
  v_smfmac_f32_16x16x64_bf16 v[44:47], v[28:31], v[152:159], v3
  ds_read_b64_tr_b16 v[24:25], v5 offset:5120
  v_smfmac_f32_16x16x64_bf16 v[40:43], v[28:31], v[232:239], v3
  ds_read_b64_tr_b16 v[26:27], v119 offset:5120
  v_smfmac_f32_16x16x64_bf16 v[52:55], v[28:31], a[24:31], v3
  ds_read_b64_tr_b16 v[72:73], v12 offset:0
  v_smfmac_f32_16x16x64_bf16 v[48:51], v[28:31], a[104:111], v3
  ds_read_b64_tr_b16 v[74:75], v12 offset:6144
  v_smfmac_f32_16x16x64_bf16 v[60:63], v[28:31], a[152:159], v3
  ds_read_b64_tr_b16 v[76:77], v12 offset:12288
  v_smfmac_f32_16x16x64_bf16 v[56:59], v[28:31], a[232:239], v3
  ds_read_b64_tr_b16 v[78:79], v12 offset:18432
  v_smfmac_f32_16x16x64_bf16 v[44:47], v[32:35], v[160:167], v3
  ds_read_b64_tr_b16 v[28:29], v5 offset:9216
  v_smfmac_f32_16x16x64_bf16 v[40:43], v[32:35], v[240:247], v3
  ds_read_b64_tr_b16 v[30:31], v119 offset:9216
  v_smfmac_f32_16x16x64_bf16 v[52:55], v[32:35], a[32:39], v3
  ds_read_b64_tr_b16 v[80:81], v13 offset:0
  v_smfmac_f32_16x16x64_bf16 v[48:51], v[32:35], a[112:119], v3
  ds_read_b64_tr_b16 v[82:83], v13 offset:6144
  v_smfmac_f32_16x16x64_bf16 v[60:63], v[32:35], a[160:167], v3
  ds_read_b64_tr_b16 v[84:85], v13 offset:12288
  v_smfmac_f32_16x16x64_bf16 v[56:59], v[32:35], a[240:247], v3
  ds_read_b64_tr_b16 v[86:87], v13 offset:18432
  s_waitcnt lgkmcnt(15)
  v_smfmac_f32_16x16x64_bf16 v[44:47], v[36:39], v[192:199], v3
  s_waitcnt lgkmcnt(12)
  v_smfmac_f32_16x16x64_bf16 v[40:43], v[36:39], v[64:71], v3
  ds_read_b64_tr_b16 v[64:65], v11 offset:24576
  v_smfmac_f32_16x16x64_bf16 v[52:55], v[36:39], a[64:71], v3
  ds_read_b64_tr_b16 v[66:67], v11 offset:30720
  s_waitcnt lgkmcnt(8)
  v_smfmac_f32_16x16x64_bf16 v[48:51], v[36:39], v[72:79], v3
  ds_read_b64_tr_b16 v[68:69], v11 offset:36864
  v_smfmac_f32_16x16x64_bf16 v[60:63], v[36:39], a[192:199], v3
  ds_read_b64_tr_b16 v[70:71], v11 offset:43008
  s_waitcnt lgkmcnt(4)
  v_smfmac_f32_16x16x64_bf16 v[56:59], v[36:39], v[80:87], v3
  ds_read_b64_tr_b16 v[72:73], v12 offset:24576
  v_smfmac_f32_16x16x64_bf16 v[44:47], v[24:27], v[168:175], v3
  ds_read_b64_tr_b16 v[74:75], v12 offset:30720
  v_smfmac_f32_16x16x64_bf16 v[40:43], v[24:27], v[248:255], v3
  ds_read_b64_tr_b16 v[76:77], v12 offset:36864
  v_smfmac_f32_16x16x64_bf16 v[52:55], v[24:27], a[40:47], v3
  ds_read_b64_tr_b16 v[78:79], v12 offset:43008
  v_smfmac_f32_16x16x64_bf16 v[48:51], v[24:27], a[120:127], v3
  ds_read_b64_tr_b16 v[80:81], v13 offset:24576
  v_smfmac_f32_16x16x64_bf16 v[60:63], v[24:27], a[168:175], v3
  ds_read_b64_tr_b16 v[82:83], v13 offset:30720
  v_smfmac_f32_16x16x64_bf16 v[56:59], v[24:27], a[248:255], v3
  ds_read_b64_tr_b16 v[84:85], v13 offset:36864
  v_smfmac_f32_16x16x64_bf16 v[44:47], v[28:31], v[200:207], v3
  ds_read_b64_tr_b16 v[86:87], v13 offset:43008
  s_waitcnt lgkmcnt(8)
  v_smfmac_f32_16x16x64_bf16 v[40:43], v[28:31], v[64:71], v3
  v_smfmac_f32_16x16x64_bf16 v[52:55], v[28:31], a[72:79], v3
  s_waitcnt lgkmcnt(4)
  v_smfmac_f32_16x16x64_bf16 v[48:51], v[28:31], v[72:79], v3
  v_smfmac_f32_16x16x64_bf16 v[60:63], v[28:31], a[200:207], v3
  s_waitcnt lgkmcnt(0)
  v_smfmac_f32_16x16x64_bf16 v[56:59], v[28:31], v[80:87], v3
  s_nop 3
  v_pk_add_f32 v[44:45], v[44:45], v[46:47]
  v_pk_add_f32 v[40:41], v[40:41], v[42:43]
  v_pk_add_f32 v[52:53], v[52:53], v[54:55]
  v_pk_add_f32 v[48:49], v[48:49], v[50:51]
  v_cvt_pk_bf16_f32 v21, v44, v45
  v_cvt_pk_bf16_f32 v20, v40, v41
  v_pk_add_f32 v[60:61], v[60:61], v[62:63]
  v_pk_add_f32 v[56:57], v[56:57], v[58:59]
  ds_write2_b32 v14, v20, v21 offset1:4
  v_cvt_pk_bf16_f32 v23, v52, v53
  v_cvt_pk_bf16_f32 v22, v48, v49
  v_cvt_pk_bf16_f32 v65, v60, v61
  v_cvt_pk_bf16_f32 v64, v56, v57
  ds_write2_b32 v14, v22, v23 offset0:128 offset1:132
  ds_write2_b32 v117, v64, v65 offset1:4
  v_cmp_u_f32 vcc, v44, v45
  s_cbranch_vccnz QK_nan
QK_nanc:
  s_waitcnt vmcnt(0) lgkmcnt(0)
  s_barrier
  s_cmp_eq_u32 s3, 3
  s_cbranch_scc1 QK_wT
  ds_read_b64_tr_b16 v[24:25], v15 offset:0
  ds_read_b64_tr_b16 v[26:27], v15 offset:512
  ds_read_b64_tr_b16 v[28:29], v15 offset:1024
  ds_read_b64_tr_b16 v[30:31], v15 offset:1536
  ds_read_b64_tr_b16 v[32:33], v15 offset:2048
  ds_read_b64_tr_b16 v[34:35], v15 offset:2560
  ds_read_b64_tr_b16 v[36:37], v15 offset:3072
  ds_read_b64_tr_b16 v[38:39], v15 offset:3584
  ds_read_b64_tr_b16 v[64:65], v15 offset:4096
  ds_read_b64_tr_b16 v[66:67], v15 offset:4608
  ds_read_b64_tr_b16 v[68:69], v15 offset:5120
  ds_read_b64_tr_b16 v[70:71], v15 offset:5632
  s_cmp_eq_u32 s3, 0
  s_cbranch_scc1 QK_w0
  s_waitcnt lgkmcnt(10)
  v_mfma_f32_16x16x32_bf16 v[72:75], v[88:91], v[24:27], 0
  s_waitcnt lgkmcnt(8)
  v_mfma_f32_16x16x32_bf16 v[72:75], v[92:95], v[28:31], v[72:75]
  s_waitcnt lgkmcnt(6)
  v_mfma_f32_16x16x32_bf16 v[72:75], v[96:99], v[32:35], v[72:75]
  s_waitcnt lgkmcnt(4)
  v_mfma_f32_16x16x32_bf16 v[72:75], v[100:103], v[36:39], v[72:75]
  s_waitcnt lgkmcnt(2)
  v_mfma_f32_16x16x32_bf16 v[72:75], v[104:107], v[64:67], v[72:75]
  s_waitcnt lgkmcnt(0)
  v_mfma_f32_16x16x32_bf16 v[72:75], v[108:111], v[68:71], v[72:75]
  v_mov_b32 v80, 0
  v_mov_b32 v116, 0x44101164
  s_nop 4
  s_branch QK_sm
QK_w0:
  s_waitcnt lgkmcnt(10)
  v_mfma_f32_16x16x32_bf16 v[72:75], v[24:27], v[24:27], v[88:91]
  s_waitcnt lgkmcnt(8)
  v_mfma_f32_16x16x32_bf16 v[72:75], v[28:31], v[28:31], v[72:75]
  s_waitcnt lgkmcnt(6)
  v_mfma_f32_16x16x32_bf16 v[72:75], v[32:35], v[32:35], v[72:75]
  s_waitcnt lgkmcnt(4)
  v_mfma_f32_16x16x32_bf16 v[72:75], v[36:39], v[36:39], v[72:75]
  s_waitcnt lgkmcnt(2)
  v_mfma_f32_16x16x32_bf16 v[72:75], v[64:67], v[64:67], v[72:75]
  s_waitcnt lgkmcnt(0)
  v_mfma_f32_16x16x32_bf16 v[72:75], v[68:71], v[68:71], v[72:75]
  v_mov_b32 v80, 0
  v_mov_b32 v116, 0x44101164
  s_nop 5
QK_sm:
  v_pk_mul_f32 v[76:77], v[72:73], s[70:71]
  v_pk_mul_f32 v[78:79], v[74:75], s[70:71]
  v_max3_f32 v21, abs(v72), abs(v73), abs(v74)
  v_exp_f32 v76, v76
  v_exp_f32 v77, v77
  v_max_f32 v21, v21, abs(v75)
  v_exp_f32 v78, v78
  v_exp_f32 v79, v79
  v_cmp_nle_f32 vcc, v21, v116
  v_pk_add_f32 v[22:23], v[76:77], v[78:79]
  s_and_b64 vcc, vcc, s[74:75]
  v_add_f32 v21, v22, v23
  s_cbranch_vccnz QK_smx
  v_bfi_b32 v21, v126, v21, s64
QK_smc:
  ds_write_b32 v114, v21
  s_nop 11
  ds_read_b128 v[40:43], v113 offset:0
  ds_read_b128 v[44:47], v113 offset:16
  ds_read_b128 v[48:51], v113 offset:32
  s_waitcnt lgkmcnt(0)
  v_bitop3_b32 v24, v40, v41, s64 bitop3:0x7e
  v_bitop3_b32 v25, v42, v43, s64 bitop3:0x7e
  v_bitop3_b32 v26, v44, v45, s64 bitop3:0x7e
  v_bitop3_b32 v27, v46, v47, s64 bitop3:0x7e
  v_bitop3_b32 v28, v48, v49, s64 bitop3:0x7e
  v_bitop3_b32 v29, v50, v51, s64 bitop3:0x7e
  v_pk_add_f32 v[30:31], v[40:41], v[42:43]
  v_pk_add_f32 v[32:33], v[44:45], v[46:47]
  v_pk_add_f32 v[34:35], v[48:49], v[50:51]
  v_or3_b32 v24, v24, v25, v26
  v_or3_b32 v27, v27, v28, v29
  v_pk_add_f32 v[36:37], v[30:31], v[32:33]
  v_or_b32 v24, v24, v27
  v_pk_add_f32 v[36:37], v[36:37], v[34:35]
  v_and_b32 v25, 1, v24
  v_cmp_gt_i32 s[48:49], 0, v24
  v_add_f32 v22, v36, v37
  v_cmp_ne_u32 vcc, 0, v25
  s_cmp_eq_u64 s[48:49], 0
  v_rcp_f32 v20, v22
  s_cbranch_scc0 QK_exl0
QK_exd:
  s_cbranch_vccnz QK_exs
QK_exc:
  v_pk_mul_f32 v[76:77], v[76:77], v[20:21] op_sel_hi:[1,0]
  v_pk_mul_f32 v[78:79], v[78:79], v[20:21] op_sel_hi:[1,0]
  v_cvt_pk_bf16_f32 v24, v76, v77
  v_cvt_pk_bf16_f32 v25, v78, v79
  v_and_or_b32 v24, v24, v121, s68
  v_and_or_b32 v25, v25, v121, s68
  s_cmp_eq_u32 s43, 0
  s_cbranch_scc1 SLOW_23
  s_mov_b64 exec, s[74:75]
  global_store_dword v18, v24, s[4:5]
  global_store_dword v118, v25, s[4:5]
  s_mov_b64 exec, -1
CONT_24:
  s_cmp_eq_u32 s3, 1
  s_cbranch_scc1 QK_wT1
  s_cmp_eq_u32 s3, 2
  s_cbranch_scc1 QK_join
  v_mov_b32 v20, -1
  v_mov_b32 v21, -1
  v_mov_b32 v22, -1
  v_mov_b32 v23, -1
  ds_write_b128 v125, v[20:23] offset:0
  ds_write_b128 v125, v[20:23] offset:1024
  ds_write_b128 v125, v[20:23] offset:2048
  ds_write_b128 v125, v[20:23] offset:3072
  ds_write_b128 v125, v[20:23] offset:4096
  ds_write_b128 v125, v[20:23] offset:5120
  ds_write_b128 v125, v[20:23] offset:6144
  ds_write_b128 v125, v[20:23] offset:7168
  ds_write_b128 v125, v[20:23] offset:8192
  ds_write_b128 v125, v[20:23] offset:9216
  s_branch QK_join
QK_wT:
  s_sleep 3
QK_wT1:
  ds_read_b128 v[108:111], v17 offset:0
  ds_read_b64_tr_b16 v[24:25], v15 offset:0
  ds_read_b64_tr_b16 v[26:27], v15 offset:512
  ds_read_b128 v[40:43], v16 offset:0
  ds_read_b128 v[44:47], v16 offset:6144
  ds_read_b128 v[84:87], v17 offset:1024
  ds_read_b64_tr_b16 v[28:29], v15 offset:1024
  ds_read_b64_tr_b16 v[30:31], v15 offset:1536
  ds_read_b128 v[48:51], v16 offset:1024
  ds_read_b128 v[52:55], v16 offset:7168
  ds_read_b64_tr_b16 v[32:33], v15 offset:2048
  ds_read_b64_tr_b16 v[34:35], v15 offset:2560
  ds_read_b128 v[56:59], v16 offset:2048
  ds_read_b128 v[60:63], v16 offset:8192
  ds_read_b64_tr_b16 v[36:37], v15 offset:3072
  ds_read_b64_tr_b16 v[38:39], v15 offset:3584
  ds_read_b128 v[72:75], v16 offset:3072
  ds_read_b128 v[76:79], v16 offset:9216
  ds_read_b64_tr_b16 v[64:65], v15 offset:4096
  ds_read_b64_tr_b16 v[66:67], v15 offset:4608
  ds_read_b128 v[80:83], v16 offset:4096
  ds_read_b128 v[88:91], v16 offset:10240
  ds_read_b64_tr_b16 v[68:69], v15 offset:5120
  ds_read_b64_tr_b16 v[70:71], v15 offset:5632
  ds_read_b128 v[92:95], v16 offset:5120
  ds_read_b128 v[20:23], v16 offset:11264
  s_waitcnt lgkmcnt(15)
  v_mfma_f32_16x16x32_bf16 v[100:103], v[40:43], v[108:111], 0
  v_mfma_f32_16x16x32_bf16 v[104:107], v[44:47], v[108:111], 0
  v_mfma_f32_16x16x32_bf16 v[96:99], v[24:27], v[108:111], 0
  ds_read_b128 v[108:111], v17 offset:2048
  v_mfma_f32_16x16x32_bf16 v[100:103], v[48:51], v[84:87], v[100:103]
  v_mfma_f32_16x16x32_bf16 v[104:107], v[52:55], v[84:87], v[104:107]
  v_mfma_f32_16x16x32_bf16 v[96:99], v[28:31], v[84:87], v[96:99]
  ds_read_b128 v[84:87], v17 offset:3072
  s_waitcnt lgkmcnt(1)
  v_mfma_f32_16x16x32_bf16 v[100:103], v[56:59], v[108:111], v[100:103]
  v_mfma_f32_16x16x32_bf16 v[104:107], v[60:63], v[108:111], v[104:107]
  v_mfma_f32_16x16x32_bf16 v[96:99], v[32:35], v[108:111], v[96:99]
  ds_read_b128 v[108:111], v17 offset:4096
  s_waitcnt lgkmcnt(1)
  v_mfma_f32_16x16x32_bf16 v[100:103], v[72:75], v[84:87], v[100:103]
  v_mfma_f32_16x16x32_bf16 v[104:107], v[76:79], v[84:87], v[104:107]
  v_mfma_f32_16x16x32_bf16 v[96:99], v[36:39], v[84:87], v[96:99]
  ds_read_b128 v[84:87], v17 offset:5120
  s_waitcnt lgkmcnt(1)
  v_mfma_f32_16x16x32_bf16 v[100:103], v[80:83], v[108:111], v[100:103]
  v_mfma_f32_16x16x32_bf16 v[104:107], v[88:91], v[108:111], v[104:107]
  v_mfma_f32_16x16x32_bf16 v[96:99], v[64:67], v[108:111], v[96:99]
  s_waitcnt lgkmcnt(0)
  v_mfma_f32_16x16x32_bf16 v[100:103], v[92:95], v[84:87], v[100:103]
  v_mfma_f32_16x16x32_bf16 v[104:107], v[20:23], v[84:87], v[104:107]
  v_mfma_f32_16x16x32_bf16 v[96:99], v[68:71], v[84:87], v[96:99]
  s_nop 5
  v_cndmask_b32 v100, v120, v100, s[24:25]
  v_cndmask_b32 v101, v120, v101, s[26:27]
  v_cndmask_b32 v102, v120, v102, s[28:29]
  v_cndmask_b32 v103, v120, v103, s[30:31]
  v_cndmask_b32 v104, v120, v104, s[32:33]
  v_cndmask_b32 v105, v120, v105, s[34:35]
  v_cndmask_b32 v106, v120, v106, s[36:37]
  v_cndmask_b32 v107, v120, v107, s[38:39]
  v_cndmask_b32 v96, v120, v96, s[72:73]
  v_cndmask_b32 v97, v120, v97, s[72:73]
  v_cndmask_b32 v98, v120, v98, s[72:73]
  v_cndmask_b32 v99, v120, v99, s[72:73]
  v_max3_f32 v20, v96, v97, v98
  v_max3_f32 v21, v99, v100, v101
  v_max3_f32 v20, v20, v102, v103
  v_max3_f32 v21, v21, v104, v105
  v_max3_f32 v20, v20, v106, v107
  v_max_f32 v20, v20, v21
  v_mov_b32 v21, v20
  s_nop 1
  v_permlane16_swap_b32 v20, v21
  v_max_f32 v20, v20, v21
  v_mov_b32 v21, v20
  s_nop 1
  v_permlane32_swap_b32 v20, v21
  v_max_f32 v20, v20, v21
  v_mul_f32 v20, s70, v20
  v_pk_fma_f32 v[96:97], v[96:97], s[70:71], v[20:21] op_sel_hi:[1,0,0] neg_lo:[0,0,1] neg_hi:[0,0,1]
  v_pk_fma_f32 v[98:99], v[98:99], s[70:71], v[20:21] op_sel_hi:[1,0,0] neg_lo:[0,0,1] neg_hi:[0,0,1]
  v_pk_fma_f32 v[100:101], v[100:101], s[70:71], v[20:21] op_sel_hi:[1,0,0] neg_lo:[0,0,1] neg_hi:[0,0,1]
  v_pk_fma_f32 v[102:103], v[102:103], s[70:71], v[20:21] op_sel_hi:[1,0,0] neg_lo:[0,0,1] neg_hi:[0,0,1]
  v_pk_fma_f32 v[104:105], v[104:105], s[70:71], v[20:21] op_sel_hi:[1,0,0] neg_lo:[0,0,1] neg_hi:[0,0,1]
  v_pk_fma_f32 v[106:107], v[106:107], s[70:71], v[20:21] op_sel_hi:[1,0,0] neg_lo:[0,0,1] neg_hi:[0,0,1]
  v_exp_f32 v96, v96
  v_exp_f32 v97, v97
  v_exp_f32 v98, v98
  v_exp_f32 v99, v99
  v_exp_f32 v100, v100
  v_exp_f32 v101, v101
  v_exp_f32 v102, v102
  v_exp_f32 v103, v103
  v_exp_f32 v104, v104
  v_exp_f32 v105, v105
  v_exp_f32 v106, v106
  v_exp_f32 v107, v107
  v_pk_add_f32 v[20:21], v[96:97], v[98:99]
  v_pk_add_f32 v[22:23], v[100:101], v[102:103]
  v_pk_add_f32 v[20:21], v[20:21], v[104:105]
  v_pk_add_f32 v[22:23], v[22:23], v[106:107]
  v_pk_add_f32 v[20:21], v[20:21], v[22:23]
  v_add_f32 v20, v20, v21
  v_mov_b32 v21, v20
  s_nop 1
  v_permlane16_swap_b32 v20, v21
  v_add_f32 v20, v20, v21
  v_mov_b32 v21, v20
  s_nop 1
  v_permlane32_swap_b32 v20, v21
  v_add_f32 v20, v20, v21
  v_rcp_f32 v20, v20
  s_nop 0
  v_pk_mul_f32 v[96:97], v[96:97], v[20:21] op_sel_hi:[1,0]
  v_pk_mul_f32 v[98:99], v[98:99], v[20:21] op_sel_hi:[1,0]
  v_pk_mul_f32 v[100:101], v[100:101], v[20:21] op_sel_hi:[1,0]
  v_pk_mul_f32 v[102:103], v[102:103], v[20:21] op_sel_hi:[1,0]
  v_pk_mul_f32 v[104:105], v[104:105], v[20:21] op_sel_hi:[1,0]
  v_pk_mul_f32 v[106:107], v[106:107], v[20:21] op_sel_hi:[1,0]
  v_cvt_pk_bf16_f32 v76, v100, v101
  v_cvt_pk_bf16_f32 v77, v102, v103
  v_cvt_pk_bf16_f32 v78, v104, v105
  v_cvt_pk_bf16_f32 v79, v106, v107
  v_cvt_pk_bf16_f32 v80, v96, v97
  v_cvt_pk_bf16_f32 v81, v98, v99
  v_and_or_b32 v76, v76, v121, s69
  v_and_or_b32 v77, v77, v121, s69
  v_and_or_b32 v78, v78, v121, s69
  v_and_or_b32 v79, v79, v121, s69
  v_and_or_b32 v80, v80, v121, s69
  v_and_or_b32 v81, v81, v121, s69
  s_cmp_eq_u32 s43, 0
  s_cbranch_scc1 SLOW_25
  global_store_dwordx4 v19, v[76:79], s[62:63]
  s_mov_b64 exec, s[72:73]
  global_store_dword v112, v80, s[62:63]
  global_store_dword v112, v81, s[62:63] offset:256
  s_mov_b64 exec, -1
CONT_26:
QK_join:
  s_waitcnt lgkmcnt(0)
  s_barrier
  s_add_u32 s44, s44, 1
  s_cmp_ge_u32 s44, 64
  s_cbranch_scc1 QK_done
  s_cmp_eq_u32 s65, 0
  s_cbranch_scc1 QK_late
QK_latec:
  s_barrier
  s_add_u32 s47, s44, 1
  s_min_u32 s47, s47, 63
  s_bitcmp1_b64 s[84:85], s47
  s_cselect_b32 s65, 1, 0
  s_cselect_b32 s47, s47, s44
  s_lshl_b32 s48, s47, 5
  s_add_u32 s48, s48, s42
  s_mul_i32 s48, s48, 12288
  s_add_u32 s48, s48, 0x3400000
  s_add_u32 s96, s4, s48
  s_addc_u32 s97, s5, 0
  s_lshl_b32 s48, s44, 5
  s_add_u32 s48, s48, s42
  s_mul_i32 s48, s48, 12288
  s_add_u32 s48, s48, 0x4c00000
  s_add_u32 s98, s4, s48
  s_addc_u32 s99, s5, 0
  s_sub_u32 s48, s88, s87
  s_mov_b32 s49, s87
  s_mov_b32 s87, s88
  s_mov_b32 s88, s49
  v_add_u32 v16, s48, v16
  v_add_u32 v115, s48, v115
  s_xor_b32 s68, s68, 0x80008000
  s_and_b32 s48, s44, 3
  s_cmp_eq_u32 s48, 0
  s_cselect_b32 s49, 0x80008000, 0
  s_xor_b32 s69, s69, s49
  s_mul_i32 s48, s48, 81920
  s_add_u32 s62, s4, s48
  s_addc_u32 s63, s5, 0
  s_add_u32 s48, s44, 0
  s_and_b32 s48, s48, 3
  s_mul_i32 s48, s48, 40960
  s_add_u32 s48, s48, s59
  s_add_u32 s60, s4, s48
  s_addc_u32 s61, s5, 0
  s_xor_b32 s45, s45, 10240
  s_lshl_b32 s48, s45, 1
  s_sub_u32 s48, s48, 10240
  v_add_u32 v5, s48, v5
  v_add_u32 v119, s48, v119
  v_add_u32 v6, s48, v6
  v_add_u32 v7, s48, v7
  v_add_u32 v125, s48, v125
  v_add_u32 v127, s48, v127
  s_branch QK_step
QK_done:
  s_endpgm
K2_vo:
  s_sub_u32 s41, s41, 8
  s_load_dwordx4 s[8:11], s[0:1], 32
  s_load_dwordx2 s[6:7], s[0:1], 96
  s_getreg_b32 s48, hwreg(HW_REG_XCC_ID)
  s_and_b32 s48, s48, 7
  s_mul_i32 s49, s48, s48
  s_lshl_b32 s49, s49, 16
  s_lshl_b32 s48, s48, 8
  s_add_u32 s48, s48, s49
  s_add_u32 s48, s48, 1
  s_lshl_b32 s49, s40, 2
  v_mov_b32 v20, s49
  v_mov_b32 v21, s48
  s_waitcnt lgkmcnt(0)
  s_cmp_lg_u32 s3, 0
  s_cbranch_scc1 HS_29
  s_mov_b64 exec, 1
  global_atomic_add v20, v21, s[6:7] sc1
  s_mov_b64 exec, -1
HS_29:
  s_lshl_b32 s42, s40, 3
  s_add_u32 s42, s42, s41
  v_add_u32 v20, 0, v0
  v_mul_u32_u24 v21, 2731, v20
  v_lshrrev_b32 v21, 16, v21
  v_mul_u32_u24 v22, 24, v21
  v_sub_u32 v22, v20, v22
  v_bfe_u32 v23, v21, 1, 2
  v_lshlrev_b32 v23, 1, v23
  v_xor_b32 v22, v22, v23
  s_mov_b32 s90, 12288
  v_mul_lo_u32 v21, v21, s90
  v_lshl_add_u32 v24, v22, 4, v21
  v_add_u32 v20, 256, v0
  v_mul_u32_u24 v21, 2731, v20
  v_lshrrev_b32 v21, 16, v21
  v_mul_u32_u24 v22, 24, v21
  v_sub_u32 v22, v20, v22
  v_bfe_u32 v23, v21, 1, 2
  v_lshlrev_b32 v23, 1, v23
  v_xor_b32 v22, v22, v23
  s_mov_b32 s90, 12288
  v_mul_lo_u32 v21, v21, s90
  v_lshl_add_u32 v25, v22, 4, v21
  v_add_u32 v20, 512, v0
  v_mul_u32_u24 v21, 2731, v20
  v_lshrrev_b32 v21, 16, v21
  v_mul_u32_u24 v22, 24, v21
  v_sub_u32 v22, v20, v22
  v_bfe_u32 v23, v21, 1, 2
  v_lshlrev_b32 v23, 1, v23
  v_xor_b32 v22, v22, v23
  s_mov_b32 s90, 12288
  v_mul_lo_u32 v21, v21, s90
  v_lshl_add_u32 v26, v22, 4, v21
  v_add_u32 v20, 0, v0
  v_mul_u32_u24 v21, 6554, v20
  v_lshrrev_b32 v21, 19, v21
  v_mul_u32_u24 v22, 80, v21
  v_sub_u32 v22, v20, v22
  v_and_b32 v23, 7, v21
  v_lshlrev_b32 v23, 1, v23
  v_xor_b32 v22, v22, v23
  s_mov_b32 s90, 1280
  v_mul_lo_u32 v21, v21, s90
  v_lshl_add_u32 v28, v22, 4, v21
  v_add_u32 v20, 256, v0
  v_mul_u32_u24 v21, 6554, v20
  v_lshrrev_b32 v21, 19, v21
  v_mul_u32_u24 v22, 80, v21
  v_sub_u32 v22, v20, v22
  v_and_b32 v23, 7, v21
  v_lshlrev_b32 v23, 1, v23
  v_xor_b32 v22, v22, v23
  s_mov_b32 s90, 1280
  v_mul_lo_u32 v21, v21, s90
  v_lshl_add_u32 v29, v22, 4, v21
  v_add_u32 v20, 512, v0
  v_mul_u32_u24 v21, 6554, v20
  v_lshrrev_b32 v21, 19, v21
  v_mul_u32_u24 v22, 80, v21
  v_sub_u32 v22, v20, v22
  v_and_b32 v23, 7, v21
  v_lshlrev_b32 v23, 1, v23
  v_xor_b32 v22, v22, v23
  s_mov_b32 s90, 1280
  v_mul_lo_u32 v21, v21, s90
  v_lshl_add_u32 v30, v22, 4, v21
  v_add_u32 v20, 768, v0
  v_mul_u32_u24 v21, 6554, v20
  v_lshrrev_b32 v21, 19, v21
  v_mul_u32_u24 v22, 80, v21
  v_sub_u32 v22, v20, v22
  v_and_b32 v23, 7, v21
  v_lshlrev_b32 v23, 1, v23
  v_xor_b32 v22, v22, v23
  s_mov_b32 s90, 1280
  v_mul_lo_u32 v21, v21, s90
  v_lshl_add_u32 v31, v22, 4, v21
  v_add_u32 v20, 1024, v0
  v_mul_u32_u24 v21, 6554, v20
  v_lshrrev_b32 v21, 19, v21
  v_mul_u32_u24 v22, 80, v21
  v_sub_u32 v22, v20, v22
  v_and_b32 v23, 7, v21
  v_lshlrev_b32 v23, 1, v23
  v_xor_b32 v22, v22, v23
  s_mov_b32 s90, 1280
  v_mul_lo_u32 v21, v21, s90
  v_lshl_add_u32 v32, v22, 4, v21
  v_add_u32 v20, 1280, v0
  v_mul_u32_u24 v21, 6554, v20
  v_lshrrev_b32 v21, 19, v21
  v_mul_u32_u24 v22, 80, v21
  v_sub_u32 v22, v20, v22
  v_and_b32 v23, 7, v21
  v_lshlrev_b32 v23, 1, v23
  v_xor_b32 v22, v22, v23
  s_mov_b32 s90, 1280
  v_mul_lo_u32 v21, v21, s90
  v_lshl_add_u32 v33, v22, 4, v21
  v_add_u32 v20, 1536, v0
  v_mul_u32_u24 v21, 6554, v20
  v_lshrrev_b32 v21, 19, v21
  v_mul_u32_u24 v22, 80, v21
  v_sub_u32 v22, v20, v22
  v_and_b32 v23, 7, v21
  v_lshlrev_b32 v23, 1, v23
  v_xor_b32 v22, v22, v23
  s_mov_b32 s90, 1280
  v_mul_lo_u32 v21, v21, s90
  v_lshl_add_u32 v34, v22, 4, v21
  v_add_u32 v20, 1792, v0
  v_mul_u32_u24 v21, 6554, v20
  v_lshrrev_b32 v21, 19, v21
  v_mul_u32_u24 v22, 80, v21
  v_sub_u32 v22, v20, v22
  v_and_b32 v23, 7, v21
  v_lshlrev_b32 v23, 1, v23
  v_xor_b32 v22, v22, v23
  s_mov_b32 s90, 1280
  v_mul_lo_u32 v21, v21, s90
  v_lshl_add_u32 v35, v22, 4, v21
  v_add_u32 v20, 2048, v0
  v_mul_u32_u24 v21, 6554, v20
  v_lshrrev_b32 v21, 19, v21
  v_mul_u32_u24 v22, 80, v21
  v_sub_u32 v22, v20, v22
  v_and_b32 v23, 7, v21
  v_lshlrev_b32 v23, 1, v23
  v_xor_b32 v22, v22, v23
  s_mov_b32 s90, 1280
  v_mul_lo_u32 v21, v21, s90
  v_lshl_add_u32 v36, v22, 4, v21
  v_add_u32 v20, 2304, v0
  v_mul_u32_u24 v21, 6554, v20
  v_lshrrev_b32 v21, 19, v21
  v_mul_u32_u24 v22, 80, v21
  v_sub_u32 v22, v20, v22
  v_and_b32 v23, 7, v21
  v_lshlrev_b32 v23, 1, v23
  v_xor_b32 v22, v22, v23
  s_mov_b32 s90, 1280
  v_mul_lo_u32 v21, v21, s90
  v_lshl_add_u32 v37, v22, 4, v21
  s_mov_b32 s91, 384
  s_mul_i32 s56, s3, 3
  v_lshrrev_b32 v20, 2, v1
  v_bfe_u32 v21, v20, 1, 2
  v_xor_b32 v21, s56, v21
  v_lshlrev_b32 v21, 5, v21
  v_mad_u32_u24 v21, v20, s91, v21
  v_and_b32 v20, 3, v1
  v_lshl_add_u32 v8, v20, 3, v21
  s_add_u32 s56, s56, 1
  v_lshrrev_b32 v20, 2, v1
  v_bfe_u32 v21, v20, 1, 2
  v_xor_b32 v21, s56, v21
  v_lshlrev_b32 v21, 5, v21
  v_mad_u32_u24 v21, v20, s91, v21
  v_and_b32 v20, 3, v1
  v_lshl_add_u32 v9, v20, 3, v21
  s_add_u32 s56, s56, 1
  v_lshrrev_b32 v20, 2, v1
  v_bfe_u32 v21, v20, 1, 2
  v_xor_b32 v21, s56, v21
  v_lshlrev_b32 v21, 5, v21
  v_mad_u32_u24 v21, v20, s91, v21
  v_and_b32 v20, 3, v1
  v_lshl_add_u32 v10, v20, 3, v21
  s_add_u32 s56, s56, 1
  s_mov_b32 s91, 1280
  s_mul_i32 s56, s3, 10
  v_lshrrev_b32 v20, 2, v1
  v_and_b32 v21, 7, v20
  v_xor_b32 v21, s56, v21
  v_lshlrev_b32 v21, 5, v21
  v_mad_u32_u24 v21, v20, s91, v21
  v_and_b32 v20, 3, v1
  v_lshl_add_u32 v40, v20, 3, v21
  s_add_u32 s56, s56, 1
  v_lshrrev_b32 v20, 2, v1
  v_and_b32 v21, 7, v20
  v_xor_b32 v21, s56, v21
  v_lshlrev_b32 v21, 5, v21
  v_mad_u32_u24 v21, v20, s91, v21
  v_and_b32 v20, 3, v1
  v_lshl_add_u32 v41, v20, 3, v21
  s_add_u32 s56, s56, 1
  v_lshrrev_b32 v20, 2, v1
  v_and_b32 v21, 7, v20
  v_xor_b32 v21, s56, v21
  v_lshlrev_b32 v21, 5, v21
  v_mad_u32_u24 v21, v20, s91, v21
  v_and_b32 v20, 3, v1
  v_lshl_add_u32 v42, v20, 3, v21
  s_add_u32 s56, s56, 1
  v_lshrrev_b32 v20, 2, v1
  v_and_b32 v21, 7, v20
  v_xor_b32 v21, s56, v21
  v_lshlrev_b32 v21, 5, v21
  v_mad_u32_u24 v21, v20, s91, v21
  v_and_b32 v20, 3, v1
  v_lshl_add_u32 v43, v20, 3, v21
  s_add_u32 s56, s56, 1
  v_lshrrev_b32 v20, 2, v1
  v_and_b32 v21, 7, v20
  v_xor_b32 v21, s56, v21
  v_lshlrev_b32 v21, 5, v21
  v_mad_u32_u24 v21, v20, s91, v21
  v_and_b32 v20, 3, v1
  v_lshl_add_u32 v44, v20, 3, v21
  s_add_u32 s56, s56, 1
  v_lshrrev_b32 v20, 2, v1
  v_and_b32 v21, 7, v20
  v_xor_b32 v21, s56, v21
  v_lshlrev_b32 v21, 5, v21
  v_mad_u32_u24 v21, v20, s91, v21
  v_and_b32 v20, 3, v1
  v_lshl_add_u32 v45, v20, 3, v21
  s_add_u32 s56, s56, 1
  v_lshrrev_b32 v20, 2, v1
  v_and_b32 v21, 7, v20
  v_xor_b32 v21, s56, v21
  v_lshlrev_b32 v21, 5, v21
  v_mad_u32_u24 v21, v20, s91, v21
  v_and_b32 v20, 3, v1
  v_lshl_add_u32 v46, v20, 3, v21
  s_add_u32 s56, s56, 1
  v_lshrrev_b32 v20, 2, v1
  v_and_b32 v21, 7, v20
  v_xor_b32 v21, s56, v21
  v_lshlrev_b32 v21, 5, v21
  v_mad_u32_u24 v21, v20, s91, v21
  v_and_b32 v20, 3, v1
  v_lshl_add_u32 v47, v20, 3, v21
  s_add_u32 s56, s56, 1
  v_lshrrev_b32 v20, 2, v1
  v_and_b32 v21, 7, v20
  v_xor_b32 v21, s56, v21
  v_lshlrev_b32 v21, 5, v21
  v_mad_u32_u24 v21, v20, s91, v21
  v_and_b32 v20, 3, v1
  v_lshl_add_u32 v48, v20, 3, v21
  s_add_u32 s56, s56, 1
  v_lshrrev_b32 v20, 2, v1
  v_and_b32 v21, 7, v20
  v_xor_b32 v21, s56, v21
  v_lshlrev_b32 v21, 5, v21
  v_mad_u32_u24 v21, v20, s91, v21
  v_and_b32 v20, 3, v1
  v_lshl_add_u32 v49, v20, 3, v21
  s_add_u32 s56, s56, 1
  s_mul_i32 s48, s42, 384
  s_add_u32 s8, s8, s48
  s_addc_u32 s9, s9, 0
  s_add_u32 s12, s8, 6291456
  s_addc_u32 s13, s9, 0
  s_mul_i32 s48, s42, 245760
  s_add_u32 s10, s10, s48
  s_addc_u32 s11, s11, 0
  s_mov_b64 s[34:35], s[8:9]
  s_mov_b64 s[36:37], s[10:11]
  s_lshl_b32 s92, s3, 10
  s_add_u32 m0, s92, 0
  s_nop 0
  global_load_lds_dwordx4 v28, s[10:11]
  s_add_u32 m0, s92, 4096
  s_nop 0
  global_load_lds_dwordx4 v29, s[10:11]
  s_add_u32 m0, s92, 8192
  s_nop 0
  global_load_lds_dwordx4 v30, s[10:11]
  s_add_u32 m0, s92, 12288
  s_nop 0
  global_load_lds_dwordx4 v31, s[10:11]
  s_add_u32 m0, s92, 16384
  s_nop 0
  global_load_lds_dwordx4 v32, s[10:11]
  s_add_u32 m0, s92, 20480
  s_nop 0
  global_load_lds_dwordx4 v33, s[10:11]
  s_add_u32 m0, s92, 24576
  s_nop 0
  global_load_lds_dwordx4 v34, s[10:11]
  s_add_u32 m0, s92, 28672
  s_nop 0
  global_load_lds_dwordx4 v35, s[10:11]
  s_add_u32 m0, s92, 32768
  s_nop 0
  global_load_lds_dwordx4 v36, s[10:11]
  s_add_u32 m0, s92, 36864
  s_nop 0
  global_load_lds_dwordx4 v37, s[10:11]
  s_add_u32 s10, s10, 40960
  s_addc_u32 s11, s11, 0
  s_add_u32 m0, s92, 40960
  s_nop 0
  global_load_lds_dwordx4 v28, s[10:11]
  s_add_u32 m0, s92, 45056
  s_nop 0
  global_load_lds_dwordx4 v29, s[10:11]
  s_add_u32 m0, s92, 49152
  s_nop 0
  global_load_lds_dwordx4 v30, s[10:11]
  s_add_u32 m0, s92, 53248
  s_nop 0
  global_load_lds_dwordx4 v31, s[10:11]
  s_add_u32 m0, s92, 57344
  s_nop 0
  global_load_lds_dwordx4 v32, s[10:11]
  s_add_u32 m0, s92, 61440
  s_nop 0
  global_load_lds_dwordx4 v33, s[10:11]
  s_add_u32 m0, s92, 65536
  s_nop 0
  global_load_lds_dwordx4 v34, s[10:11]
  s_add_u32 m0, s92, 69632
  s_nop 0
  global_load_lds_dwordx4 v35, s[10:11]
  s_add_u32 m0, s92, 73728
  s_nop 0
  global_load_lds_dwordx4 v36, s[10:11]
  s_add_u32 m0, s92, 77824
  s_nop 0
  global_load_lds_dwordx4 v37, s[10:11]
  s_add_u32 s10, s10, 40960
  s_addc_u32 s11, s11, 0
  s_add_u32 m0, s92, 81920
  s_nop 0
  global_load_lds_dwordx4 v28, s[10:11]
  s_add_u32 m0, s92, 86016
  s_nop 0
  global_load_lds_dwordx4 v29, s[10:11]
  s_add_u32 m0, s92, 90112
  s_nop 0
  global_load_lds_dwordx4 v30, s[10:11]
  s_add_u32 m0, s92, 94208
  s_nop 0
  global_load_lds_dwordx4 v31, s[10:11]
  s_add_u32 m0, s92, 98304
  s_nop 0
  global_load_lds_dwordx4 v32, s[10:11]
  s_add_u32 m0, s92, 102400
  s_nop 0
  global_load_lds_dwordx4 v33, s[10:11]
  s_add_u32 m0, s92, 106496
  s_nop 0
  global_load_lds_dwordx4 v34, s[10:11]
  s_add_u32 m0, s92, 110592
  s_nop 0
  global_load_lds_dwordx4 v35, s[10:11]
  s_add_u32 m0, s92, 114688
  s_nop 0
  global_load_lds_dwordx4 v36, s[10:11]
  s_add_u32 m0, s92, 118784
  s_nop 0
  global_load_lds_dwordx4 v37, s[10:11]
  s_add_u32 s10, s10, 40960
  s_addc_u32 s11, s11, 0
  s_add_u32 m0, s92, 122880
  s_nop 0
  global_load_lds_dwordx4 v28, s[10:11]
  s_add_u32 m0, s92, 126976
  s_nop 0
  global_load_lds_dwordx4 v29, s[10:11]
  s_add_u32 m0, s92, 131072
  s_nop 0
  global_load_lds_dwordx4 v30, s[10:11]
  s_add_u32 m0, s92, 135168
  s_nop 0
  global_load_lds_dwordx4 v31, s[10:11]
  s_add_u32 m0, s92, 139264
  s_nop 0
  global_load_lds_dwordx4 v32, s[10:11]
  s_add_u32 m0, s92, 143360
  s_nop 0
  global_load_lds_dwordx4 v33, s[10:11]
  s_add_u32 m0, s92, 147456
  s_nop 0
  global_load_lds_dwordx4 v34, s[10:11]
  s_add_u32 m0, s92, 151552
  s_nop 0
  global_load_lds_dwordx4 v35, s[10:11]
  s_add_u32 m0, s92, 155648
  s_nop 0
  global_load_lds_dwordx4 v36, s[10:11]
  s_add_u32 m0, s92, 159744
  s_nop 0
  global_load_lds_dwordx4 v37, s[10:11]
  s_add_u32 s10, s10, 40960
  s_addc_u32 s11, s11, 0
  s_waitcnt vmcnt(30)
  s_waitcnt lgkmcnt(0)
  s_barrier
  v_add_u32 v52, 0, v40
  ds_read_b64_tr_b16 a[16:17], v52
  ds_read_b64_tr_b16 a[18:19], v52 offset:20480
  v_add_u32 v53, 0, v41
  ds_read_b64_tr_b16 a[40:41], v53
  ds_read_b64_tr_b16 a[42:43], v53 offset:20480
  v_add_u32 v54, 0, v42
  ds_read_b64_tr_b16 a[64:65], v54
  ds_read_b64_tr_b16 a[66:67], v54 offset:20480
  v_add_u32 v55, 0, v43
  ds_read_b64_tr_b16 a[88:89], v55
  ds_read_b64_tr_b16 a[90:91], v55 offset:20480
  v_add_u32 v52, 0, v44
  ds_read_b64_tr_b16 a[112:113], v52
  ds_read_b64_tr_b16 a[114:115], v52 offset:20480
  v_add_u32 v53, 0, v45
  ds_read_b64_tr_b16 a[136:137], v53
  ds_read_b64_tr_b16 a[138:139], v53 offset:20480
  v_add_u32 v54, 0, v46
  ds_read_b64_tr_b16 a[160:161], v54
  ds_read_b64_tr_b16 a[162:163], v54 offset:20480
  v_add_u32 v55, 0, v47
  ds_read_b64_tr_b16 a[184:185], v55
  ds_read_b64_tr_b16 a[186:187], v55 offset:20480
  v_add_u32 v52, 0, v48
  ds_read_b64_tr_b16 a[208:209], v52
  ds_read_b64_tr_b16 a[210:211], v52 offset:20480
  v_add_u32 v53, 0, v49
  ds_read_b64_tr_b16 a[232:233], v53
  ds_read_b64_tr_b16 a[234:235], v53 offset:20480
  s_waitcnt vmcnt(20)
  s_waitcnt lgkmcnt(0)
  s_barrier
  s_add_u32 m0, s92, 0
  s_nop 0
  global_load_lds_dwordx4 v28, s[10:11]
  s_add_u32 m0, s92, 4096
  s_nop 0
  global_load_lds_dwordx4 v29, s[10:11]
  s_add_u32 m0, s92, 8192
  s_nop 0
  global_load_lds_dwordx4 v30, s[10:11]
  s_add_u32 m0, s92, 12288
  s_nop 0
  global_load_lds_dwordx4 v31, s[10:11]
  s_add_u32 m0, s92, 16384
  s_nop 0
  global_load_lds_dwordx4 v32, s[10:11]
  s_add_u32 m0, s92, 20480
  s_nop 0
  global_load_lds_dwordx4 v33, s[10:11]
  s_add_u32 m0, s92, 24576
  s_nop 0
  global_load_lds_dwordx4 v34, s[10:11]
  s_add_u32 m0, s92, 28672
  s_nop 0
  global_load_lds_dwordx4 v35, s[10:11]
  s_add_u32 m0, s92, 32768
  s_nop 0
  global_load_lds_dwordx4 v36, s[10:11]
  s_add_u32 m0, s92, 36864
  s_nop 0
  global_load_lds_dwordx4 v37, s[10:11]
  s_add_u32 s10, s10, 40960
  s_addc_u32 s11, s11, 0
  v_add_u32 v52, 40960, v40
  ds_read_b64_tr_b16 a[20:21], v52
  ds_read_b64_tr_b16 a[22:23], v52 offset:20480
  v_add_u32 v53, 40960, v41
  ds_read_b64_tr_b16 a[44:45], v53
  ds_read_b64_tr_b16 a[46:47], v53 offset:20480
  v_add_u32 v54, 40960, v42
  ds_read_b64_tr_b16 a[68:69], v54
  ds_read_b64_tr_b16 a[70:71], v54 offset:20480
  v_add_u32 v55, 40960, v43
  ds_read_b64_tr_b16 a[92:93], v55
  ds_read_b64_tr_b16 a[94:95], v55 offset:20480
  v_add_u32 v52, 40960, v44
  ds_read_b64_tr_b16 a[116:117], v52
  ds_read_b64_tr_b16 a[118:119], v52 offset:20480
  v_add_u32 v53, 40960, v45
  ds_read_b64_tr_b16 a[140:141], v53
  ds_read_b64_tr_b16 a[142:143], v53 offset:20480
  v_add_u32 v54, 40960, v46
  ds_read_b64_tr_b16 a[164:165], v54
  ds_read_b64_tr_b16 a[166:167], v54 offset:20480
  v_add_u32 v55, 40960, v47
  ds_read_b64_tr_b16 a[188:189], v55
  ds_read_b64_tr_b16 a[190:191], v55 offset:20480
  v_add_u32 v52, 40960, v48
  ds_read_b64_tr_b16 a[212:213], v52
  ds_read_b64_tr_b16 a[214:215], v52 offset:20480
  v_add_u32 v53, 40960, v49
  ds_read_b64_tr_b16 a[236:237], v53
  ds_read_b64_tr_b16 a[238:239], v53 offset:20480
  s_waitcnt vmcnt(20)
  s_waitcnt lgkmcnt(0)
  s_barrier
  s_add_u32 m0, s92, 40960
  s_nop 0
  global_load_lds_dwordx4 v28, s[10:11]
  s_add_u32 m0, s92, 45056
  s_nop 0
  global_load_lds_dwordx4 v29, s[10:11]
  s_add_u32 m0, s92, 49152
  s_nop 0
  global_load_lds_dwordx4 v30, s[10:11]
  s_add_u32 m0, s92, 53248
  s_nop 0
  global_load_lds_dwordx4 v31, s[10:11]
  s_add_u32 m0, s92, 57344
  s_nop 0
  global_load_lds_dwordx4 v32, s[10:11]
  s_add_u32 m0, s92, 61440
  s_nop 0
  global_load_lds_dwordx4 v33, s[10:11]
  s_add_u32 m0, s92, 65536
  s_nop 0
  global_load_lds_dwordx4 v34, s[10:11]
  s_add_u32 m0, s92, 69632
  s_nop 0
  global_load_lds_dwordx4 v35, s[10:11]
  s_add_u32 m0, s92, 73728
  s_nop 0
  global_load_lds_dwordx4 v36, s[10:11]
  s_add_u32 m0, s92, 77824
  s_nop 0
  global_load_lds_dwordx4 v37, s[10:11]
  s_add_u32 s10, s10, 40960
  s_addc_u32 s11, s11, 0
  v_add_u32 v52, 81920, v40
  ds_read_b64_tr_b16 a[24:25], v52
  ds_read_b64_tr_b16 a[26:27], v52 offset:20480
  v_add_u32 v53, 81920, v41
  ds_read_b64_tr_b16 a[48:49], v53
  ds_read_b64_tr_b16 a[50:51], v53 offset:20480
  v_add_u32 v54, 81920, v42
  ds_read_b64_tr_b16 a[72:73], v54
  ds_read_b64_tr_b16 a[74:75], v54 offset:20480
  v_add_u32 v55, 81920, v43
  ds_read_b64_tr_b16 a[96:97], v55
  ds_read_b64_tr_b16 a[98:99], v55 offset:20480
  v_add_u32 v52, 81920, v44
  ds_read_b64_tr_b16 a[120:121], v52
  ds_read_b64_tr_b16 a[122:123], v52 offset:20480
  v_add_u32 v53, 81920, v45
  ds_read_b64_tr_b16 a[144:145], v53
  ds_read_b64_tr_b16 a[146:147], v53 offset:20480
  v_add_u32 v54, 81920, v46
  ds_read_b64_tr_b16 a[168:169], v54
  ds_read_b64_tr_b16 a[170:171], v54 offset:20480
  v_add_u32 v55, 81920, v47
  ds_read_b64_tr_b16 a[192:193], v55
  ds_read_b64_tr_b16 a[194:195], v55 offset:20480
  v_add_u32 v52, 81920, v48
  ds_read_b64_tr_b16 a[216:217], v52
  ds_read_b64_tr_b16 a[218:219], v52 offset:20480
  v_add_u32 v53, 81920, v49
  ds_read_b64_tr_b16 a[240:241], v53
  ds_read_b64_tr_b16 a[242:243], v53 offset:20480
  s_waitcnt vmcnt(20)
  s_waitcnt lgkmcnt(0)
  s_barrier
  v_add_u32 v52, 122880, v40
  ds_read_b64_tr_b16 a[28:29], v52
  ds_read_b64_tr_b16 a[30:31], v52 offset:20480
  v_add_u32 v53, 122880, v41
  ds_read_b64_tr_b16 a[52:53], v53
  ds_read_b64_tr_b16 a[54:55], v53 offset:20480
  v_add_u32 v54, 122880, v42
  ds_read_b64_tr_b16 a[76:77], v54
  ds_read_b64_tr_b16 a[78:79], v54 offset:20480
  v_add_u32 v55, 122880, v43
  ds_read_b64_tr_b16 a[100:101], v55
  ds_read_b64_tr_b16 a[102:103], v55 offset:20480
  v_add_u32 v52, 122880, v44
  ds_read_b64_tr_b16 a[124:125], v52
  ds_read_b64_tr_b16 a[126:127], v52 offset:20480
  v_add_u32 v53, 122880, v45
  ds_read_b64_tr_b16 a[148:149], v53
  ds_read_b64_tr_b16 a[150:151], v53 offset:20480
  v_add_u32 v54, 122880, v46
  ds_read_b64_tr_b16 a[172:173], v54
  ds_read_b64_tr_b16 a[174:175], v54 offset:20480
  v_add_u32 v55, 122880, v47
  ds_read_b64_tr_b16 a[196:197], v55
  ds_read_b64_tr_b16 a[198:199], v55 offset:20480
  v_add_u32 v52, 122880, v48
  ds_read_b64_tr_b16 a[220:221], v52
  ds_read_b64_tr_b16 a[222:223], v52 offset:20480
  v_add_u32 v53, 122880, v49
  ds_read_b64_tr_b16 a[244:245], v53
  ds_read_b64_tr_b16 a[246:247], v53 offset:20480
  s_waitcnt vmcnt(10)
  s_waitcnt lgkmcnt(0)
  s_barrier
  s_add_u32 m0, s92, 114688
  s_nop 0
  global_load_lds_dwordx4 v24, s[12:13]
  s_add_u32 m0, s92, 118784
  s_nop 0
  global_load_lds_dwordx4 v25, s[12:13]
  s_add_u32 m0, s92, 122880
  s_nop 0
  global_load_lds_dwordx4 v26, s[12:13]
  s_add_u32 s12, s12, 393216
  s_addc_u32 s13, s13, 0
  s_add_u32 m0, s92, 126976
  s_nop 0
  global_load_lds_dwordx4 v24, s[12:13]
  s_add_u32 m0, s92, 131072
  s_nop 0
  global_load_lds_dwordx4 v25, s[12:13]
  s_add_u32 m0, s92, 135168
  s_nop 0
  global_load_lds_dwordx4 v26, s[12:13]
  s_add_u32 s12, s12, 393216
  s_addc_u32 s13, s13, 0
  s_add_u32 m0, s92, 139264
  s_nop 0
  global_load_lds_dwordx4 v24, s[12:13]
  s_add_u32 m0, s92, 143360
  s_nop 0
  global_load_lds_dwordx4 v25, s[12:13]
  s_add_u32 m0, s92, 147456
  s_nop 0
  global_load_lds_dwordx4 v26, s[12:13]
  s_add_u32 s12, s12, 393216
  s_addc_u32 s13, s13, 0
  s_add_u32 m0, s92, 151552
  s_nop 0
  global_load_lds_dwordx4 v24, s[12:13]
  s_add_u32 m0, s92, 155648
  s_nop 0
  global_load_lds_dwordx4 v25, s[12:13]
  s_add_u32 m0, s92, 159744
  s_nop 0
  global_load_lds_dwordx4 v26, s[12:13]
  s_add_u32 s12, s12, 393216
  s_addc_u32 s13, s13, 0
  v_add_u32 v52, 0, v40
  ds_read_b64_tr_b16 a[32:33], v52
  ds_read_b64_tr_b16 a[34:35], v52 offset:20480
  v_add_u32 v53, 0, v41
  ds_read_b64_tr_b16 a[56:57], v53
  ds_read_b64_tr_b16 a[58:59], v53 offset:20480
  v_add_u32 v54, 0, v42
  ds_read_b64_tr_b16 a[80:81], v54
  ds_read_b64_tr_b16 a[82:83], v54 offset:20480
  v_add_u32 v55, 0, v43
  ds_read_b64_tr_b16 a[104:105], v55
  ds_read_b64_tr_b16 a[106:107], v55 offset:20480
  v_add_u32 v52, 0, v44
  ds_read_b64_tr_b16 a[128:129], v52
  ds_read_b64_tr_b16 a[130:131], v52 offset:20480
  v_add_u32 v53, 0, v45
  ds_read_b64_tr_b16 a[152:153], v53
  ds_read_b64_tr_b16 a[154:155], v53 offset:20480
  v_add_u32 v54, 0, v46
  ds_read_b64_tr_b16 a[176:177], v54
  ds_read_b64_tr_b16 a[178:179], v54 offset:20480
  v_add_u32 v55, 0, v47
  ds_read_b64_tr_b16 a[200:201], v55
  ds_read_b64_tr_b16 a[202:203], v55 offset:20480
  v_add_u32 v52, 0, v48
  ds_read_b64_tr_b16 a[224:225], v52
  ds_read_b64_tr_b16 a[226:227], v52 offset:20480
  v_add_u32 v53, 0, v49
  ds_read_b64_tr_b16 a[248:249], v53
  ds_read_b64_tr_b16 a[250:251], v53 offset:20480
  s_waitcnt vmcnt(12)
  s_waitcnt lgkmcnt(0)
  s_barrier
  s_add_u32 m0, s92, 0
  s_nop 0
  global_load_lds_dwordx4 v24, s[8:9]
  s_add_u32 m0, s92, 4096
  s_nop 0
  global_load_lds_dwordx4 v25, s[8:9]
  s_add_u32 m0, s92, 8192
  s_nop 0
  global_load_lds_dwordx4 v26, s[8:9]
  s_add_u32 s8, s8, 393216
  s_addc_u32 s9, s9, 0
  s_add_u32 m0, s92, 12288
  s_nop 0
  global_load_lds_dwordx4 v24, s[8:9]
  s_add_u32 m0, s92, 16384
  s_nop 0
  global_load_lds_dwordx4 v25, s[8:9]
  s_add_u32 m0, s92, 20480
  s_nop 0
  global_load_lds_dwordx4 v26, s[8:9]
  s_add_u32 s8, s8, 393216
  s_addc_u32 s9, s9, 0
  s_add_u32 m0, s92, 24576
  s_nop 0
  global_load_lds_dwordx4 v24, s[8:9]
  s_add_u32 m0, s92, 28672
  s_nop 0
  global_load_lds_dwordx4 v25, s[8:9]
  s_add_u32 m0, s92, 32768
  s_nop 0
  global_load_lds_dwordx4 v26, s[8:9]
  s_add_u32 s8, s8, 393216
  s_addc_u32 s9, s9, 0
  v_add_u32 v52, 40960, v40
  ds_read_b64_tr_b16 a[36:37], v52
  ds_read_b64_tr_b16 a[38:39], v52 offset:20480
  v_add_u32 v53, 40960, v41
  ds_read_b64_tr_b16 a[60:61], v53
  ds_read_b64_tr_b16 a[62:63], v53 offset:20480
  v_add_u32 v54, 40960, v42
  ds_read_b64_tr_b16 a[84:85], v54
  ds_read_b64_tr_b16 a[86:87], v54 offset:20480
  v_add_u32 v55, 40960, v43
  ds_read_b64_tr_b16 a[108:109], v55
  ds_read_b64_tr_b16 a[110:111], v55 offset:20480
  v_add_u32 v52, 40960, v44
  ds_read_b64_tr_b16 a[132:133], v52
  ds_read_b64_tr_b16 a[134:135], v52 offset:20480
  v_add_u32 v53, 40960, v45
  ds_read_b64_tr_b16 a[156:157], v53
  ds_read_b64_tr_b16 a[158:159], v53 offset:20480
  v_add_u32 v54, 40960, v46
  ds_read_b64_tr_b16 a[180:181], v54
  ds_read_b64_tr_b16 a[182:183], v54 offset:20480
  v_add_u32 v55, 40960, v47
  ds_read_b64_tr_b16 a[204:205], v55
  ds_read_b64_tr_b16 a[206:207], v55 offset:20480
  v_add_u32 v52, 40960, v48
  ds_read_b64_tr_b16 a[228:229], v52
  ds_read_b64_tr_b16 a[230:231], v52 offset:20480
  v_add_u32 v53, 40960, v49
  ds_read_b64_tr_b16 a[252:253], v53
  ds_read_b64_tr_b16 a[254:255], v53 offset:20480
  s_waitcnt vmcnt(3)
  s_waitcnt lgkmcnt(0)
  s_barrier
  s_add_u32 m0, s92, 36864
  s_nop 0
  global_load_lds_dwordx4 v24, s[8:9]
  s_add_u32 m0, s92, 40960
  s_nop 0
  global_load_lds_dwordx4 v25, s[8:9]
  s_add_u32 m0, s92, 45056
  s_nop 0
  global_load_lds_dwordx4 v26, s[8:9]
  s_add_u32 s8, s8, 393216
  s_addc_u32 s9, s9, 0
  s_add_u32 m0, s92, 49152
  s_nop 0
  global_load_lds_dwordx4 v24, s[8:9]
  s_add_u32 m0, s92, 53248
  s_nop 0
  global_load_lds_dwordx4 v25, s[8:9]
  s_add_u32 m0, s92, 57344
  s_nop 0
  global_load_lds_dwordx4 v26, s[8:9]
  s_add_u32 s8, s8, 393216
  s_addc_u32 s9, s9, 0
  s_add_u32 m0, s92, 61440
  s_nop 0
  global_load_lds_dwordx4 v24, s[8:9]
  s_add_u32 m0, s92, 65536
  s_nop 0
  global_load_lds_dwordx4 v25, s[8:9]
  s_add_u32 m0, s92, 69632
  s_nop 0
  global_load_lds_dwordx4 v26, s[8:9]
  s_add_u32 s8, s8, 393216
  s_addc_u32 s9, s9, 0
  s_add_u32 m0, s92, 73728
  s_nop 0
  global_load_lds_dwordx4 v24, s[8:9]
  s_add_u32 m0, s92, 77824
  s_nop 0
  global_load_lds_dwordx4 v25, s[8:9]
  s_add_u32 m0, s92, 81920
  s_nop 0
  global_load_lds_dwordx4 v26, s[8:9]
  s_add_u32 s8, s8, 393216
  s_addc_u32 s9, s9, 0
  s_add_u32 m0, s92, 86016
  s_nop 0
  global_load_lds_dwordx4 v24, s[8:9]
  s_add_u32 m0, s92, 90112
  s_nop 0
  global_load_lds_dwordx4 v25, s[8:9]
  s_add_u32 m0, s92, 94208
  s_nop 0
  global_load_lds_dwordx4 v26, s[8:9]
  s_add_u32 s8, s8, 393216
  s_addc_u32 s9, s9, 0
  s_add_u32 m0, s92, 98304
  s_nop 0
  global_load_lds_dwordx4 v24, s[8:9]
  s_add_u32 m0, s92, 102400
  s_nop 0
  global_load_lds_dwordx4 v25, s[8:9]
  s_add_u32 m0, s92, 106496
  s_nop 0
  global_load_lds_dwordx4 v26, s[8:9]
  s_add_u32 s8, s8, 393216
  s_addc_u32 s9, s9, 0
  v_add_u32 v52, 0, v8
  ds_read_b64_tr_b16 v[80:81], v52
  ds_read_b64_tr_b16 v[82:83], v52 offset:6144
  v_add_u32 v53, 0, v9
  ds_read_b64_tr_b16 v[144:145], v53
  ds_read_b64_tr_b16 v[146:147], v53 offset:6144
  v_add_u32 v54, 0, v10
  ds_read_b64_tr_b16 v[208:209], v54
  ds_read_b64_tr_b16 v[210:211], v54 offset:6144
  v_add_u32 v55, 12288, v8
  ds_read_b64_tr_b16 v[84:85], v55
  ds_read_b64_tr_b16 v[86:87], v55 offset:6144
  v_add_u32 v52, 12288, v9
  ds_read_b64_tr_b16 v[148:149], v52
  ds_read_b64_tr_b16 v[150:151], v52 offset:6144
  v_add_u32 v53, 12288, v10
  ds_read_b64_tr_b16 v[212:213], v53
  ds_read_b64_tr_b16 v[214:215], v53 offset:6144
  s_waitcnt vmcnt(15)
  s_waitcnt lgkmcnt(0)
  s_barrier
  s_add_u32 m0, s92, 0
  s_nop 0
  global_load_lds_dwordx4 v24, s[8:9]
  s_add_u32 m0, s92, 4096
  s_nop 0
  global_load_lds_dwordx4 v25, s[8:9]
  s_add_u32 m0, s92, 8192
  s_nop 0
  global_load_lds_dwordx4 v26, s[8:9]
  s_add_u32 s8, s8, 393216
  s_addc_u32 s9, s9, 0
  s_add_u32 m0, s92, 12288
  s_nop 0
  global_load_lds_dwordx4 v24, s[8:9]
  s_add_u32 m0, s92, 16384
  s_nop 0
  global_load_lds_dwordx4 v25, s[8:9]
  s_add_u32 m0, s92, 20480
  s_nop 0
  global_load_lds_dwordx4 v26, s[8:9]
  s_add_u32 s8, s8, 393216
  s_addc_u32 s9, s9, 0
  v_add_u32 v52, 24576, v8
  ds_read_b64_tr_b16 v[88:89], v52
  ds_read_b64_tr_b16 v[90:91], v52 offset:6144
  v_add_u32 v53, 24576, v9
  ds_read_b64_tr_b16 v[152:153], v53
  ds_read_b64_tr_b16 v[154:155], v53 offset:6144
  v_add_u32 v54, 24576, v10
  ds_read_b64_tr_b16 v[216:217], v54
  ds_read_b64_tr_b16 v[218:219], v54 offset:6144
  v_add_u32 v55, 36864, v8
  ds_read_b64_tr_b16 v[92:93], v55
  ds_read_b64_tr_b16 v[94:95], v55 offset:6144
  v_add_u32 v52, 36864, v9
  ds_read_b64_tr_b16 v[156:157], v52
  ds_read_b64_tr_b16 v[158:159], v52 offset:6144
  v_add_u32 v53, 36864, v10
  ds_read_b64_tr_b16 v[220:221], v53
  ds_read_b64_tr_b16 v[222:223], v53 offset:6144
  s_waitcnt vmcnt(15)
  s_waitcnt lgkmcnt(0)
  s_barrier
  s_add_u32 m0, s92, 24576
  s_nop 0
  global_load_lds_dwordx4 v24, s[8:9]
  s_add_u32 m0, s92, 28672
  s_nop 0
  global_load_lds_dwordx4 v25, s[8:9]
  s_add_u32 m0, s92, 32768
  s_nop 0
  global_load_lds_dwordx4 v26, s[8:9]
  s_add_u32 s8, s8, 393216
  s_addc_u32 s9, s9, 0
  s_add_u32 m0, s92, 36864
  s_nop 0
  global_load_lds_dwordx4 v24, s[8:9]
  s_add_u32 m0, s92, 40960
  s_nop 0
  global_load_lds_dwordx4 v25, s[8:9]
  s_add_u32 m0, s92, 45056
  s_nop 0
  global_load_lds_dwordx4 v26, s[8:9]
  s_add_u32 s8, s8, 393216
  s_addc_u32 s9, s9, 0
  v_add_u32 v52, 49152, v8
  ds_read_b64_tr_b16 v[96:97], v52
  ds_read_b64_tr_b16 v[98:99], v52 offset:6144
  v_add_u32 v53, 49152, v9
  ds_read_b64_tr_b16 v[160:161], v53
  ds_read_b64_tr_b16 v[162:163], v53 offset:6144
  v_add_u32 v54, 49152, v10
  ds_read_b64_tr_b16 v[224:225], v54
  ds_read_b64_tr_b16 v[226:227], v54 offset:6144
  v_add_u32 v55, 61440, v8
  ds_read_b64_tr_b16 v[100:101], v55
  ds_read_b64_tr_b16 v[102:103], v55 offset:6144
  v_add_u32 v52, 61440, v9
  ds_read_b64_tr_b16 v[164:165], v52
  ds_read_b64_tr_b16 v[166:167], v52 offset:6144
  v_add_u32 v53, 61440, v10
  ds_read_b64_tr_b16 v[228:229], v53
  ds_read_b64_tr_b16 v[230:231], v53 offset:6144
  s_waitcnt vmcnt(15)
  s_waitcnt lgkmcnt(0)
  s_barrier
  s_add_u32 m0, s92, 49152
  s_nop 0
  global_load_lds_dwordx4 v24, s[8:9]
  s_add_u32 m0, s92, 53248
  s_nop 0
  global_load_lds_dwordx4 v25, s[8:9]
  s_add_u32 m0, s92, 57344
  s_nop 0
  global_load_lds_dwordx4 v26, s[8:9]
  s_add_u32 s8, s8, 393216
  s_addc_u32 s9, s9, 0
  s_add_u32 m0, s92, 61440
  s_nop 0
  global_load_lds_dwordx4 v24, s[8:9]
  s_add_u32 m0, s92, 65536
  s_nop 0
  global_load_lds_dwordx4 v25, s[8:9]
  s_add_u32 m0, s92, 69632
  s_nop 0
  global_load_lds_dwordx4 v26, s[8:9]
  s_add_u32 s8, s8, 393216
  s_addc_u32 s9, s9, 0
  v_add_u32 v52, 73728, v8
  ds_read_b64_tr_b16 v[104:105], v52
  ds_read_b64_tr_b16 v[106:107], v52 offset:6144
  v_add_u32 v53, 73728, v9
  ds_read_b64_tr_b16 v[168:169], v53
  ds_read_b64_tr_b16 v[170:171], v53 offset:6144
  v_add_u32 v54, 73728, v10
  ds_read_b64_tr_b16 v[232:233], v54
  ds_read_b64_tr_b16 v[234:235], v54 offset:6144
  v_add_u32 v55, 86016, v8
  ds_read_b64_tr_b16 v[108:109], v55
  ds_read_b64_tr_b16 v[110:111], v55 offset:6144
  v_add_u32 v52, 86016, v9
  ds_read_b64_tr_b16 v[172:173], v52
  ds_read_b64_tr_b16 v[174:175], v52 offset:6144
  v_add_u32 v53, 86016, v10
  ds_read_b64_tr_b16 v[236:237], v53
  ds_read_b64_tr_b16 v[238:239], v53 offset:6144
  s_waitcnt vmcnt(15)
  s_waitcnt lgkmcnt(0)
  s_barrier
  s_add_u32 m0, s92, 73728
  s_nop 0
  global_load_lds_dwordx4 v24, s[8:9]
  s_add_u32 m0, s92, 77824
  s_nop 0
  global_load_lds_dwordx4 v25, s[8:9]
  s_add_u32 m0, s92, 81920
  s_nop 0
  global_load_lds_dwordx4 v26, s[8:9]
  s_add_u32 s8, s8, 393216
  s_addc_u32 s9, s9, 0
  v_add_u32 v52, 98304, v8
  ds_read_b64_tr_b16 v[112:113], v52
  ds_read_b64_tr_b16 v[114:115], v52 offset:6144
  v_add_u32 v53, 98304, v9
  ds_read_b64_tr_b16 v[176:177], v53
  ds_read_b64_tr_b16 v[178:179], v53 offset:6144
  v_add_u32 v54, 98304, v10
  ds_read_b64_tr_b16 v[240:241], v54
  ds_read_b64_tr_b16 v[242:243], v54 offset:6144
  v_add_u32 v55, 0, v8
  ds_read_b64_tr_b16 v[116:117], v55
  ds_read_b64_tr_b16 v[118:119], v55 offset:6144
  v_add_u32 v52, 0, v9
  ds_read_b64_tr_b16 v[180:181], v52
  ds_read_b64_tr_b16 v[182:183], v52 offset:6144
  v_add_u32 v53, 0, v10
  ds_read_b64_tr_b16 v[244:245], v53
  ds_read_b64_tr_b16 v[246:247], v53 offset:6144
  s_waitcnt vmcnt(12)
  s_waitcnt lgkmcnt(0)
  s_barrier
  v_add_u32 v52, 12288, v8
  ds_read_b64_tr_b16 v[120:121], v52
  ds_read_b64_tr_b16 v[122:123], v52 offset:6144
  v_add_u32 v53, 12288, v9
  ds_read_b64_tr_b16 v[184:185], v53
  ds_read_b64_tr_b16 v[186:187], v53 offset:6144
  v_add_u32 v54, 12288, v10
  ds_read_b64_tr_b16 v[248:249], v54
  ds_read_b64_tr_b16 v[250:251], v54 offset:6144
  v_add_u32 v55, 24576, v8
  ds_read_b64_tr_b16 v[124:125], v55
  ds_read_b64_tr_b16 v[126:127], v55 offset:6144
  v_add_u32 v52, 24576, v9
  ds_read_b64_tr_b16 v[188:189], v52
  ds_read_b64_tr_b16 v[190:191], v52 offset:6144
  v_add_u32 v53, 24576, v10
  ds_read_b64_tr_b16 v[252:253], v53
  ds_read_b64_tr_b16 v[254:255], v53 offset:6144
  s_waitcnt vmcnt(6)
  s_waitcnt lgkmcnt(0)
  s_barrier
  v_add_u32 v52, 36864, v8
  ds_read_b64_tr_b16 v[128:129], v52
  ds_read_b64_tr_b16 v[130:131], v52 offset:6144
  v_add_u32 v53, 36864, v9
  ds_read_b64_tr_b16 v[192:193], v53
  ds_read_b64_tr_b16 v[194:195], v53 offset:6144
  v_add_u32 v54, 36864, v10
  ds_read_b64_tr_b16 a[0:1], v54
  ds_read_b64_tr_b16 a[2:3], v54 offset:6144
  v_add_u32 v55, 49152, v8
  ds_read_b64_tr_b16 v[132:133], v55
  ds_read_b64_tr_b16 v[134:135], v55 offset:6144
  v_add_u32 v52, 49152, v9
  ds_read_b64_tr_b16 v[196:197], v52
  ds_read_b64_tr_b16 v[198:199], v52 offset:6144
  v_add_u32 v53, 49152, v10
  ds_read_b64_tr_b16 a[4:5], v53
  ds_read_b64_tr_b16 a[6:7], v53 offset:6144
  s_waitcnt vmcnt(0)
  s_waitcnt lgkmcnt(0)
  s_barrier
  v_add_u32 v52, 61440, v8
  ds_read_b64_tr_b16 v[136:137], v52
  ds_read_b64_tr_b16 v[138:139], v52 offset:6144
  v_add_u32 v53, 61440, v9
  ds_read_b64_tr_b16 v[200:201], v53
  ds_read_b64_tr_b16 v[202:203], v53 offset:6144
  v_add_u32 v54, 61440, v10
  ds_read_b64_tr_b16 a[8:9], v54
  ds_read_b64_tr_b16 a[10:11], v54 offset:6144
  v_add_u32 v55, 73728, v8
  ds_read_b64_tr_b16 v[140:141], v55
  ds_read_b64_tr_b16 v[142:143], v55 offset:6144
  v_add_u32 v52, 73728, v9
  ds_read_b64_tr_b16 v[204:205], v52
  ds_read_b64_tr_b16 v[206:207], v52 offset:6144
  v_add_u32 v53, 73728, v10
  ds_read_b64_tr_b16 a[12:13], v53
  ds_read_b64_tr_b16 a[14:15], v53 offset:6144
  s_waitcnt lgkmcnt(0)
  s_barrier
  v_add_u32 v8, 114688, v8
  v_add_u32 v9, 114688, v9
  v_add_u32 v10, 114688, v10
  v_mov_b32 v3, 0x4444
  v_mov_b32 v20, 0xeeee
  v_and_b32 v21, 2, v1
  v_cmp_ne_u32 vcc, 0, v21
  s_nop 1
  v_cndmask_b32 v3, v3, v20, vcc
  s_mul_i32 s67, s3, 3072
  s_cmp_eq_u32 s3, 3
  s_cselect_b32 s67, 8192, s67
  s_mul_i32 s48, s3, 10
  v_min_u32 v2, 9, v1
  v_add_u32 v2, s48, v2
  v_lshlrev_b32 v2, 8, v2
  v_lshlrev_b32 v4, 4, v1
  v_add_u32 v4, s67, v4
  v_bfe_u32 v20, v1, 5, 1
  v_lshlrev_b32 v5, 9, v20
  v_bfe_u32 v20, v1, 3, 1
  v_lshl_add_u32 v5, v20, 8, v5
  v_bfe_u32 v20, v1, 3, 1
  v_lshl_add_u32 v5, v20, 4, v5
  v_bfe_u32 v20, v1, 0, 1
  v_lshl_add_u32 v5, v20, 6, v5
  v_bfe_u32 v20, v1, 1, 1
  v_lshl_add_u32 v5, v20, 7, v5
  v_bfe_u32 v20, v1, 4, 1
  v_lshl_add_u32 v5, v20, 5, v5
  v_bfe_u32 v20, v1, 2, 1
  v_lshl_add_u32 v5, v20, 3, v5
  v_add_u32 v5, 0, v5
  v_xor_b32 v14, 16, v5
  v_bfe_u32 v20, v1, 1, 4
  v_lshlrev_b32 v20, 2, v20
  v_lshl_add_u32 v6, v1, 6, v20
  v_add_u32 v6, 0, v6
  v_add_u32 v7, 4096, v6
  v_and_b32 v21, 31, v1
  v_lshl_add_u32 v18, v21, 6, v20
  v_add_u32 v18, 8192, v18
  v_lshlrev_b32 v15, 4, v1
  v_bfe_u32 v20, v1, 4, 1
  v_lshlrev_b32 v19, 6, v20
  v_bfe_u32 v20, v1, 5, 1
  v_lshl_add_u32 v19, v20, 7, v19
  v_bfe_u32 v20, v1, 3, 1
  v_lshl_add_u32 v19, v20, 5, v19
  v_bfe_u32 v20, v1, 2, 1
  v_lshl_add_u32 v19, v20, 4, v19
  v_bfe_u32 v20, v1, 0, 1
  v_lshl_add_u32 v19, v20, 3, v19
  v_bfe_u32 v20, v1, 1, 1
  v_lshl_add_u32 v19, v20, 2, v19
  s_mul_i32 s48, s3, 768
  s_add_u32 s48, s48, 20480
  v_add_u32 v19, s48, v19
  s_and_b32 s48, s3, 1
  s_lshl_b32 s48, s48, 4
  v_xor_b32 v19, s48, v19
  v_xor_b32 v16, 16, v19
  s_mul_i32 s48, s40, 81920
  s_mul_i32 s49, s3, 20480
  s_add_u32 s48, s48, s49
  s_lshl_b32 s49, s41, 9
  s_add_u32 s80, s48, s49
  s_add_u32 s80, s80, 0x1801000
  v_lshlrev_b32 v17, 3, v1
  s_mov_b32 s78, 0xfffefffe
  v_mov_b32 v24, -1
  v_mov_b32 v25, -1
  v_mov_b32 v26, -1
  v_mov_b32 v27, -1
  v_lshlrev_b32 v28, 4, v0
  v_add_u32 v28, 0, v28
  ds_write_b128 v28, v[24:27] offset:0
  ds_write_b128 v28, v[24:27] offset:4096
  ds_write_b128 v28, v[24:27] offset:8192
  ds_write_b128 v28, v[24:27] offset:12288
  ds_write_b128 v28, v[24:27] offset:16384
  s_cmp_lg_u32 s3, 0
  s_cbranch_scc1 OW_30
  s_lshl_b32 s49, s40, 2
  v_mov_b32 v20, s49
  v_mov_b32 v21, 32
HR_31:
  global_load_dword v22, v20, s[6:7] sc1
  global_load_dwordx2 v[24:25], v21, s[6:7] sc1
  s_waitcnt vmcnt(0)
  v_readfirstlane_b32 s48, v22
  v_readfirstlane_b32 s50, v24
  v_readfirstlane_b32 s57, v25
  s_and_b32 s49, s48, 0xff
  s_cmp_lg_u32 s49, 31
  s_cbranch_scc1 HS_33
  s_cmp_eq_u32 s50, 64
  s_cbranch_scc1 HD_32
HS_33:
  s_sleep 24
  s_add_u32 s66, s66, 1
  s_cmp_lt_u32 s66, 2097152
  s_cbranch_scc1 HR_31
  s_branch K2_abort
HD_32:
  s_bfe_u32 s49, s48, 0x80008
  s_mul_i32 s49, s49, s49
  s_lshr_b32 s48, s48, 16
  s_mul_i32 s48, s48, 31
  s_cmp_eq_u32 s48, s49
  s_cselect_b32 s43, 1, 0
OW_30:
  s_barrier
  s_lshl_b32 s49, s40, 2
  v_mov_b32 v20, s49
  v_mov_b32 v21, 32
HR_34:
  global_load_dword v22, v20, s[6:7] sc1
  global_load_dwordx2 v[24:25], v21, s[6:7] sc1
  s_waitcnt vmcnt(0)
  v_readfirstlane_b32 s48, v22
  v_readfirstlane_b32 s50, v24
  v_readfirstlane_b32 s57, v25
  s_and_b32 s49, s48, 0xff
  s_cmp_lg_u32 s49, 31
  s_cbranch_scc1 HS_36
  s_cmp_eq_u32 s50, 64
  s_cbranch_scc1 HD_35
HS_36:
  s_sleep 8
  s_add_u32 s66, s66, 1
  s_cmp_lt_u32 s66, 2097152
  s_cbranch_scc1 HR_34
  s_branch K2_abort
HD_35:
  s_bfe_u32 s49, s48, 0x80008
  s_mul_i32 s49, s49, s49
  s_lshr_b32 s48, s48, 16
  s_mul_i32 s48, s48, 31
  s_cmp_eq_u32 s48, s49
  s_cselect_b32 s43, 1, 0
  s_mul_i32 s59, s40, 10240
  s_add_u32 s59, s59, 0x1000000
  s_add_u32 s60, s4, s59
  s_addc_u32 s61, s5, 0
  s_mov_b32 s45, 0
  s_mov_b32 s44, 0
  s_waitcnt vmcnt(0) lgkmcnt(0)
  s_barrier
VO_step:
  v_mov_b32 v40, 0
  v_mov_b32 v41, 0
  v_mov_b32 v42, 0
  v_mov_b32 v43, 0
  v_mov_b32 v68, 0
  v_mov_b32 v69, 0
  v_mov_b32 v70, 0
  v_mov_b32 v71, 0
  v_mov_b32 v72, 0
  v_mov_b32 v73, 0
  v_mov_b32 v74, 0
  v_mov_b32 v75, 0
  v_mov_b32 v76, 0
  v_mov_b32 v77, 0
  v_mov_b32 v78, 0
  v_mov_b32 v79, 0
  ds_read_b64_tr_b16 v[44:45], v8 offset:0
  ds_read_b64_tr_b16 v[46:47], v8 offset:6144
  ds_read_b64_tr_b16 v[48:49], v8 offset:12288
  ds_read_b64_tr_b16 v[50:51], v8 offset:18432
  ds_read_b64_tr_b16 v[52:53], v9 offset:0
  ds_read_b64_tr_b16 v[54:55], v9 offset:6144
  ds_read_b64_tr_b16 v[56:57], v9 offset:12288
  ds_read_b64_tr_b16 v[58:59], v9 offset:18432
  ds_read_b64_tr_b16 v[60:61], v10 offset:0
  ds_read_b64_tr_b16 v[62:63], v10 offset:6144
  ds_read_b64_tr_b16 v[64:65], v10 offset:12288
  ds_read_b64_tr_b16 v[66:67], v10 offset:18432
  s_lshl_b32 s48, s45, 5
  s_add_u32 s48, s48, s80
  s_add_u32 s24, s4, s48
  s_addc_u32 s25, s5, 0
  s_add_u32 s48, s48, 8192
  s_add_u32 s26, s4, s48
  s_addc_u32 s27, s5, 0
  s_add_u32 s48, s48, 8192
  s_add_u32 s28, s4, s48
  s_addc_u32 s29, s5, 0
  s_add_u32 s48, s48, 8192
  s_sub_u32 s81, 20480, s45
  s_add_u32 s48, s45, s67
  s_add_u32 m0, s48, 0
  s_nop 0
  s_cmp_ge_u32 s44, 2
  s_cbranch_scc1 VO_lg
VO_lp:
  global_load_dword v23, v2, s[60:61] sc1
  s_waitcnt vmcnt(0)
  v_cmp_ne_u32 vcc, -1, v23
  s_cbranch_vccnz VO_lg
  s_sleep 8
  s_add_u32 s66, s66, 1
  s_cmp_lt_u32 s66, 2097152
  s_cbranch_scc1 VO_lp
  s_branch K2_abort
VO_lg:
VO_poll:
  global_load_lds_dwordx4 v4, s[60:61] sc1
  global_load_lds_dwordx4 v4, s[60:61] offset:1024 sc1
  s_cmp_ge_u32 s3, 2
  s_cbranch_scc1 VO_n3
  global_load_lds_dwordx4 v4, s[60:61] offset:2048 sc1
VO_n3:
  ds_read_b32 v20, v6
  ds_read_b32 v21, v7
  ds_read_b32 v22, v18
  ds_read_b64_tr_b16 v[24:25], v5 offset:8192
  ds_read_b64_tr_b16 v[26:27], v14 offset:8192
  ds_read_b64_tr_b16 v[28:29], v5 offset:0
  ds_read_b64_tr_b16 v[30:31], v14 offset:0
  ds_read_b64_tr_b16 v[32:33], v5 offset:1024
  ds_read_b64_tr_b16 v[34:35], v14 offset:1024
  s_waitcnt lgkmcnt(6)
  v_max3_u32 v20, v20, v21, v22
  v_cmp_eq_u32 vcc, -1, v20
  s_cbranch_vccz VO_go
  s_waitcnt vmcnt(3)
  s_add_u32 s66, s66, 1
  s_cmp_lt_u32 s66, 2097152
  s_cbranch_scc1 VO_poll
  s_branch K2_abort
VO_go:
  s_waitcnt lgkmcnt(4)
  v_smfmac_f32_16x16x64_bf16 v[68:71], v[24:27], v[44:51], v3
  ds_read_b64_tr_b16 v[36:37], v5 offset:2048
  ds_read_b64_tr_b16 v[38:39], v14 offset:2048
  v_smfmac_f32_16x16x64_bf16 v[72:75], v[24:27], v[52:59], v3
  ds_read_b64_tr_b16 v[44:45], v8 offset:24576
  ds_read_b64_tr_b16 v[46:47], v8 offset:30720
  v_smfmac_f32_16x16x64_bf16 v[76:79], v[24:27], v[60:67], v3
  ds_read_b64_tr_b16 v[48:49], v8 offset:36864
  ds_read_b64_tr_b16 v[50:51], v8 offset:43008
  s_waitcnt lgkmcnt(8)
  v_smfmac_f32_16x16x64_bf16 v[68:71], v[28:31], v[80:87], v3
  ds_read_b64_tr_b16 v[24:25], v5 offset:3072
  ds_read_b64_tr_b16 v[26:27], v14 offset:3072
  v_smfmac_f32_16x16x64_bf16 v[72:75], v[28:31], v[144:151], v3
  ds_read_b64_tr_b16 v[52:53], v9 offset:24576
  ds_read_b64_tr_b16 v[54:55], v9 offset:30720
  v_smfmac_f32_16x16x64_bf16 v[76:79], v[28:31], v[208:215], v3
  ds_read_b64_tr_b16 v[56:57], v9 offset:36864
  ds_read_b64_tr_b16 v[58:59], v9 offset:43008
  s_waitcnt lgkmcnt(12)
  v_smfmac_f32_16x16x64_bf16 v[68:71], v[32:35], v[88:95], v3
  ds_read_b64_tr_b16 v[28:29], v5 offset:9216
  ds_read_b64_tr_b16 v[30:31], v14 offset:9216
  v_smfmac_f32_16x16x64_bf16 v[72:75], v[32:35], v[152:159], v3
  ds_read_b64_tr_b16 v[60:61], v10 offset:24576
  ds_read_b64_tr_b16 v[62:63], v10 offset:30720
  v_smfmac_f32_16x16x64_bf16 v[76:79], v[32:35], v[216:223], v3
  ds_read_b64_tr_b16 v[64:65], v10 offset:36864
  s_waitcnt lgkmcnt(15)
  v_smfmac_f32_16x16x64_bf16 v[68:71], v[36:39], v[96:103], v3
  ds_read_b64_tr_b16 v[32:33], v5 offset:4096
  ds_read_b64_tr_b16 v[34:35], v14 offset:4096
  v_smfmac_f32_16x16x64_bf16 v[72:75], v[36:39], v[160:167], v3
  ds_read_b64_tr_b16 v[66:67], v10 offset:43008
  v_smfmac_f32_16x16x64_bf16 v[76:79], v[36:39], v[224:231], v3
  s_waitcnt lgkmcnt(12)
  v_smfmac_f32_16x16x64_bf16 v[68:71], v[24:27], v[104:111], v3
  ds_read_b64_tr_b16 v[36:37], v5 offset:5120
  v_smfmac_f32_16x16x64_bf16 v[72:75], v[24:27], v[168:175], v3
  ds_read_b64_tr_b16 v[38:39], v14 offset:5120
  v_smfmac_f32_16x16x64_bf16 v[76:79], v[24:27], v[232:239], v3
  s_waitcnt lgkmcnt(8)
  v_smfmac_f32_16x16x64_bf16 v[68:71], v[28:31], v[44:51], v3
  ds_read_b64_tr_b16 v[24:25], v5 offset:6144
  v_smfmac_f32_16x16x64_bf16 v[72:75], v[28:31], v[52:59], v3
  ds_read_b64_tr_b16 v[26:27], v14 offset:6144
  s_waitcnt lgkmcnt(4)
  v_smfmac_f32_16x16x64_bf16 v[76:79], v[28:31], v[60:67], v3
  v_smfmac_f32_16x16x64_bf16 v[68:71], v[32:35], v[112:119], v3
  ds_read_b64_tr_b16 v[28:29], v5 offset:7168
  v_mov_b32 v44, 0
  v_smfmac_f32_16x16x64_bf16 v[72:75], v[32:35], v[176:183], v3
  ds_read_b64_tr_b16 v[30:31], v14 offset:7168
  v_mov_b32 v45, 0
  v_smfmac_f32_16x16x64_bf16 v[76:79], v[32:35], v[240:247], v3
  v_mov_b32 v46, 0
  s_waitcnt lgkmcnt(4)
  v_smfmac_f32_16x16x64_bf16 v[68:71], v[36:39], v[120:127], v3
  v_mov_b32 v47, 0
  v_smfmac_f32_16x16x64_bf16 v[72:75], v[36:39], v[184:191], v3
  v_mov_b32 v48, 0
  v_smfmac_f32_16x16x64_bf16 v[76:79], v[36:39], v[248:255], v3
  v_mov_b32 v49, 0
  s_waitcnt lgkmcnt(2)
  v_smfmac_f32_16x16x64_bf16 v[68:71], v[24:27], v[128:135], v3
  v_mov_b32 v50, 0
  v_smfmac_f32_16x16x64_bf16 v[72:75], v[24:27], v[192:199], v3
  v_mov_b32 v51, 0
  v_smfmac_f32_16x16x64_bf16 v[76:79], v[24:27], a[0:7], v3
  v_mov_b32 v52, 0
  s_waitcnt lgkmcnt(0)
  v_smfmac_f32_16x16x64_bf16 v[68:71], v[28:31], v[136:143], v3
  v_mov_b32 v53, 0
  v_smfmac_f32_16x16x64_bf16 v[72:75], v[28:31], v[200:207], v3
  v_mov_b32 v54, 0
  v_smfmac_f32_16x16x64_bf16 v[76:79], v[28:31], a[8:15], v3
  v_mov_b32 v55, 0
  v_add_u32 v11, s81, v5
  v_add_u32 v12, s81, v14
  v_mov_b32 v56, 0
  v_mov_b32 v57, 0
  v_mov_b32 v58, 0
  v_mov_b32 v59, 0
  v_mov_b32 v60, 0
  v_mov_b32 v61, 0
  v_pk_add_f32 v[68:69], v[68:69], v[70:71]
  v_pk_add_f32 v[72:73], v[72:73], v[74:75]
  v_pk_add_f32 v[76:77], v[76:77], v[78:79]
  v_cvt_pk_bf16_f32 v20, v68, v69
  v_cvt_pk_bf16_f32 v21, v72, v73
  v_cvt_pk_bf16_f32 v22, v76, v77
  ds_write_b32 v19, v20 offset:0
  ds_write_b32 v16, v21 offset:256
  ds_write_b32 v19, v22 offset:512
  v_cmp_u_f32 vcc, v68, v69
  s_cbranch_vccnz VO_nan
VO_nanc:
  s_waitcnt vmcnt(0) lgkmcnt(0)
  s_barrier
  s_cmp_eq_u32 s43, 0
  s_cbranch_scc1 VO_slow
  ds_read_b64_tr_b16 v[24:25], v11 offset:0
  ds_read_b64_tr_b16 v[26:27], v12 offset:0
  ds_read_b64_tr_b16 v[28:29], v11 offset:1024
  ds_read_b64_tr_b16 v[30:31], v12 offset:1024
  ds_read_b64_tr_b16 v[32:33], v11 offset:2048
  ds_read_b64_tr_b16 v[34:35], v12 offset:2048
  v_mov_b32 v62, 0
  v_mov_b32 v63, 0
  v_mov_b32 v64, 0
  v_mov_b32 v65, 0
  v_mov_b32 v66, 0
  v_mov_b32 v67, 0
  v_mov_b32 v68, 0
  v_mov_b32 v69, 0
  v_mov_b32 v70, 0
  v_mov_b32 v71, 0
  v_mov_b32 v72, 0
  v_mov_b32 v73, 0
  v_mov_b32 v74, 0
  v_mov_b32 v75, 0
  v_mov_b32 v76, 0
  v_mov_b32 v77, 0
  v_mov_b32 v78, 0
  v_mov_b32 v79, 0
  s_waitcnt lgkmcnt(4)
  v_smfmac_f32_16x16x64_bf16 v[40:43], v[24:27], a[16:23], v3
  v_smfmac_f32_16x16x64_bf16 v[44:47], v[24:27], a[40:47], v3
  s_waitcnt lgkmcnt(2)
  v_smfmac_f32_16x16x64_bf16 v[40:43], v[28:31], a[24:31], v3
  v_smfmac_f32_16x16x64_bf16 v[44:47], v[28:31], a[48:55], v3
  s_waitcnt lgkmcnt(0)
  v_smfmac_f32_16x16x64_bf16 v[40:43], v[32:35], a[32:39], v3
  v_smfmac_f32_16x16x64_bf16 v[44:47], v[32:35], a[56:63], v3
  v_smfmac_f32_16x16x64_bf16 v[48:51], v[24:27], a[64:71], v3
  v_smfmac_f32_16x16x64_bf16 v[52:55], v[24:27], a[88:95], v3
  v_smfmac_f32_16x16x64_bf16 v[48:51], v[28:31], a[72:79], v3
  s_nop 0
  v_smfmac_f32_16x16x64_bf16 v[52:55], v[28:31], a[96:103], v3
  s_nop 0
  v_smfmac_f32_16x16x64_bf16 v[48:51], v[32:35], a[80:87], v3
  s_nop 0
  v_smfmac_f32_16x16x64_bf16 v[52:55], v[32:35], a[104:111], v3
  s_nop 1
  v_smfmac_f32_16x16x64_bf16 v[56:59], v[24:27], a[112:119], v3
  v_add_f32 v40, v40, v42
  v_smfmac_f32_16x16x64_bf16 v[60:63], v[24:27], a[136:143], v3
  v_add_f32 v41, v41, v43
  v_smfmac_f32_16x16x64_bf16 v[56:59], v[28:31], a[120:127], v3
  v_add_f32 v44, v44, v46
  v_cvt_pk_bf16_f32 v20, v40, v41
  v_smfmac_f32_16x16x64_bf16 v[60:63], v[28:31], a[144:151], v3
  v_add_f32 v45, v45, v47
  v_smfmac_f32_16x16x64_bf16 v[56:59], v[32:35], a[128:135], v3
  v_min_u32 v20, -2, v20
  v_cvt_pk_bf16_f32 v21, v44, v45
  v_smfmac_f32_16x16x64_bf16 v[60:63], v[32:35], a[152:159], v3
  v_min_u32 v21, -2, v21
  v_smfmac_f32_16x16x64_bf16 v[64:67], v[24:27], a[160:167], v3
  v_add_f32 v48, v48, v50
  v_smfmac_f32_16x16x64_bf16 v[68:71], v[24:27], a[184:191], v3
  global_store_dwordx2 v17, v[20:21], s[24:25] offset:-4096
  v_add_f32 v49, v49, v51
  v_smfmac_f32_16x16x64_bf16 v[64:67], v[28:31], a[168:175], v3
  v_add_f32 v52, v52, v54
  v_cvt_pk_bf16_f32 v22, v48, v49
  v_smfmac_f32_16x16x64_bf16 v[68:71], v[28:31], a[192:199], v3
  v_add_f32 v53, v53, v55
  v_smfmac_f32_16x16x64_bf16 v[64:67], v[32:35], a[176:183], v3
  v_min_u32 v22, -2, v22
  v_cvt_pk_bf16_f32 v23, v52, v53
  v_smfmac_f32_16x16x64_bf16 v[68:71], v[32:35], a[200:207], v3
  v_min_u32 v23, -2, v23
  v_smfmac_f32_16x16x64_bf16 v[72:75], v[24:27], a[208:215], v3
  v_add_f32 v56, v56, v58
  v_smfmac_f32_16x16x64_bf16 v[76:79], v[24:27], a[232:239], v3
  global_store_dwordx2 v17, v[22:23], s[24:25] offset:0
  v_add_f32 v57, v57, v59
  v_smfmac_f32_16x16x64_bf16 v[72:75], v[28:31], a[216:223], v3
  v_add_f32 v60, v60, v62
  v_cvt_pk_bf16_f32 v20, v56, v57
  v_smfmac_f32_16x16x64_bf16 v[76:79], v[28:31], a[240:247], v3
  v_add_f32 v61, v61, v63
  v_smfmac_f32_16x16x64_bf16 v[72:75], v[32:35], a[224:231], v3
  v_min_u32 v20, -2, v20
  v_cvt_pk_bf16_f32 v21, v60, v61
  v_smfmac_f32_16x16x64_bf16 v[76:79], v[32:35], a[248:255], v3
  v_min_u32 v21, -2, v21
  v_add_f32 v64, v64, v66
  v_add_f32 v65, v65, v67
  v_add_f32 v68, v68, v70
  v_add_f32 v69, v69, v71
  global_store_dwordx2 v17, v[20:21], s[26:27] offset:-4096
  v_cvt_pk_bf16_f32 v22, v64, v65
  v_cvt_pk_bf16_f32 v23, v68, v69
  v_min_u32 v22, -2, v22
  v_min_u32 v23, -2, v23
  v_add_f32 v72, v72, v74
  v_add_f32 v73, v73, v75
  v_add_f32 v76, v76, v78
  v_add_f32 v77, v77, v79
  global_store_dwordx2 v17, v[22:23], s[26:27] offset:0
  v_cvt_pk_bf16_f32 v20, v72, v73
  v_cvt_pk_bf16_f32 v21, v76, v77
  v_min_u32 v20, -2, v20
  v_min_u32 v21, -2, v21
  global_store_dwordx2 v17, v[20:21], s[28:29] offset:-4096
VO_cont:
  s_cmp_lg_u32 s3, 0
  s_cbranch_scc1 VR_37
  v_mov_b32 v20, -1
  v_mov_b32 v21, -1
  v_mov_b32 v22, -1
  v_mov_b32 v23, -1
  ds_write_b128 v15, v[20:23] offset:0
  ds_write_b128 v15, v[20:23] offset:1024
  ds_write_b128 v15, v[20:23] offset:2048
  ds_write_b128 v15, v[20:23] offset:3072
  ds_write_b128 v15, v[20:23] offset:4096
  ds_write_b128 v15, v[20:23] offset:5120
  ds_write_b128 v15, v[20:23] offset:6144
  ds_write_b128 v15, v[20:23] offset:7168
  ds_write_b128 v15, v[20:23] offset:8192
  ds_write_b128 v15, v[20:23] offset:9216
VR_37:
  s_waitcnt lgkmcnt(0)
  s_barrier
  s_add_u32 s44, s44, 1
  s_cmp_ge_u32 s44, 64
  s_cbranch_scc1 VO_done
  s_add_u32 s48, s44, 0
  s_and_b32 s48, s48, 3
  s_mul_i32 s48, s48, 40960
  s_add_u32 s48, s48, s59
  s_add_u32 s60, s4, s48
  s_addc_u32 s61, s5, 0
  s_xor_b32 s45, s45, 10240
  s_lshl_b32 s48, s45, 1
  s_sub_u32 s48, s48, 10240
  v_add_u32 v5, s48, v5
  v_add_u32 v14, s48, v14
  v_add_u32 v6, s48, v6
  v_add_u32 v7, s48, v7
  v_add_u32 v18, s48, v18
  v_add_u32 v15, s48, v15
  s_sleep 14
  s_branch VO_step
VO_done:
  s_endpgm
K2_init:
  s_cmp_eq_u32 s41, 31
  s_cbranch_scc1 K2_init2
  s_load_dwordx2 s[6:7], s[0:1], 96
  s_getreg_b32 s48, hwreg(HW_REG_XCC_ID)
  s_and_b32 s48, s48, 7
  s_mul_i32 s49, s48, s48
  s_lshl_b32 s49, s49, 16
  s_lshl_b32 s48, s48, 8
  s_add_u32 s48, s48, s49
  s_add_u32 s48, s48, 1
  s_lshl_b32 s49, s40, 2
  v_mov_b32 v20, s49
  v_mov_b32 v21, s48
  s_waitcnt lgkmcnt(0)
  s_cmp_lg_u32 s3, 0
  s_cbranch_scc1 HS_38
  s_mov_b64 exec, 1
  global_atomic_add v20, v21, s[6:7] sc1
  s_mov_b64 exec, -1
HS_38:
K2_init2:
  s_load_dwordx4 s[12:15], s[0:1], 0
  s_lshl_b32 s16, s40, 4
  s_add_u32 s16, s16, s41
  s_sub_u32 s16, s16, 16
  s_lshl_b32 s19, s16, 3
  s_lshl_b32 s48, s3, 1
  s_add_u32 s19, s19, s48
  s_waitcnt lgkmcnt(0)
  s_cmp_lg_u32 s41, 31
  s_cbranch_scc1 IN_m0a
  v_add_u32 v3, 0, v0
  v_lshrrev_b32 v4, 6, v3
  v_lshlrev_b32 v5, 4, v4
  v_and_b32 v6, 8, v3
  v_add_u32 v5, v5, v6
  v_lshrrev_b32 v6, 2, v3
  v_xor_b32 v6, v6, v4
  v_and_b32 v6, 1, v6
  v_lshl_add_u32 v5, v6, 2, v5
  v_bfe_u32 v6, v3, 1, 1
  v_add_u32 v5, v5, v6
  v_and_b32 v6, 1, v3
  v_lshl_add_u32 v5, v6, 1, v5
  v_bfe_u32 v6, v3, 4, 2
  v_mul_u32_u24 v6, 2560, v6
  v_lshl_add_u32 v5, v5, 1, v6
  global_load_ushort v120, v5, s[14:15]
  global_load_ushort v121, v5, s[14:15] offset:1280
  v_add_u32 v3, 256, v0
  v_lshrrev_b32 v4, 6, v3
  v_lshlrev_b32 v5, 4, v4
  v_and_b32 v6, 8, v3
  v_add_u32 v5, v5, v6
  v_lshrrev_b32 v6, 2, v3
  v_xor_b32 v6, v6, v4
  v_and_b32 v6, 1, v6
  v_lshl_add_u32 v5, v6, 2, v5
  v_bfe_u32 v6, v3, 1, 1
  v_add_u32 v5, v5, v6
  v_and_b32 v6, 1, v3
  v_lshl_add_u32 v5, v6, 1, v5
  v_bfe_u32 v6, v3, 4, 2
  v_mul_u32_u24 v6, 2560, v6
  v_lshl_add_u32 v5, v5, 1, v6
  global_load_ushort v122, v5, s[14:15]
  global_load_ushort v123, v5, s[14:15] offset:1280
  v_add_u32 v3, 512, v0
  v_lshrrev_b32 v4, 6, v3
  v_lshlrev_b32 v5, 4, v4
  v_and_b32 v6, 8, v3
  v_add_u32 v5, v5, v6
  v_lshrrev_b32 v6, 2, v3
  v_xor_b32 v6, v6, v4
  v_and_b32 v6, 1, v6
  v_lshl_add_u32 v5, v6, 2, v5
  v_bfe_u32 v6, v3, 1, 1
  v_add_u32 v5, v5, v6
  v_and_b32 v6, 1, v3
  v_lshl_add_u32 v5, v6, 1, v5
  v_bfe_u32 v6, v3, 4, 2
  v_mul_u32_u24 v6, 2560, v6
  v_lshl_add_u32 v5, v5, 1, v6
  global_load_ushort v124, v5, s[14:15]
  global_load_ushort v125, v5, s[14:15] offset:1280
  v_add_u32 v3, 768, v0
  v_lshrrev_b32 v4, 6, v3
  v_lshlrev_b32 v5, 4, v4
  v_and_b32 v6, 8, v3
  v_add_u32 v5, v5, v6
  v_lshrrev_b32 v6, 2, v3
  v_xor_b32 v6, v6, v4
  v_and_b32 v6, 1, v6
  v_lshl_add_u32 v5, v6, 2, v5
  v_bfe_u32 v6, v3, 1, 1
  v_add_u32 v5, v5, v6
  v_and_b32 v6, 1, v3
  v_lshl_add_u32 v5, v6, 1, v5
  v_bfe_u32 v6, v3, 4, 2
  v_mul_u32_u24 v6, 2560, v6
  v_lshl_add_u32 v5, v5, 1, v6
  global_load_ushort v126, v5, s[14:15]
  global_load_ushort v127, v5, s[14:15] offset:1280
  v_add_u32 v3, 1024, v0
  v_lshrrev_b32 v4, 6, v3
  v_lshlrev_b32 v5, 4, v4
  v_and_b32 v6, 8, v3
  v_add_u32 v5, v5, v6
  v_lshrrev_b32 v6, 2, v3
  v_xor_b32 v6, v6, v4
  v_and_b32 v6, 1, v6
  v_lshl_add_u32 v5, v6, 2, v5
  v_bfe_u32 v6, v3, 1, 1
  v_add_u32 v5, v5, v6
  v_and_b32 v6, 1, v3
  v_lshl_add_u32 v5, v6, 1, v5
  v_bfe_u32 v6, v3, 4, 2
  v_mul_u32_u24 v6, 2560, v6
  v_lshl_add_u32 v5, v5, 1, v6
  global_load_ushort v128, v5, s[14:15]
  global_load_ushort v129, v5, s[14:15] offset:1280
  v_add_u32 v3, 1280, v0
  v_lshrrev_b32 v4, 6, v3
  v_lshlrev_b32 v5, 4, v4
  v_and_b32 v6, 8, v3
  v_add_u32 v5, v5, v6
  v_lshrrev_b32 v6, 2, v3
  v_xor_b32 v6, v6, v4
  v_and_b32 v6, 1, v6
  v_lshl_add_u32 v5, v6, 2, v5
  v_bfe_u32 v6, v3, 1, 1
  v_add_u32 v5, v5, v6
  v_and_b32 v6, 1, v3
  v_lshl_add_u32 v5, v6, 1, v5
  v_bfe_u32 v6, v3, 4, 2
  v_mul_u32_u24 v6, 2560, v6
  v_lshl_add_u32 v5, v5, 1, v6
  global_load_ushort v130, v5, s[14:15]
  global_load_ushort v131, v5, s[14:15] offset:1280
  v_add_u32 v3, 1536, v0
  v_lshrrev_b32 v4, 6, v3
  v_lshlrev_b32 v5, 4, v4
  v_and_b32 v6, 8, v3
  v_add_u32 v5, v5, v6
  v_lshrrev_b32 v6, 2, v3
  v_xor_b32 v6, v6, v4
  v_and_b32 v6, 1, v6
  v_lshl_add_u32 v5, v6, 2, v5
  v_bfe_u32 v6, v3, 1, 1
  v_add_u32 v5, v5, v6
  v_and_b32 v6, 1, v3
  v_lshl_add_u32 v5, v6, 1, v5
  v_bfe_u32 v6, v3, 4, 2
  v_mul_u32_u24 v6, 2560, v6
  v_lshl_add_u32 v5, v5, 1, v6
  global_load_ushort v132, v5, s[14:15]
  global_load_ushort v133, v5, s[14:15] offset:1280
  v_add_u32 v3, 1792, v0
  v_lshrrev_b32 v4, 6, v3
  v_lshlrev_b32 v5, 4, v4
  v_and_b32 v6, 8, v3
  v_add_u32 v5, v5, v6
  v_lshrrev_b32 v6, 2, v3
  v_xor_b32 v6, v6, v4
  v_and_b32 v6, 1, v6
  v_lshl_add_u32 v5, v6, 2, v5
  v_bfe_u32 v6, v3, 1, 1
  v_add_u32 v5, v5, v6
  v_and_b32 v6, 1, v3
  v_lshl_add_u32 v5, v6, 1, v5
  v_bfe_u32 v6, v3, 4, 2
  v_mul_u32_u24 v6, 2560, v6
  v_lshl_add_u32 v5, v5, 1, v6
  global_load_ushort v134, v5, s[14:15]
  global_load_ushort v135, v5, s[14:15] offset:1280
  v_add_u32 v3, 2048, v0
  v_lshrrev_b32 v4, 6, v3
  v_lshlrev_b32 v5, 4, v4
  v_and_b32 v6, 8, v3
  v_add_u32 v5, v5, v6
  v_lshrrev_b32 v6, 2, v3
  v_xor_b32 v6, v6, v4
  v_and_b32 v6, 1, v6
  v_lshl_add_u32 v5, v6, 2, v5
  v_bfe_u32 v6, v3, 1, 1
  v_add_u32 v5, v5, v6
  v_and_b32 v6, 1, v3
  v_lshl_add_u32 v5, v6, 1, v5
  v_bfe_u32 v6, v3, 4, 2
  v_mul_u32_u24 v6, 2560, v6
  v_lshl_add_u32 v5, v5, 1, v6
  global_load_ushort v136, v5, s[14:15]
  global_load_ushort v137, v5, s[14:15] offset:1280
  v_add_u32 v3, 2304, v0
  v_lshrrev_b32 v4, 6, v3
  v_lshlrev_b32 v5, 4, v4
  v_and_b32 v6, 8, v3
  v_add_u32 v5, v5, v6
  v_lshrrev_b32 v6, 2, v3
  v_xor_b32 v6, v6, v4
  v_and_b32 v6, 1, v6
  v_lshl_add_u32 v5, v6, 2, v5
  v_bfe_u32 v6, v3, 1, 1
  v_add_u32 v5, v5, v6
  v_and_b32 v6, 1, v3
  v_lshl_add_u32 v5, v6, 1, v5
  v_bfe_u32 v6, v3, 4, 2
  v_mul_u32_u24 v6, 2560, v6
  v_lshl_add_u32 v5, v5, 1, v6
  global_load_ushort v138, v5, s[14:15]
  global_load_ushort v139, v5, s[14:15] offset:1280
IN_m0a:
  v_and_b32 v3, 15, v1
  v_lshrrev_b32 v4, 4, v1
  v_mul_u32_u24 v5, 1280, v4
  v_lshrrev_b32 v6, 2, v3
  v_lshl_add_u32 v5, v6, 6, v5
  v_and_b32 v7, 3, v3
  v_lshl_add_u32 v5, v7, 3, v5
  v_lshlrev_b32 v6, 11, v6
  v_lshl_add_u32 v6, v7, 8, v6
  v_lshl_add_u32 v6, v4, 4, v6
  s_add_u32 s25, s19, 1
  s_mul_i32 s17, s19, 5120
  s_add_u32 s20, s12, s17
  s_addc_u32 s21, s13, 0
  global_load_dwordx2 v[64:65], v5, s[20:21] offset:0
  global_load_dwordx2 v[66:67], v5, s[20:21] offset:32
  global_load_dwordx2 v[68:69], v5, s[20:21] offset:256
  global_load_dwordx2 v[70:71], v5, s[20:21] offset:288
  global_load_dwordx2 v[72:73], v5, s[20:21] offset:512
  global_load_dwordx2 v[74:75], v5, s[20:21] offset:544
  global_load_dwordx2 v[76:77], v5, s[20:21] offset:768
  global_load_dwordx2 v[78:79], v5, s[20:21] offset:800
  global_load_dwordx2 v[80:81], v5, s[20:21] offset:1024
  global_load_dwordx2 v[82:83], v5, s[20:21] offset:1056
  s_mul_i32 s17, s25, 5120
  s_add_u32 s20, s12, s17
  s_addc_u32 s21, s13, 0
  global_load_dwordx2 v[84:85], v5, s[20:21] offset:0
  global_load_dwordx2 v[86:87], v5, s[20:21] offset:32
  global_load_dwordx2 v[88:89], v5, s[20:21] offset:256
  global_load_dwordx2 v[90:91], v5, s[20:21] offset:288
  global_load_dwordx2 v[92:93], v5, s[20:21] offset:512
  global_load_dwordx2 v[94:95], v5, s[20:21] offset:544
  global_load_dwordx2 v[96:97], v5, s[20:21] offset:768
  global_load_dwordx2 v[98:99], v5, s[20:21] offset:800
  global_load_dwordx2 v[100:101], v5, s[20:21] offset:1024
  global_load_dwordx2 v[102:103], v5, s[20:21] offset:1056
  v_lshlrev_b32 v104, 4, v0
  v_mov_b32 v108, -1
  v_mov_b32 v112, 0
  v_mov_b32 v109, -1
  v_mov_b32 v113, 0
  v_mov_b32 v110, -1
  v_mov_b32 v114, 0
  v_mov_b32 v111, -1
  v_mov_b32 v115, 0
  s_min_u32 s17, s16, 29
  s_lshl_b32 s17, s17, 12
  s_add_u32 s17, s17, 0x100a000
  s_add_u32 s20, s4, s17
  s_addc_u32 s21, s5, 0
  global_store_dwordx4 v104, v[108:111], s[20:21] sc1
  s_add_u32 s20, s20, 4096
  s_addc_u32 s21, s21, 0
  s_lshl_b32 s17, s16, 13
  s_add_u32 s17, s17, 0x1300000
  s_add_u32 s20, s4, s17
  s_addc_u32 s21, s5, 0
  global_store_dwordx4 v104, v[112:115], s[20:21] sc1
  s_add_u32 s20, s20, 4096
  s_addc_u32 s21, s21, 0
  global_store_dwordx4 v104, v[112:115], s[20:21] sc1
  s_add_u32 s20, s20, 4096
  s_addc_u32 s21, s21, 0
  s_mul_i32 s17, s16, 12288
  s_add_u32 s17, s17, 0x1800000
  s_add_u32 s20, s4, s17
  s_addc_u32 s21, s5, 0
  global_store_dwordx4 v104, v[108:111], s[20:21] sc1
  s_add_u32 s20, s20, 4096
  s_addc_u32 s21, s21, 0
  global_store_dwordx4 v104, v[108:111], s[20:21] sc1
  s_add_u32 s20, s20, 4096
  s_addc_u32 s21, s21, 0
  global_store_dwordx4 v104, v[108:111], s[20:21] sc1
  s_add_u32 s20, s20, 4096
  s_addc_u32 s21, s21, 0
  s_add_u32 s26, s4, 0x15fffff
  s_and_b32 s26, s26, 0xFFE00000
  s_sub_u32 s26, s26, s4
  s_lshl_b32 s17, s16, 14
  s_add_u32 s17, s17, s26
  s_add_u32 s20, s4, s17
  s_addc_u32 s21, s5, 0
  global_store_dwordx4 v104, v[112:115], s[20:21] sc1
  s_add_u32 s20, s20, 4096
  s_addc_u32 s21, s21, 0
  global_store_dwordx4 v104, v[112:115], s[20:21] sc1
  s_add_u32 s20, s20, 4096
  s_addc_u32 s21, s21, 0
  global_store_dwordx4 v104, v[112:115], s[20:21] sc1
  s_add_u32 s20, s20, 4096
  s_addc_u32 s21, s21, 0
  global_store_dwordx4 v104, v[112:115], s[20:21] sc1
  s_add_u32 s20, s20, 4096
  s_addc_u32 s21, s21, 0
  s_waitcnt vmcnt(20)
  s_lshr_b32 s17, s19, 3
  s_mul_i32 s17, s17, 40960
  s_bfe_u32 s18, s19, 0x10002
  s_lshl_b32 s18, s18, 10
  s_add_u32 s17, s17, s18
  s_and_b32 s18, s19, 3
  s_lshl_b32 s18, s18, 6
  s_add_u32 s17, s17, s18
  s_add_u32 s22, s4, s17
  s_addc_u32 s23, s5, 0
  v_lshlrev_b32 v16, 16, v64
  v_and_b32 v17, 0xffff0000, v64
  v_lshlrev_b32 v18, 16, v65
  v_and_b32 v19, 0xffff0000, v65
  v_lshlrev_b32 v20, 16, v66
  v_and_b32 v21, 0xffff0000, v66
  v_lshlrev_b32 v22, 16, v67
  v_and_b32 v23, 0xffff0000, v67
  v_lshlrev_b32 v24, 16, v68
  v_and_b32 v25, 0xffff0000, v68
  v_lshlrev_b32 v26, 16, v69
  v_and_b32 v27, 0xffff0000, v69
  v_lshlrev_b32 v28, 16, v70
  v_and_b32 v29, 0xffff0000, v70
  v_lshlrev_b32 v30, 16, v71
  v_and_b32 v31, 0xffff0000, v71
  v_lshlrev_b32 v32, 16, v72
  v_and_b32 v33, 0xffff0000, v72
  v_lshlrev_b32 v34, 16, v73
  v_and_b32 v35, 0xffff0000, v73
  v_lshlrev_b32 v36, 16, v74
  v_and_b32 v37, 0xffff0000, v74
  v_lshlrev_b32 v38, 16, v75
  v_and_b32 v39, 0xffff0000, v75
  v_lshlrev_b32 v40, 16, v76
  v_and_b32 v41, 0xffff0000, v76
  v_lshlrev_b32 v42, 16, v77
  v_and_b32 v43, 0xffff0000, v77
  v_lshlrev_b32 v44, 16, v78
  v_and_b32 v45, 0xffff0000, v78
  v_lshlrev_b32 v46, 16, v79
  v_and_b32 v47, 0xffff0000, v79
  v_lshlrev_b32 v48, 16, v80
  v_and_b32 v49, 0xffff0000, v80
  v_lshlrev_b32 v50, 16, v81
  v_and_b32 v51, 0xffff0000, v81
  v_lshlrev_b32 v52, 16, v82
  v_and_b32 v53, 0xffff0000, v82
  v_lshlrev_b32 v54, 16, v83
  v_and_b32 v55, 0xffff0000, v83
  v_add_f32 v8, v16, v20
  v_add_f32 v9, v17, v21
  v_add_f32 v10, v18, v22
  v_add_f32 v11, v19, v23
  v_add_f32 v8, v8, v24
  v_add_f32 v9, v9, v25
  v_add_f32 v10, v10, v26
  v_add_f32 v11, v11, v27
  v_add_f32 v8, v8, v28
  v_add_f32 v9, v9, v29
  v_add_f32 v10, v10, v30
  v_add_f32 v11, v11, v31
  v_add_f32 v8, v8, v32
  v_add_f32 v9, v9, v33
  v_add_f32 v10, v10, v34
  v_add_f32 v11, v11, v35
  v_add_f32 v8, v8, v36
  v_add_f32 v9, v9, v37
  v_add_f32 v10, v10, v38
  v_add_f32 v11, v11, v39
  v_add_f32 v8, v8, v40
  v_add_f32 v9, v9, v41
  v_add_f32 v10, v10, v42
  v_add_f32 v11, v11, v43
  v_add_f32 v8, v8, v44
  v_add_f32 v9, v9, v45
  v_add_f32 v10, v10, v46
  v_add_f32 v11, v11, v47
  v_add_f32 v8, v8, v48
  v_add_f32 v9, v9, v49
  v_add_f32 v10, v10, v50
  v_add_f32 v11, v11, v51
  v_add_f32 v8, v8, v52
  v_add_f32 v9, v9, v53
  v_add_f32 v10, v10, v54
  v_add_f32 v11, v11, v55
  v_add_f32 v8, v8, v9
  v_add_f32 v10, v10, v11
  v_add_f32 v8, v8, v10
  s_nop 1
  v_add_f32_dpp v8, v8, v8 row_ror:8 row_mask:0xf bank_mask:0xf
  s_nop 1
  v_add_f32_dpp v8, v8, v8 row_ror:4 row_mask:0xf bank_mask:0xf
  s_nop 1
  v_add_f32_dpp v8, v8, v8 row_ror:2 row_mask:0xf bank_mask:0xf
  s_nop 1
  v_add_f32_dpp v8, v8, v8 row_ror:1 row_mask:0xf bank_mask:0xf
  v_mul_f32 v12, 0x3acccccd, v8
  v_sub_f32 v16, v16, v12
  v_sub_f32 v17, v17, v12
  v_sub_f32 v18, v18, v12
  v_sub_f32 v19, v19, v12
  v_sub_f32 v20, v20, v12
  v_sub_f32 v21, v21, v12
  v_sub_f32 v22, v22, v12
  v_sub_f32 v23, v23, v12
  v_sub_f32 v24, v24, v12
  v_sub_f32 v25, v25, v12
  v_sub_f32 v26, v26, v12
  v_sub_f32 v27, v27, v12
  v_sub_f32 v28, v28, v12
  v_sub_f32 v29, v29, v12
  v_sub_f32 v30, v30, v12
  v_sub_f32 v31, v31, v12
  v_sub_f32 v32, v32, v12
  v_sub_f32 v33, v33, v12
  v_sub_f32 v34, v34, v12
  v_sub_f32 v35, v35, v12
  v_sub_f32 v36, v36, v12
  v_sub_f32 v37, v37, v12
  v_sub_f32 v38, v38, v12
  v_sub_f32 v39, v39, v12
  v_sub_f32 v40, v40, v12
  v_sub_f32 v41, v41, v12
  v_sub_f32 v42, v42, v12
  v_sub_f32 v43, v43, v12
  v_sub_f32 v44, v44, v12
  v_sub_f32 v45, v45, v12
  v_sub_f32 v46, v46, v12
  v_sub_f32 v47, v47, v12
  v_sub_f32 v48, v48, v12
  v_sub_f32 v49, v49, v12
  v_sub_f32 v50, v50, v12
  v_sub_f32 v51, v51, v12
  v_sub_f32 v52, v52, v12
  v_sub_f32 v53, v53, v12
  v_sub_f32 v54, v54, v12
  v_sub_f32 v55, v55, v12
  v_mul_f32 v8, v16, v16
  v_mul_f32 v9, v17, v17
  v_mul_f32 v10, v18, v18
  v_mul_f32 v11, v19, v19
  v_fmac_f32 v8, v20, v20
  v_fmac_f32 v9, v21, v21
  v_fmac_f32 v10, v22, v22
  v_fmac_f32 v11, v23, v23
  v_fmac_f32 v8, v24, v24
  v_fmac_f32 v9, v25, v25
  v_fmac_f32 v10, v26, v26
  v_fmac_f32 v11, v27, v27
  v_fmac_f32 v8, v28, v28
  v_fmac_f32 v9, v29, v29
  v_fmac_f32 v10, v30, v30
  v_fmac_f32 v11, v31, v31
  v_fmac_f32 v8, v32, v32
  v_fmac_f32 v9, v33, v33
  v_fmac_f32 v10, v34, v34
  v_fmac_f32 v11, v35, v35
  v_fmac_f32 v8, v36, v36
  v_fmac_f32 v9, v37, v37
  v_fmac_f32 v10, v38, v38
  v_fmac_f32 v11, v39, v39
  v_fmac_f32 v8, v40, v40
  v_fmac_f32 v9, v41, v41
  v_fmac_f32 v10, v42, v42
  v_fmac_f32 v11, v43, v43
  v_fmac_f32 v8, v44, v44
  v_fmac_f32 v9, v45, v45
  v_fmac_f32 v10, v46, v46
  v_fmac_f32 v11, v47, v47
  v_fmac_f32 v8, v48, v48
  v_fmac_f32 v9, v49, v49
  v_fmac_f32 v10, v50, v50
  v_fmac_f32 v11, v51, v51
  v_fmac_f32 v8, v52, v52
  v_fmac_f32 v9, v53, v53
  v_fmac_f32 v10, v54, v54
  v_fmac_f32 v11, v55, v55
  v_add_f32 v8, v8, v9
  v_add_f32 v10, v10, v11
  v_add_f32 v8, v8, v10
  s_nop 1
  v_add_f32_dpp v8, v8, v8 row_ror:8 row_mask:0xf bank_mask:0xf
  s_nop 1
  v_add_f32_dpp v8, v8, v8 row_ror:4 row_mask:0xf bank_mask:0xf
  s_nop 1
  v_add_f32_dpp v8, v8, v8 row_ror:2 row_mask:0xf bank_mask:0xf
  s_nop 1
  v_add_f32_dpp v8, v8, v8 row_ror:1 row_mask:0xf bank_mask:0xf
  v_mov_b32 v9, 0x3727C5AC
  v_fmac_f32 v9, 0x3acccccd, v8
  v_rsq_f32 v8, v9
  s_nop 0
  v_mul_f32 v16, v16, v8
  v_mul_f32 v17, v17, v8
  v_mul_f32 v18, v18, v8
  v_mul_f32 v19, v19, v8
  v_mul_f32 v20, v20, v8
  v_mul_f32 v21, v21, v8
  v_mul_f32 v22, v22, v8
  v_mul_f32 v23, v23, v8
  v_mul_f32 v24, v24, v8
  v_mul_f32 v25, v25, v8
  v_mul_f32 v26, v26, v8
  v_mul_f32 v27, v27, v8
  v_mul_f32 v28, v28, v8
  v_mul_f32 v29, v29, v8
  v_mul_f32 v30, v30, v8
  v_mul_f32 v31, v31, v8
  v_mul_f32 v32, v32, v8
  v_mul_f32 v33, v33, v8
  v_mul_f32 v34, v34, v8
  v_mul_f32 v35, v35, v8
  v_mul_f32 v36, v36, v8
  v_mul_f32 v37, v37, v8
  v_mul_f32 v38, v38, v8
  v_mul_f32 v39, v39, v8
  v_mul_f32 v40, v40, v8
  v_mul_f32 v41, v41, v8
  v_mul_f32 v42, v42, v8
  v_mul_f32 v43, v43, v8
  v_mul_f32 v44, v44, v8
  v_mul_f32 v45, v45, v8
  v_mul_f32 v46, v46, v8
  v_mul_f32 v47, v47, v8
  v_mul_f32 v48, v48, v8
  v_mul_f32 v49, v49, v8
  v_mul_f32 v50, v50, v8
  v_mul_f32 v51, v51, v8
  v_mul_f32 v52, v52, v8
  v_mul_f32 v53, v53, v8
  v_mul_f32 v54, v54, v8
  v_mul_f32 v55, v55, v8
  v_cvt_pk_bf16_f32 v64, v16, v17
  v_cvt_pk_bf16_f32 v65, v18, v19
  v_cvt_pk_bf16_f32 v66, v20, v21
  v_cvt_pk_bf16_f32 v67, v22, v23
  v_cvt_pk_bf16_f32 v68, v24, v25
  v_cvt_pk_bf16_f32 v69, v26, v27
  v_cvt_pk_bf16_f32 v70, v28, v29
  v_cvt_pk_bf16_f32 v71, v30, v31
  v_cvt_pk_bf16_f32 v72, v32, v33
  v_cvt_pk_bf16_f32 v73, v34, v35
  v_cvt_pk_bf16_f32 v74, v36, v37
  v_cvt_pk_bf16_f32 v75, v38, v39
  v_cvt_pk_bf16_f32 v76, v40, v41
  v_cvt_pk_bf16_f32 v77, v42, v43
  v_cvt_pk_bf16_f32 v78, v44, v45
  v_cvt_pk_bf16_f32 v79, v46, v47
  v_cvt_pk_bf16_f32 v80, v48, v49
  v_cvt_pk_bf16_f32 v81, v50, v51
  v_cvt_pk_bf16_f32 v82, v52, v53
  v_cvt_pk_bf16_f32 v83, v54, v55
  global_store_dwordx4 v6, v[64:67], s[22:23] sc1
  s_add_u32 s22, s22, 8192
  s_addc_u32 s23, s23, 0
  global_store_dwordx4 v6, v[68:71], s[22:23] sc1
  s_add_u32 s22, s22, 8192
  s_addc_u32 s23, s23, 0
  global_store_dwordx4 v6, v[72:75], s[22:23] sc1
  s_add_u32 s22, s22, 8192
  s_addc_u32 s23, s23, 0
  global_store_dwordx4 v6, v[76:79], s[22:23] sc1
  s_add_u32 s22, s22, 8192
  s_addc_u32 s23, s23, 0
  global_store_dwordx4 v6, v[80:83], s[22:23] sc1
  s_waitcnt vmcnt(15)
  s_lshr_b32 s17, s25, 3
  s_mul_i32 s17, s17, 40960
  s_bfe_u32 s18, s25, 0x10002
  s_lshl_b32 s18, s18, 10
  s_add_u32 s17, s17, s18
  s_and_b32 s18, s25, 3
  s_lshl_b32 s18, s18, 6
  s_add_u32 s17, s17, s18
  s_add_u32 s22, s4, s17
  s_addc_u32 s23, s5, 0
  v_lshlrev_b32 v16, 16, v84
  v_and_b32 v17, 0xffff0000, v84
  v_lshlrev_b32 v18, 16, v85
  v_and_b32 v19, 0xffff0000, v85
  v_lshlrev_b32 v20, 16, v86
  v_and_b32 v21, 0xffff0000, v86
  v_lshlrev_b32 v22, 16, v87
  v_and_b32 v23, 0xffff0000, v87
  v_lshlrev_b32 v24, 16, v88
  v_and_b32 v25, 0xffff0000, v88
  v_lshlrev_b32 v26, 16, v89
  v_and_b32 v27, 0xffff0000, v89
  v_lshlrev_b32 v28, 16, v90
  v_and_b32 v29, 0xffff0000, v90
  v_lshlrev_b32 v30, 16, v91
  v_and_b32 v31, 0xffff0000, v91
  v_lshlrev_b32 v32, 16, v92
  v_and_b32 v33, 0xffff0000, v92
  v_lshlrev_b32 v34, 16, v93
  v_and_b32 v35, 0xffff0000, v93
  v_lshlrev_b32 v36, 16, v94
  v_and_b32 v37, 0xffff0000, v94
  v_lshlrev_b32 v38, 16, v95
  v_and_b32 v39, 0xffff0000, v95
  v_lshlrev_b32 v40, 16, v96
  v_and_b32 v41, 0xffff0000, v96
  v_lshlrev_b32 v42, 16, v97
  v_and_b32 v43, 0xffff0000, v97
  v_lshlrev_b32 v44, 16, v98
  v_and_b32 v45, 0xffff0000, v98
  v_lshlrev_b32 v46, 16, v99
  v_and_b32 v47, 0xffff0000, v99
  v_lshlrev_b32 v48, 16, v100
  v_and_b32 v49, 0xffff0000, v100
  v_lshlrev_b32 v50, 16, v101
  v_and_b32 v51, 0xffff0000, v101
  v_lshlrev_b32 v52, 16, v102
  v_and_b32 v53, 0xffff0000, v102
  v_lshlrev_b32 v54, 16, v103
  v_and_b32 v55, 0xffff0000, v103
  v_add_f32 v8, v16, v20
  v_add_f32 v9, v17, v21
  v_add_f32 v10, v18, v22
  v_add_f32 v11, v19, v23
  v_add_f32 v8, v8, v24
  v_add_f32 v9, v9, v25
  v_add_f32 v10, v10, v26
  v_add_f32 v11, v11, v27
  v_add_f32 v8, v8, v28
  v_add_f32 v9, v9, v29
  v_add_f32 v10, v10, v30
  v_add_f32 v11, v11, v31
  v_add_f32 v8, v8, v32
  v_add_f32 v9, v9, v33
  v_add_f32 v10, v10, v34
  v_add_f32 v11, v11, v35
  v_add_f32 v8, v8, v36
  v_add_f32 v9, v9, v37
  v_add_f32 v10, v10, v38
  v_add_f32 v11, v11, v39
  v_add_f32 v8, v8, v40
  v_add_f32 v9, v9, v41
  v_add_f32 v10, v10, v42
  v_add_f32 v11, v11, v43
  v_add_f32 v8, v8, v44
  v_add_f32 v9, v9, v45
  v_add_f32 v10, v10, v46
  v_add_f32 v11, v11, v47
  v_add_f32 v8, v8, v48
  v_add_f32 v9, v9, v49
  v_add_f32 v10, v10, v50
  v_add_f32 v11, v11, v51
  v_add_f32 v8, v8, v52
  v_add_f32 v9, v9, v53
  v_add_f32 v10, v10, v54
  v_add_f32 v11, v11, v55
  v_add_f32 v8, v8, v9
  v_add_f32 v10, v10, v11
  v_add_f32 v8, v8, v10
  s_nop 1
  v_add_f32_dpp v8, v8, v8 row_ror:8 row_mask:0xf bank_mask:0xf
  s_nop 1
  v_add_f32_dpp v8, v8, v8 row_ror:4 row_mask:0xf bank_mask:0xf
  s_nop 1
  v_add_f32_dpp v8, v8, v8 row_ror:2 row_mask:0xf bank_mask:0xf
  s_nop 1
  v_add_f32_dpp v8, v8, v8 row_ror:1 row_mask:0xf bank_mask:0xf
  v_mul_f32 v12, 0x3acccccd, v8
  v_sub_f32 v16, v16, v12
  v_sub_f32 v17, v17, v12
  v_sub_f32 v18, v18, v12
  v_sub_f32 v19, v19, v12
  v_sub_f32 v20, v20, v12
  v_sub_f32 v21, v21, v12
  v_sub_f32 v22, v22, v12
  v_sub_f32 v23, v23, v12
  v_sub_f32 v24, v24, v12
  v_sub_f32 v25, v25, v12
  v_sub_f32 v26, v26, v12
  v_sub_f32 v27, v27, v12
  v_sub_f32 v28, v28, v12
  v_sub_f32 v29, v29, v12
  v_sub_f32 v30, v30, v12
  v_sub_f32 v31, v31, v12
  v_sub_f32 v32, v32, v12
  v_sub_f32 v33, v33, v12
  v_sub_f32 v34, v34, v12
  v_sub_f32 v35, v35, v12
  v_sub_f32 v36, v36, v12
  v_sub_f32 v37, v37, v12
  v_sub_f32 v38, v38, v12
  v_sub_f32 v39, v39, v12
  v_sub_f32 v40, v40, v12
  v_sub_f32 v41, v41, v12
  v_sub_f32 v42, v42, v12
  v_sub_f32 v43, v43, v12
  v_sub_f32 v44, v44, v12
  v_sub_f32 v45, v45, v12
  v_sub_f32 v46, v46, v12
  v_sub_f32 v47, v47, v12
  v_sub_f32 v48, v48, v12
  v_sub_f32 v49, v49, v12
  v_sub_f32 v50, v50, v12
  v_sub_f32 v51, v51, v12
  v_sub_f32 v52, v52, v12
  v_sub_f32 v53, v53, v12
  v_sub_f32 v54, v54, v12
  v_sub_f32 v55, v55, v12
  v_mul_f32 v8, v16, v16
  v_mul_f32 v9, v17, v17
  v_mul_f32 v10, v18, v18
  v_mul_f32 v11, v19, v19
  v_fmac_f32 v8, v20, v20
  v_fmac_f32 v9, v21, v21
  v_fmac_f32 v10, v22, v22
  v_fmac_f32 v11, v23, v23
  v_fmac_f32 v8, v24, v24
  v_fmac_f32 v9, v25, v25
  v_fmac_f32 v10, v26, v26
  v_fmac_f32 v11, v27, v27
  v_fmac_f32 v8, v28, v28
  v_fmac_f32 v9, v29, v29
  v_fmac_f32 v10, v30, v30
  v_fmac_f32 v11, v31, v31
  v_fmac_f32 v8, v32, v32
  v_fmac_f32 v9, v33, v33
  v_fmac_f32 v10, v34, v34
  v_fmac_f32 v11, v35, v35
  v_fmac_f32 v8, v36, v36
  v_fmac_f32 v9, v37, v37
  v_fmac_f32 v10, v38, v38
  v_fmac_f32 v11, v39, v39
  v_fmac_f32 v8, v40, v40
  v_fmac_f32 v9, v41, v41
  v_fmac_f32 v10, v42, v42
  v_fmac_f32 v11, v43, v43
  v_fmac_f32 v8, v44, v44
  v_fmac_f32 v9, v45, v45
  v_fmac_f32 v10, v46, v46
  v_fmac_f32 v11, v47, v47
  v_fmac_f32 v8, v48, v48
  v_fmac_f32 v9, v49, v49
  v_fmac_f32 v10, v50, v50
  v_fmac_f32 v11, v51, v51
  v_fmac_f32 v8, v52, v52
  v_fmac_f32 v9, v53, v53
  v_fmac_f32 v10, v54, v54
  v_fmac_f32 v11, v55, v55
  v_add_f32 v8, v8, v9
  v_add_f32 v10, v10, v11
  v_add_f32 v8, v8, v10
  s_nop 1
  v_add_f32_dpp v8, v8, v8 row_ror:8 row_mask:0xf bank_mask:0xf
  s_nop 1
  v_add_f32_dpp v8, v8, v8 row_ror:4 row_mask:0xf bank_mask:0xf
  s_nop 1
  v_add_f32_dpp v8, v8, v8 row_ror:2 row_mask:0xf bank_mask:0xf
  s_nop 1
  v_add_f32_dpp v8, v8, v8 row_ror:1 row_mask:0xf bank_mask:0xf
  v_mov_b32 v9, 0x3727C5AC
  v_fmac_f32 v9, 0x3acccccd, v8
  v_rsq_f32 v8, v9
  s_nop 0
  v_mul_f32 v16, v16, v8
  v_mul_f32 v17, v17, v8
  v_mul_f32 v18, v18, v8
  v_mul_f32 v19, v19, v8
  v_mul_f32 v20, v20, v8
  v_mul_f32 v21, v21, v8
  v_mul_f32 v22, v22, v8
  v_mul_f32 v23, v23, v8
  v_mul_f32 v24, v24, v8
  v_mul_f32 v25, v25, v8
  v_mul_f32 v26, v26, v8
  v_mul_f32 v27, v27, v8
  v_mul_f32 v28, v28, v8
  v_mul_f32 v29, v29, v8
  v_mul_f32 v30, v30, v8
  v_mul_f32 v31, v31, v8
  v_mul_f32 v32, v32, v8
  v_mul_f32 v33, v33, v8
  v_mul_f32 v34, v34, v8
  v_mul_f32 v35, v35, v8
  v_mul_f32 v36, v36, v8
  v_mul_f32 v37, v37, v8
  v_mul_f32 v38, v38, v8
  v_mul_f32 v39, v39, v8
  v_mul_f32 v40, v40, v8
  v_mul_f32 v41, v41, v8
  v_mul_f32 v42, v42, v8
  v_mul_f32 v43, v43, v8
  v_mul_f32 v44, v44, v8
  v_mul_f32 v45, v45, v8
  v_mul_f32 v46, v46, v8
  v_mul_f32 v47, v47, v8
  v_mul_f32 v48, v48, v8
  v_mul_f32 v49, v49, v8
  v_mul_f32 v50, v50, v8
  v_mul_f32 v51, v51, v8
  v_mul_f32 v52, v52, v8
  v_mul_f32 v53, v53, v8
  v_mul_f32 v54, v54, v8
  v_mul_f32 v55, v55, v8
  v_cvt_pk_bf16_f32 v84, v16, v17
  v_cvt_pk_bf16_f32 v85, v18, v19
  v_cvt_pk_bf16_f32 v86, v20, v21
  v_cvt_pk_bf16_f32 v87, v22, v23
  v_cvt_pk_bf16_f32 v88, v24, v25
  v_cvt_pk_bf16_f32 v89, v26, v27
  v_cvt_pk_bf16_f32 v90, v28, v29
  v_cvt_pk_bf16_f32 v91, v30, v31
  v_cvt_pk_bf16_f32 v92, v32, v33
  v_cvt_pk_bf16_f32 v93, v34, v35
  v_cvt_pk_bf16_f32 v94, v36, v37
  v_cvt_pk_bf16_f32 v95, v38, v39
  v_cvt_pk_bf16_f32 v96, v40, v41
  v_cvt_pk_bf16_f32 v97, v42, v43
  v_cvt_pk_bf16_f32 v98, v44, v45
  v_cvt_pk_bf16_f32 v99, v46, v47
  v_cvt_pk_bf16_f32 v100, v48, v49
  v_cvt_pk_bf16_f32 v101, v50, v51
  v_cvt_pk_bf16_f32 v102, v52, v53
  v_cvt_pk_bf16_f32 v103, v54, v55
  global_store_dwordx4 v6, v[84:87], s[22:23] sc1
  s_add_u32 s22, s22, 8192
  s_addc_u32 s23, s23, 0
  global_store_dwordx4 v6, v[88:91], s[22:23] sc1
  s_add_u32 s22, s22, 8192
  s_addc_u32 s23, s23, 0
  global_store_dwordx4 v6, v[92:95], s[22:23] sc1
  s_add_u32 s22, s22, 8192
  s_addc_u32 s23, s23, 0
  global_store_dwordx4 v6, v[96:99], s[22:23] sc1
  s_add_u32 s22, s22, 8192
  s_addc_u32 s23, s23, 0
  global_store_dwordx4 v6, v[100:103], s[22:23] sc1
  s_cmp_lg_u32 s41, 31
  s_cbranch_scc1 IN_nom
  s_mul_i32 s17, s40, 10240
  s_add_u32 s17, s17, 0x1000000
  s_add_u32 s20, s4, s17
  s_addc_u32 s21, s5, 0
  s_mov_b32 s22, 0xfffefffe
  v_lshlrev_b32 v5, 2, v0
  v_lshl_or_b32 v120, v121, 16, v120
  v_pk_min_u16 v120, s22, v120
  global_store_dword v5, v120, s[20:21] offset:0 sc1
  v_lshl_or_b32 v122, v123, 16, v122
  v_pk_min_u16 v122, s22, v122
  global_store_dword v5, v122, s[20:21] offset:1024 sc1
  v_lshl_or_b32 v124, v125, 16, v124
  v_pk_min_u16 v124, s22, v124
  global_store_dword v5, v124, s[20:21] offset:2048 sc1
  v_lshl_or_b32 v126, v127, 16, v126
  v_pk_min_u16 v126, s22, v126
  global_store_dword v5, v126, s[20:21] offset:3072 sc1
  s_add_u32 s20, s20, 4096
  s_addc_u32 s21, s21, 0
  v_lshl_or_b32 v128, v129, 16, v128
  v_pk_min_u16 v128, s22, v128
  global_store_dword v5, v128, s[20:21] offset:0 sc1
  v_lshl_or_b32 v130, v131, 16, v130
  v_pk_min_u16 v130, s22, v130
  global_store_dword v5, v130, s[20:21] offset:1024 sc1
  v_lshl_or_b32 v132, v133, 16, v132
  v_pk_min_u16 v132, s22, v132
  global_store_dword v5, v132, s[20:21] offset:2048 sc1
  v_lshl_or_b32 v134, v135, 16, v134
  v_pk_min_u16 v134, s22, v134
  global_store_dword v5, v134, s[20:21] offset:3072 sc1
  s_add_u32 s20, s20, 4096
  s_addc_u32 s21, s21, 0
  v_lshl_or_b32 v136, v137, 16, v136
  v_pk_min_u16 v136, s22, v136
  global_store_dword v5, v136, s[20:21] offset:0 sc1
  v_lshl_or_b32 v138, v139, 16, v138
  v_pk_min_u16 v138, s22, v138
  global_store_dword v5, v138, s[20:21] offset:1024 sc1
IN_nom:
  s_waitcnt vmcnt(0)
  s_barrier
  s_cmp_lg_u32 s3, 0
  s_cbranch_scc1 IN_c0
  v_mov_b32 v3, 32
  v_mov_b32 v4, 1
  s_mov_b64 exec, 1
  global_atomic_add v3, v4, s[6:7] sc1
  s_mov_b64 exec, -1
IN_c0:
  s_cmp_lt_u32 s41, 26
  s_cbranch_scc1 IN_done
  s_mov_b64 exec, 1
  s_lshl_b32 s18, s16, 2
  s_add_u32 s18, s18, s3
  s_and_b32 s17, s18, 31
  s_lshl_b32 s17, s17, 14
  s_lshr_b32 s18, s18, 5
  s_lshl_b32 s18, s18, 10
  s_add_u32 s18, s18, s17
  s_add_u32 s18, s18, s26
  s_add_u32 s18, s18, 0x40000
  v_mov_b32 v4, 0
  s_mov_b32 s24, 0
  s_mov_b32 s28, -1
  s_mov_b32 s29, -1
  s_getreg_b32 s19, hwreg(HW_REG_XCC_ID)
  s_bfe_u32 s19, s19, 0x10002
IN_cal:
  s_add_u32 s17, s18, 0
  v_mov_b32 v3, s17
  s_memtime s[20:21]
  s_waitcnt lgkmcnt(0)
  global_store_dword v3, v4, s[4:5] sc1
  s_waitcnt vmcnt(0)
  global_load_dword v5, v3, s[4:5] sc1
  s_waitcnt vmcnt(0)
  s_memtime s[22:23]
  s_waitcnt lgkmcnt(0)
  s_sub_u32 s30, s22, s20
  s_add_u32 s17, s18, 8192
  v_mov_b32 v3, s17
  s_memtime s[20:21]
  s_waitcnt lgkmcnt(0)
  global_store_dword v3, v4, s[4:5] sc1
  s_waitcnt vmcnt(0)
  global_load_dword v5, v3, s[4:5] sc1
  s_waitcnt vmcnt(0)
  s_memtime s[22:23]
  s_waitcnt lgkmcnt(0)
  s_sub_u32 s31, s22, s20
  s_min_u32 s28, s28, s30
  s_min_u32 s29, s29, s31
  s_add_u32 s18, s18, 256
  s_add_u32 s24, s24, 1
  s_cmp_lt_u32 s24, 4
  s_cbranch_scc1 IN_cal
  s_cmp_lt_u32 s29, s28
  s_cselect_b32 s27, 1, 0
  s_xor_b32 s27, s27, s19
  s_add_u32 s27, s27, 0x10000
  v_mov_b32 v3, 36
  v_mov_b32 v4, s27
  global_atomic_add v3, v4, s[6:7] sc1
  s_mov_b64 exec, -1
IN_done:
  s_cmp_ge_u32 s41, 31
  s_cbranch_scc1 K2_exit
  s_cmp_eq_u32 s41, 30
  s_cbranch_scc1 K2_fwd
  s_cmp_ge_u32 s41, 26
  s_cbranch_scc1 K2_pf
  s_sub_u32 s41, s41, 16
  s_cmp_lg_u32 s3, 0
  s_cbranch_scc1 OW_39
  s_sleep 96
  s_lshl_b32 s49, s40, 2
  v_mov_b32 v20, s49
  v_mov_b32 v21, 32
HR_40:
  global_load_dword v22, v20, s[6:7] sc1
  global_load_dwordx2 v[24:25], v21, s[6:7] sc1
  s_waitcnt vmcnt(0)
  v_readfirstlane_b32 s48, v22
  v_readfirstlane_b32 s50, v24
  v_readfirstlane_b32 s57, v25
  s_and_b32 s49, s48, 0xff
  s_cmp_lg_u32 s49, 31
  s_cbranch_scc1 HS_42
  s_lshr_b32 s49, s57, 16
  s_cmp_lg_u32 s49, 96
  s_cbranch_scc1 HS_42
  s_cmp_eq_u32 s50, 64
  s_cbranch_scc1 HD_41
HS_42:
  s_sleep 48
  s_add_u32 s66, s66, 1
  s_cmp_lt_u32 s66, 2097152
  s_cbranch_scc1 HR_40
  s_branch K2_abort
HD_41:
  s_bfe_u32 s49, s48, 0x80008
  s_mul_i32 s49, s49, s49
  s_lshr_b32 s48, s48, 16
  s_mul_i32 s48, s48, 31
  s_cmp_eq_u32 s48, s49
  s_cselect_b32 s43, 1, 0
OW_39:
  s_barrier
  s_lshl_b32 s49, s40, 2
  v_mov_b32 v20, s49
  v_mov_b32 v21, 32
HR_43:
  global_load_dword v22, v20, s[6:7] sc1
  global_load_dwordx2 v[24:25], v21, s[6:7] sc1
  s_waitcnt vmcnt(0)
  v_readfirstlane_b32 s48, v22
  v_readfirstlane_b32 s50, v24
  v_readfirstlane_b32 s57, v25
  s_and_b32 s49, s48, 0xff
  s_cmp_lg_u32 s49, 31
  s_cbranch_scc1 HS_45
  s_lshr_b32 s49, s57, 16
  s_cmp_lg_u32 s49, 96
  s_cbranch_scc1 HS_45
  s_cmp_eq_u32 s50, 64
  s_cbranch_scc1 HD_44
HS_45:
  s_sleep 48
  s_add_u32 s66, s66, 1
  s_cmp_lt_u32 s66, 2097152
  s_cbranch_scc1 HR_43
  s_branch K2_abort
HD_44:
  s_bfe_u32 s49, s48, 0x80008
  s_mul_i32 s49, s49, s49
  s_lshr_b32 s48, s48, 16
  s_mul_i32 s48, s48, 31
  s_cmp_eq_u32 s48, s49
  s_cselect_b32 s43, 1, 0
  s_and_b32 s57, s57, 0xffff
  s_cmp_gt_u32 s57, 48
  s_cselect_b32 s57, 8192, 0
  s_lshl_b32 s42, s41, 2
  s_add_u32 s42, s42, s3
  s_and_b32 s55, s3, 1
  s_lshl_b32 s56, s40, 1
  s_add_u32 s56, s56, s55
  v_lshlrev_b32 v9, 4, v1
  v_lshlrev_b32 v8, 3, v1
  v_mov_b32 v3, 0x4444
  v_mov_b32 v20, 0xeeee
  v_and_b32 v21, 2, v1
  v_cmp_ne_u32 vcc, 0, v21
  s_nop 1
  v_cndmask_b32 v3, v3, v20, vcc
  s_mul_i32 s48, s56, 3072
  s_add_u32 s48, s48, 0x1300000
  v_add_u32 v10, s48, v9
  s_mul_i32 s87, s55, 10240
  v_add_u32 v11, s87, v9
  s_lshr_b32 s48, s3, 1
  s_mul_i32 s48, s48, 5120
  s_add_u32 s87, s87, s48
  s_mul_i32 s48, s40, 20480
  s_add_u32 s48, s48, s87
  s_add_u32 s48, s48, 0x1310000
  v_add_u32 v18, s48, v9
  v_add_u32 v4, 4096, v18
  s_mul_i32 s48, s40, 2621440
  s_lshl_b32 s49, s42, 9
  s_add_u32 s48, s48, s49
  s_add_u32 s48, s48, 0x6400000
  v_add_u32 v19, s48, v8
  v_add_u32 v5, 20480, v19
  s_mul_i32 s48, s40, 81920
  s_lshl_b32 s49, s42, 11
  s_add_u32 s48, s48, s49
  s_add_u32 s48, s48, 0x1800000
  v_add_u32 v6, s48, v9
  s_lshl_b32 s91, s3, 11
  s_add_u32 s91, s91, 81920
  v_add_u32 v243, s91, v9
  s_lshl_b32 s48, s55, 2
  s_add_u32 s48, s48, s91
  v_add_u32 v241, s48, v8
  v_xor_b32 v244, 4, v241
  s_lshl_b32 s48, s3, 9
  s_add_u32 s48, s48, 90112
  v_add_u32 v245, s48, v8
  v_xor_b32 v246, 512, v245
  s_lshl_b32 s48, s3, 11
  s_add_u32 s48, s48, 94208
  v_add_u32 v247, s48, v9
  v_xor_b32 v248, 2048, v247
  s_waitcnt lgkmcnt(0)
  s_add_u32 s58, s4, 0x15fffff
  s_and_b32 s58, s58, 0xFFE00000
  s_sub_u32 s58, s58, s4
  s_add_u32 s58, s58, s57
  s_add_u32 s48, s40, 1
  s_and_b32 s48, s48, 3
  s_mul_i32 s48, s48, 40
  s_add_u32 s48, s48, s42
  s_mul_i32 s48, s48, 1536
  s_add_u32 s48, s48, 0
  s_lshr_b32 s51, s48, 13
  s_lshl_b32 s51, s51, 13
  s_add_u32 s48, s48, s51
  s_add_u32 s48, s48, s58
  v_add_u32 v12, s48, v8
  s_mul_i32 s48, s40, 40
  s_add_u32 s48, s48, s42
  s_mul_i32 s48, s48, 1536
  s_add_u32 s48, s48, 0
  s_lshr_b32 s51, s48, 13
  s_lshl_b32 s51, s51, 13
  s_add_u32 s48, s48, s51
  s_add_u32 s48, s48, s58
  v_add_u32 v15, s48, v8
  s_add_u32 s48, s40, 2
  s_and_b32 s48, s48, 3
  s_mul_i32 s48, s48, 40
  s_add_u32 s48, s48, s42
  s_mul_i32 s48, s48, 1536
  s_add_u32 s48, s48, 512
  s_lshr_b32 s51, s48, 13
  s_lshl_b32 s51, s51, 13
  s_add_u32 s48, s48, s51
  s_add_u32 s48, s48, s58
  v_add_u32 v13, s48, v8
  s_mul_i32 s48, s40, 40
  s_add_u32 s48, s48, s42
  s_mul_i32 s48, s48, 1536
  s_add_u32 s48, s48, 512
  s_lshr_b32 s51, s48, 13
  s_lshl_b32 s51, s51, 13
  s_add_u32 s48, s48, s51
  s_add_u32 s48, s48, s58
  v_add_u32 v16, s48, v8
  s_add_u32 s48, s40, 3
  s_and_b32 s48, s48, 3
  s_mul_i32 s48, s48, 40
  s_add_u32 s48, s48, s42
  s_mul_i32 s48, s48, 1536
  s_add_u32 s48, s48, 1024
  s_lshr_b32 s51, s48, 13
  s_lshl_b32 s51, s51, 13
  s_add_u32 s48, s48, s51
  s_add_u32 s48, s48, s58
  v_add_u32 v14, s48, v8
  s_mul_i32 s48, s40, 40
  s_add_u32 s48, s48, s42
  s_mul_i32 s48, s48, 1536
  s_add_u32 s48, s48, 1024
  s_lshr_b32 s51, s48, 13
  s_lshl_b32 s51, s51, 13
  s_add_u32 s48, s48, s51
  s_add_u32 s48, s48, s58
  v_add_u32 v17, s48, v8
  v_bfe_u32 v20, v1, 4, 1
  v_lshlrev_b32 v7, 6, v20
  v_bfe_u32 v20, v1, 5, 1
  v_lshl_add_u32 v7, v20, 7, v7
  v_bfe_u32 v20, v1, 3, 1
  v_lshl_add_u32 v7, v20, 5, v7
  v_bfe_u32 v20, v1, 2, 1
  v_lshl_add_u32 v7, v20, 4, v7
  v_bfe_u32 v20, v1, 0, 1
  v_lshl_add_u32 v7, v20, 3, v7
  v_bfe_u32 v20, v1, 1, 1
  v_lshl_add_u32 v7, v20, 2, v7
  s_lshl_b32 s49, s55, 4
  v_xor_b32 v7, s49, v7
  s_lshl_b32 s48, s42, 8
  v_add_u32 v7, s48, v7
  s_mov_b32 s74, 0x33333333
  s_mov_b32 s75, 0x33333333
  s_mov_b32 s78, 0xfffefffe
  s_mov_b32 s79, 0x80008000
  s_cmp_eq_u32 s55, 1
  s_cselect_b64 s[76:77], -1, 0
  v_mov_b32 v64, 0
  v_mov_b32 v65, 0
  v_mov_b32 v66, 0
  v_mov_b32 v67, 0
  v_mov_b32 v68, 0
  v_mov_b32 v69, 0
  v_mov_b32 v70, 0
  v_mov_b32 v71, 0
  v_mov_b32 v72, 0
  v_mov_b32 v73, 0
  v_mov_b32 v74, 0
  v_mov_b32 v75, 0
  v_mov_b32 v228, -1
  v_mov_b32 v229, -1
  v_mov_b32 v230, -1
  v_mov_b32 v231, -1
  v_lshlrev_b32 v20, 4, v0
  v_add_u32 v21, 49152, v20
  ds_write_b128 v20, v[64:67] offset:0
  ds_write_b128 v21, v[64:67] offset:0
  ds_write_b128 v20, v[64:67] offset:4096
  ds_write_b128 v21, v[64:67] offset:4096
  ds_write_b128 v20, v[64:67] offset:8192
  ds_write_b128 v21, v[64:67] offset:8192
  ds_write_b128 v20, v[64:67] offset:12288
  ds_write_b128 v21, v[64:67] offset:12288
  ds_write_b128 v20, v[64:67] offset:16384
  ds_write_b128 v21, v[64:67] offset:16384
  ds_write_b128 v20, v[64:67] offset:20480
  ds_write_b128 v21, v[64:67] offset:20480
  ds_write_b128 v20, v[64:67] offset:24576
  ds_write_b128 v21, v[64:67] offset:24576
  ds_write_b128 v20, v[64:67] offset:28672
  ds_write_b128 v21, v[64:67] offset:28672
  ds_write_b128 v20, v[64:67] offset:32768
  ds_write_b128 v21, v[64:67] offset:32768
  ds_write_b128 v20, v[64:67] offset:36864
  ds_write_b128 v21, v[64:67] offset:36864
  ds_write_b128 v20, v[64:67] offset:40960
  ds_write_b128 v21, v[64:67] offset:40960
  ds_write_b128 v20, v[64:67] offset:45056
  ds_write_b128 v21, v[64:67] offset:45056
  ds_write_b128 v21, v[64:67] offset:49152
  s_lshl_b32 s48, s56, 2
  s_mul_i32 s49, s48, 40960
  s_lshl_b32 s50, s42, 10
  s_add_u32 s49, s49, s50
  s_add_u32 s49, s49, 0x9000000
  v_add_u32 v232, s49, v9
  v_add_u32 v233, 40960, v232
  v_add_u32 v234, 40960, v233
  v_add_u32 v235, 40960, v234
  v_xor_b32 v236, 1024, v232
  v_xor_b32 v237, 1024, v233
  v_xor_b32 v238, 1024, v234
  v_xor_b32 v239, 1024, v235
  s_lshl_b32 s48, s48, 8
  s_add_u32 s48, s48, 0x1366000
  v_lshlrev_b32 v240, 2, v1
  v_add_u32 v240, s48, v240
  s_mov_b64 s[84:85], 0
  s_waitcnt lgkmcnt(0)
  s_barrier
  s_mul_i32 s59, s40, 10240
  s_add_u32 s59, s59, 0x1000000
  s_add_u32 s60, s4, s59
  s_addc_u32 s61, s5, 0
  s_mov_b32 s45, 0
  s_mov_b32 s44, 0
  s_mov_b32 s53, -1
  s_lshl_b32 s52, s40, 6
  s_add_u32 s52, s52, s42
  s_lshl_b32 s52, s52, 2
  s_add_u32 s52, s52, 0x1370000
  s_lshl_b32 s48, s40, 11
  s_add_u32 s48, s48, 0x1366000
  v_lshlrev_b32 v28, 2, v1
  v_add_u32 v28, s48, v28
  s_mov_b64 s[92:93], 0
  s_cmp_lg_u32 s3, 0
  s_cbranch_scc1 OW_46
MW_47:
  s_bitcmp1_b64 s[92:93], s44
  s_cbranch_scc1 MD_48
  global_load_dword v20, v28, s[4:5] offset:0 sc1
  global_load_dword v21, v28, s[4:5] offset:256 sc1
  global_load_dword v22, v28, s[4:5] offset:512 sc1
  global_load_dword v23, v28, s[4:5] offset:768 sc1
  global_load_dword v24, v28, s[4:5] offset:1024 sc1
  global_load_dword v25, v28, s[4:5] offset:1280 sc1
  global_load_dword v26, v28, s[4:5] offset:1536 sc1
  global_load_dword v27, v28, s[4:5] offset:1792 sc1
  s_waitcnt vmcnt(0)
  v_and_b32 v20, v20, v21
  v_and_b32 v20, v20, v22
  v_and_b32 v20, v20, v23
  v_and_b32 v20, v20, v24
  v_and_b32 v20, v20, v25
  v_and_b32 v20, v20, v26
  v_and_b32 v20, v20, v27
  v_cmp_eq_u32 s[92:93], 1, v20
  s_nop 1
  s_bitcmp1_b64 s[92:93], s44
  s_cbranch_scc1 MD_48
  s_sleep 24
  s_add_u32 s66, s66, 1
  s_cmp_lt_u32 s66, 0x200000
  s_cbranch_scc1 MW_47
  s_endpgm
MD_48:
OW_46:
  s_barrier
MW_49:
  s_bitcmp1_b64 s[84:85], s44
  s_cbranch_scc1 MD_50
  global_load_dword v20, v240, s[4:5] offset:0 sc1
  global_load_dword v21, v240, s[4:5] offset:256 sc1
  global_load_dword v22, v240, s[4:5] offset:512 sc1
  global_load_dword v23, v240, s[4:5] offset:768 sc1
  s_waitcnt vmcnt(0)
  v_and_b32 v20, v20, v21
  v_and_b32 v20, v20, v22
  v_and_b32 v20, v20, v23
  v_cmp_eq_u32 s[84:85], 1, v20
  s_nop 1
  s_bitcmp1_b64 s[84:85], s44
  s_cbranch_scc1 MD_50
  s_sleep 8
  s_add_u32 s66, s66, 1
  s_cmp_lt_u32 s66, 0x200000
  s_cbranch_scc1 MW_49
  s_endpgm
MD_50:
  s_mul_i32 s48, s44, 1310720
  s_add_u32 s50, s4, s48
  s_addc_u32 s51, s5, 0
  global_load_dwordx4 v[96:99], v232, s[50:51] sc1
  global_load_dwordx4 v[100:103], v233, s[50:51] sc1
  global_load_dwordx4 v[104:107], v234, s[50:51] sc1
  global_load_dwordx4 v[108:111], v235, s[50:51] sc1
  global_load_dwordx4 v[116:119], v236, s[50:51] sc1
  global_load_dwordx4 v[120:123], v237, s[50:51] sc1
  global_load_dwordx4 v[124:127], v238, s[50:51] sc1
  global_load_dwordx4 v[128:131], v239, s[50:51] sc1
  s_add_u32 s64, s4, 491520
  s_addc_u32 s65, s5, 0
  s_add_u32 s82, s4, 327680
  s_addc_u32 s83, s5, 0
CB0_top:
  s_sub_u32 s47, s44, 1
  s_mov_b32 s46, s47
  s_and_b32 s48, s46, 3
  s_mul_i32 s49, s48, 81920
  s_add_u32 s62, s4, s49
  s_addc_u32 s63, s5, 0
  s_mul_i32 s48, s48, 20480
  s_add_u32 s89, s48, s87
  v_add_u32 v242, s48, v11
  s_bitcmp1_b32 s46, 2
  s_cselect_b32 s69, 0, 0x80008000
  s_cselect_b32 s71, 1.0, -1.0
  s_and_b32 s90, s46, 1
  s_xor_b32 s90, s90, 1
  s_mov_b32 m0, s89
  s_nop 0
  global_load_lds_dwordx4 v18, s[62:63] offset:0 sc1
  global_load_lds_dwordx4 v18, s[62:63] offset:1024 sc1
  global_load_lds_dwordx4 v18, s[62:63] offset:2048 sc1
  global_load_lds_dwordx4 v18, s[62:63] offset:3072 sc1
  s_add_u32 m0, s89, 4096
  s_nop 0
  global_load_lds_dwordx4 v4, s[62:63] sc1
  s_add_u32 s48, s44, 1
  s_and_b32 s48, s48, 3
  s_mul_i32 s48, s48, 40960
  s_add_u32 s48, s48, s59
  s_add_u32 s60, s4, s48
  s_addc_u32 s61, s5, 0
  s_add_u32 s48, s44, 3
  s_and_b32 s48, s48, 3
  s_mul_i32 s48, s48, 40960
  s_add_u32 s48, s48, s59
  s_add_u32 s80, s4, s48
  s_addc_u32 s81, s5, 0
  s_add_u32 s47, s44, 1
  s_min_u32 s47, s47, 63
  s_bitcmp1_b64 s[84:85], s47
  s_cselect_b32 s88, 1, 0
  s_cbranch_scc0 UE_51
  s_mul_i32 s48, s47, 1310720
  s_add_u32 s50, s4, s48
  s_addc_u32 s51, s5, 0
  global_load_dwordx4 v[176:179], v232, s[50:51] sc1
  global_load_dwordx4 v[180:183], v233, s[50:51] sc1
  global_load_dwordx4 v[184:187], v234, s[50:51] sc1
  global_load_dwordx4 v[188:191], v235, s[50:51] sc1
  global_load_dwordx4 v[192:195], v236, s[50:51] sc1
  global_load_dwordx4 v[196:199], v237, s[50:51] sc1
  global_load_dwordx4 v[200:203], v238, s[50:51] sc1
  global_load_dwordx4 v[204:207], v239, s[50:51] sc1
UE_51:
  s_bitcmp1_b32 s44, 1
  s_cselect_b32 s68, 0, 1
  s_xor_b32 s49, s68, 1
  v_mov_b32 v212, s49
  v_mov_b32 v213, s49
  v_mov_b32 v214, s49
  v_mov_b32 v215, s49
  v_mov_b32 v216, s49
  v_mov_b32 v217, s49
  s_waitcnt vmcnt(8)
  s_cmp_eq_u32 s53, -1
  s_cbranch_scc1 OF_52
  s_lshl_b32 s48, s53, 10
  s_add_u32 s48, s48, s52
  v_mov_b32 v20, s48
  v_mov_b32 v21, 1
  s_mov_b64 exec, 1
  s_cmp_eq_u32 s43, 0
  s_cbranch_scc1 SLOW_53
  global_store_dword v20, v21, s[4:5]
CONT_54:
  s_mov_b64 exec, -1
OF_52:
  ds_write_b128 v243, v[228:231]
  ds_write_b128 v243, v[228:231] offset:1024
  s_mov_b32 m0, s91
  s_waitcnt lgkmcnt(0)
CB0_yp:
  global_load_lds_dwordx4 v6, s[4:5] sc1
  global_load_lds_dwordx4 v6, s[4:5] offset:1024 sc1
  ds_read2st64_b32 v[112:113], v241 offset0:0 offset1:2
  ds_read2st64_b32 v[114:115], v241 offset0:4 offset1:6
  ds_read2st64_b32 v[132:133], v244 offset0:0 offset1:2
  ds_read2st64_b32 v[134:135], v244 offset0:4 offset1:6
  s_waitcnt lgkmcnt(2)
  v_max3_u32 v20, v112, v113, v114
  v_max_u32 v20, v20, v115
  v_cmp_eq_u32 vcc, -1, v20
  s_cbranch_vccz CB0_yg
  s_waitcnt vmcnt(2)
  s_add_u32 s66, s66, 1
  s_cmp_lt_u32 s66, 2097152
  s_cbranch_scc1 CB0_yp
  s_branch K2_abort
CB0_yg:
  s_waitcnt lgkmcnt(0)
  s_cmp_eq_u32 s44, 63
  s_cbranch_scc1 CB0_fin
CB0_pp:
  global_load_dwordx4 v[64:67], v10, s[4:5] sc1
  global_load_dwordx4 v[68:71], v10, s[4:5] offset:1024 sc1
  s_mov_b64 exec, s[74:75]
  global_load_dwordx4 v[72:75], v10, s[4:5] offset:2048 sc1
  s_mov_b64 exec, -1
  s_waitcnt vmcnt(3)
CB0_pc:
  v_bitop3_b32 v20, v64, v65, v66 bitop3:0x80
  v_bitop3_b32 v21, v72, v73, v74 bitop3:0x80
  v_bitop3_b32 v22, v67, v68, v69 bitop3:0x80
  v_and_b32 v21, v21, v75
  v_bitop3_b32 v20, v20, v70, v71 bitop3:0x80
  v_cndmask_b32 v21, v22, v21, s[74:75]
  v_bitop3_b32 v20, v20, v21, v22 bitop3:0x80
  v_and_b32 v20, s79, v20
  v_cmp_ne_u32 vcc, s79, v20
  s_cbranch_vccz CB0_pg
  s_add_u32 s66, s66, 1
  s_cmp_lt_u32 s66, 2097152
  s_cbranch_scc1 CB0_pp
  s_branch K2_abort
CB0_pg:
  v_mfma_f32_16x16x32_bf16 v[222:225], v[72:75], v[132:135], 0
  v_smfmac_f32_16x16x64_bf16 v[222:225], v[64:67], v[116:123], v3
  v_smfmac_f32_16x16x64_bf16 v[222:225], v[68:71], v[124:131], v3
  v_mfma_f32_16x16x32_bf16 v[218:221], v[72:75], v[112:115], 0
  v_smfmac_f32_16x16x64_bf16 v[218:221], v[64:67], v[96:103], v3
  v_smfmac_f32_16x16x64_bf16 v[218:221], v[68:71], v[104:111], v3
  s_nop 4
  v_pk_add_f32 v[222:223], v[222:223], v[224:225] neg_lo:[1,1] neg_hi:[1,1]
  v_or_b32 v222, 1, v222
  v_or_b32 v223, 1, v223
  ds_write_b64 v246, v[222:223]
  ds_read_b64 v[20:21], v245
  v_pk_add_f32 v[218:219], v[218:219], v[220:221] neg_lo:[1,1] neg_hi:[1,1]
CB0_sx:
  ds_read_b64 v[22:23], v245
  s_waitcnt lgkmcnt(1)
  v_and_b32 v2, v20, v21
  v_pk_add_f32 v[226:227], v[218:219], v[20:21]
  v_and_b32 v2, 1, v2
  v_cmp_ne_u32 vcc, 1, v2
  s_cbranch_vccz CB0_sxg
  ds_read_b64 v[20:21], v245
  s_waitcnt lgkmcnt(1)
  v_and_b32 v2, v22, v23
  v_pk_add_f32 v[226:227], v[218:219], v[22:23]
  v_and_b32 v2, 1, v2
  v_cmp_ne_u32 vcc, 1, v2
  s_cbranch_vccz CB0_sxg
  s_add_u32 s66, s66, 1
  s_cmp_lt_u32 s66, 2097152
  s_cbranch_scc1 CB0_sx
  s_branch K2_abort
CB0_sxg:
  v_and_or_b32 v226, v226, -2, s68
  v_and_or_b32 v227, v227, -2, s68
  global_store_dwordx2 v12, v[226:227], s[4:5] sc1
  global_store_dwordx2 v13, v[226:227], s[4:5] sc1
  global_store_dwordx2 v14, v[226:227], s[4:5] sc1
  s_sleep 7
  s_waitcnt lgkmcnt(0)
CB0_xp:
  global_load_dwordx2 v[212:213], v15, s[4:5] sc1
  global_load_dwordx2 v[214:215], v16, s[4:5] sc1
  global_load_dwordx2 v[216:217], v17, s[4:5] sc1
  s_waitcnt vmcnt(3)
  v_bitop3_b32 v20, v212, v213, s68 bitop3:0x7e
  v_bitop3_b32 v21, v214, v215, s68 bitop3:0x7e
  v_bitop3_b32 v22, v216, v217, s68 bitop3:0x7e
  v_pk_add_f32 v[218:219], v[226:227], v[212:213]
  v_or3_b32 v20, v20, v21, v22
  v_pk_add_f32 v[220:221], v[214:215], v[216:217]
  v_and_b32 v20, 1, v20
  v_cmp_ne_u32 vcc, 0, v20
  s_cbranch_vccz CB0_xg
  s_add_u32 s66, s66, 1
  s_cmp_lt_u32 s66, 2097152
  s_cbranch_scc1 CB0_xp
  s_branch K2_abort
CB0_xg:
  v_pk_add_f32 v[218:219], v[218:219], v[220:221]
  v_cvt_pk_bf16_f32 v218, v218, v219
  v_pk_min_u16 v218, s78, v218
  s_cmp_eq_u32 s43, 0
  s_cbranch_scc1 SLOW_55
  global_store_dword v7, v218, s[60:61]
CONT_56:
  s_cmp_eq_u32 s44, 0
  s_cbranch_scc1 CB0_first
  s_branch CB0_pt1
CB0_pt:
  s_mov_b32 m0, s89
  s_nop 0
  global_load_lds_dwordx4 v18, s[62:63] offset:0 sc1
  global_load_lds_dwordx4 v18, s[62:63] offset:1024 sc1
  global_load_lds_dwordx4 v18, s[62:63] offset:2048 sc1
  global_load_lds_dwordx4 v18, s[62:63] offset:3072 sc1
  s_add_u32 m0, s89, 4096
  s_nop 0
  global_load_lds_dwordx4 v4, s[62:63] sc1
  s_waitcnt vmcnt(0)
CB0_pt1:
  v_mov_b32 v20, 0
  v_mov_b32 v21, 0
  ds_read_b128 v[24:27], v242 offset:0
  ds_read_b128 v[28:31], v242 offset:1024
  ds_read_b128 v[32:35], v242 offset:2048
  ds_read_b128 v[36:39], v242 offset:3072
  ds_read_b128 v[40:43], v242 offset:4096
  ds_read_b128 v[44:47], v242 offset:5120
  ds_read_b128 v[48:51], v242 offset:6144
  ds_read_b128 v[52:55], v242 offset:7168
  s_waitcnt lgkmcnt(7)
  v_mfma_f32_16x16x32_bf16 v[84:87], v[156:159], v[24:27], 0
  v_bitop3_b32 v22, v24, v25, s69 bitop3:0x7e
  v_bitop3_b32 v23, v26, v27, s69 bitop3:0x7e
  v_mfma_f32_16x16x32_bf16 v[76:79], v[136:139], v[24:27], 0
  v_or3_b32 v20, v20, v22, v23
  ds_read_b128 v[24:27], v242 offset:8192
  s_waitcnt lgkmcnt(7)
  v_mfma_f32_16x16x32_bf16 v[84:87], v[160:163], v[28:31], v[84:87]
  v_bitop3_b32 v22, v28, v29, s69 bitop3:0x7e
  v_bitop3_b32 v23, v30, v31, s69 bitop3:0x7e
  v_mfma_f32_16x16x32_bf16 v[76:79], v[140:143], v[28:31], v[76:79]
  v_or3_b32 v21, v21, v22, v23
  ds_read_b128 v[28:31], v242 offset:9216
  s_waitcnt lgkmcnt(7)
  v_mfma_f32_16x16x32_bf16 v[84:87], v[164:167], v[32:35], v[84:87]
  v_bitop3_b32 v22, v32, v33, s69 bitop3:0x7e
  v_bitop3_b32 v23, v34, v35, s69 bitop3:0x7e
  v_mfma_f32_16x16x32_bf16 v[76:79], v[144:147], v[32:35], v[76:79]
  v_or3_b32 v20, v20, v22, v23
  s_waitcnt lgkmcnt(6)
  v_mfma_f32_16x16x32_bf16 v[84:87], v[168:171], v[36:39], v[84:87]
  v_bitop3_b32 v22, v36, v37, s69 bitop3:0x7e
  v_bitop3_b32 v23, v38, v39, s69 bitop3:0x7e
  v_mfma_f32_16x16x32_bf16 v[76:79], v[148:151], v[36:39], v[76:79]
  v_or3_b32 v21, v21, v22, v23
  s_waitcnt lgkmcnt(5)
  v_mfma_f32_16x16x32_bf16 v[84:87], v[172:175], v[40:43], v[84:87]
  v_bitop3_b32 v22, v40, v41, s69 bitop3:0x7e
  v_bitop3_b32 v23, v42, v43, s69 bitop3:0x7e
  v_mfma_f32_16x16x32_bf16 v[76:79], v[152:155], v[40:43], v[76:79]
  v_or3_b32 v20, v20, v22, v23
  s_waitcnt lgkmcnt(4)
  v_mfma_f32_16x16x32_bf16 v[88:91], v[156:159], v[44:47], 0
  v_bitop3_b32 v22, v44, v45, s69 bitop3:0x7e
  v_bitop3_b32 v23, v46, v47, s69 bitop3:0x7e
  v_mfma_f32_16x16x32_bf16 v[80:83], v[136:139], v[44:47], 0
  v_or3_b32 v21, v21, v22, v23
  s_waitcnt lgkmcnt(3)
  v_mfma_f32_16x16x32_bf16 v[88:91], v[160:163], v[48:51], v[88:91]
  v_bitop3_b32 v22, v48, v49, s69 bitop3:0x7e
  v_bitop3_b32 v23, v50, v51, s69 bitop3:0x7e
  v_mfma_f32_16x16x32_bf16 v[80:83], v[140:143], v[48:51], v[80:83]
  v_or3_b32 v20, v20, v22, v23
  s_waitcnt lgkmcnt(2)
  v_mfma_f32_16x16x32_bf16 v[88:91], v[164:167], v[52:55], v[88:91]
  v_bitop3_b32 v22, v52, v53, s69 bitop3:0x7e
  v_bitop3_b32 v23, v54, v55, s69 bitop3:0x7e
  v_mfma_f32_16x16x32_bf16 v[80:83], v[144:147], v[52:55], v[80:83]
  v_or3_b32 v21, v21, v22, v23
  s_waitcnt lgkmcnt(1)
  v_mfma_f32_16x16x32_bf16 v[88:91], v[168:171], v[24:27], v[88:91]
  v_bitop3_b32 v22, v24, v25, s69 bitop3:0x7e
  v_bitop3_b32 v23, v26, v27, s69 bitop3:0x7e
  v_mfma_f32_16x16x32_bf16 v[80:83], v[148:151], v[24:27], v[80:83]
  v_or3_b32 v20, v20, v22, v23
  s_waitcnt lgkmcnt(0)
  v_mfma_f32_16x16x32_bf16 v[88:91], v[172:175], v[28:31], v[88:91]
  v_bitop3_b32 v22, v28, v29, s69 bitop3:0x7e
  v_bitop3_b32 v23, v30, v31, s69 bitop3:0x7e
  v_mfma_f32_16x16x32_bf16 v[80:83], v[152:155], v[28:31], v[80:83]
  v_or3_b32 v21, v21, v22, v23
  v_or_b32 v20, v20, v21
  v_and_b32 v20, s79, v20
  v_cmp_ne_u32 vcc, 0, v20
  s_cbranch_vccz CB0_ptg
  s_add_u32 s66, s66, 1
  s_cmp_lt_u32 s66, 2097152
  s_cbranch_scc1 CB0_pt
  s_branch K2_abort
CB0_ptg:
  s_mul_i32 s48, s46, 40960
  s_add_u32 s50, s4, s48
  s_addc_u32 s51, s5, 0
  v_and_or_b32 v84, v84, -2, s90
  v_and_or_b32 v85, v85, -2, s90
  v_and_or_b32 v86, v86, -2, s90
  v_and_or_b32 v87, v87, -2, s90
  v_and_or_b32 v88, v88, -2, s90
  v_and_or_b32 v89, v89, -2, s90
  v_and_or_b32 v90, v90, -2, s90
  v_and_or_b32 v91, v91, -2, s90
  ds_write_b128 v248, v[84:87]
  ds_write_b128 v248, v[88:91] offset:1024
CB0_tx:
  ds_read_b128 v[56:59], v247
  ds_read_b128 v[60:63], v247 offset:1024
  s_waitcnt lgkmcnt(0)
  v_bitop3_b32 v20, v56, v57, s90 bitop3:0x7e
  v_bitop3_b32 v21, v58, v59, s90 bitop3:0x7e
  v_bitop3_b32 v22, v60, v61, s90 bitop3:0x7e
  v_bitop3_b32 v23, v62, v63, s90 bitop3:0x7e
  v_or3_b32 v20, v20, v21, v22
  v_or_b32 v20, v20, v23
  v_and_b32 v20, 1, v20
  v_cmp_ne_u32 vcc, 0, v20
  s_cbranch_vccz CB0_txg
  s_add_u32 s66, s66, 1
  s_cmp_lt_u32 s66, 2097152
  s_cbranch_scc1 CB0_tx
  s_branch K2_abort
CB0_txg:
  v_pk_add_f32 v[76:77], v[76:77], v[56:57]
  v_pk_add_f32 v[78:79], v[78:79], v[58:59]
  v_pk_add_f32 v[80:81], v[80:81], v[60:61]
  v_pk_add_f32 v[82:83], v[82:83], v[62:63]
  v_mul_f32 v76, s71, v76
  v_mul_f32 v77, s71, v77
  v_mul_f32 v78, s71, v78
  v_mul_f32 v79, s71, v79
  v_mul_f32 v80, s71, v80
  v_mul_f32 v81, s71, v81
  v_mul_f32 v82, s71, v82
  v_mul_f32 v83, s71, v83
  v_cvt_pk_bf16_f32 v92, v76, v77
  v_cvt_pk_bf16_f32 v93, v78, v79
  v_cvt_pk_bf16_f32 v94, v80, v81
  v_cvt_pk_bf16_f32 v95, v82, v83
  s_waitcnt vmcnt(1)
  s_cmp_eq_u32 s43, 0
  s_cbranch_scc1 SLOW_57
  global_store_dwordx2 v19, v[92:93], s[50:51]
  global_store_dwordx2 v5, v[94:95], s[50:51]
CONT_58:
  s_mov_b32 s53, s46
CB0_nopr:
  s_cmp_eq_u32 s43, 0
  s_cbranch_scc1 SLOW_59
  global_store_dwordx4 v6, v[228:231], s[4:5]
  global_store_dwordx4 v6, v[228:231], s[4:5] offset:1024
  global_store_dword v7, v228, s[80:81]
CONT_60:
  s_cmp_eq_u32 s88, 0
  s_cbranch_scc1 UL_61
  v_mov_b32 v136, v176
  v_mov_b32 v137, v177
  v_mov_b32 v138, v178
  v_mov_b32 v139, v179
  v_mov_b32 v140, v180
  v_mov_b32 v141, v181
  v_mov_b32 v142, v182
  v_mov_b32 v143, v183
  v_mov_b32 v144, v184
  v_mov_b32 v145, v185
  v_mov_b32 v146, v186
  v_mov_b32 v147, v187
  v_mov_b32 v148, v188
  v_mov_b32 v149, v189
  v_mov_b32 v150, v190
  v_mov_b32 v151, v191
  v_mov_b32 v156, v192
  v_mov_b32 v157, v193
  v_mov_b32 v158, v194
  v_mov_b32 v159, v195
  v_mov_b32 v160, v196
  v_mov_b32 v161, v197
  v_mov_b32 v162, v198
  v_mov_b32 v163, v199
  v_mov_b32 v164, v200
  v_mov_b32 v165, v201
  v_mov_b32 v166, v202
  v_mov_b32 v167, v203
  v_mov_b32 v168, v204
  v_mov_b32 v169, v205
  v_mov_b32 v170, v206
  v_mov_b32 v171, v207
UC_62:
  s_add_u32 s44, s44, 1
  s_branch CB1_top
CB0_fin:
  s_waitcnt vmcnt(0)
  s_branch CB0e_pt1
CB0e_pt:
  s_mov_b32 m0, s89
  s_nop 0
  global_load_lds_dwordx4 v18, s[62:63] offset:0 sc1
  global_load_lds_dwordx4 v18, s[62:63] offset:1024 sc1
  global_load_lds_dwordx4 v18, s[62:63] offset:2048 sc1
  global_load_lds_dwordx4 v18, s[62:63] offset:3072 sc1
  s_add_u32 m0, s89, 4096
  s_nop 0
  global_load_lds_dwordx4 v4, s[62:63] sc1
  s_waitcnt vmcnt(0)
CB0e_pt1:
  v_mov_b32 v20, 0
  v_mov_b32 v21, 0
  ds_read_b128 v[24:27], v242 offset:0
  ds_read_b128 v[28:31], v242 offset:1024
  ds_read_b128 v[32:35], v242 offset:2048
  ds_read_b128 v[36:39], v242 offset:3072
  ds_read_b128 v[40:43], v242 offset:4096
  ds_read_b128 v[44:47], v242 offset:5120
  ds_read_b128 v[48:51], v242 offset:6144
  ds_read_b128 v[52:55], v242 offset:7168
  s_waitcnt lgkmcnt(7)
  v_mfma_f32_16x16x32_bf16 v[84:87], v[156:159], v[24:27], 0
  v_bitop3_b32 v22, v24, v25, s69 bitop3:0x7e
  v_bitop3_b32 v23, v26, v27, s69 bitop3:0x7e
  v_mfma_f32_16x16x32_bf16 v[76:79], v[136:139], v[24:27], 0
  v_or3_b32 v20, v20, v22, v23
  ds_read_b128 v[24:27], v242 offset:8192
  s_waitcnt lgkmcnt(7)
  v_mfma_f32_16x16x32_bf16 v[84:87], v[160:163], v[28:31], v[84:87]
  v_bitop3_b32 v22, v28, v29, s69 bitop3:0x7e
  v_bitop3_b32 v23, v30, v31, s69 bitop3:0x7e
  v_mfma_f32_16x16x32_bf16 v[76:79], v[140:143], v[28:31], v[76:79]
  v_or3_b32 v21, v21, v22, v23
  ds_read_b128 v[28:31], v242 offset:9216
  s_waitcnt lgkmcnt(7)
  v_mfma_f32_16x16x32_bf16 v[84:87], v[164:167], v[32:35], v[84:87]
  v_bitop3_b32 v22, v32, v33, s69 bitop3:0x7e
  v_bitop3_b32 v23, v34, v35, s69 bitop3:0x7e
  v_mfma_f32_16x16x32_bf16 v[76:79], v[144:147], v[32:35], v[76:79]
  v_or3_b32 v20, v20, v22, v23
  s_waitcnt lgkmcnt(6)
  v_mfma_f32_16x16x32_bf16 v[84:87], v[168:171], v[36:39], v[84:87]
  v_bitop3_b32 v22, v36, v37, s69 bitop3:0x7e
  v_bitop3_b32 v23, v38, v39, s69 bitop3:0x7e
  v_mfma_f32_16x16x32_bf16 v[76:79], v[148:151], v[36:39], v[76:79]
  v_or3_b32 v21, v21, v22, v23
  s_waitcnt lgkmcnt(5)
  v_mfma_f32_16x16x32_bf16 v[84:87], v[172:175], v[40:43], v[84:87]
  v_bitop3_b32 v22, v40, v41, s69 bitop3:0x7e
  v_bitop3_b32 v23, v42, v43, s69 bitop3:0x7e
  v_mfma_f32_16x16x32_bf16 v[76:79], v[152:155], v[40:43], v[76:79]
  v_or3_b32 v20, v20, v22, v23
  s_waitcnt lgkmcnt(4)
  v_mfma_f32_16x16x32_bf16 v[88:91], v[156:159], v[44:47], 0
  v_bitop3_b32 v22, v44, v45, s69 bitop3:0x7e
  v_bitop3_b32 v23, v46, v47, s69 bitop3:0x7e
  v_mfma_f32_16x16x32_bf16 v[80:83], v[136:139], v[44:47], 0
  v_or3_b32 v21, v21, v22, v23
  s_waitcnt lgkmcnt(3)
  v_mfma_f32_16x16x32_bf16 v[88:91], v[160:163], v[48:51], v[88:91]
  v_bitop3_b32 v22, v48, v49, s69 bitop3:0x7e
  v_bitop3_b32 v23, v50, v51, s69 bitop3:0x7e
  v_mfma_f32_16x16x32_bf16 v[80:83], v[140:143], v[48:51], v[80:83]
  v_or3_b32 v20, v20, v22, v23
  s_waitcnt lgkmcnt(2)
  v_mfma_f32_16x16x32_bf16 v[88:91], v[164:167], v[52:55], v[88:91]
  v_bitop3_b32 v22, v52, v53, s69 bitop3:0x7e
  v_bitop3_b32 v23, v54, v55, s69 bitop3:0x7e
  v_mfma_f32_16x16x32_bf16 v[80:83], v[144:147], v[52:55], v[80:83]
  v_or3_b32 v21, v21, v22, v23
  s_waitcnt lgkmcnt(1)
  v_mfma_f32_16x16x32_bf16 v[88:91], v[168:171], v[24:27], v[88:91]
  v_bitop3_b32 v22, v24, v25, s69 bitop3:0x7e
  v_bitop3_b32 v23, v26, v27, s69 bitop3:0x7e
  v_mfma_f32_16x16x32_bf16 v[80:83], v[148:151], v[24:27], v[80:83]
  v_or3_b32 v20, v20, v22, v23
  s_waitcnt lgkmcnt(0)
  v_mfma_f32_16x16x32_bf16 v[88:91], v[172:175], v[28:31], v[88:91]
  v_bitop3_b32 v22, v28, v29, s69 bitop3:0x7e
  v_bitop3_b32 v23, v30, v31, s69 bitop3:0x7e
  v_mfma_f32_16x16x32_bf16 v[80:83], v[152:155], v[28:31], v[80:83]
  v_or3_b32 v21, v21, v22, v23
  v_or_b32 v20, v20, v21
  v_and_b32 v20, s79, v20
  v_cmp_ne_u32 vcc, 0, v20
  s_cbranch_vccz CB0e_ptg
  s_add_u32 s66, s66, 1
  s_cmp_lt_u32 s66, 2097152
  s_cbranch_scc1 CB0e_pt
  s_branch K2_abort
CB0e_ptg:
  s_mul_i32 s48, s46, 40960
  s_add_u32 s50, s4, s48
  s_addc_u32 s51, s5, 0
  v_and_or_b32 v84, v84, -2, s90
  v_and_or_b32 v85, v85, -2, s90
  v_and_or_b32 v86, v86, -2, s90
  v_and_or_b32 v87, v87, -2, s90
  v_and_or_b32 v88, v88, -2, s90
  v_and_or_b32 v89, v89, -2, s90
  v_and_or_b32 v90, v90, -2, s90
  v_and_or_b32 v91, v91, -2, s90
  ds_write_b128 v248, v[84:87]
  ds_write_b128 v248, v[88:91] offset:1024
CB0e_tx:
  ds_read_b128 v[56:59], v247
  ds_read_b128 v[60:63], v247 offset:1024
  s_waitcnt lgkmcnt(0)
  v_bitop3_b32 v20, v56, v57, s90 bitop3:0x7e
  v_bitop3_b32 v21, v58, v59, s90 bitop3:0x7e
  v_bitop3_b32 v22, v60, v61, s90 bitop3:0x7e
  v_bitop3_b32 v23, v62, v63, s90 bitop3:0x7e
  v_or3_b32 v20, v20, v21, v22
  v_or_b32 v20, v20, v23
  v_and_b32 v20, 1, v20
  v_cmp_ne_u32 vcc, 0, v20
  s_cbranch_vccz CB0e_txg
  s_add_u32 s66, s66, 1
  s_cmp_lt_u32 s66, 2097152
  s_cbranch_scc1 CB0e_tx
  s_branch K2_abort
CB0e_txg:
  v_pk_add_f32 v[76:77], v[76:77], v[56:57]
  v_pk_add_f32 v[78:79], v[78:79], v[58:59]
  v_pk_add_f32 v[80:81], v[80:81], v[60:61]
  v_pk_add_f32 v[82:83], v[82:83], v[62:63]
  v_mul_f32 v76, s71, v76
  v_mul_f32 v77, s71, v77
  v_mul_f32 v78, s71, v78
  v_mul_f32 v79, s71, v79
  v_mul_f32 v80, s71, v80
  v_mul_f32 v81, s71, v81
  v_mul_f32 v82, s71, v82
  v_mul_f32 v83, s71, v83
  v_cvt_pk_bf16_f32 v92, v76, v77
  v_cvt_pk_bf16_f32 v93, v78, v79
  v_cvt_pk_bf16_f32 v94, v80, v81
  v_cvt_pk_bf16_f32 v95, v82, v83
  global_store_dwordx2 v19, v[92:93], s[50:51] sc1
  global_store_dwordx2 v5, v[94:95], s[50:51] sc1
  s_mov_b32 s53, s46
  s_barrier
  s_mov_b32 s46, s44
  s_and_b32 s48, s46, 3
  s_mul_i32 s49, s48, 81920
  s_add_u32 s62, s4, s49
  s_addc_u32 s63, s5, 0
  s_mul_i32 s48, s48, 20480
  s_add_u32 s89, s48, s87
  v_add_u32 v242, s48, v11
  s_bitcmp1_b32 s46, 2
  s_cselect_b32 s69, 0, 0x80008000
  s_cselect_b32 s71, 1.0, -1.0
  s_and_b32 s90, s46, 1
  s_xor_b32 s90, s90, 1
CB0f_pt:
  s_mov_b32 m0, s89
  s_nop 0
  global_load_lds_dwordx4 v18, s[62:63] offset:0 sc1
  global_load_lds_dwordx4 v18, s[62:63] offset:1024 sc1
  global_load_lds_dwordx4 v18, s[62:63] offset:2048 sc1
  global_load_lds_dwordx4 v18, s[62:63] offset:3072 sc1
  s_add_u32 m0, s89, 4096
  s_nop 0
  global_load_lds_dwordx4 v4, s[62:63] sc1
  s_waitcnt vmcnt(0)
CB0f_pt1:
  v_mov_b32 v20, 0
  v_mov_b32 v21, 0
  ds_read_b128 v[24:27], v242 offset:0
  ds_read_b128 v[28:31], v242 offset:1024
  ds_read_b128 v[32:35], v242 offset:2048
  ds_read_b128 v[36:39], v242 offset:3072
  ds_read_b128 v[40:43], v242 offset:4096
  ds_read_b128 v[44:47], v242 offset:5120
  ds_read_b128 v[48:51], v242 offset:6144
  ds_read_b128 v[52:55], v242 offset:7168
  s_waitcnt lgkmcnt(7)
  v_mfma_f32_16x16x32_bf16 v[84:87], v[116:119], v[24:27], 0
  v_bitop3_b32 v22, v24, v25, s69 bitop3:0x7e
  v_bitop3_b32 v23, v26, v27, s69 bitop3:0x7e
  v_mfma_f32_16x16x32_bf16 v[76:79], v[96:99], v[24:27], 0
  v_or3_b32 v20, v20, v22, v23
  ds_read_b128 v[24:27], v242 offset:8192
  s_waitcnt lgkmcnt(7)
  v_mfma_f32_16x16x32_bf16 v[84:87], v[120:123], v[28:31], v[84:87]
  v_bitop3_b32 v22, v28, v29, s69 bitop3:0x7e
  v_bitop3_b32 v23, v30, v31, s69 bitop3:0x7e
  v_mfma_f32_16x16x32_bf16 v[76:79], v[100:103], v[28:31], v[76:79]
  v_or3_b32 v21, v21, v22, v23
  ds_read_b128 v[28:31], v242 offset:9216
  s_waitcnt lgkmcnt(7)
  v_mfma_f32_16x16x32_bf16 v[84:87], v[124:127], v[32:35], v[84:87]
  v_bitop3_b32 v22, v32, v33, s69 bitop3:0x7e
  v_bitop3_b32 v23, v34, v35, s69 bitop3:0x7e
  v_mfma_f32_16x16x32_bf16 v[76:79], v[104:107], v[32:35], v[76:79]
  v_or3_b32 v20, v20, v22, v23
  s_waitcnt lgkmcnt(6)
  v_mfma_f32_16x16x32_bf16 v[84:87], v[128:131], v[36:39], v[84:87]
  v_bitop3_b32 v22, v36, v37, s69 bitop3:0x7e
  v_bitop3_b32 v23, v38, v39, s69 bitop3:0x7e
  v_mfma_f32_16x16x32_bf16 v[76:79], v[108:111], v[36:39], v[76:79]
  v_or3_b32 v21, v21, v22, v23
  s_waitcnt lgkmcnt(5)
  v_mfma_f32_16x16x32_bf16 v[84:87], v[132:135], v[40:43], v[84:87]
  v_bitop3_b32 v22, v40, v41, s69 bitop3:0x7e
  v_bitop3_b32 v23, v42, v43, s69 bitop3:0x7e
  v_mfma_f32_16x16x32_bf16 v[76:79], v[112:115], v[40:43], v[76:79]
  v_or3_b32 v20, v20, v22, v23
  s_waitcnt lgkmcnt(4)
  v_mfma_f32_16x16x32_bf16 v[88:91], v[116:119], v[44:47], 0
  v_bitop3_b32 v22, v44, v45, s69 bitop3:0x7e
  v_bitop3_b32 v23, v46, v47, s69 bitop3:0x7e
  v_mfma_f32_16x16x32_bf16 v[80:83], v[96:99], v[44:47], 0
  v_or3_b32 v21, v21, v22, v23
  s_waitcnt lgkmcnt(3)
  v_mfma_f32_16x16x32_bf16 v[88:91], v[120:123], v[48:51], v[88:91]
  v_bitop3_b32 v22, v48, v49, s69 bitop3:0x7e
  v_bitop3_b32 v23, v50, v51, s69 bitop3:0x7e
  v_mfma_f32_16x16x32_bf16 v[80:83], v[100:103], v[48:51], v[80:83]
  v_or3_b32 v20, v20, v22, v23
  s_waitcnt lgkmcnt(2)
  v_mfma_f32_16x16x32_bf16 v[88:91], v[124:127], v[52:55], v[88:91]
  v_bitop3_b32 v22, v52, v53, s69 bitop3:0x7e
  v_bitop3_b32 v23, v54, v55, s69 bitop3:0x7e
  v_mfma_f32_16x16x32_bf16 v[80:83], v[104:107], v[52:55], v[80:83]
  v_or3_b32 v21, v21, v22, v23
  s_waitcnt lgkmcnt(1)
  v_mfma_f32_16x16x32_bf16 v[88:91], v[128:131], v[24:27], v[88:91]
  v_bitop3_b32 v22, v24, v25, s69 bitop3:0x7e
  v_bitop3_b32 v23, v26, v27, s69 bitop3:0x7e
  v_mfma_f32_16x16x32_bf16 v[80:83], v[108:111], v[24:27], v[80:83]
  v_or3_b32 v20, v20, v22, v23
  s_waitcnt lgkmcnt(0)
  v_mfma_f32_16x16x32_bf16 v[88:91], v[132:135], v[28:31], v[88:91]
  v_bitop3_b32 v22, v28, v29, s69 bitop3:0x7e
  v_bitop3_b32 v23, v30, v31, s69 bitop3:0x7e
  v_mfma_f32_16x16x32_bf16 v[80:83], v[112:115], v[28:31], v[80:83]
  v_or3_b32 v21, v21, v22, v23
  v_or_b32 v20, v20, v21
  v_and_b32 v20, s79, v20
  v_cmp_ne_u32 vcc, 0, v20
  s_cbranch_vccz CB0f_ptg
  s_add_u32 s66, s66, 1
  s_cmp_lt_u32 s66, 2097152
  s_cbranch_scc1 CB0f_pt
  s_branch K2_abort
CB0f_ptg:
  s_mul_i32 s48, s46, 40960
  s_add_u32 s50, s4, s48
  s_addc_u32 s51, s5, 0
  v_and_or_b32 v84, v84, -2, s90
  v_and_or_b32 v85, v85, -2, s90
  v_and_or_b32 v86, v86, -2, s90
  v_and_or_b32 v87, v87, -2, s90
  v_and_or_b32 v88, v88, -2, s90
  v_and_or_b32 v89, v89, -2, s90
  v_and_or_b32 v90, v90, -2, s90
  v_and_or_b32 v91, v91, -2, s90
  ds_write_b128 v248, v[84:87]
  ds_write_b128 v248, v[88:91] offset:1024
CB0f_tx:
  ds_read_b128 v[56:59], v247
  ds_read_b128 v[60:63], v247 offset:1024
  s_waitcnt lgkmcnt(0)
  v_bitop3_b32 v20, v56, v57, s90 bitop3:0x7e
  v_bitop3_b32 v21, v58, v59, s90 bitop3:0x7e
  v_bitop3_b32 v22, v60, v61, s90 bitop3:0x7e
  v_bitop3_b32 v23, v62, v63, s90 bitop3:0x7e
  v_or3_b32 v20, v20, v21, v22
  v_or_b32 v20, v20, v23
  v_and_b32 v20, 1, v20
  v_cmp_ne_u32 vcc, 0, v20
  s_cbranch_vccz CB0f_txg
  s_add_u32 s66, s66, 1
  s_cmp_lt_u32 s66, 2097152
  s_cbranch_scc1 CB0f_tx
  s_branch K2_abort
CB0f_txg:
  v_pk_add_f32 v[76:77], v[76:77], v[56:57]
  v_pk_add_f32 v[78:79], v[78:79], v[58:59]
  v_pk_add_f32 v[80:81], v[80:81], v[60:61]
  v_pk_add_f32 v[82:83], v[82:83], v[62:63]
  v_mul_f32 v76, s71, v76
  v_mul_f32 v77, s71, v77
  v_mul_f32 v78, s71, v78
  v_mul_f32 v79, s71, v79
  v_mul_f32 v80, s71, v80
  v_mul_f32 v81, s71, v81
  v_mul_f32 v82, s71, v82
  v_mul_f32 v83, s71, v83
  v_cvt_pk_bf16_f32 v92, v76, v77
  v_cvt_pk_bf16_f32 v93, v78, v79
  v_cvt_pk_bf16_f32 v94, v80, v81
  v_cvt_pk_bf16_f32 v95, v82, v83
  global_store_dwordx2 v19, v[92:93], s[50:51] sc1
  global_store_dwordx2 v5, v[94:95], s[50:51] sc1
  s_mov_b32 s53, s46
  s_sub_u32 s86, s53, 1
  s_cmp_eq_u32 s86, -1
  s_cbranch_scc1 OF_65
  s_lshl_b32 s48, s86, 10
  s_add_u32 s48, s48, s52
  v_mov_b32 v20, s48
  v_mov_b32 v21, 1
  s_mov_b64 exec, 1
  global_store_dword v20, v21, s[4:5] sc1
  s_mov_b64 exec, -1
OF_65:
  s_waitcnt vmcnt(0)
  s_cmp_eq_u32 s53, -1
  s_cbranch_scc1 OF_66
  s_lshl_b32 s48, s53, 10
  s_add_u32 s48, s48, s52
  v_mov_b32 v20, s48
  v_mov_b32 v21, 1
  s_mov_b64 exec, 1
  global_store_dword v20, v21, s[4:5] sc1
  s_mov_b64 exec, -1
OF_66:
  s_endpgm
CB1_top:
  s_sub_u32 s47, s44, 1
  s_mov_b32 s46, s47
  s_and_b32 s48, s46, 3
  s_mul_i32 s49, s48, 81920
  s_add_u32 s62, s4, s49
  s_addc_u32 s63, s5, 0
  s_mul_i32 s48, s48, 20480
  s_add_u32 s89, s48, s87
  v_add_u32 v242, s48, v11
  s_bitcmp1_b32 s46, 2
  s_cselect_b32 s69, 0, 0x80008000
  s_cselect_b32 s71, 1.0, -1.0
  s_and_b32 s90, s46, 1
  s_xor_b32 s90, s90, 1
  s_mov_b32 m0, s89
  s_nop 0
  global_load_lds_dwordx4 v18, s[62:63] offset:0 sc1
  global_load_lds_dwordx4 v18, s[62:63] offset:1024 sc1
  global_load_lds_dwordx4 v18, s[62:63] offset:2048 sc1
  global_load_lds_dwordx4 v18, s[62:63] offset:3072 sc1
  s_add_u32 m0, s89, 4096
  s_nop 0
  global_load_lds_dwordx4 v4, s[62:63] sc1
  s_add_u32 s48, s44, 1
  s_and_b32 s48, s48, 3
  s_mul_i32 s48, s48, 40960
  s_add_u32 s48, s48, s59
  s_add_u32 s60, s4, s48
  s_addc_u32 s61, s5, 0
  s_add_u32 s48, s44, 3
  s_and_b32 s48, s48, 3
  s_mul_i32 s48, s48, 40960
  s_add_u32 s48, s48, s59
  s_add_u32 s80, s4, s48
  s_addc_u32 s81, s5, 0
  s_add_u32 s47, s44, 1
  s_min_u32 s47, s47, 63
  s_bitcmp1_b64 s[84:85], s47
  s_cselect_b32 s88, 1, 0
  s_cbranch_scc0 UE_67
  s_mul_i32 s48, s47, 1310720
  s_add_u32 s50, s4, s48
  s_addc_u32 s51, s5, 0
  global_load_dwordx4 v[176:179], v232, s[50:51] sc1
  global_load_dwordx4 v[180:183], v233, s[50:51] sc1
  global_load_dwordx4 v[184:187], v234, s[50:51] sc1
  global_load_dwordx4 v[188:191], v235, s[50:51] sc1
  global_load_dwordx4 v[192:195], v236, s[50:51] sc1
  global_load_dwordx4 v[196:199], v237, s[50:51] sc1
  global_load_dwordx4 v[200:203], v238, s[50:51] sc1
  global_load_dwordx4 v[204:207], v239, s[50:51] sc1
UE_67:
  s_bitcmp1_b32 s44, 1
  s_cselect_b32 s68, 0, 1
  s_xor_b32 s49, s68, 1
  v_mov_b32 v212, s49
  v_mov_b32 v213, s49
  v_mov_b32 v214, s49
  v_mov_b32 v215, s49
  v_mov_b32 v216, s49
  v_mov_b32 v217, s49
  s_waitcnt vmcnt(8)
  s_cmp_eq_u32 s53, -1
  s_cbranch_scc1 OF_68
  s_lshl_b32 s48, s53, 10
  s_add_u32 s48, s48, s52
  v_mov_b32 v20, s48
  v_mov_b32 v21, 1
  s_mov_b64 exec, 1
  s_cmp_eq_u32 s43, 0
  s_cbranch_scc1 SLOW_69
  global_store_dword v20, v21, s[4:5]
CONT_70:
  s_mov_b64 exec, -1
OF_68:
  ds_write_b128 v243, v[228:231]
  ds_write_b128 v243, v[228:231] offset:1024
  s_mov_b32 m0, s91
  s_waitcnt lgkmcnt(0)
CB1_yp:
  global_load_lds_dwordx4 v6, s[82:83] sc1
  global_load_lds_dwordx4 v6, s[82:83] offset:1024 sc1
  ds_read2st64_b32 v[152:153], v241 offset0:0 offset1:2
  ds_read2st64_b32 v[154:155], v241 offset0:4 offset1:6
  ds_read2st64_b32 v[172:173], v244 offset0:0 offset1:2
  ds_read2st64_b32 v[174:175], v244 offset0:4 offset1:6
  s_waitcnt lgkmcnt(2)
  v_max3_u32 v20, v152, v153, v154
  v_max_u32 v20, v20, v155
  v_cmp_eq_u32 vcc, -1, v20
  s_cbranch_vccz CB1_yg
  s_waitcnt vmcnt(2)
  s_add_u32 s66, s66, 1
  s_cmp_lt_u32 s66, 2097152
  s_cbranch_scc1 CB1_yp
  s_branch K2_abort
CB1_yg:
  s_waitcnt lgkmcnt(0)
  s_cmp_eq_u32 s44, 63
  s_cbranch_scc1 CB1_fin
CB1_pp:
  global_load_dwordx4 v[64:67], v10, s[4:5] sc1
  global_load_dwordx4 v[68:71], v10, s[4:5] offset:1024 sc1
  s_mov_b64 exec, s[74:75]
  global_load_dwordx4 v[72:75], v10, s[4:5] offset:2048 sc1
  s_mov_b64 exec, -1
  s_waitcnt vmcnt(3)
CB1_pc:
  v_bitop3_b32 v20, v64, v65, v66 bitop3:0xfe
  v_bitop3_b32 v21, v72, v73, v74 bitop3:0xfe
  v_bitop3_b32 v22, v67, v68, v69 bitop3:0xfe
  v_or_b32 v21, v21, v75
  v_bitop3_b32 v20, v20, v70, v71 bitop3:0xfe
  v_cndmask_b32 v21, v22, v21, s[74:75]
  v_bitop3_b32 v20, v20, v21, v22 bitop3:0xfe
  v_and_b32 v20, s79, v20
  v_cmp_ne_u32 vcc, 0, v20
  s_cbranch_vccz CB1_pg
  s_add_u32 s66, s66, 1
  s_cmp_lt_u32 s66, 2097152
  s_cbranch_scc1 CB1_pp
  s_branch K2_abort
CB1_pg:
  v_mfma_f32_16x16x32_bf16 v[222:225], v[72:75], v[172:175], 0
  v_smfmac_f32_16x16x64_bf16 v[222:225], v[64:67], v[156:163], v3
  v_smfmac_f32_16x16x64_bf16 v[222:225], v[68:71], v[164:171], v3
  v_mfma_f32_16x16x32_bf16 v[218:221], v[72:75], v[152:155], 0
  v_smfmac_f32_16x16x64_bf16 v[218:221], v[64:67], v[136:143], v3
  v_smfmac_f32_16x16x64_bf16 v[218:221], v[68:71], v[144:151], v3
  s_nop 4
  v_pk_add_f32 v[222:223], v[222:223], v[224:225]
  v_and_b32 v222, -2, v222
  v_and_b32 v223, -2, v223
  ds_write_b64 v246, v[222:223]
  ds_read_b64 v[20:21], v245
  v_pk_add_f32 v[218:219], v[218:219], v[220:221]
CB1_sx:
  ds_read_b64 v[22:23], v245
  s_waitcnt lgkmcnt(1)
  v_or_b32 v2, v20, v21
  v_pk_add_f32 v[226:227], v[218:219], v[20:21]
  v_and_b32 v2, 1, v2
  v_cmp_ne_u32 vcc, 0, v2
  s_cbranch_vccz CB1_sxg
  ds_read_b64 v[20:21], v245
  s_waitcnt lgkmcnt(1)
  v_or_b32 v2, v22, v23
  v_pk_add_f32 v[226:227], v[218:219], v[22:23]
  v_and_b32 v2, 1, v2
  v_cmp_ne_u32 vcc, 0, v2
  s_cbranch_vccz CB1_sxg
  s_add_u32 s66, s66, 1
  s_cmp_lt_u32 s66, 2097152
  s_cbranch_scc1 CB1_sx
  s_branch K2_abort
CB1_sxg:
  v_and_or_b32 v226, v226, -2, s68
  v_and_or_b32 v227, v227, -2, s68
  global_store_dwordx2 v12, v[226:227], s[64:65] sc1
  global_store_dwordx2 v13, v[226:227], s[64:65] sc1
  global_store_dwordx2 v14, v[226:227], s[64:65] sc1
  s_sleep 7
  s_waitcnt lgkmcnt(0)
CB1_xp:
  global_load_dwordx2 v[212:213], v15, s[64:65] sc1
  global_load_dwordx2 v[214:215], v16, s[64:65] sc1
  global_load_dwordx2 v[216:217], v17, s[64:65] sc1
  s_waitcnt vmcnt(3)
  v_bitop3_b32 v20, v212, v213, s68 bitop3:0x7e
  v_bitop3_b32 v21, v214, v215, s68 bitop3:0x7e
  v_bitop3_b32 v22, v216, v217, s68 bitop3:0x7e
  v_pk_add_f32 v[218:219], v[226:227], v[212:213]
  v_or3_b32 v20, v20, v21, v22
  v_pk_add_f32 v[220:221], v[214:215], v[216:217]
  v_and_b32 v20, 1, v20
  v_cmp_ne_u32 vcc, 0, v20
  s_cbranch_vccz CB1_xg
  s_add_u32 s66, s66, 1
  s_cmp_lt_u32 s66, 2097152
  s_cbranch_scc1 CB1_xp
  s_branch K2_abort
CB1_xg:
  v_pk_add_f32 v[218:219], v[218:219], v[220:221]
  v_cvt_pk_bf16_f32 v218, v218, v219
  v_pk_min_u16 v218, s78, v218
  s_cmp_eq_u32 s43, 0
  s_cbranch_scc1 SLOW_71
  global_store_dword v7, v218, s[60:61]
CONT_72:
  s_branch CB1_pt1
CB1_pt:
  s_mov_b32 m0, s89
  s_nop 0
  global_load_lds_dwordx4 v18, s[62:63] offset:0 sc1
  global_load_lds_dwordx4 v18, s[62:63] offset:1024 sc1
  global_load_lds_dwordx4 v18, s[62:63] offset:2048 sc1
  global_load_lds_dwordx4 v18, s[62:63] offset:3072 sc1
  s_add_u32 m0, s89, 4096
  s_nop 0
  global_load_lds_dwordx4 v4, s[62:63] sc1
  s_waitcnt vmcnt(0)
CB1_pt1:
  v_mov_b32 v20, 0
  v_mov_b32 v21, 0
  ds_read_b128 v[24:27], v242 offset:0
  ds_read_b128 v[28:31], v242 offset:1024
  ds_read_b128 v[32:35], v242 offset:2048
  ds_read_b128 v[36:39], v242 offset:3072
  ds_read_b128 v[40:43], v242 offset:4096
  ds_read_b128 v[44:47], v242 offset:5120
  ds_read_b128 v[48:51], v242 offset:6144
  ds_read_b128 v[52:55], v242 offset:7168
  s_waitcnt lgkmcnt(7)
  v_mfma_f32_16x16x32_bf16 v[84:87], v[116:119], v[24:27], 0
  v_bitop3_b32 v22, v24, v25, s69 bitop3:0x7e
  v_bitop3_b32 v23, v26, v27, s69 bitop3:0x7e
  v_mfma_f32_16x16x32_bf16 v[76:79], v[96:99], v[24:27], 0
  v_or3_b32 v20, v20, v22, v23
  ds_read_b128 v[24:27], v242 offset:8192
  s_waitcnt lgkmcnt(7)
  v_mfma_f32_16x16x32_bf16 v[84:87], v[120:123], v[28:31], v[84:87]
  v_bitop3_b32 v22, v28, v29, s69 bitop3:0x7e
  v_bitop3_b32 v23, v30, v31, s69 bitop3:0x7e
  v_mfma_f32_16x16x32_bf16 v[76:79], v[100:103], v[28:31], v[76:79]
  v_or3_b32 v21, v21, v22, v23
  ds_read_b128 v[28:31], v242 offset:9216
  s_waitcnt lgkmcnt(7)
  v_mfma_f32_16x16x32_bf16 v[84:87], v[124:127], v[32:35], v[84:87]
  v_bitop3_b32 v22, v32, v33, s69 bitop3:0x7e
  v_bitop3_b32 v23, v34, v35, s69 bitop3:0x7e
  v_mfma_f32_16x16x32_bf16 v[76:79], v[104:107], v[32:35], v[76:79]
  v_or3_b32 v20, v20, v22, v23
  s_waitcnt lgkmcnt(6)
  v_mfma_f32_16x16x32_bf16 v[84:87], v[128:131], v[36:39], v[84:87]
  v_bitop3_b32 v22, v36, v37, s69 bitop3:0x7e
  v_bitop3_b32 v23, v38, v39, s69 bitop3:0x7e
  v_mfma_f32_16x16x32_bf16 v[76:79], v[108:111], v[36:39], v[76:79]
  v_or3_b32 v21, v21, v22, v23
  s_waitcnt lgkmcnt(5)
  v_mfma_f32_16x16x32_bf16 v[84:87], v[132:135], v[40:43], v[84:87]
  v_bitop3_b32 v22, v40, v41, s69 bitop3:0x7e
  v_bitop3_b32 v23, v42, v43, s69 bitop3:0x7e
  v_mfma_f32_16x16x32_bf16 v[76:79], v[112:115], v[40:43], v[76:79]
  v_or3_b32 v20, v20, v22, v23
  s_waitcnt lgkmcnt(4)
  v_mfma_f32_16x16x32_bf16 v[88:91], v[116:119], v[44:47], 0
  v_bitop3_b32 v22, v44, v45, s69 bitop3:0x7e
  v_bitop3_b32 v23, v46, v47, s69 bitop3:0x7e
  v_mfma_f32_16x16x32_bf16 v[80:83], v[96:99], v[44:47], 0
  v_or3_b32 v21, v21, v22, v23
  s_waitcnt lgkmcnt(3)
  v_mfma_f32_16x16x32_bf16 v[88:91], v[120:123], v[48:51], v[88:91]
  v_bitop3_b32 v22, v48, v49, s69 bitop3:0x7e
  v_bitop3_b32 v23, v50, v51, s69 bitop3:0x7e
  v_mfma_f32_16x16x32_bf16 v[80:83], v[100:103], v[48:51], v[80:83]
  v_or3_b32 v20, v20, v22, v23
  s_waitcnt lgkmcnt(2)
  v_mfma_f32_16x16x32_bf16 v[88:91], v[124:127], v[52:55], v[88:91]
  v_bitop3_b32 v22, v52, v53, s69 bitop3:0x7e
  v_bitop3_b32 v23, v54, v55, s69 bitop3:0x7e
  v_mfma_f32_16x16x32_bf16 v[80:83], v[104:107], v[52:55], v[80:83]
  v_or3_b32 v21, v21, v22, v23
  s_waitcnt lgkmcnt(1)
  v_mfma_f32_16x16x32_bf16 v[88:91], v[128:131], v[24:27], v[88:91]
  v_bitop3_b32 v22, v24, v25, s69 bitop3:0x7e
  v_bitop3_b32 v23, v26, v27, s69 bitop3:0x7e
  v_mfma_f32_16x16x32_bf16 v[80:83], v[108:111], v[24:27], v[80:83]
  v_or3_b32 v20, v20, v22, v23
  s_waitcnt lgkmcnt(0)
  v_mfma_f32_16x16x32_bf16 v[88:91], v[132:135], v[28:31], v[88:91]
  v_bitop3_b32 v22, v28, v29, s69 bitop3:0x7e
  v_bitop3_b32 v23, v30, v31, s69 bitop3:0x7e
  v_mfma_f32_16x16x32_bf16 v[80:83], v[112:115], v[28:31], v[80:83]
  v_or3_b32 v21, v21, v22, v23
  v_or_b32 v20, v20, v21
  v_and_b32 v20, s79, v20
  v_cmp_ne_u32 vcc, 0, v20
  s_cbranch_vccz CB1_ptg
  s_add_u32 s66, s66, 1
  s_cmp_lt_u32 s66, 2097152
  s_cbranch_scc1 CB1_pt
  s_branch K2_abort
CB1_ptg:
  s_mul_i32 s48, s46, 40960
  s_add_u32 s50, s4, s48
  s_addc_u32 s51, s5, 0
  v_and_or_b32 v84, v84, -2, s90
  v_and_or_b32 v85, v85, -2, s90
  v_and_or_b32 v86, v86, -2, s90
  v_and_or_b32 v87, v87, -2, s90
  v_and_or_b32 v88, v88, -2, s90
  v_and_or_b32 v89, v89, -2, s90
  v_and_or_b32 v90, v90, -2, s90
  v_and_or_b32 v91, v91, -2, s90
  ds_write_b128 v248, v[84:87]
  ds_write_b128 v248, v[88:91] offset:1024
CB1_tx:
  ds_read_b128 v[56:59], v247
  ds_read_b128 v[60:63], v247 offset:1024
  s_waitcnt lgkmcnt(0)
  v_bitop3_b32 v20, v56, v57, s90 bitop3:0x7e
  v_bitop3_b32 v21, v58, v59, s90 bitop3:0x7e
  v_bitop3_b32 v22, v60, v61, s90 bitop3:0x7e
  v_bitop3_b32 v23, v62, v63, s90 bitop3:0x7e
  v_or3_b32 v20, v20, v21, v22
  v_or_b32 v20, v20, v23
  v_and_b32 v20, 1, v20
  v_cmp_ne_u32 vcc, 0, v20
  s_cbranch_vccz CB1_txg
  s_add_u32 s66, s66, 1
  s_cmp_lt_u32 s66, 2097152
  s_cbranch_scc1 CB1_tx
  s_branch K2_abort
CB1_txg:
  v_pk_add_f32 v[76:77], v[76:77], v[56:57]
  v_pk_add_f32 v[78:79], v[78:79], v[58:59]
  v_pk_add_f32 v[80:81], v[80:81], v[60:61]
  v_pk_add_f32 v[82:83], v[82:83], v[62:63]
  v_mul_f32 v76, s71, v76
  v_mul_f32 v77, s71, v77
  v_mul_f32 v78, s71, v78
  v_mul_f32 v79, s71, v79
  v_mul_f32 v80, s71, v80
  v_mul_f32 v81, s71, v81
  v_mul_f32 v82, s71, v82
  v_mul_f32 v83, s71, v83
  v_cvt_pk_bf16_f32 v92, v76, v77
  v_cvt_pk_bf16_f32 v93, v78, v79
  v_cvt_pk_bf16_f32 v94, v80, v81
  v_cvt_pk_bf16_f32 v95, v82, v83
  s_waitcnt vmcnt(1)
  s_cmp_eq_u32 s43, 0
  s_cbranch_scc1 SLOW_73
  global_store_dwordx2 v19, v[92:93], s[50:51]
  global_store_dwordx2 v5, v[94:95], s[50:51]
CONT_74:
  s_mov_b32 s53, s46
CB1_nopr:
  s_cmp_eq_u32 s43, 0
  s_cbranch_scc1 SLOW_75
  global_store_dwordx4 v6, v[228:231], s[82:83]
  global_store_dwordx4 v6, v[228:231], s[82:83] offset:1024
  global_store_dword v7, v228, s[80:81]
CONT_76:
  s_cmp_eq_u32 s88, 0
  s_cbranch_scc1 UL_77
  v_mov_b32 v96, v176
  v_mov_b32 v97, v177
  v_mov_b32 v98, v178
  v_mov_b32 v99, v179
  v_mov_b32 v100, v180
  v_mov_b32 v101, v181
  v_mov_b32 v102, v182
  v_mov_b32 v103, v183
  v_mov_b32 v104, v184
  v_mov_b32 v105, v185
  v_mov_b32 v106, v186
  v_mov_b32 v107, v187
  v_mov_b32 v108, v188
  v_mov_b32 v109, v189
  v_mov_b32 v110, v190
  v_mov_b32 v111, v191
  v_mov_b32 v116, v192
  v_mov_b32 v117, v193
  v_mov_b32 v118, v194
  v_mov_b32 v119, v195
  v_mov_b32 v120, v196
  v_mov_b32 v121, v197
  v_mov_b32 v122, v198
  v_mov_b32 v123, v199
  v_mov_b32 v124, v200
  v_mov_b32 v125, v201
  v_mov_b32 v126, v202
  v_mov_b32 v127, v203
  v_mov_b32 v128, v204
  v_mov_b32 v129, v205
  v_mov_b32 v130, v206
  v_mov_b32 v131, v207
UC_78:
  s_add_u32 s44, s44, 1
  s_branch CB0_top
CB1_fin:
  s_waitcnt vmcnt(0)
  s_branch CB1e_pt1
CB1e_pt:
  s_mov_b32 m0, s89
  s_nop 0
  global_load_lds_dwordx4 v18, s[62:63] offset:0 sc1
  global_load_lds_dwordx4 v18, s[62:63] offset:1024 sc1
  global_load_lds_dwordx4 v18, s[62:63] offset:2048 sc1
  global_load_lds_dwordx4 v18, s[62:63] offset:3072 sc1
  s_add_u32 m0, s89, 4096
  s_nop 0
  global_load_lds_dwordx4 v4, s[62:63] sc1
  s_waitcnt vmcnt(0)
CB1e_pt1:
  v_mov_b32 v20, 0
  v_mov_b32 v21, 0
  ds_read_b128 v[24:27], v242 offset:0
  ds_read_b128 v[28:31], v242 offset:1024
  ds_read_b128 v[32:35], v242 offset:2048
  ds_read_b128 v[36:39], v242 offset:3072
  ds_read_b128 v[40:43], v242 offset:4096
  ds_read_b128 v[44:47], v242 offset:5120
  ds_read_b128 v[48:51], v242 offset:6144
  ds_read_b128 v[52:55], v242 offset:7168
  s_waitcnt lgkmcnt(7)
  v_mfma_f32_16x16x32_bf16 v[84:87], v[116:119], v[24:27], 0
  v_bitop3_b32 v22, v24, v25, s69 bitop3:0x7e
  v_bitop3_b32 v23, v26, v27, s69 bitop3:0x7e
  v_mfma_f32_16x16x32_bf16 v[76:79], v[96:99], v[24:27], 0
  v_or3_b32 v20, v20, v22, v23
  ds_read_b128 v[24:27], v242 offset:8192
  s_waitcnt lgkmcnt(7)
  v_mfma_f32_16x16x32_bf16 v[84:87], v[120:123], v[28:31], v[84:87]
  v_bitop3_b32 v22, v28, v29, s69 bitop3:0x7e
  v_bitop3_b32 v23, v30, v31, s69 bitop3:0x7e
  v_mfma_f32_16x16x32_bf16 v[76:79], v[100:103], v[28:31], v[76:79]
  v_or3_b32 v21, v21, v22, v23
  ds_read_b128 v[28:31], v242 offset:9216
  s_waitcnt lgkmcnt(7)
  v_mfma_f32_16x16x32_bf16 v[84:87], v[124:127], v[32:35], v[84:87]
  v_bitop3_b32 v22, v32, v33, s69 bitop3:0x7e
  v_bitop3_b32 v23, v34, v35, s69 bitop3:0x7e
  v_mfma_f32_16x16x32_bf16 v[76:79], v[104:107], v[32:35], v[76:79]
  v_or3_b32 v20, v20, v22, v23
  s_waitcnt lgkmcnt(6)
  v_mfma_f32_16x16x32_bf16 v[84:87], v[128:131], v[36:39], v[84:87]
  v_bitop3_b32 v22, v36, v37, s69 bitop3:0x7e
  v_bitop3_b32 v23, v38, v39, s69 bitop3:0x7e
  v_mfma_f32_16x16x32_bf16 v[76:79], v[108:111], v[36:39], v[76:79]
  v_or3_b32 v21, v21, v22, v23
  s_waitcnt lgkmcnt(5)
  v_mfma_f32_16x16x32_bf16 v[84:87], v[132:135], v[40:43], v[84:87]
  v_bitop3_b32 v22, v40, v41, s69 bitop3:0x7e
  v_bitop3_b32 v23, v42, v43, s69 bitop3:0x7e
  v_mfma_f32_16x16x32_bf16 v[76:79], v[112:115], v[40:43], v[76:79]
  v_or3_b32 v20, v20, v22, v23
  s_waitcnt lgkmcnt(4)
  v_mfma_f32_16x16x32_bf16 v[88:91], v[116:119], v[44:47], 0
  v_bitop3_b32 v22, v44, v45, s69 bitop3:0x7e
  v_bitop3_b32 v23, v46, v47, s69 bitop3:0x7e
  v_mfma_f32_16x16x32_bf16 v[80:83], v[96:99], v[44:47], 0
  v_or3_b32 v21, v21, v22, v23
  s_waitcnt lgkmcnt(3)
  v_mfma_f32_16x16x32_bf16 v[88:91], v[120:123], v[48:51], v[88:91]
  v_bitop3_b32 v22, v48, v49, s69 bitop3:0x7e
  v_bitop3_b32 v23, v50, v51, s69 bitop3:0x7e
  v_mfma_f32_16x16x32_bf16 v[80:83], v[100:103], v[48:51], v[80:83]
  v_or3_b32 v20, v20, v22, v23
  s_waitcnt lgkmcnt(2)
  v_mfma_f32_16x16x32_bf16 v[88:91], v[124:127], v[52:55], v[88:91]
  v_bitop3_b32 v22, v52, v53, s69 bitop3:0x7e
  v_bitop3_b32 v23, v54, v55, s69 bitop3:0x7e
  v_mfma_f32_16x16x32_bf16 v[80:83], v[104:107], v[52:55], v[80:83]
  v_or3_b32 v21, v21, v22, v23
  s_waitcnt lgkmcnt(1)
  v_mfma_f32_16x16x32_bf16 v[88:91], v[128:131], v[24:27], v[88:91]
  v_bitop3_b32 v22, v24, v25, s69 bitop3:0x7e
  v_bitop3_b32 v23, v26, v27, s69 bitop3:0x7e
  v_mfma_f32_16x16x32_bf16 v[80:83], v[108:111], v[24:27], v[80:83]
  v_or3_b32 v20, v20, v22, v23
  s_waitcnt lgkmcnt(0)
  v_mfma_f32_16x16x32_bf16 v[88:91], v[132:135], v[28:31], v[88:91]
  v_bitop3_b32 v22, v28, v29, s69 bitop3:0x7e
  v_bitop3_b32 v23, v30, v31, s69 bitop3:0x7e
  v_mfma_f32_16x16x32_bf16 v[80:83], v[112:115], v[28:31], v[80:83]
  v_or3_b32 v21, v21, v22, v23
  v_or_b32 v20, v20, v21
  v_and_b32 v20, s79, v20
  v_cmp_ne_u32 vcc, 0, v20
  s_cbranch_vccz CB1e_ptg
  s_add_u32 s66, s66, 1
  s_cmp_lt_u32 s66, 2097152
  s_cbranch_scc1 CB1e_pt
  s_branch K2_abort
CB1e_ptg:
  s_mul_i32 s48, s46, 40960
  s_add_u32 s50, s4, s48
  s_addc_u32 s51, s5, 0
  v_and_or_b32 v84, v84, -2, s90
  v_and_or_b32 v85, v85, -2, s90
  v_and_or_b32 v86, v86, -2, s90
  v_and_or_b32 v87, v87, -2, s90
  v_and_or_b32 v88, v88, -2, s90
  v_and_or_b32 v89, v89, -2, s90
  v_and_or_b32 v90, v90, -2, s90
  v_and_or_b32 v91, v91, -2, s90
  ds_write_b128 v248, v[84:87]
  ds_write_b128 v248, v[88:91] offset:1024
CB1e_tx:
  ds_read_b128 v[56:59], v247
  ds_read_b128 v[60:63], v247 offset:1024
  s_waitcnt lgkmcnt(0)
  v_bitop3_b32 v20, v56, v57, s90 bitop3:0x7e
  v_bitop3_b32 v21, v58, v59, s90 bitop3:0x7e
  v_bitop3_b32 v22, v60, v61, s90 bitop3:0x7e
  v_bitop3_b32 v23, v62, v63, s90 bitop3:0x7e
  v_or3_b32 v20, v20, v21, v22
  v_or_b32 v20, v20, v23
  v_and_b32 v20, 1, v20
  v_cmp_ne_u32 vcc, 0, v20
  s_cbranch_vccz CB1e_txg
  s_add_u32 s66, s66, 1
  s_cmp_lt_u32 s66, 2097152
  s_cbranch_scc1 CB1e_tx
  s_branch K2_abort
CB1e_txg:
  v_pk_add_f32 v[76:77], v[76:77], v[56:57]
  v_pk_add_f32 v[78:79], v[78:79], v[58:59]
  v_pk_add_f32 v[80:81], v[80:81], v[60:61]
  v_pk_add_f32 v[82:83], v[82:83], v[62:63]
  v_mul_f32 v76, s71, v76
  v_mul_f32 v77, s71, v77
  v_mul_f32 v78, s71, v78
  v_mul_f32 v79, s71, v79
  v_mul_f32 v80, s71, v80
  v_mul_f32 v81, s71, v81
  v_mul_f32 v82, s71, v82
  v_mul_f32 v83, s71, v83
  v_cvt_pk_bf16_f32 v92, v76, v77
  v_cvt_pk_bf16_f32 v93, v78, v79
  v_cvt_pk_bf16_f32 v94, v80, v81
  v_cvt_pk_bf16_f32 v95, v82, v83
  global_store_dwordx2 v19, v[92:93], s[50:51] sc1
  global_store_dwordx2 v5, v[94:95], s[50:51] sc1
  s_mov_b32 s53, s46
  s_barrier
  s_mov_b32 s46, s44
  s_and_b32 s48, s46, 3
  s_mul_i32 s49, s48, 81920
  s_add_u32 s62, s4, s49
  s_addc_u32 s63, s5, 0
  s_mul_i32 s48, s48, 20480
  s_add_u32 s89, s48, s87
  v_add_u32 v242, s48, v11
  s_bitcmp1_b32 s46, 2
  s_cselect_b32 s69, 0, 0x80008000
  s_cselect_b32 s71, 1.0, -1.0
  s_and_b32 s90, s46, 1
  s_xor_b32 s90, s90, 1
CB1f_pt:
  s_mov_b32 m0, s89
  s_nop 0
  global_load_lds_dwordx4 v18, s[62:63] offset:0 sc1
  global_load_lds_dwordx4 v18, s[62:63] offset:1024 sc1
  global_load_lds_dwordx4 v18, s[62:63] offset:2048 sc1
  global_load_lds_dwordx4 v18, s[62:63] offset:3072 sc1
  s_add_u32 m0, s89, 4096
  s_nop 0
  global_load_lds_dwordx4 v4, s[62:63] sc1
  s_waitcnt vmcnt(0)
CB1f_pt1:
  v_mov_b32 v20, 0
  v_mov_b32 v21, 0
  ds_read_b128 v[24:27], v242 offset:0
  ds_read_b128 v[28:31], v242 offset:1024
  ds_read_b128 v[32:35], v242 offset:2048
  ds_read_b128 v[36:39], v242 offset:3072
  ds_read_b128 v[40:43], v242 offset:4096
  ds_read_b128 v[44:47], v242 offset:5120
  ds_read_b128 v[48:51], v242 offset:6144
  ds_read_b128 v[52:55], v242 offset:7168
  s_waitcnt lgkmcnt(7)
  v_mfma_f32_16x16x32_bf16 v[84:87], v[156:159], v[24:27], 0
  v_bitop3_b32 v22, v24, v25, s69 bitop3:0x7e
  v_bitop3_b32 v23, v26, v27, s69 bitop3:0x7e
  v_mfma_f32_16x16x32_bf16 v[76:79], v[136:139], v[24:27], 0
  v_or3_b32 v20, v20, v22, v23
  ds_read_b128 v[24:27], v242 offset:8192
  s_waitcnt lgkmcnt(7)
  v_mfma_f32_16x16x32_bf16 v[84:87], v[160:163], v[28:31], v[84:87]
  v_bitop3_b32 v22, v28, v29, s69 bitop3:0x7e
  v_bitop3_b32 v23, v30, v31, s69 bitop3:0x7e
  v_mfma_f32_16x16x32_bf16 v[76:79], v[140:143], v[28:31], v[76:79]
  v_or3_b32 v21, v21, v22, v23
  ds_read_b128 v[28:31], v242 offset:9216
  s_waitcnt lgkmcnt(7)
  v_mfma_f32_16x16x32_bf16 v[84:87], v[164:167], v[32:35], v[84:87]
  v_bitop3_b32 v22, v32, v33, s69 bitop3:0x7e
  v_bitop3_b32 v23, v34, v35, s69 bitop3:0x7e
  v_mfma_f32_16x16x32_bf16 v[76:79], v[144:147], v[32:35], v[76:79]
  v_or3_b32 v20, v20, v22, v23
  s_waitcnt lgkmcnt(6)
  v_mfma_f32_16x16x32_bf16 v[84:87], v[168:171], v[36:39], v[84:87]
  v_bitop3_b32 v22, v36, v37, s69 bitop3:0x7e
  v_bitop3_b32 v23, v38, v39, s69 bitop3:0x7e
  v_mfma_f32_16x16x32_bf16 v[76:79], v[148:151], v[36:39], v[76:79]
  v_or3_b32 v21, v21, v22, v23
  s_waitcnt lgkmcnt(5)
  v_mfma_f32_16x16x32_bf16 v[84:87], v[172:175], v[40:43], v[84:87]
  v_bitop3_b32 v22, v40, v41, s69 bitop3:0x7e
  v_bitop3_b32 v23, v42, v43, s69 bitop3:0x7e
  v_mfma_f32_16x16x32_bf16 v[76:79], v[152:155], v[40:43], v[76:79]
  v_or3_b32 v20, v20, v22, v23
  s_waitcnt lgkmcnt(4)
  v_mfma_f32_16x16x32_bf16 v[88:91], v[156:159], v[44:47], 0
  v_bitop3_b32 v22, v44, v45, s69 bitop3:0x7e
  v_bitop3_b32 v23, v46, v47, s69 bitop3:0x7e
  v_mfma_f32_16x16x32_bf16 v[80:83], v[136:139], v[44:47], 0
  v_or3_b32 v21, v21, v22, v23
  s_waitcnt lgkmcnt(3)
  v_mfma_f32_16x16x32_bf16 v[88:91], v[160:163], v[48:51], v[88:91]
  v_bitop3_b32 v22, v48, v49, s69 bitop3:0x7e
  v_bitop3_b32 v23, v50, v51, s69 bitop3:0x7e
  v_mfma_f32_16x16x32_bf16 v[80:83], v[140:143], v[48:51], v[80:83]
  v_or3_b32 v20, v20, v22, v23
  s_waitcnt lgkmcnt(2)
  v_mfma_f32_16x16x32_bf16 v[88:91], v[164:167], v[52:55], v[88:91]
  v_bitop3_b32 v22, v52, v53, s69 bitop3:0x7e
  v_bitop3_b32 v23, v54, v55, s69 bitop3:0x7e
  v_mfma_f32_16x16x32_bf16 v[80:83], v[144:147], v[52:55], v[80:83]
  v_or3_b32 v21, v21, v22, v23
  s_waitcnt lgkmcnt(1)
  v_mfma_f32_16x16x32_bf16 v[88:91], v[168:171], v[24:27], v[88:91]
  v_bitop3_b32 v22, v24, v25, s69 bitop3:0x7e
  v_bitop3_b32 v23, v26, v27, s69 bitop3:0x7e
  v_mfma_f32_16x16x32_bf16 v[80:83], v[148:151], v[24:27], v[80:83]
  v_or3_b32 v20, v20, v22, v23
  s_waitcnt lgkmcnt(0)
  v_mfma_f32_16x16x32_bf16 v[88:91], v[172:175], v[28:31], v[88:91]
  v_bitop3_b32 v22, v28, v29, s69 bitop3:0x7e
  v_bitop3_b32 v23, v30, v31, s69 bitop3:0x7e
  v_mfma_f32_16x16x32_bf16 v[80:83], v[152:155], v[28:31], v[80:83]
  v_or3_b32 v21, v21, v22, v23
  v_or_b32 v20, v20, v21
  v_and_b32 v20, s79, v20
  v_cmp_ne_u32 vcc, 0, v20
  s_cbranch_vccz CB1f_ptg
  s_add_u32 s66, s66, 1
  s_cmp_lt_u32 s66, 2097152
  s_cbranch_scc1 CB1f_pt
  s_branch K2_abort
CB1f_ptg:
  s_mul_i32 s48, s46, 40960
  s_add_u32 s50, s4, s48
  s_addc_u32 s51, s5, 0
  v_and_or_b32 v84, v84, -2, s90
  v_and_or_b32 v85, v85, -2, s90
  v_and_or_b32 v86, v86, -2, s90
  v_and_or_b32 v87, v87, -2, s90
  v_and_or_b32 v88, v88, -2, s90
  v_and_or_b32 v89, v89, -2, s90
  v_and_or_b32 v90, v90, -2, s90
  v_and_or_b32 v91, v91, -2, s90
  ds_write_b128 v248, v[84:87]
  ds_write_b128 v248, v[88:91] offset:1024
CB1f_tx:
  ds_read_b128 v[56:59], v247
  ds_read_b128 v[60:63], v247 offset:1024
  s_waitcnt lgkmcnt(0)
  v_bitop3_b32 v20, v56, v57, s90 bitop3:0x7e
  v_bitop3_b32 v21, v58, v59, s90 bitop3:0x7e
  v_bitop3_b32 v22, v60, v61, s90 bitop3:0x7e
  v_bitop3_b32 v23, v62, v63, s90 bitop3:0x7e
  v_or3_b32 v20, v20, v21, v22
  v_or_b32 v20, v20, v23
  v_and_b32 v20, 1, v20
  v_cmp_ne_u32 vcc, 0, v20
  s_cbranch_vccz CB1f_txg
  s_add_u32 s66, s66, 1
  s_cmp_lt_u32 s66, 2097152
  s_cbranch_scc1 CB1f_tx
  s_branch K2_abort
CB1f_txg:
  v_pk_add_f32 v[76:77], v[76:77], v[56:57]
  v_pk_add_f32 v[78:79], v[78:79], v[58:59]
  v_pk_add_f32 v[80:81], v[80:81], v[60:61]
  v_pk_add_f32 v[82:83], v[82:83], v[62:63]
  v_mul_f32 v76, s71, v76
  v_mul_f32 v77, s71, v77
  v_mul_f32 v78, s71, v78
  v_mul_f32 v79, s71, v79
  v_mul_f32 v80, s71, v80
  v_mul_f32 v81, s71, v81
  v_mul_f32 v82, s71, v82
  v_mul_f32 v83, s71, v83
  v_cvt_pk_bf16_f32 v92, v76, v77
  v_cvt_pk_bf16_f32 v93, v78, v79
  v_cvt_pk_bf16_f32 v94, v80, v81
  v_cvt_pk_bf16_f32 v95, v82, v83
  global_store_dwordx2 v19, v[92:93], s[50:51] sc1
  global_store_dwordx2 v5, v[94:95], s[50:51] sc1
  s_mov_b32 s53, s46
  s_sub_u32 s86, s53, 1
  s_cmp_eq_u32 s86, -1
  s_cbranch_scc1 OF_81
  s_lshl_b32 s48, s86, 10
  s_add_u32 s48, s48, s52
  v_mov_b32 v20, s48
  v_mov_b32 v21, 1
  s_mov_b64 exec, 1
  global_store_dword v20, v21, s[4:5] sc1
  s_mov_b64 exec, -1
OF_81:
  s_waitcnt vmcnt(0)
  s_cmp_eq_u32 s53, -1
  s_cbranch_scc1 OF_82
  s_lshl_b32 s48, s53, 10
  s_add_u32 s48, s48, s52
  v_mov_b32 v20, s48
  v_mov_b32 v21, 1
  s_mov_b64 exec, 1
  global_store_dword v20, v21, s[4:5] sc1
  s_mov_b64 exec, -1
OF_82:
  s_endpgm
K2_fwd:
  s_cmp_lg_u32 s3, 0
  s_cbranch_scc1 OW_83
  s_sleep 127
  s_sleep 127
  v_mov_b32 v20, 32
IW_84:
  global_load_dword v21, v20, s[6:7] sc1
  s_waitcnt vmcnt(0)
  v_cmp_ne_u32 vcc, 64, v21
  s_cbranch_vccz ID_85
  s_sleep 24
  s_add_u32 s66, s66, 1
  s_cmp_lt_u32 s66, 0x200000
  s_cbranch_scc1 IW_84
  s_endpgm
ID_85:
OW_83:
  s_barrier
  s_mul_i32 s48, s40, 256
  s_add_u32 s48, s48, 0x1370000
  v_min_u32 v8, 39, v1
  v_lshlrev_b32 v8, 2, v8
  v_add_u32 v8, s48, v8
  s_mul_i32 s48, s40, 2621440
  s_mul_i32 s49, s3, 10240
  s_add_u32 s48, s48, s49
  s_add_u32 s48, s48, 0x6400000
  v_lshlrev_b32 v9, 4, v1
  v_add_u32 v9, s48, v9
  v_add_u32 v10, 4096, v9
  v_add_u32 v11, 8192, v9
  s_lshl_b32 s58, s40, 2
  s_add_u32 s58, s58, 0x136e000
  s_mov_b32 s44, 0
FW_loop:
  s_lshl_b32 s48, s44, 10
  s_add_u32 s50, s4, s48
  s_addc_u32 s51, s5, 0
FW_poll:
  global_load_dword v12, v8, s[50:51] sc1
  s_waitcnt vmcnt(0)
  v_cmp_ne_u32 vcc, 1, v12
  s_cbranch_vccz FW_go
  s_sleep 6
  s_add_u32 s66, s66, 1
  s_cmp_lt_u32 s66, 2097152
  s_cbranch_scc1 FW_poll
  s_branch K2_abort
FW_go:
  s_mul_i32 s48, s44, 40960
  s_add_u32 s50, s4, s48
  s_addc_u32 s51, s5, 0
  s_add_u32 s52, s50, 0xa00000
  s_addc_u32 s53, s51, 0
  global_load_dwordx4 v[24:27], v9, s[50:51] offset:0 sc1
  global_load_dwordx4 v[28:31], v9, s[50:51] offset:1024 sc1
  global_load_dwordx4 v[32:35], v9, s[50:51] offset:2048 sc1
  global_load_dwordx4 v[36:39], v9, s[50:51] offset:3072 sc1
  global_load_dwordx4 v[40:43], v10, s[50:51] offset:0 sc1
  global_load_dwordx4 v[44:47], v10, s[50:51] offset:1024 sc1
  global_load_dwordx4 v[48:51], v10, s[50:51] offset:2048 sc1
  global_load_dwordx4 v[52:55], v10, s[50:51] offset:3072 sc1
  global_load_dwordx4 v[56:59], v11, s[50:51] offset:0 sc1
  global_load_dwordx4 v[60:63], v11, s[50:51] offset:1024 sc1
  s_waitcnt vmcnt(9)
  global_store_dwordx4 v9, v[24:27], s[52:53] offset:0 sc1
  s_waitcnt vmcnt(9)
  global_store_dwordx4 v9, v[28:31], s[52:53] offset:1024 sc1
  s_waitcnt vmcnt(9)
  global_store_dwordx4 v9, v[32:35], s[52:53] offset:2048 sc1
  s_waitcnt vmcnt(9)
  global_store_dwordx4 v9, v[36:39], s[52:53] offset:3072 sc1
  s_waitcnt vmcnt(9)
  global_store_dwordx4 v10, v[40:43], s[52:53] offset:0 sc1
  s_waitcnt vmcnt(9)
  global_store_dwordx4 v10, v[44:47], s[52:53] offset:1024 sc1
  s_waitcnt vmcnt(9)
  global_store_dwordx4 v10, v[48:51], s[52:53] offset:2048 sc1
  s_waitcnt vmcnt(9)
  global_store_dwordx4 v10, v[52:55], s[52:53] offset:3072 sc1
  s_waitcnt vmcnt(9)
  global_store_dwordx4 v11, v[56:59], s[52:53] offset:0 sc1
  s_waitcnt vmcnt(9)
  global_store_dwordx4 v11, v[60:63], s[52:53] offset:1024 sc1
  s_waitcnt vmcnt(0)
  s_barrier
  s_cmp_eq_u32 s44, -1
  s_cbranch_scc1 FS_86
  s_cmp_lg_u32 s3, 0
  s_cbranch_scc1 FS_86
  s_lshl_b32 s48, s44, 4
  s_add_u32 s48, s48, s58
  v_mov_b32 v5, s48
  v_mov_b32 v6, 1
  s_mov_b64 exec, 1
  global_store_dword v5, v6, s[4:5] sc1
  s_mov_b64 exec, -1
FS_86:
  s_add_u32 s44, s44, 1
  s_cmp_lt_u32 s44, 62
  s_cbranch_scc1 FW_loop
  s_endpgm
K2_pf:
  s_sub_u32 s41, s41, 26
  s_cmp_lg_u32 s3, 0
  s_cbranch_scc1 OW_87
  s_sleep 96
  v_mov_b32 v20, 32
IW_88:
  global_load_dword v21, v20, s[6:7] sc1
  s_waitcnt vmcnt(0)
  v_cmp_ne_u32 vcc, 64, v21
  s_cbranch_vccz ID_89
  s_sleep 24
  s_add_u32 s66, s66, 1
  s_cmp_lt_u32 s66, 0x200000
  s_cbranch_scc1 IW_88
  s_endpgm
ID_89:
OW_87:
  s_barrier
  s_load_dwordx2 s[6:7], s[0:1], 96
  s_lshl_b32 s42, s40, 3
  s_lshl_b32 s48, s41, 1
  s_add_u32 s42, s42, s48
  v_lshlrev_b32 v8, 7, v1
  s_mul_i32 s48, s42, 40960
  s_add_u32 s48, s48, 0x9000000
  s_mul_i32 s49, s42, 12288
  s_mov_b32 s56, 1310720
  s_mov_b32 s57, 1310720
  s_cmp_eq_u32 s3, 0
  s_cbranch_scc1 PFW_90
  s_sub_u32 s50, s3, 1
  s_lshl_b32 s50, s50, 15
  s_add_u32 s50, s50, s48
  v_add_u32 v10, s50, v8
  v_add_u32 v11, 8192, v10
  v_add_u32 v12, 16384, v10
  v_add_u32 v13, 24576, v10
  s_cmp_lg_u32 s3, 3
  s_cbranch_scc1 PFJ_91
  s_add_u32 s50, s49, 0x3404000
  v_add_u32 v12, s50, v8
  s_add_u32 s50, s49, 0x4c04000
  v_add_u32 v13, s50, v8
  s_mov_b32 s57, 393216
  s_branch PFJ_91
PFW_90:
  s_add_u32 s50, s49, 0x3400000
  v_add_u32 v10, s50, v8
  v_add_u32 v11, 8192, v10
  s_add_u32 s50, s49, 0x4c00000
  v_add_u32 v12, s50, v8
  v_add_u32 v13, 8192, v12
  s_mov_b32 s56, 393216
  s_mov_b32 s57, 393216
PFJ_91:
  s_lshl_b32 s48, s42, 8
  s_add_u32 s48, s48, 0x1360000
  v_lshlrev_b32 v14, 2, v1
  v_add_u32 v14, s48, v14
  v_add_u32 v15, 0x2000, v14
  v_add_u32 v16, 0x6000, v14
  s_mov_b64 s[84:85], 0
  s_mul_i32 s59, s40, 10240
  s_add_u32 s59, s59, 0x1000000
  s_add_u32 s60, s4, s59
  s_addc_u32 s61, s5, 0
  s_mov_b32 s44, 0
  s_waitcnt lgkmcnt(0)
  s_cmp_lg_u32 s3, 0
  s_cbranch_scc1 OW_92
MW_93:
  s_bitcmp1_b64 s[84:85], s44
  s_cbranch_scc1 MD_94
  global_load_dword v20, v14, s[4:5] offset:0 sc1
  global_load_dword v21, v14, s[4:5] offset:256 sc1
  global_load_dword v22, v15, s[4:5] offset:0 sc1
  global_load_dword v23, v15, s[4:5] offset:256 sc1
  global_load_dword v24, v16, s[4:5] offset:0 sc1
  global_load_dword v25, v16, s[4:5] offset:256 sc1
  s_waitcnt vmcnt(0)
  v_and_b32 v20, v20, v21
  v_and_b32 v20, v20, v22
  v_and_b32 v20, v20, v23
  v_and_b32 v20, v20, v24
  v_and_b32 v20, v20, v25
  v_cmp_eq_u32 s[84:85], 1, v20
  s_nop 1
  s_bitcmp1_b64 s[84:85], s44
  s_cbranch_scc1 MD_94
  s_sleep 32
  s_add_u32 s66, s66, 1
  s_cmp_lt_u32 s66, 0x200000
  s_cbranch_scc1 MW_93
  s_endpgm
MD_94:
OW_92:
  s_barrier
PF_loop:
MW_95:
  s_bitcmp1_b64 s[84:85], s44
  s_cbranch_scc1 MD_96
  global_load_dword v20, v14, s[4:5] offset:0 sc1
  global_load_dword v21, v14, s[4:5] offset:256 sc1
  global_load_dword v22, v15, s[4:5] offset:0 sc1
  global_load_dword v23, v15, s[4:5] offset:256 sc1
  global_load_dword v24, v16, s[4:5] offset:0 sc1
  global_load_dword v25, v16, s[4:5] offset:256 sc1
  s_waitcnt vmcnt(0)
  v_and_b32 v20, v20, v21
  v_and_b32 v20, v20, v22
  v_and_b32 v20, v20, v23
  v_and_b32 v20, v20, v24
  v_and_b32 v20, v20, v25
  v_cmp_eq_u32 s[84:85], 1, v20
  s_nop 1
  s_bitcmp1_b64 s[84:85], s44
  s_cbranch_scc1 MD_96
  s_sleep 32
  s_add_u32 s66, s66, 1
  s_cmp_lt_u32 s66, 0x200000
  s_cbranch_scc1 MW_95
  s_endpgm
MD_96:
  s_cmp_lt_u32 s44, 2
  s_cbranch_scc1 PF_go
  s_max_u32 s48, s44, 4
  s_sub_u32 s48, s48, 4
  s_lshl_b32 s48, s48, 10
  s_mul_i32 s49, s40, 256
  s_add_u32 s48, s48, s49
  s_add_u32 s48, s48, 0x1370000
  v_mov_b32 v17, s48
  s_sub_u32 s48, s44, 2
  s_and_b32 s48, s48, 3
  s_mul_i32 s48, s48, 40960
  s_add_u32 s48, s48, s59
  s_add_u32 s60, s4, s48
  s_addc_u32 s61, s5, 0
PF_poll:
  global_load_dword v9, v8, s[60:61] sc1
  global_load_dword v18, v17, s[4:5] sc1
  s_waitcnt vmcnt(0)
  v_cmp_eq_u32 vcc, -1, v9
  s_cbranch_vccz PF_adv
  v_cmp_ne_u32 vcc, 1, v18
  s_cbranch_vccz PF_go
  s_sleep 3
  s_add_u32 s66, s66, 1
  s_cmp_lt_u32 s66, 2097152
  s_cbranch_scc1 PF_poll
  s_branch K2_abort
PF_adv:
  s_sleep 2
PF_go:
  s_mul_i32 s48, s44, s56
  s_add_u32 s50, s4, s48
  s_addc_u32 s51, s5, 0
  s_mul_i32 s48, s44, s57
  s_add_u32 s52, s4, s48
  s_addc_u32 s53, s5, 0
  global_load_dword v24, v10, s[50:51]
  global_load_dword v25, v11, s[50:51]
  global_load_dword v26, v12, s[52:53]
  global_load_dword v27, v13, s[52:53]
  s_add_u32 s44, s44, 1
  s_cmp_lt_u32 s44, 64
  s_cbranch_scc1 PF_loop
  s_endpgm
QK_nan:
  v_mov_b32 v28, 0
  v_mov_b32 v29, 0
  ds_read_b128 v[24:27], v125 offset:0
  s_waitcnt lgkmcnt(0)
  v_pk_max_u16 v28, v28, v24
  v_pk_max_u16 v29, v29, v25
  v_pk_max_u16 v28, v28, v26
  v_pk_max_u16 v29, v29, v27
  ds_read_b128 v[24:27], v125 offset:1024
  s_waitcnt lgkmcnt(0)
  v_pk_max_u16 v28, v28, v24
  v_pk_max_u16 v29, v29, v25
  v_pk_max_u16 v28, v28, v26
  v_pk_max_u16 v29, v29, v27
  ds_read_b128 v[24:27], v125 offset:2048
  s_waitcnt lgkmcnt(0)
  v_pk_max_u16 v28, v28, v24
  v_pk_max_u16 v29, v29, v25
  v_pk_max_u16 v28, v28, v26
  v_pk_max_u16 v29, v29, v27
  ds_read_b128 v[24:27], v125 offset:3072
  s_waitcnt lgkmcnt(0)
  v_pk_max_u16 v28, v28, v24
  v_pk_max_u16 v29, v29, v25
  v_pk_max_u16 v28, v28, v26
  v_pk_max_u16 v29, v29, v27
  ds_read_b128 v[24:27], v125 offset:4096
  s_waitcnt lgkmcnt(0)
  v_pk_max_u16 v28, v28, v24
  v_pk_max_u16 v29, v29, v25
  v_pk_max_u16 v28, v28, v26
  v_pk_max_u16 v29, v29, v27
  ds_read_b128 v[24:27], v125 offset:5120
  s_waitcnt lgkmcnt(0)
  v_pk_max_u16 v28, v28, v24
  v_pk_max_u16 v29, v29, v25
  v_pk_max_u16 v28, v28, v26
  v_pk_max_u16 v29, v29, v27
  ds_read_b128 v[24:27], v125 offset:6144
  s_waitcnt lgkmcnt(0)
  v_pk_max_u16 v28, v28, v24
  v_pk_max_u16 v29, v29, v25
  v_pk_max_u16 v28, v28, v26
  v_pk_max_u16 v29, v29, v27
  ds_read_b128 v[24:27], v125 offset:7168
  s_waitcnt lgkmcnt(0)
  v_pk_max_u16 v28, v28, v24
  v_pk_max_u16 v29, v29, v25
  v_pk_max_u16 v28, v28, v26
  v_pk_max_u16 v29, v29, v27
  ds_read_b128 v[24:27], v125 offset:8192
  s_waitcnt lgkmcnt(0)
  v_pk_max_u16 v28, v28, v24
  v_pk_max_u16 v29, v29, v25
  v_pk_max_u16 v28, v28, v26
  v_pk_max_u16 v29, v29, v27
  ds_read_b128 v[24:27], v125 offset:9216
  s_waitcnt lgkmcnt(0)
  v_pk_max_u16 v28, v28, v24
  v_pk_max_u16 v29, v29, v25
  v_pk_max_u16 v28, v28, v26
  v_pk_max_u16 v29, v29, v27
  v_pk_max_u16 v28, v28, v29
  v_lshrrev_b32 v29, 16, v28
  v_and_b32 v28, 0xffff, v28
  v_max_u32 v28, v28, v29
  v_cmp_eq_u32 vcc, 0xffff, v28
  s_cbranch_vccnz QK_nanr
  s_branch QK_nanc
QK_nanr:
  s_add_u32 s66, s66, 1
  s_cmp_lt_u32 s66, 2097152
  s_cbranch_scc1 QK_step
  s_branch K2_abort
QK_smx:
  v_max3_f32 v20, v72, v73, v74
  v_max_f32 v20, v20, v75
  v_mov_b32 v21, v20
  s_nop 1
  v_permlane16_swap_b32 v20, v21
  v_max_f32 v20, v20, v21
  v_mov_b32 v21, v20
  s_nop 1
  v_permlane32_swap_b32 v20, v21
  v_max_f32 v20, v20, v21
  v_mul_f32 v20, s70, v20
  v_mov_b32 v80, v20
  v_pk_fma_f32 v[76:77], v[72:73], s[70:71], v[20:21] op_sel_hi:[1,0,0] neg_lo:[0,0,1] neg_hi:[0,0,1]
  v_pk_fma_f32 v[78:79], v[74:75], s[70:71], v[20:21] op_sel_hi:[1,0,0] neg_lo:[0,0,1] neg_hi:[0,0,1]
  v_exp_f32 v76, v76
  v_exp_f32 v77, v77
  v_exp_f32 v78, v78
  v_exp_f32 v79, v79
  ds_write_b32 v114, v20 offset:768
  v_pk_add_f32 v[22:23], v[76:77], v[78:79]
  v_add_f32 v21, v22, v23
  v_bfi_b32 v21, v126, v21, s64
  v_or_b32 v21, 1, v21
  s_branch QK_smc
QK_exl0:
  ds_read_b128 v[52:55], v113 offset:0
  ds_read_b128 v[56:59], v113 offset:16
  ds_read_b128 v[60:63], v113 offset:32
QK_exl:
  ds_read_b128 v[40:43], v113 offset:0
  ds_read_b128 v[44:47], v113 offset:16
  ds_read_b128 v[48:51], v113 offset:32
  s_waitcnt lgkmcnt(3)
  v_bitop3_b32 v24, v52, v53, s64 bitop3:0x7e
  v_bitop3_b32 v25, v54, v55, s64 bitop3:0x7e
  v_bitop3_b32 v26, v56, v57, s64 bitop3:0x7e
  v_bitop3_b32 v27, v58, v59, s64 bitop3:0x7e
  v_bitop3_b32 v28, v60, v61, s64 bitop3:0x7e
  v_bitop3_b32 v29, v62, v63, s64 bitop3:0x7e
  v_pk_add_f32 v[30:31], v[52:53], v[54:55]
  v_pk_add_f32 v[32:33], v[56:57], v[58:59]
  v_pk_add_f32 v[34:35], v[60:61], v[62:63]
  v_or3_b32 v24, v24, v25, v26
  v_or3_b32 v27, v27, v28, v29
  v_pk_add_f32 v[36:37], v[30:31], v[32:33]
  v_or_b32 v24, v24, v27
  v_pk_add_f32 v[36:37], v[36:37], v[34:35]
  v_and_b32 v25, 1, v24
  v_cmp_gt_i32 s[48:49], 0, v24
  v_add_f32 v22, v36, v37
  v_cmp_ne_u32 vcc, 0, v25
  s_cmp_eq_u64 s[48:49], 0
  v_rcp_f32 v20, v22
  s_cbranch_scc1 QK_exd
  ds_read_b128 v[52:55], v113 offset:0
  ds_read_b128 v[56:59], v113 offset:16
  ds_read_b128 v[60:63], v113 offset:32
  s_waitcnt lgkmcnt(3)
  v_bitop3_b32 v24, v40, v41, s64 bitop3:0x7e
  v_bitop3_b32 v25, v42, v43, s64 bitop3:0x7e
  v_bitop3_b32 v26, v44, v45, s64 bitop3:0x7e
  v_bitop3_b32 v27, v46, v47, s64 bitop3:0x7e
  v_bitop3_b32 v28, v48, v49, s64 bitop3:0x7e
  v_bitop3_b32 v29, v50, v51, s64 bitop3:0x7e
  v_pk_add_f32 v[30:31], v[40:41], v[42:43]
  v_pk_add_f32 v[32:33], v[44:45], v[46:47]
  v_pk_add_f32 v[34:35], v[48:49], v[50:51]
  v_or3_b32 v24, v24, v25, v26
  v_or3_b32 v27, v27, v28, v29
  v_pk_add_f32 v[36:37], v[30:31], v[32:33]
  v_or_b32 v24, v24, v27
  v_pk_add_f32 v[36:37], v[36:37], v[34:35]
  v_and_b32 v25, 1, v24
  v_cmp_gt_i32 s[48:49], 0, v24
  v_add_f32 v22, v36, v37
  v_cmp_ne_u32 vcc, 0, v25
  s_cmp_eq_u64 s[48:49], 0
  v_rcp_f32 v20, v22
  s_cbranch_scc1 QK_exd
  s_add_u32 s66, s66, 1
  s_cmp_lt_u32 s66, 2097152
  s_cbranch_scc1 QK_exl
  s_branch K2_abort
QK_exs:
  s_waitcnt lgkmcnt(0)
  ds_read_b128 v[40:43], v113 offset:0
  ds_read_b128 v[44:47], v113 offset:16
  ds_read_b128 v[48:51], v113 offset:32
  ds_read_b32 v52, v113 offset:768
  ds_read_b32 v53, v113 offset:784
  ds_read_b32 v54, v113 offset:800
  s_waitcnt lgkmcnt(0)
  v_and_b32 v24, 1, v40
  v_cmp_ne_u32 vcc, 0, v24
  v_add_f32 v41, abs(v40), abs(v41)
  v_add_f32 v42, abs(v42), abs(v43)
  v_cndmask_b32 v52, 0, v52, vcc
  v_add_f32 v40, v41, v42
  v_and_b32 v24, 1, v44
  v_cmp_ne_u32 vcc, 0, v24
  v_add_f32 v45, abs(v44), abs(v45)
  v_add_f32 v46, abs(v46), abs(v47)
  v_cndmask_b32 v53, 0, v53, vcc
  v_add_f32 v44, v45, v46
  v_and_b32 v24, 1, v48
  v_cmp_ne_u32 vcc, 0, v24
  v_add_f32 v49, abs(v48), abs(v49)
  v_add_f32 v50, abs(v50), abs(v51)
  v_cndmask_b32 v54, 0, v54, vcc
  v_add_f32 v48, v49, v50
  v_max3_f32 v23, v52, v53, v54
  v_sub_f32 v52, v52, v23
  v_sub_f32 v53, v53, v23
  v_sub_f32 v54, v54, v23
  v_sub_f32 v20, v80, v23
  v_exp_f32 v52, v52
  v_exp_f32 v53, v53
  v_exp_f32 v54, v54
  v_exp_f32 v20, v20
  v_mul_f32 v22, v52, v40
  v_fma_f32 v22, v53, v44, v22
  v_fma_f32 v22, v54, v48, v22
  v_rcp_f32 v22, v22
  s_nop 0
  v_mul_f32 v20, v20, v22
  s_branch QK_exc
SLOW_23:
  s_mov_b64 exec, s[74:75]
  global_store_dword v18, v24, s[4:5] sc1
  global_store_dword v118, v25, s[4:5] sc1
  s_mov_b64 exec, -1
  s_branch CONT_24
SLOW_25:
  global_store_dwordx4 v19, v[76:79], s[62:63] sc1
  s_mov_b64 exec, s[72:73]
  global_store_dword v112, v80, s[62:63] sc1
  global_store_dword v112, v81, s[62:63] offset:256 sc1
  s_mov_b64 exec, -1
  s_branch CONT_26
QK_late:
MW_27:
  s_bitcmp1_b64 s[84:85], s44
  s_cbranch_scc1 MD_28
  global_load_dword v20, v122, s[4:5] offset:0 sc1
  global_load_dword v21, v123, s[4:5] offset:0 sc1
  s_waitcnt vmcnt(0)
  v_and_b32 v20, v20, v21
  v_cmp_eq_u32 s[84:85], 1, v20
  s_nop 1
  s_bitcmp1_b64 s[84:85], s44
  s_cbranch_scc1 MD_28
  s_sleep 8
  s_add_u32 s66, s66, 1
  s_cmp_lt_u32 s66, 0x200000
  s_cbranch_scc1 MW_27
  s_endpgm
MD_28:
  s_lshl_b32 s48, s44, 5
  s_add_u32 s48, s48, s42
  s_mul_i32 s48, s48, 12288
  s_add_u32 s48, s48, 0x3400000
  s_add_u32 s50, s4, s48
  s_addc_u32 s51, s5, 0
  s_add_u32 m0, s86, s88
  s_nop 0
  global_load_lds_dwordx4 v124, s[50:51] offset:0 sc1
  s_nop 0
  s_nop 0
  s_nop 0
  global_load_lds_dwordx4 v124, s[50:51] offset:1024 sc1
  s_nop 0
  s_nop 0
  s_nop 0
  global_load_lds_dwordx4 v124, s[50:51] offset:2048 sc1
  s_nop 0
  s_nop 0
  s_nop 0
  s_waitcnt vmcnt(0)
  s_branch QK_latec
VO_nan:
  v_mov_b32 v28, 0
  v_mov_b32 v29, 0
  ds_read_b128 v[24:27], v15 offset:0
  s_waitcnt lgkmcnt(0)
  v_pk_max_u16 v28, v28, v24
  v_pk_max_u16 v29, v29, v25
  v_pk_max_u16 v28, v28, v26
  v_pk_max_u16 v29, v29, v27
  ds_read_b128 v[24:27], v15 offset:1024
  s_waitcnt lgkmcnt(0)
  v_pk_max_u16 v28, v28, v24
  v_pk_max_u16 v29, v29, v25
  v_pk_max_u16 v28, v28, v26
  v_pk_max_u16 v29, v29, v27
  ds_read_b128 v[24:27], v15 offset:2048
  s_waitcnt lgkmcnt(0)
  v_pk_max_u16 v28, v28, v24
  v_pk_max_u16 v29, v29, v25
  v_pk_max_u16 v28, v28, v26
  v_pk_max_u16 v29, v29, v27
  ds_read_b128 v[24:27], v15 offset:3072
  s_waitcnt lgkmcnt(0)
  v_pk_max_u16 v28, v28, v24
  v_pk_max_u16 v29, v29, v25
  v_pk_max_u16 v28, v28, v26
  v_pk_max_u16 v29, v29, v27
  ds_read_b128 v[24:27], v15 offset:4096
  s_waitcnt lgkmcnt(0)
  v_pk_max_u16 v28, v28, v24
  v_pk_max_u16 v29, v29, v25
  v_pk_max_u16 v28, v28, v26
  v_pk_max_u16 v29, v29, v27
  ds_read_b128 v[24:27], v15 offset:5120
  s_waitcnt lgkmcnt(0)
  v_pk_max_u16 v28, v28, v24
  v_pk_max_u16 v29, v29, v25
  v_pk_max_u16 v28, v28, v26
  v_pk_max_u16 v29, v29, v27
  ds_read_b128 v[24:27], v15 offset:6144
  s_waitcnt lgkmcnt(0)
  v_pk_max_u16 v28, v28, v24
  v_pk_max_u16 v29, v29, v25
  v_pk_max_u16 v28, v28, v26
  v_pk_max_u16 v29, v29, v27
  ds_read_b128 v[24:27], v15 offset:7168
  s_waitcnt lgkmcnt(0)
  v_pk_max_u16 v28, v28, v24
  v_pk_max_u16 v29, v29, v25
  v_pk_max_u16 v28, v28, v26
  v_pk_max_u16 v29, v29, v27
  ds_read_b128 v[24:27], v15 offset:8192
  s_waitcnt lgkmcnt(0)
  v_pk_max_u16 v28, v28, v24
  v_pk_max_u16 v29, v29, v25
  v_pk_max_u16 v28, v28, v26
  v_pk_max_u16 v29, v29, v27
  ds_read_b128 v[24:27], v15 offset:9216
  s_waitcnt lgkmcnt(0)
  v_pk_max_u16 v28, v28, v24
  v_pk_max_u16 v29, v29, v25
  v_pk_max_u16 v28, v28, v26
  v_pk_max_u16 v29, v29, v27
  v_pk_max_u16 v28, v28, v29
  v_lshrrev_b32 v29, 16, v28
  v_and_b32 v28, 0xffff, v28
  v_max_u32 v28, v28, v29
  v_cmp_eq_u32 vcc, 0xffff, v28
  s_cbranch_vccnz VO_nanr
  s_branch VO_nanc
VO_nanr:
  s_add_u32 s66, s66, 1
  s_cmp_lt_u32 s66, 2097152
  s_cbranch_scc1 VO_step
  s_branch K2_abort
VO_slow:
  ds_read_b64_tr_b16 v[24:25], v11 offset:0
  ds_read_b64_tr_b16 v[26:27], v12 offset:0
  ds_read_b64_tr_b16 v[28:29], v11 offset:1024
  ds_read_b64_tr_b16 v[30:31], v12 offset:1024
  ds_read_b64_tr_b16 v[32:33], v11 offset:2048
  ds_read_b64_tr_b16 v[34:35], v12 offset:2048
  v_mov_b32 v62, 0
  v_mov_b32 v63, 0
  v_mov_b32 v64, 0
  v_mov_b32 v65, 0
  v_mov_b32 v66, 0
  v_mov_b32 v67, 0
  v_mov_b32 v68, 0
  v_mov_b32 v69, 0
  v_mov_b32 v70, 0
  v_mov_b32 v71, 0
  v_mov_b32 v72, 0
  v_mov_b32 v73, 0
  v_mov_b32 v74, 0
  v_mov_b32 v75, 0
  v_mov_b32 v76, 0
  v_mov_b32 v77, 0
  v_mov_b32 v78, 0
  v_mov_b32 v79, 0
  s_waitcnt lgkmcnt(4)
  v_smfmac_f32_16x16x64_bf16 v[40:43], v[24:27], a[16:23], v3
  v_smfmac_f32_16x16x64_bf16 v[44:47], v[24:27], a[40:47], v3
  s_waitcnt lgkmcnt(2)
  v_smfmac_f32_16x16x64_bf16 v[40:43], v[28:31], a[24:31], v3
  v_smfmac_f32_16x16x64_bf16 v[44:47], v[28:31], a[48:55], v3
  s_waitcnt lgkmcnt(0)
  v_smfmac_f32_16x16x64_bf16 v[40:43], v[32:35], a[32:39], v3
  v_smfmac_f32_16x16x64_bf16 v[44:47], v[32:35], a[56:63], v3
  v_smfmac_f32_16x16x64_bf16 v[48:51], v[24:27], a[64:71], v3
  v_smfmac_f32_16x16x64_bf16 v[52:55], v[24:27], a[88:95], v3
  v_smfmac_f32_16x16x64_bf16 v[48:51], v[28:31], a[72:79], v3
  s_nop 0
  v_smfmac_f32_16x16x64_bf16 v[52:55], v[28:31], a[96:103], v3
  s_nop 0
  v_smfmac_f32_16x16x64_bf16 v[48:51], v[32:35], a[80:87], v3
  s_nop 0
  v_smfmac_f32_16x16x64_bf16 v[52:55], v[32:35], a[104:111], v3
  s_nop 1
  v_smfmac_f32_16x16x64_bf16 v[56:59], v[24:27], a[112:119], v3
  v_add_f32 v40, v40, v42
  v_smfmac_f32_16x16x64_bf16 v[60:63], v[24:27], a[136:143], v3
  v_add_f32 v41, v41, v43
  v_smfmac_f32_16x16x64_bf16 v[56:59], v[28:31], a[120:127], v3
  v_add_f32 v44, v44, v46
  v_cvt_pk_bf16_f32 v20, v40, v41
  v_smfmac_f32_16x16x64_bf16 v[60:63], v[28:31], a[144:151], v3
  v_add_f32 v45, v45, v47
  v_smfmac_f32_16x16x64_bf16 v[56:59], v[32:35], a[128:135], v3
  v_min_u32 v20, -2, v20
  v_cvt_pk_bf16_f32 v21, v44, v45
  v_smfmac_f32_16x16x64_bf16 v[60:63], v[32:35], a[152:159], v3
  v_min_u32 v21, -2, v21
  v_smfmac_f32_16x16x64_bf16 v[64:67], v[24:27], a[160:167], v3
  v_add_f32 v48, v48, v50
  v_smfmac_f32_16x16x64_bf16 v[68:71], v[24:27], a[184:191], v3
  global_store_dwordx2 v17, v[20:21], s[24:25] offset:-4096 sc1
  v_add_f32 v49, v49, v51
  v_smfmac_f32_16x16x64_bf16 v[64:67], v[28:31], a[168:175], v3
  v_add_f32 v52, v52, v54
  v_cvt_pk_bf16_f32 v22, v48, v49
  v_smfmac_f32_16x16x64_bf16 v[68:71], v[28:31], a[192:199], v3
  v_add_f32 v53, v53, v55
  v_smfmac_f32_16x16x64_bf16 v[64:67], v[32:35], a[176:183], v3
  v_min_u32 v22, -2, v22
  v_cvt_pk_bf16_f32 v23, v52, v53
  v_smfmac_f32_16x16x64_bf16 v[68:71], v[32:35], a[200:207], v3
  v_min_u32 v23, -2, v23
  v_smfmac_f32_16x16x64_bf16 v[72:75], v[24:27], a[208:215], v3
  v_add_f32 v56, v56, v58
  v_smfmac_f32_16x16x64_bf16 v[76:79], v[24:27], a[232:239], v3
  global_store_dwordx2 v17, v[22:23], s[24:25] offset:0 sc1
  v_add_f32 v57, v57, v59
  v_smfmac_f32_16x16x64_bf16 v[72:75], v[28:31], a[216:223], v3
  v_add_f32 v60, v60, v62
  v_cvt_pk_bf16_f32 v20, v56, v57
  v_smfmac_f32_16x16x64_bf16 v[76:79], v[28:31], a[240:247], v3
  v_add_f32 v61, v61, v63
  v_smfmac_f32_16x16x64_bf16 v[72:75], v[32:35], a[224:231], v3
  v_min_u32 v20, -2, v20
  v_cvt_pk_bf16_f32 v21, v60, v61
  v_smfmac_f32_16x16x64_bf16 v[76:79], v[32:35], a[248:255], v3
  v_min_u32 v21, -2, v21
  v_add_f32 v64, v64, v66
  v_add_f32 v65, v65, v67
  v_add_f32 v68, v68, v70
  v_add_f32 v69, v69, v71
  global_store_dwordx2 v17, v[20:21], s[26:27] offset:-4096 sc1
  v_cvt_pk_bf16_f32 v22, v64, v65
  v_cvt_pk_bf16_f32 v23, v68, v69
  v_min_u32 v22, -2, v22
  v_min_u32 v23, -2, v23
  v_add_f32 v72, v72, v74
  v_add_f32 v73, v73, v75
  v_add_f32 v76, v76, v78
  v_add_f32 v77, v77, v79
  global_store_dwordx2 v17, v[22:23], s[26:27] offset:0 sc1
  v_cvt_pk_bf16_f32 v20, v72, v73
  v_cvt_pk_bf16_f32 v21, v76, v77
  v_min_u32 v20, -2, v20
  v_min_u32 v21, -2, v21
  global_store_dwordx2 v17, v[20:21], s[28:29] offset:-4096 sc1
  s_branch VO_cont
SLOW_53:
  global_store_dword v20, v21, s[4:5] sc1
  s_branch CONT_54
SLOW_55:
  global_store_dword v7, v218, s[60:61] sc1
  s_branch CONT_56
CB0_first:
  s_waitcnt vmcnt(1)
  s_branch CB0_nopr
SLOW_57:
  global_store_dwordx2 v19, v[92:93], s[50:51] sc1
  global_store_dwordx2 v5, v[94:95], s[50:51] sc1
  s_branch CONT_58
SLOW_59:
  global_store_dwordx4 v6, v[228:231], s[4:5] sc1
  global_store_dwordx4 v6, v[228:231], s[4:5] offset:1024 sc1
  global_store_dword v7, v228, s[80:81] sc1
  s_branch CONT_60
UL_61:
MW_63:
  s_bitcmp1_b64 s[84:85], s47
  s_cbranch_scc1 MD_64
  global_load_dword v20, v240, s[4:5] offset:0 sc1
  global_load_dword v21, v240, s[4:5] offset:256 sc1
  global_load_dword v22, v240, s[4:5] offset:512 sc1
  global_load_dword v23, v240, s[4:5] offset:768 sc1
  s_waitcnt vmcnt(0)
  v_and_b32 v20, v20, v21
  v_and_b32 v20, v20, v22
  v_and_b32 v20, v20, v23
  v_cmp_eq_u32 s[84:85], 1, v20
  s_nop 1
  s_bitcmp1_b64 s[84:85], s47
  s_cbranch_scc1 MD_64
  s_sleep 8
  s_add_u32 s66, s66, 1
  s_cmp_lt_u32 s66, 0x200000
  s_cbranch_scc1 MW_63
  s_endpgm
MD_64:
  s_mul_i32 s48, s47, 1310720
  s_add_u32 s50, s4, s48
  s_addc_u32 s51, s5, 0
  global_load_dwordx4 v[136:139], v232, s[50:51] sc1
  global_load_dwordx4 v[140:143], v233, s[50:51] sc1
  global_load_dwordx4 v[144:147], v234, s[50:51] sc1
  global_load_dwordx4 v[148:151], v235, s[50:51] sc1
  global_load_dwordx4 v[156:159], v236, s[50:51] sc1
  global_load_dwordx4 v[160:163], v237, s[50:51] sc1
  global_load_dwordx4 v[164:167], v238, s[50:51] sc1
  global_load_dwordx4 v[168:171], v239, s[50:51] sc1
  s_branch UC_62
SLOW_69:
  global_store_dword v20, v21, s[4:5] sc1
  s_branch CONT_70
SLOW_71:
  global_store_dword v7, v218, s[60:61] sc1
  s_branch CONT_72
SLOW_73:
  global_store_dwordx2 v19, v[92:93], s[50:51] sc1
  global_store_dwordx2 v5, v[94:95], s[50:51] sc1
  s_branch CONT_74
SLOW_75:
  global_store_dwordx4 v6, v[228:231], s[82:83] sc1
  global_store_dwordx4 v6, v[228:231], s[82:83] offset:1024 sc1
  global_store_dword v7, v228, s[80:81] sc1
  s_branch CONT_76
UL_77:
MW_79:
  s_bitcmp1_b64 s[84:85], s47
  s_cbranch_scc1 MD_80
  global_load_dword v20, v240, s[4:5] offset:0 sc1
  global_load_dword v21, v240, s[4:5] offset:256 sc1
  global_load_dword v22, v240, s[4:5] offset:512 sc1
  global_load_dword v23, v240, s[4:5] offset:768 sc1
  s_waitcnt vmcnt(0)
  v_and_b32 v20, v20, v21
  v_and_b32 v20, v20, v22
  v_and_b32 v20, v20, v23
  v_cmp_eq_u32 s[84:85], 1, v20
  s_nop 1
  s_bitcmp1_b64 s[84:85], s47
  s_cbranch_scc1 MD_80
  s_sleep 8
  s_add_u32 s66, s66, 1
  s_cmp_lt_u32 s66, 0x200000
  s_cbranch_scc1 MW_79
  s_endpgm
MD_80:
  s_mul_i32 s48, s47, 1310720
  s_add_u32 s50, s4, s48
  s_addc_u32 s51, s5, 0
  global_load_dwordx4 v[96:99], v232, s[50:51] sc1
  global_load_dwordx4 v[100:103], v233, s[50:51] sc1
  global_load_dwordx4 v[104:107], v234, s[50:51] sc1
  global_load_dwordx4 v[108:111], v235, s[50:51] sc1
  global_load_dwordx4 v[116:119], v236, s[50:51] sc1
  global_load_dwordx4 v[120:123], v237, s[50:51] sc1
  global_load_dwordx4 v[124:127], v238, s[50:51] sc1
  global_load_dwordx4 v[128:131], v239, s[50:51] sc1
  s_branch UC_78
K2_abort:
  v_mov_b32 v20, 64
  v_mov_b32 v21, s2
  v_add_u32 v21, 0x10000, v21
  global_store_dword v20, v21, s[6:7]
K2_exit:
  s_endpgm
K2_bulk:
  s_sub_u32 s40, s40, 4
  s_lshl_b32 s41, s41, 2
  s_add_u32 s40, s40, s41
  s_cmp_ge_u32 s40, 96
  s_cbranch_scc1 K2_ug
  s_load_dwordx4 s[8:11], s[0:1], 16
  s_load_dwordx2 s[14:15], s[0:1], 32
  s_lshr_b32 s41, s40, 5
  s_and_b32 s42, s40, 31
  s_mov_b32 s44, 0
  v_add_u32 v240, 0, v0
  v_mul_u32_u24 v241, 2731, v240
  v_lshrrev_b32 v241, 16, v241
  v_mul_u32_u24 v242, 24, v241
  v_sub_u32 v242, v240, v242
  v_bfe_u32 v243, v241, 1, 2
  v_lshlrev_b32 v243, 1, v243
  v_xor_b32 v242, v242, v243
  s_mov_b32 s90, 12288
  v_mul_lo_u32 v241, v241, s90
  v_lshl_add_u32 v8, v242, 4, v241
  v_add_u32 v240, 256, v0
  v_mul_u32_u24 v241, 2731, v240
  v_lshrrev_b32 v241, 16, v241
  v_mul_u32_u24 v242, 24, v241
  v_sub_u32 v242, v240, v242
  v_bfe_u32 v243, v241, 1, 2
  v_lshlrev_b32 v243, 1, v243
  v_xor_b32 v242, v242, v243
  s_mov_b32 s90, 12288
  v_mul_lo_u32 v241, v241, s90
  v_lshl_add_u32 v9, v242, 4, v241
  v_add_u32 v240, 512, v0
  v_mul_u32_u24 v241, 2731, v240
  v_lshrrev_b32 v241, 16, v241
  v_mul_u32_u24 v242, 24, v241
  v_sub_u32 v242, v240, v242
  v_bfe_u32 v243, v241, 1, 2
  v_lshlrev_b32 v243, 1, v243
  v_xor_b32 v242, v242, v243
  s_mov_b32 s90, 12288
  v_mul_lo_u32 v241, v241, s90
  v_lshl_add_u32 v10, v242, 4, v241
  s_mov_b32 s91, 384
  s_mul_i32 s54, s3, 3
  s_and_b32 s55, s3, 1
  s_add_u32 s56, s54, s55
  v_lshrrev_b32 v240, 2, v1
  v_bfe_u32 v241, v240, 1, 2
  v_xor_b32 v241, s56, v241
  v_lshlrev_b32 v241, 5, v241
  v_mad_u32_u24 v241, v240, s91, v241
  v_and_b32 v240, 3, v1
  v_lshl_add_u32 v12, v240, 3, v241
  s_add_u32 s56, s56, 1
  v_lshrrev_b32 v240, 2, v1
  v_bfe_u32 v241, v240, 1, 2
  v_xor_b32 v241, s56, v241
  v_lshlrev_b32 v241, 5, v241
  v_mad_u32_u24 v241, v240, s91, v241
  v_and_b32 v240, 3, v1
  v_lshl_add_u32 v13, v240, 3, v241
  s_add_u32 s56, s54, 2
  s_cmp_eq_u32 s55, 1
  s_cselect_b32 s56, s54, s56
  v_lshrrev_b32 v240, 2, v1
  v_bfe_u32 v241, v240, 1, 2
  v_xor_b32 v241, s56, v241
  v_lshlrev_b32 v241, 5, v241
  v_mad_u32_u24 v241, v240, s91, v241
  v_and_b32 v240, 3, v1
  v_lshl_add_u32 v14, v240, 3, v241
  s_waitcnt lgkmcnt(0)
  s_cmp_eq_u32 s41, 0
  s_cselect_b32 s12, s10, s8
  s_cselect_b32 s13, s11, s9
  s_mov_b32 s57, 0x4c00000
  s_cselect_b32 s57, 0x3400000, s57
  s_cmp_eq_u32 s41, 2
  s_cselect_b32 s12, s14, s12
  s_cselect_b32 s13, s15, s13
  s_cselect_b32 s57, 0x7800000, s57
  s_mul_i32 s48, s42, 384
  s_add_u32 s34, s12, s48
  s_addc_u32 s35, s13, 0
  s_add_u32 s12, s34, 7471104
  s_addc_u32 s13, s35, 0
  s_lshl_b32 s92, s3, 10
  s_add_u32 m0, s92, 0
  s_nop 0
  global_load_lds_dwordx4 v8, s[12:13]
  s_add_u32 m0, s92, 4096
  s_nop 0
  global_load_lds_dwordx4 v9, s[12:13]
  s_add_u32 m0, s92, 8192
  s_nop 0
  global_load_lds_dwordx4 v10, s[12:13]
  s_sub_u32 s12, s12, 393216
  s_subb_u32 s13, s13, 0
  s_add_u32 m0, s92, 12288
  s_nop 0
  global_load_lds_dwordx4 v8, s[12:13]
  s_add_u32 m0, s92, 16384
  s_nop 0
  global_load_lds_dwordx4 v9, s[12:13]
  s_add_u32 m0, s92, 20480
  s_nop 0
  global_load_lds_dwordx4 v10, s[12:13]
  s_sub_u32 s12, s12, 393216
  s_subb_u32 s13, s13, 0
  s_add_u32 m0, s92, 24576
  s_nop 0
  global_load_lds_dwordx4 v8, s[12:13]
  s_add_u32 m0, s92, 28672
  s_nop 0
  global_load_lds_dwordx4 v9, s[12:13]
  s_add_u32 m0, s92, 32768
  s_nop 0
  global_load_lds_dwordx4 v10, s[12:13]
  s_sub_u32 s12, s12, 393216
  s_subb_u32 s13, s13, 0
  s_add_u32 m0, s92, 36864
  s_nop 0
  global_load_lds_dwordx4 v8, s[12:13]
  s_add_u32 m0, s92, 40960
  s_nop 0
  global_load_lds_dwordx4 v9, s[12:13]
  s_add_u32 m0, s92, 45056
  s_nop 0
  global_load_lds_dwordx4 v10, s[12:13]
  s_sub_u32 s12, s12, 393216
  s_subb_u32 s13, s13, 0
  s_add_u32 m0, s92, 49152
  s_nop 0
  global_load_lds_dwordx4 v8, s[12:13]
  s_add_u32 m0, s92, 53248
  s_nop 0
  global_load_lds_dwordx4 v9, s[12:13]
  s_add_u32 m0, s92, 57344
  s_nop 0
  global_load_lds_dwordx4 v10, s[12:13]
  s_sub_u32 s12, s12, 393216
  s_subb_u32 s13, s13, 0
  s_add_u32 m0, s92, 61440
  s_nop 0
  global_load_lds_dwordx4 v8, s[12:13]
  s_add_u32 m0, s92, 65536
  s_nop 0
  global_load_lds_dwordx4 v9, s[12:13]
  s_add_u32 m0, s92, 69632
  s_nop 0
  global_load_lds_dwordx4 v10, s[12:13]
  s_sub_u32 s12, s12, 393216
  s_subb_u32 s13, s13, 0
  s_add_u32 m0, s92, 73728
  s_nop 0
  global_load_lds_dwordx4 v8, s[12:13]
  s_add_u32 m0, s92, 77824
  s_nop 0
  global_load_lds_dwordx4 v9, s[12:13]
  s_add_u32 m0, s92, 81920
  s_nop 0
  global_load_lds_dwordx4 v10, s[12:13]
  s_sub_u32 s12, s12, 393216
  s_subb_u32 s13, s13, 0
  s_add_u32 m0, s92, 86016
  s_nop 0
  global_load_lds_dwordx4 v8, s[12:13]
  s_add_u32 m0, s92, 90112
  s_nop 0
  global_load_lds_dwordx4 v9, s[12:13]
  s_add_u32 m0, s92, 94208
  s_nop 0
  global_load_lds_dwordx4 v10, s[12:13]
  s_sub_u32 s12, s12, 393216
  s_subb_u32 s13, s13, 0
  s_add_u32 m0, s92, 98304
  s_nop 0
  global_load_lds_dwordx4 v8, s[12:13]
  s_add_u32 m0, s92, 102400
  s_nop 0
  global_load_lds_dwordx4 v9, s[12:13]
  s_add_u32 m0, s92, 106496
  s_nop 0
  global_load_lds_dwordx4 v10, s[12:13]
  s_sub_u32 s12, s12, 393216
  s_subb_u32 s13, s13, 0
  s_waitcnt vmcnt(21)
  s_waitcnt lgkmcnt(0)
  s_barrier
  v_add_u32 v16, 0, v12
  ds_read_b64_tr_b16 a[76:77], v16
  ds_read_b64_tr_b16 a[78:79], v16 offset:6144
  v_add_u32 v17, 0, v13
  ds_read_b64_tr_b16 a[156:157], v17
  ds_read_b64_tr_b16 a[158:159], v17 offset:6144
  v_add_u32 v18, 0, v14
  ds_read_b64_tr_b16 a[236:237], v18
  ds_read_b64_tr_b16 a[238:239], v18 offset:6144
  v_add_u32 v19, 12288, v12
  ds_read_b64_tr_b16 a[72:73], v19
  ds_read_b64_tr_b16 a[74:75], v19 offset:6144
  v_add_u32 v16, 12288, v13
  ds_read_b64_tr_b16 a[152:153], v16
  ds_read_b64_tr_b16 a[154:155], v16 offset:6144
  v_add_u32 v17, 12288, v14
  ds_read_b64_tr_b16 a[232:233], v17
  ds_read_b64_tr_b16 a[234:235], v17 offset:6144
  s_waitcnt vmcnt(15)
  s_waitcnt lgkmcnt(0)
  s_barrier
  s_add_u32 m0, s92, 0
  s_nop 0
  global_load_lds_dwordx4 v8, s[12:13]
  s_add_u32 m0, s92, 4096
  s_nop 0
  global_load_lds_dwordx4 v9, s[12:13]
  s_add_u32 m0, s92, 8192
  s_nop 0
  global_load_lds_dwordx4 v10, s[12:13]
  s_sub_u32 s12, s12, 393216
  s_subb_u32 s13, s13, 0
  s_add_u32 m0, s92, 12288
  s_nop 0
  global_load_lds_dwordx4 v8, s[12:13]
  s_add_u32 m0, s92, 16384
  s_nop 0
  global_load_lds_dwordx4 v9, s[12:13]
  s_add_u32 m0, s92, 20480
  s_nop 0
  global_load_lds_dwordx4 v10, s[12:13]
  s_sub_u32 s12, s12, 393216
  s_subb_u32 s13, s13, 0
  v_add_u32 v16, 24576, v12
  ds_read_b64_tr_b16 a[68:69], v16
  ds_read_b64_tr_b16 a[70:71], v16 offset:6144
  v_add_u32 v17, 24576, v13
  ds_read_b64_tr_b16 a[148:149], v17
  ds_read_b64_tr_b16 a[150:151], v17 offset:6144
  v_add_u32 v18, 24576, v14
  ds_read_b64_tr_b16 a[228:229], v18
  ds_read_b64_tr_b16 a[230:231], v18 offset:6144
  v_add_u32 v19, 36864, v12
  ds_read_b64_tr_b16 a[64:65], v19
  ds_read_b64_tr_b16 a[66:67], v19 offset:6144
  v_add_u32 v16, 36864, v13
  ds_read_b64_tr_b16 a[144:145], v16
  ds_read_b64_tr_b16 a[146:147], v16 offset:6144
  v_add_u32 v17, 36864, v14
  ds_read_b64_tr_b16 a[224:225], v17
  ds_read_b64_tr_b16 a[226:227], v17 offset:6144
  s_waitcnt vmcnt(15)
  s_waitcnt lgkmcnt(0)
  s_barrier
  s_add_u32 m0, s92, 24576
  s_nop 0
  global_load_lds_dwordx4 v8, s[12:13]
  s_add_u32 m0, s92, 28672
  s_nop 0
  global_load_lds_dwordx4 v9, s[12:13]
  s_add_u32 m0, s92, 32768
  s_nop 0
  global_load_lds_dwordx4 v10, s[12:13]
  s_sub_u32 s12, s12, 393216
  s_subb_u32 s13, s13, 0
  s_add_u32 m0, s92, 36864
  s_nop 0
  global_load_lds_dwordx4 v8, s[12:13]
  s_add_u32 m0, s92, 40960
  s_nop 0
  global_load_lds_dwordx4 v9, s[12:13]
  s_add_u32 m0, s92, 45056
  s_nop 0
  global_load_lds_dwordx4 v10, s[12:13]
  s_sub_u32 s12, s12, 393216
  s_subb_u32 s13, s13, 0
  v_add_u32 v16, 49152, v12
  ds_read_b64_tr_b16 a[60:61], v16
  ds_read_b64_tr_b16 a[62:63], v16 offset:6144
  v_add_u32 v17, 49152, v13
  ds_read_b64_tr_b16 a[140:141], v17
  ds_read_b64_tr_b16 a[142:143], v17 offset:6144
  v_add_u32 v18, 49152, v14
  ds_read_b64_tr_b16 a[220:221], v18
  ds_read_b64_tr_b16 a[222:223], v18 offset:6144
  v_add_u32 v19, 61440, v12
  ds_read_b64_tr_b16 a[56:57], v19
  ds_read_b64_tr_b16 a[58:59], v19 offset:6144
  v_add_u32 v16, 61440, v13
  ds_read_b64_tr_b16 a[136:137], v16
  ds_read_b64_tr_b16 a[138:139], v16 offset:6144
  v_add_u32 v17, 61440, v14
  ds_read_b64_tr_b16 a[216:217], v17
  ds_read_b64_tr_b16 a[218:219], v17 offset:6144
  s_waitcnt vmcnt(15)
  s_waitcnt lgkmcnt(0)
  s_barrier
  s_add_u32 m0, s92, 49152
  s_nop 0
  global_load_lds_dwordx4 v8, s[12:13]
  s_add_u32 m0, s92, 53248
  s_nop 0
  global_load_lds_dwordx4 v9, s[12:13]
  s_add_u32 m0, s92, 57344
  s_nop 0
  global_load_lds_dwordx4 v10, s[12:13]
  s_sub_u32 s12, s12, 393216
  s_subb_u32 s13, s13, 0
  s_add_u32 m0, s92, 61440
  s_nop 0
  global_load_lds_dwordx4 v8, s[12:13]
  s_add_u32 m0, s92, 65536
  s_nop 0
  global_load_lds_dwordx4 v9, s[12:13]
  s_add_u32 m0, s92, 69632
  s_nop 0
  global_load_lds_dwordx4 v10, s[12:13]
  s_sub_u32 s12, s12, 393216
  s_subb_u32 s13, s13, 0
  v_mov_b32 v106, 32
  global_load_dword v107, v106, s[6:7] sc1
  v_add_u32 v16, 73728, v12
  ds_read_b64_tr_b16 a[52:53], v16
  ds_read_b64_tr_b16 a[54:55], v16 offset:6144
  v_add_u32 v17, 73728, v13
  ds_read_b64_tr_b16 a[132:133], v17
  ds_read_b64_tr_b16 a[134:135], v17 offset:6144
  v_add_u32 v18, 73728, v14
  ds_read_b64_tr_b16 a[212:213], v18
  ds_read_b64_tr_b16 a[214:215], v18 offset:6144
  v_add_u32 v19, 86016, v12
  ds_read_b64_tr_b16 a[48:49], v19
  ds_read_b64_tr_b16 a[50:51], v19 offset:6144
  v_add_u32 v16, 86016, v13
  ds_read_b64_tr_b16 a[128:129], v16
  ds_read_b64_tr_b16 a[130:131], v16 offset:6144
  v_add_u32 v17, 86016, v14
  ds_read_b64_tr_b16 a[208:209], v17
  ds_read_b64_tr_b16 a[210:211], v17 offset:6144
  s_waitcnt vmcnt(16)
  s_waitcnt lgkmcnt(0)
  s_barrier
  s_add_u32 m0, s92, 73728
  s_nop 0
  global_load_lds_dwordx4 v8, s[12:13]
  s_add_u32 m0, s92, 77824
  s_nop 0
  global_load_lds_dwordx4 v9, s[12:13]
  s_add_u32 m0, s92, 81920
  s_nop 0
  global_load_lds_dwordx4 v10, s[12:13]
  s_sub_u32 s12, s12, 393216
  s_subb_u32 s13, s13, 0
  s_add_u32 m0, s92, 86016
  s_nop 0
  global_load_lds_dwordx4 v8, s[12:13]
  s_add_u32 m0, s92, 90112
  s_nop 0
  global_load_lds_dwordx4 v9, s[12:13]
  s_add_u32 m0, s92, 94208
  s_nop 0
  global_load_lds_dwordx4 v10, s[12:13]
  s_sub_u32 s12, s12, 393216
  s_subb_u32 s13, s13, 0
  v_add_u32 v16, 98304, v12
  ds_read_b64_tr_b16 a[44:45], v16
  ds_read_b64_tr_b16 a[46:47], v16 offset:6144
  v_add_u32 v17, 98304, v13
  ds_read_b64_tr_b16 a[124:125], v17
  ds_read_b64_tr_b16 a[126:127], v17 offset:6144
  v_add_u32 v18, 98304, v14
  ds_read_b64_tr_b16 a[204:205], v18
  ds_read_b64_tr_b16 a[206:207], v18 offset:6144
  v_add_u32 v19, 0, v12
  ds_read_b64_tr_b16 a[40:41], v19
  ds_read_b64_tr_b16 a[42:43], v19 offset:6144
  v_add_u32 v16, 0, v13
  ds_read_b64_tr_b16 a[120:121], v16
  ds_read_b64_tr_b16 a[122:123], v16 offset:6144
  v_add_u32 v17, 0, v14
  ds_read_b64_tr_b16 a[200:201], v17
  ds_read_b64_tr_b16 a[202:203], v17 offset:6144
  s_waitcnt vmcnt(16)
  s_waitcnt lgkmcnt(0)
  s_barrier
  s_add_u32 m0, s92, 98304
  s_nop 0
  global_load_lds_dwordx4 v8, s[12:13]
  s_add_u32 m0, s92, 102400
  s_nop 0
  global_load_lds_dwordx4 v9, s[12:13]
  s_add_u32 m0, s92, 106496
  s_nop 0
  global_load_lds_dwordx4 v10, s[12:13]
  s_sub_u32 s12, s12, 393216
  s_subb_u32 s13, s13, 0
  s_add_u32 m0, s92, 0
  s_nop 0
  global_load_lds_dwordx4 v8, s[12:13]
  s_add_u32 m0, s92, 4096
  s_nop 0
  global_load_lds_dwordx4 v9, s[12:13]
  s_add_u32 m0, s92, 8192
  s_nop 0
  global_load_lds_dwordx4 v10, s[12:13]
  s_sub_u32 s12, s12, 393216
  s_subb_u32 s13, s13, 0
  s_waitcnt vmcnt(12)
  v_cmp_ne_u32 vcc, 64, v107
  s_cbranch_vccz PI_97
  v_mov_b32 v20, 32
IW_98:
  global_load_dword v21, v20, s[6:7] sc1
  s_waitcnt vmcnt(0)
  v_cmp_ne_u32 vcc, 64, v21
  s_cbranch_vccz ID_99
  s_sleep 24
  s_add_u32 s66, s66, 1
  s_cmp_lt_u32 s66, 0x200000
  s_cbranch_scc1 IW_98
  s_endpgm
ID_99:
PI_97:
  v_lshlrev_b32 v104, 4, v1
  s_mul_i32 s48, s3, 10240
  v_add_u32 v105, s48, v104
  v_add_u32 v104, 110592, v104
  s_add_u32 s48, s48, 110592
  s_mov_b64 s[50:51], s[4:5]
  s_add_u32 m0, s48, 0
  s_nop 0
  global_load_lds_dwordx4 v105, s[50:51] offset:0 sc1
  global_load_lds_dwordx4 v105, s[50:51] offset:1024 sc1
  global_load_lds_dwordx4 v105, s[50:51] offset:2048 sc1
  global_load_lds_dwordx4 v105, s[50:51] offset:3072 sc1
  s_add_u32 s50, s50, 4096
  s_addc_u32 s51, s51, 0
  s_add_u32 m0, s48, 4096
  s_nop 0
  global_load_lds_dwordx4 v105, s[50:51] offset:0 sc1
  global_load_lds_dwordx4 v105, s[50:51] offset:1024 sc1
  global_load_lds_dwordx4 v105, s[50:51] offset:2048 sc1
  global_load_lds_dwordx4 v105, s[50:51] offset:3072 sc1
  s_add_u32 s50, s50, 4096
  s_addc_u32 s51, s51, 0
  s_add_u32 m0, s48, 8192
  s_nop 0
  global_load_lds_dwordx4 v105, s[50:51] offset:0 sc1
  global_load_lds_dwordx4 v105, s[50:51] offset:1024 sc1
  v_add_u32 v16, 12288, v12
  ds_read_b64_tr_b16 a[36:37], v16
  ds_read_b64_tr_b16 a[38:39], v16 offset:6144
  v_add_u32 v17, 12288, v13
  ds_read_b64_tr_b16 a[116:117], v17
  ds_read_b64_tr_b16 a[118:119], v17 offset:6144
  v_add_u32 v18, 12288, v14
  ds_read_b64_tr_b16 a[196:197], v18
  ds_read_b64_tr_b16 a[198:199], v18 offset:6144
  v_add_u32 v19, 24576, v12
  ds_read_b64_tr_b16 a[32:33], v19
  ds_read_b64_tr_b16 a[34:35], v19 offset:6144
  v_add_u32 v16, 24576, v13
  ds_read_b64_tr_b16 a[112:113], v16
  ds_read_b64_tr_b16 a[114:115], v16 offset:6144
  v_add_u32 v17, 24576, v14
  ds_read_b64_tr_b16 a[192:193], v17
  ds_read_b64_tr_b16 a[194:195], v17 offset:6144
  s_waitcnt lgkmcnt(0)
  s_barrier
  s_add_u32 m0, s92, 12288
  s_nop 0
  global_load_lds_dwordx4 v8, s[12:13]
  s_add_u32 m0, s92, 16384
  s_nop 0
  global_load_lds_dwordx4 v9, s[12:13]
  s_add_u32 m0, s92, 20480
  s_nop 0
  global_load_lds_dwordx4 v10, s[12:13]
  s_sub_u32 s12, s12, 393216
  s_subb_u32 s13, s13, 0
  v_add_u32 v16, 36864, v12
  ds_read_b64_tr_b16 a[28:29], v16
  ds_read_b64_tr_b16 a[30:31], v16 offset:6144
  v_add_u32 v17, 36864, v13
  ds_read_b64_tr_b16 a[108:109], v17
  ds_read_b64_tr_b16 a[110:111], v17 offset:6144
  v_add_u32 v18, 36864, v14
  ds_read_b64_tr_b16 a[188:189], v18
  ds_read_b64_tr_b16 a[190:191], v18 offset:6144
  v_add_u32 v19, 49152, v12
  ds_read_b64_tr_b16 a[24:25], v19
  ds_read_b64_tr_b16 a[26:27], v19 offset:6144
  v_add_u32 v16, 49152, v13
  ds_read_b64_tr_b16 a[104:105], v16
  ds_read_b64_tr_b16 a[106:107], v16 offset:6144
  v_add_u32 v17, 49152, v14
  ds_read_b64_tr_b16 a[184:185], v17
  ds_read_b64_tr_b16 a[186:187], v17 offset:6144
  s_waitcnt vmcnt(22)
  s_waitcnt lgkmcnt(0)
  s_barrier
  s_waitcnt vmcnt(3)
  v_add_u32 v16, 61440, v12
  ds_read_b64_tr_b16 a[20:21], v16
  ds_read_b64_tr_b16 a[22:23], v16 offset:6144
  v_add_u32 v17, 61440, v13
  ds_read_b64_tr_b16 a[100:101], v17
  ds_read_b64_tr_b16 a[102:103], v17 offset:6144
  v_add_u32 v18, 61440, v14
  ds_read_b64_tr_b16 a[180:181], v18
  ds_read_b64_tr_b16 a[182:183], v18 offset:6144
  v_add_u32 v19, 73728, v12
  ds_read_b64_tr_b16 a[16:17], v19
  ds_read_b64_tr_b16 a[18:19], v19 offset:6144
  v_add_u32 v16, 73728, v13
  ds_read_b64_tr_b16 a[96:97], v16
  ds_read_b64_tr_b16 a[98:99], v16 offset:6144
  v_add_u32 v17, 73728, v14
  ds_read_b64_tr_b16 a[176:177], v17
  ds_read_b64_tr_b16 a[178:179], v17 offset:6144
  s_waitcnt lgkmcnt(0)
  s_barrier
  ds_read_b128 v[80:83], v104 offset:38912
  ds_read_b128 v[84:87], v104 offset:39936
  ds_read_b128 v[88:91], v104 offset:36864
  ds_read_b128 v[92:95], v104 offset:37888
  ds_read_b128 v[96:99], v104 offset:34816
  ds_read_b128 v[100:103], v104 offset:35840
  s_waitcnt lgkmcnt(5)
  v_mfma_f32_16x16x32_bf16 v[32:35], a[76:79], v[80:83], 0
  v_mfma_f32_16x16x32_bf16 v[40:43], a[156:159], v[80:83], 0
  v_mfma_f32_16x16x32_bf16 v[48:51], a[236:239], v[80:83], 0
  s_waitcnt lgkmcnt(4)
  v_mfma_f32_16x16x32_bf16 v[36:39], a[76:79], v[84:87], 0
  v_mfma_f32_16x16x32_bf16 v[44:47], a[156:159], v[84:87], 0
  v_mfma_f32_16x16x32_bf16 v[52:55], a[236:239], v[84:87], 0
  ds_read_b128 v[80:83], v104 offset:32768
  ds_read_b128 v[84:87], v104 offset:33792
  s_waitcnt lgkmcnt(5)
  v_mfma_f32_16x16x32_bf16 v[32:35], a[72:75], v[88:91], v[32:35]
  v_mfma_f32_16x16x32_bf16 v[40:43], a[152:155], v[88:91], v[40:43]
  v_mfma_f32_16x16x32_bf16 v[48:51], a[232:235], v[88:91], v[48:51]
  s_waitcnt lgkmcnt(4)
  v_mfma_f32_16x16x32_bf16 v[36:39], a[72:75], v[92:95], v[36:39]
  v_mfma_f32_16x16x32_bf16 v[44:47], a[152:155], v[92:95], v[44:47]
  v_mfma_f32_16x16x32_bf16 v[52:55], a[232:235], v[92:95], v[52:55]
  ds_read_b128 v[88:91], v104 offset:30720
  ds_read_b128 v[92:95], v104 offset:31744
  s_waitcnt lgkmcnt(5)
  v_mfma_f32_16x16x32_bf16 v[32:35], a[68:71], v[96:99], v[32:35]
  v_mfma_f32_16x16x32_bf16 v[40:43], a[148:151], v[96:99], v[40:43]
  v_mfma_f32_16x16x32_bf16 v[48:51], a[228:231], v[96:99], v[48:51]
  s_waitcnt lgkmcnt(4)
  v_mfma_f32_16x16x32_bf16 v[36:39], a[68:71], v[100:103], v[36:39]
  v_mfma_f32_16x16x32_bf16 v[44:47], a[148:151], v[100:103], v[44:47]
  v_mfma_f32_16x16x32_bf16 v[52:55], a[228:231], v[100:103], v[52:55]
  ds_read_b128 v[96:99], v104 offset:28672
  ds_read_b128 v[100:103], v104 offset:29696
  s_waitcnt lgkmcnt(5)
  v_mfma_f32_16x16x32_bf16 v[32:35], a[64:67], v[80:83], v[32:35]
  v_mfma_f32_16x16x32_bf16 v[40:43], a[144:147], v[80:83], v[40:43]
  v_mfma_f32_16x16x32_bf16 v[48:51], a[224:227], v[80:83], v[48:51]
  s_waitcnt lgkmcnt(4)
  v_mfma_f32_16x16x32_bf16 v[36:39], a[64:67], v[84:87], v[36:39]
  v_mfma_f32_16x16x32_bf16 v[44:47], a[144:147], v[84:87], v[44:47]
  v_mfma_f32_16x16x32_bf16 v[52:55], a[224:227], v[84:87], v[52:55]
  ds_read_b128 v[80:83], v104 offset:26624
  ds_read_b128 v[84:87], v104 offset:27648
  s_waitcnt lgkmcnt(5)
  v_mfma_f32_16x16x32_bf16 v[32:35], a[60:63], v[88:91], v[32:35]
  v_mfma_f32_16x16x32_bf16 v[40:43], a[140:143], v[88:91], v[40:43]
  v_mfma_f32_16x16x32_bf16 v[48:51], a[220:223], v[88:91], v[48:51]
  s_waitcnt lgkmcnt(4)
  v_mfma_f32_16x16x32_bf16 v[36:39], a[60:63], v[92:95], v[36:39]
  v_mfma_f32_16x16x32_bf16 v[44:47], a[140:143], v[92:95], v[44:47]
  v_mfma_f32_16x16x32_bf16 v[52:55], a[220:223], v[92:95], v[52:55]
  ds_read_b128 v[88:91], v104 offset:24576
  ds_read_b128 v[92:95], v104 offset:25600
  s_waitcnt lgkmcnt(5)
  v_mfma_f32_16x16x32_bf16 v[32:35], a[56:59], v[96:99], v[32:35]
  v_mfma_f32_16x16x32_bf16 v[40:43], a[136:139], v[96:99], v[40:43]
  v_mfma_f32_16x16x32_bf16 v[48:51], a[216:219], v[96:99], v[48:51]
  s_waitcnt lgkmcnt(4)
  v_mfma_f32_16x16x32_bf16 v[36:39], a[56:59], v[100:103], v[36:39]
  v_mfma_f32_16x16x32_bf16 v[44:47], a[136:139], v[100:103], v[44:47]
  v_mfma_f32_16x16x32_bf16 v[52:55], a[216:219], v[100:103], v[52:55]
  s_waitcnt lgkmcnt(3)
  v_mfma_f32_16x16x32_bf16 v[32:35], a[52:55], v[80:83], v[32:35]
  v_mfma_f32_16x16x32_bf16 v[40:43], a[132:135], v[80:83], v[40:43]
  v_mfma_f32_16x16x32_bf16 v[48:51], a[212:215], v[80:83], v[48:51]
  s_waitcnt lgkmcnt(2)
  v_mfma_f32_16x16x32_bf16 v[36:39], a[52:55], v[84:87], v[36:39]
  v_mfma_f32_16x16x32_bf16 v[44:47], a[132:135], v[84:87], v[44:47]
  v_mfma_f32_16x16x32_bf16 v[52:55], a[212:215], v[84:87], v[52:55]
  s_waitcnt lgkmcnt(1)
  v_mfma_f32_16x16x32_bf16 v[32:35], a[48:51], v[88:91], v[32:35]
  v_mfma_f32_16x16x32_bf16 v[40:43], a[128:131], v[88:91], v[40:43]
  v_mfma_f32_16x16x32_bf16 v[48:51], a[208:211], v[88:91], v[48:51]
  s_waitcnt lgkmcnt(0)
  v_mfma_f32_16x16x32_bf16 v[36:39], a[48:51], v[92:95], v[36:39]
  v_mfma_f32_16x16x32_bf16 v[44:47], a[128:131], v[92:95], v[44:47]
  v_mfma_f32_16x16x32_bf16 v[52:55], a[208:211], v[92:95], v[52:55]
  v_add_u32 v16, 86016, v12
  ds_read_b64_tr_b16 a[12:13], v16
  ds_read_b64_tr_b16 a[14:15], v16 offset:6144
  v_add_u32 v17, 86016, v13
  ds_read_b64_tr_b16 a[92:93], v17
  ds_read_b64_tr_b16 a[94:95], v17 offset:6144
  v_add_u32 v18, 86016, v14
  ds_read_b64_tr_b16 a[172:173], v18
  ds_read_b64_tr_b16 a[174:175], v18 offset:6144
  v_add_u32 v19, 98304, v12
  ds_read_b64_tr_b16 a[8:9], v19
  ds_read_b64_tr_b16 a[10:11], v19 offset:6144
  v_add_u32 v16, 98304, v13
  ds_read_b64_tr_b16 a[88:89], v16
  ds_read_b64_tr_b16 a[90:91], v16 offset:6144
  v_add_u32 v17, 98304, v14
  ds_read_b64_tr_b16 a[168:169], v17
  ds_read_b64_tr_b16 a[170:171], v17 offset:6144
  s_waitcnt vmcnt(0)
  s_waitcnt lgkmcnt(0)
  s_barrier
  ds_read_b128 v[96:99], v104 offset:22528
  ds_read_b128 v[100:103], v104 offset:23552
  ds_read_b128 v[80:83], v104 offset:20480
  ds_read_b128 v[84:87], v104 offset:21504
  ds_read_b128 v[88:91], v104 offset:18432
  ds_read_b128 v[92:95], v104 offset:19456
  s_waitcnt lgkmcnt(5)
  v_mfma_f32_16x16x32_bf16 v[32:35], a[44:47], v[96:99], v[32:35]
  v_mfma_f32_16x16x32_bf16 v[40:43], a[124:127], v[96:99], v[40:43]
  v_mfma_f32_16x16x32_bf16 v[48:51], a[204:207], v[96:99], v[48:51]
  s_waitcnt lgkmcnt(4)
  v_mfma_f32_16x16x32_bf16 v[36:39], a[44:47], v[100:103], v[36:39]
  v_mfma_f32_16x16x32_bf16 v[44:47], a[124:127], v[100:103], v[44:47]
  v_mfma_f32_16x16x32_bf16 v[52:55], a[204:207], v[100:103], v[52:55]
  ds_read_b128 v[96:99], v104 offset:16384
  ds_read_b128 v[100:103], v104 offset:17408
  s_waitcnt lgkmcnt(5)
  v_mfma_f32_16x16x32_bf16 v[32:35], a[40:43], v[80:83], v[32:35]
  v_mfma_f32_16x16x32_bf16 v[40:43], a[120:123], v[80:83], v[40:43]
  v_mfma_f32_16x16x32_bf16 v[48:51], a[200:203], v[80:83], v[48:51]
  s_waitcnt lgkmcnt(4)
  v_mfma_f32_16x16x32_bf16 v[36:39], a[40:43], v[84:87], v[36:39]
  v_mfma_f32_16x16x32_bf16 v[44:47], a[120:123], v[84:87], v[44:47]
  v_mfma_f32_16x16x32_bf16 v[52:55], a[200:203], v[84:87], v[52:55]
  ds_read_b128 v[80:83], v104 offset:14336
  ds_read_b128 v[84:87], v104 offset:15360
  s_waitcnt lgkmcnt(5)
  v_mfma_f32_16x16x32_bf16 v[32:35], a[36:39], v[88:91], v[32:35]
  v_mfma_f32_16x16x32_bf16 v[40:43], a[116:119], v[88:91], v[40:43]
  v_mfma_f32_16x16x32_bf16 v[48:51], a[196:199], v[88:91], v[48:51]
  s_waitcnt lgkmcnt(4)
  v_mfma_f32_16x16x32_bf16 v[36:39], a[36:39], v[92:95], v[36:39]
  v_mfma_f32_16x16x32_bf16 v[44:47], a[116:119], v[92:95], v[44:47]
  v_mfma_f32_16x16x32_bf16 v[52:55], a[196:199], v[92:95], v[52:55]
  ds_read_b128 v[88:91], v104 offset:12288
  ds_read_b128 v[92:95], v104 offset:13312
  s_waitcnt lgkmcnt(5)
  v_mfma_f32_16x16x32_bf16 v[32:35], a[32:35], v[96:99], v[32:35]
  v_mfma_f32_16x16x32_bf16 v[40:43], a[112:115], v[96:99], v[40:43]
  v_mfma_f32_16x16x32_bf16 v[48:51], a[192:195], v[96:99], v[48:51]
  s_waitcnt lgkmcnt(4)
  v_mfma_f32_16x16x32_bf16 v[36:39], a[32:35], v[100:103], v[36:39]
  v_mfma_f32_16x16x32_bf16 v[44:47], a[112:115], v[100:103], v[44:47]
  v_mfma_f32_16x16x32_bf16 v[52:55], a[192:195], v[100:103], v[52:55]
  ds_read_b128 v[96:99], v104 offset:10240
  ds_read_b128 v[100:103], v104 offset:11264
  s_waitcnt lgkmcnt(5)
  v_mfma_f32_16x16x32_bf16 v[32:35], a[28:31], v[80:83], v[32:35]
  v_mfma_f32_16x16x32_bf16 v[40:43], a[108:111], v[80:83], v[40:43]
  v_mfma_f32_16x16x32_bf16 v[48:51], a[188:191], v[80:83], v[48:51]
  s_waitcnt lgkmcnt(4)
  v_mfma_f32_16x16x32_bf16 v[36:39], a[28:31], v[84:87], v[36:39]
  v_mfma_f32_16x16x32_bf16 v[44:47], a[108:111], v[84:87], v[44:47]
  v_mfma_f32_16x16x32_bf16 v[52:55], a[188:191], v[84:87], v[52:55]
  ds_read_b128 v[80:83], v104 offset:8192
  ds_read_b128 v[84:87], v104 offset:9216
  s_waitcnt lgkmcnt(5)
  v_mfma_f32_16x16x32_bf16 v[32:35], a[24:27], v[88:91], v[32:35]
  v_mfma_f32_16x16x32_bf16 v[40:43], a[104:107], v[88:91], v[40:43]
  v_mfma_f32_16x16x32_bf16 v[48:51], a[184:187], v[88:91], v[48:51]
  s_waitcnt lgkmcnt(4)
  v_mfma_f32_16x16x32_bf16 v[36:39], a[24:27], v[92:95], v[36:39]
  v_mfma_f32_16x16x32_bf16 v[44:47], a[104:107], v[92:95], v[44:47]
  v_mfma_f32_16x16x32_bf16 v[52:55], a[184:187], v[92:95], v[52:55]
  s_waitcnt lgkmcnt(3)
  v_mfma_f32_16x16x32_bf16 v[32:35], a[20:23], v[96:99], v[32:35]
  v_mfma_f32_16x16x32_bf16 v[40:43], a[100:103], v[96:99], v[40:43]
  v_mfma_f32_16x16x32_bf16 v[48:51], a[180:183], v[96:99], v[48:51]
  s_waitcnt lgkmcnt(2)
  v_mfma_f32_16x16x32_bf16 v[36:39], a[20:23], v[100:103], v[36:39]
  v_mfma_f32_16x16x32_bf16 v[44:47], a[100:103], v[100:103], v[44:47]
  v_mfma_f32_16x16x32_bf16 v[52:55], a[180:183], v[100:103], v[52:55]
  s_waitcnt lgkmcnt(1)
  v_mfma_f32_16x16x32_bf16 v[32:35], a[16:19], v[80:83], v[32:35]
  v_mfma_f32_16x16x32_bf16 v[40:43], a[96:99], v[80:83], v[40:43]
  v_mfma_f32_16x16x32_bf16 v[48:51], a[176:179], v[80:83], v[48:51]
  s_waitcnt lgkmcnt(0)
  v_mfma_f32_16x16x32_bf16 v[36:39], a[16:19], v[84:87], v[36:39]
  v_mfma_f32_16x16x32_bf16 v[44:47], a[96:99], v[84:87], v[44:47]
  v_mfma_f32_16x16x32_bf16 v[52:55], a[176:179], v[84:87], v[52:55]
  v_add_u32 v16, 0, v12
  ds_read_b64_tr_b16 a[4:5], v16
  ds_read_b64_tr_b16 a[6:7], v16 offset:6144
  v_add_u32 v17, 0, v13
  ds_read_b64_tr_b16 a[84:85], v17
  ds_read_b64_tr_b16 a[86:87], v17 offset:6144
  v_add_u32 v18, 0, v14
  ds_read_b64_tr_b16 a[164:165], v18
  ds_read_b64_tr_b16 a[166:167], v18 offset:6144
  v_add_u32 v19, 12288, v12
  ds_read_b64_tr_b16 a[0:1], v19
  ds_read_b64_tr_b16 a[2:3], v19 offset:6144
  v_add_u32 v16, 12288, v13
  ds_read_b64_tr_b16 a[80:81], v16
  ds_read_b64_tr_b16 a[82:83], v16 offset:6144
  v_add_u32 v17, 12288, v14
  ds_read_b64_tr_b16 a[160:161], v17
  ds_read_b64_tr_b16 a[162:163], v17 offset:6144
  s_waitcnt lgkmcnt(0)
  s_barrier
  ds_read_b128 v[88:91], v104 offset:6144
  ds_read_b128 v[92:95], v104 offset:7168
  ds_read_b128 v[96:99], v104 offset:4096
  ds_read_b128 v[100:103], v104 offset:5120
  ds_read_b128 v[80:83], v104 offset:2048
  ds_read_b128 v[84:87], v104 offset:3072
  s_waitcnt lgkmcnt(5)
  v_mfma_f32_16x16x32_bf16 v[32:35], a[12:15], v[88:91], v[32:35]
  v_mfma_f32_16x16x32_bf16 v[40:43], a[92:95], v[88:91], v[40:43]
  v_mfma_f32_16x16x32_bf16 v[48:51], a[172:175], v[88:91], v[48:51]
  s_waitcnt lgkmcnt(4)
  v_mfma_f32_16x16x32_bf16 v[36:39], a[12:15], v[92:95], v[36:39]
  v_mfma_f32_16x16x32_bf16 v[44:47], a[92:95], v[92:95], v[44:47]
  v_mfma_f32_16x16x32_bf16 v[52:55], a[172:175], v[92:95], v[52:55]
  ds_read_b128 v[88:91], v104 offset:0
  ds_read_b128 v[92:95], v104 offset:1024
  s_waitcnt lgkmcnt(5)
  v_mfma_f32_16x16x32_bf16 v[32:35], a[8:11], v[96:99], v[32:35]
  v_mfma_f32_16x16x32_bf16 v[40:43], a[88:91], v[96:99], v[40:43]
  v_mfma_f32_16x16x32_bf16 v[48:51], a[168:171], v[96:99], v[48:51]
  s_waitcnt lgkmcnt(4)
  v_mfma_f32_16x16x32_bf16 v[36:39], a[8:11], v[100:103], v[36:39]
  v_mfma_f32_16x16x32_bf16 v[44:47], a[88:91], v[100:103], v[44:47]
  v_mfma_f32_16x16x32_bf16 v[52:55], a[168:171], v[100:103], v[52:55]
  s_waitcnt lgkmcnt(3)
  v_mfma_f32_16x16x32_bf16 v[32:35], a[4:7], v[80:83], v[32:35]
  v_mfma_f32_16x16x32_bf16 v[40:43], a[84:87], v[80:83], v[40:43]
  v_mfma_f32_16x16x32_bf16 v[48:51], a[164:167], v[80:83], v[48:51]
  s_waitcnt lgkmcnt(2)
  v_mfma_f32_16x16x32_bf16 v[36:39], a[4:7], v[84:87], v[36:39]
  v_mfma_f32_16x16x32_bf16 v[44:47], a[84:87], v[84:87], v[44:47]
  v_mfma_f32_16x16x32_bf16 v[52:55], a[164:167], v[84:87], v[52:55]
  s_waitcnt lgkmcnt(1)
  v_mfma_f32_16x16x32_bf16 v[32:35], a[0:3], v[88:91], v[32:35]
  v_mfma_f32_16x16x32_bf16 v[40:43], a[80:83], v[88:91], v[40:43]
  v_mfma_f32_16x16x32_bf16 v[48:51], a[160:163], v[88:91], v[48:51]
  s_waitcnt lgkmcnt(0)
  v_mfma_f32_16x16x32_bf16 v[36:39], a[0:3], v[92:95], v[36:39]
  v_mfma_f32_16x16x32_bf16 v[44:47], a[80:83], v[92:95], v[44:47]
  v_mfma_f32_16x16x32_bf16 v[52:55], a[160:163], v[92:95], v[52:55]
  s_mul_i32 s48, s42, 12288
  s_add_u32 s57, s57, s48
  s_add_u32 s56, s54, s55
  s_lshr_b32 s56, s56, 1
  s_lshl_b32 s56, s56, 10
  v_lshlrev_b32 v8, 4, v1
  v_add_u32 v8, s56, v8
  s_lshr_b32 s56, s3, 1
  s_mul_i32 s56, s56, 3072
  s_add_u32 s56, s56, 1024
  s_lshl_b32 s55, s55, 3
  s_add_u32 s56, s56, s55
  v_lshlrev_b32 v9, 4, v1
  v_add_u32 v9, s56, v9
  v_add_u32 v10, 6144, v8
  v_add_u32 v11, 6144, v9
  s_lshl_b32 s58, s40, 8
  s_add_u32 s58, s58, 0x1360000
  s_mov_b32 s59, 0x0
  v_lshlrev_b32 v3, 4, v1
  v_add_u32 v7, 40960, v3
  s_mul_i32 s86, s3, 10240
  v_add_u32 v4, s86, v3
  s_mov_b32 s46, -1
  s_mov_b32 s47, -1
  s_cmp_ge_u32 s44, 64
  s_cbranch_scc1 PROJ_end
  s_waitcnt vmcnt(0)
  s_barrier
  s_add_u32 s52, s44, 1
  s_cmp_ge_u32 s52, 64
  s_cselect_b32 s54, s44, s52
  s_mul_i32 s48, s54, 40960
  s_add_u32 s48, s48, s59
  s_add_u32 s50, s4, s48
  s_addc_u32 s51, s5, 0
  s_add_u32 m0, s86, 40960
  s_nop 0
  global_load_lds_dwordx4 v4, s[50:51] offset:0 sc1
  s_nop 0
  s_nop 0
  s_nop 0
  global_load_lds_dwordx4 v4, s[50:51] offset:1024 sc1
  s_nop 0
  s_nop 0
  s_nop 0
  global_load_lds_dwordx4 v4, s[50:51] offset:2048 sc1
  s_nop 0
  s_nop 0
  s_nop 0
  global_load_lds_dwordx4 v4, s[50:51] offset:3072 sc1
  s_nop 0
  s_nop 0
  s_nop 0
  s_add_u32 s50, s50, 4096
  s_addc_u32 s51, s51, 0
  s_add_u32 m0, s86, 45056
  s_nop 0
  global_load_lds_dwordx4 v4, s[50:51] offset:0 sc1
  s_nop 0
  s_nop 0
  s_nop 0
  global_load_lds_dwordx4 v4, s[50:51] offset:1024 sc1
  s_nop 0
  s_nop 0
  s_nop 0
  global_load_lds_dwordx4 v4, s[50:51] offset:2048 sc1
  s_nop 0
  s_nop 0
  s_nop 0
  global_load_lds_dwordx4 v4, s[50:51] offset:3072 sc1
  s_nop 0
  s_nop 0
  s_nop 0
  s_add_u32 s50, s50, 4096
  s_addc_u32 s51, s51, 0
  s_add_u32 m0, s86, 49152
  s_nop 0
  global_load_lds_dwordx4 v4, s[50:51] offset:0 sc1
  s_nop 0
  s_nop 0
  s_nop 0
  global_load_lds_dwordx4 v4, s[50:51] offset:1024 sc1
  s_nop 0
  s_nop 0
  s_nop 0
  s_nop 7
  s_mul_i32 s60, s44, 393216
  s_add_u32 s60, s60, s57
  s_add_u32 s62, s4, s60
  s_addc_u32 s63, s5, 0
  v_cvt_pk_bf16_f32 v104, v32, v33
  v_cvt_pk_bf16_f32 v105, v34, v35
  v_cvt_pk_bf16_f32 v106, v40, v41
  v_cvt_pk_bf16_f32 v107, v42, v43
  v_cvt_pk_bf16_f32 v108, v48, v49
  v_cvt_pk_bf16_f32 v109, v50, v51
  global_store_dwordx4 v8, v[104:107], s[62:63] sc1
  global_store_dwordx2 v9, v[108:109], s[62:63] sc1
  v_cvt_pk_bf16_f32 v112, v36, v37
  v_cvt_pk_bf16_f32 v113, v38, v39
  v_cvt_pk_bf16_f32 v114, v44, v45
  v_cvt_pk_bf16_f32 v115, v46, v47
  v_cvt_pk_bf16_f32 v116, v52, v53
  v_cvt_pk_bf16_f32 v117, v54, v55
  global_store_dwordx4 v10, v[112:115], s[62:63] sc1
  global_store_dwordx2 v11, v[116:117], s[62:63] sc1
  s_waitcnt vmcnt(0)
  s_barrier
  s_cmp_eq_u32 s44, -1
  s_cbranch_scc1 FS_100
  s_cmp_lg_u32 s3, 0
  s_cbranch_scc1 FS_100
  s_lshl_b32 s48, s44, 2
  s_add_u32 s48, s48, s58
  v_mov_b32 v5, s48
  v_mov_b32 v6, 1
  s_mov_b64 exec, 1
  global_store_dword v5, v6, s[4:5] sc1
  s_mov_b64 exec, -1
FS_100:
  s_mov_b32 s47, s46
  s_mov_b32 s46, s44
  s_mov_b32 s44, s52
  s_cmp_ge_u32 s44, 64
  s_cbranch_scc1 PROJ_fin0
PROJ_loop:
  s_waitcnt vmcnt(0)
  s_barrier
  s_cmp_eq_u32 s47, -1
  s_cbranch_scc1 FS_101
  s_cmp_lg_u32 s3, 0
  s_cbranch_scc1 FS_101
  s_lshl_b32 s48, s47, 2
  s_add_u32 s48, s48, s58
  v_mov_b32 v5, s48
  v_mov_b32 v6, 1
  s_mov_b64 exec, 1
  global_store_dword v5, v6, s[4:5] sc1
  s_mov_b64 exec, -1
FS_101:
  s_add_u32 s52, s44, 1
  s_cmp_ge_u32 s52, 64
  s_cselect_b32 s54, s44, s52
  ds_read_b128 v[80:83], v7 offset:0
  ds_read_b128 v[84:87], v7 offset:1024
  ds_read_b128 v[88:91], v7 offset:2048
  ds_read_b128 v[92:95], v7 offset:3072
  s_mul_i32 s60, s46, 393216
  s_add_u32 s60, s60, s57
  s_add_u32 s62, s4, s60
  s_addc_u32 s63, s5, 0
  v_cvt_pk_bf16_f32 v104, v32, v33
  v_cvt_pk_bf16_f32 v105, v34, v35
  v_cvt_pk_bf16_f32 v106, v40, v41
  v_cvt_pk_bf16_f32 v107, v42, v43
  ds_read_b128 v[96:99], v7 offset:4096
  ds_read_b128 v[100:103], v7 offset:5120
  s_waitcnt lgkmcnt(5)
  v_mfma_f32_16x16x32_bf16 v[56:59], a[0:3], v[80:83], 0
  v_cvt_pk_bf16_f32 v108, v48, v49
  v_cvt_pk_bf16_f32 v109, v50, v51
  v_mfma_f32_16x16x32_bf16 v[64:67], a[80:83], v[80:83], 0
  global_store_dwordx4 v8, v[104:107], s[62:63] sc1
  v_mfma_f32_16x16x32_bf16 v[72:75], a[160:163], v[80:83], 0
  s_waitcnt lgkmcnt(4)
  v_mfma_f32_16x16x32_bf16 v[60:63], a[0:3], v[84:87], 0
  v_mfma_f32_16x16x32_bf16 v[68:71], a[80:83], v[84:87], 0
  global_store_dwordx2 v9, v[108:109], s[62:63] sc1
  v_mfma_f32_16x16x32_bf16 v[76:79], a[160:163], v[84:87], 0
  ds_read_b128 v[80:83], v7 offset:6144
  ds_read_b128 v[84:87], v7 offset:7168
  s_waitcnt lgkmcnt(5)
  v_mfma_f32_16x16x32_bf16 v[56:59], a[4:7], v[88:91], v[56:59]
  v_mfma_f32_16x16x32_bf16 v[64:67], a[84:87], v[88:91], v[64:67]
  v_cvt_pk_bf16_f32 v112, v36, v37
  v_cvt_pk_bf16_f32 v113, v38, v39
  v_mfma_f32_16x16x32_bf16 v[72:75], a[164:167], v[88:91], v[72:75]
  v_cvt_pk_bf16_f32 v114, v44, v45
  v_cvt_pk_bf16_f32 v115, v46, v47
  s_waitcnt lgkmcnt(4)
  v_mfma_f32_16x16x32_bf16 v[60:63], a[4:7], v[92:95], v[60:63]
  v_cvt_pk_bf16_f32 v116, v52, v53
  v_cvt_pk_bf16_f32 v117, v54, v55
  v_mfma_f32_16x16x32_bf16 v[68:71], a[84:87], v[92:95], v[68:71]
  global_store_dwordx4 v10, v[112:115], s[62:63] sc1
  v_mfma_f32_16x16x32_bf16 v[76:79], a[164:167], v[92:95], v[76:79]
  ds_read_b128 v[88:91], v7 offset:8192
  ds_read_b128 v[92:95], v7 offset:9216
  s_waitcnt lgkmcnt(5)
  v_mfma_f32_16x16x32_bf16 v[56:59], a[8:11], v[96:99], v[56:59]
  v_mfma_f32_16x16x32_bf16 v[64:67], a[88:91], v[96:99], v[64:67]
  global_store_dwordx2 v11, v[116:117], s[62:63] sc1
  v_mfma_f32_16x16x32_bf16 v[72:75], a[168:171], v[96:99], v[72:75]
  s_waitcnt lgkmcnt(4)
  v_mfma_f32_16x16x32_bf16 v[60:63], a[8:11], v[100:103], v[60:63]
  v_mfma_f32_16x16x32_bf16 v[68:71], a[88:91], v[100:103], v[68:71]
  s_mul_i32 s48, s54, 40960
  s_add_u32 s48, s48, s59
  v_mfma_f32_16x16x32_bf16 v[76:79], a[168:171], v[100:103], v[76:79]
  s_add_u32 s50, s4, s48
  s_addc_u32 s51, s5, 0
  ds_read_b128 v[96:99], v7 offset:10240
  ds_read_b128 v[100:103], v7 offset:11264
  s_waitcnt lgkmcnt(5)
  v_mfma_f32_16x16x32_bf16 v[56:59], a[12:15], v[80:83], v[56:59]
  s_add_u32 m0, s86, 0
  s_nop 0
  v_mfma_f32_16x16x32_bf16 v[64:67], a[92:95], v[80:83], v[64:67]
  global_load_lds_dwordx4 v4, s[50:51] offset:0 sc1
  v_mfma_f32_16x16x32_bf16 v[72:75], a[172:175], v[80:83], v[72:75]
  s_waitcnt lgkmcnt(4)
  v_mfma_f32_16x16x32_bf16 v[60:63], a[12:15], v[84:87], v[60:63]
  v_mfma_f32_16x16x32_bf16 v[68:71], a[92:95], v[84:87], v[68:71]
  global_load_lds_dwordx4 v4, s[50:51] offset:1024 sc1
  v_mfma_f32_16x16x32_bf16 v[76:79], a[172:175], v[84:87], v[76:79]
  ds_read_b128 v[80:83], v7 offset:12288
  ds_read_b128 v[84:87], v7 offset:13312
  s_waitcnt lgkmcnt(5)
  v_mfma_f32_16x16x32_bf16 v[56:59], a[16:19], v[88:91], v[56:59]
  v_mfma_f32_16x16x32_bf16 v[64:67], a[96:99], v[88:91], v[64:67]
  global_load_lds_dwordx4 v4, s[50:51] offset:2048 sc1
  v_mfma_f32_16x16x32_bf16 v[72:75], a[176:179], v[88:91], v[72:75]
  s_waitcnt lgkmcnt(4)
  v_mfma_f32_16x16x32_bf16 v[60:63], a[16:19], v[92:95], v[60:63]
  v_mfma_f32_16x16x32_bf16 v[68:71], a[96:99], v[92:95], v[68:71]
  global_load_lds_dwordx4 v4, s[50:51] offset:3072 sc1
  v_mfma_f32_16x16x32_bf16 v[76:79], a[176:179], v[92:95], v[76:79]
  ds_read_b128 v[88:91], v7 offset:14336
  ds_read_b128 v[92:95], v7 offset:15360
  s_waitcnt lgkmcnt(5)
  v_mfma_f32_16x16x32_bf16 v[56:59], a[20:23], v[96:99], v[56:59]
  v_mfma_f32_16x16x32_bf16 v[64:67], a[100:103], v[96:99], v[64:67]
  s_add_u32 s50, s50, 4096
  s_addc_u32 s51, s51, 0
  v_mfma_f32_16x16x32_bf16 v[72:75], a[180:183], v[96:99], v[72:75]
  s_add_u32 m0, s86, 4096
  s_nop 0
  s_waitcnt lgkmcnt(4)
  v_mfma_f32_16x16x32_bf16 v[60:63], a[20:23], v[100:103], v[60:63]
  global_load_lds_dwordx4 v4, s[50:51] offset:0 sc1
  v_mfma_f32_16x16x32_bf16 v[68:71], a[100:103], v[100:103], v[68:71]
  v_mfma_f32_16x16x32_bf16 v[76:79], a[180:183], v[100:103], v[76:79]
  ds_read_b128 v[96:99], v7 offset:16384
  ds_read_b128 v[100:103], v7 offset:17408
  s_waitcnt lgkmcnt(5)
  v_mfma_f32_16x16x32_bf16 v[56:59], a[24:27], v[80:83], v[56:59]
  global_load_lds_dwordx4 v4, s[50:51] offset:1024 sc1
  v_mfma_f32_16x16x32_bf16 v[64:67], a[104:107], v[80:83], v[64:67]
  v_mfma_f32_16x16x32_bf16 v[72:75], a[184:187], v[80:83], v[72:75]
  s_waitcnt lgkmcnt(4)
  v_mfma_f32_16x16x32_bf16 v[60:63], a[24:27], v[84:87], v[60:63]
  global_load_lds_dwordx4 v4, s[50:51] offset:2048 sc1
  v_mfma_f32_16x16x32_bf16 v[68:71], a[104:107], v[84:87], v[68:71]
  v_mfma_f32_16x16x32_bf16 v[76:79], a[184:187], v[84:87], v[76:79]
  ds_read_b128 v[80:83], v7 offset:18432
  ds_read_b128 v[84:87], v7 offset:19456
  s_waitcnt lgkmcnt(5)
  v_mfma_f32_16x16x32_bf16 v[56:59], a[28:31], v[88:91], v[56:59]
  global_load_lds_dwordx4 v4, s[50:51] offset:3072 sc1
  v_mfma_f32_16x16x32_bf16 v[64:67], a[108:111], v[88:91], v[64:67]
  v_mfma_f32_16x16x32_bf16 v[72:75], a[188:191], v[88:91], v[72:75]
  s_waitcnt lgkmcnt(4)
  v_mfma_f32_16x16x32_bf16 v[60:63], a[28:31], v[92:95], v[60:63]
  s_add_u32 s50, s50, 4096
  s_addc_u32 s51, s51, 0
  v_mfma_f32_16x16x32_bf16 v[68:71], a[108:111], v[92:95], v[68:71]
  s_add_u32 m0, s86, 8192
  s_nop 0
  v_mfma_f32_16x16x32_bf16 v[76:79], a[188:191], v[92:95], v[76:79]
  global_load_lds_dwordx4 v4, s[50:51] offset:0 sc1
  ds_read_b128 v[88:91], v7 offset:20480
  ds_read_b128 v[92:95], v7 offset:21504
  s_waitcnt lgkmcnt(5)
  v_mfma_f32_16x16x32_bf16 v[56:59], a[32:35], v[96:99], v[56:59]
  v_mfma_f32_16x16x32_bf16 v[64:67], a[112:115], v[96:99], v[64:67]
  v_mfma_f32_16x16x32_bf16 v[72:75], a[192:195], v[96:99], v[72:75]
  global_load_lds_dwordx4 v4, s[50:51] offset:1024 sc1
  s_waitcnt lgkmcnt(4)
  v_mfma_f32_16x16x32_bf16 v[60:63], a[32:35], v[100:103], v[60:63]
  v_mfma_f32_16x16x32_bf16 v[68:71], a[112:115], v[100:103], v[68:71]
  v_mfma_f32_16x16x32_bf16 v[76:79], a[192:195], v[100:103], v[76:79]
  ds_read_b128 v[96:99], v7 offset:22528
  ds_read_b128 v[100:103], v7 offset:23552
  s_waitcnt lgkmcnt(5)
  v_mfma_f32_16x16x32_bf16 v[56:59], a[36:39], v[80:83], v[56:59]
  v_mfma_f32_16x16x32_bf16 v[64:67], a[116:119], v[80:83], v[64:67]
  v_mfma_f32_16x16x32_bf16 v[72:75], a[196:199], v[80:83], v[72:75]
  s_waitcnt lgkmcnt(4)
  v_mfma_f32_16x16x32_bf16 v[60:63], a[36:39], v[84:87], v[60:63]
  v_mfma_f32_16x16x32_bf16 v[68:71], a[116:119], v[84:87], v[68:71]
  v_mfma_f32_16x16x32_bf16 v[76:79], a[196:199], v[84:87], v[76:79]
  ds_read_b128 v[80:83], v7 offset:24576
  ds_read_b128 v[84:87], v7 offset:25600
  s_waitcnt lgkmcnt(5)
  v_mfma_f32_16x16x32_bf16 v[56:59], a[40:43], v[88:91], v[56:59]
  v_mfma_f32_16x16x32_bf16 v[64:67], a[120:123], v[88:91], v[64:67]
  v_mfma_f32_16x16x32_bf16 v[72:75], a[200:203], v[88:91], v[72:75]
  s_waitcnt lgkmcnt(4)
  v_mfma_f32_16x16x32_bf16 v[60:63], a[40:43], v[92:95], v[60:63]
  v_mfma_f32_16x16x32_bf16 v[68:71], a[120:123], v[92:95], v[68:71]
  v_mfma_f32_16x16x32_bf16 v[76:79], a[200:203], v[92:95], v[76:79]
  ds_read_b128 v[88:91], v7 offset:26624
  ds_read_b128 v[92:95], v7 offset:27648
  s_waitcnt lgkmcnt(5)
  v_mfma_f32_16x16x32_bf16 v[56:59], a[44:47], v[96:99], v[56:59]
  v_mfma_f32_16x16x32_bf16 v[64:67], a[124:127], v[96:99], v[64:67]
  v_mfma_f32_16x16x32_bf16 v[72:75], a[204:207], v[96:99], v[72:75]
  s_waitcnt lgkmcnt(4)
  v_mfma_f32_16x16x32_bf16 v[60:63], a[44:47], v[100:103], v[60:63]
  v_mfma_f32_16x16x32_bf16 v[68:71], a[124:127], v[100:103], v[68:71]
  v_mfma_f32_16x16x32_bf16 v[76:79], a[204:207], v[100:103], v[76:79]
  ds_read_b128 v[96:99], v7 offset:28672
  ds_read_b128 v[100:103], v7 offset:29696
  s_waitcnt lgkmcnt(5)
  v_mfma_f32_16x16x32_bf16 v[56:59], a[48:51], v[80:83], v[56:59]
  v_mfma_f32_16x16x32_bf16 v[64:67], a[128:131], v[80:83], v[64:67]
  v_mfma_f32_16x16x32_bf16 v[72:75], a[208:211], v[80:83], v[72:75]
  s_waitcnt lgkmcnt(4)
  v_mfma_f32_16x16x32_bf16 v[60:63], a[48:51], v[84:87], v[60:63]
  v_mfma_f32_16x16x32_bf16 v[68:71], a[128:131], v[84:87], v[68:71]
  v_mfma_f32_16x16x32_bf16 v[76:79], a[208:211], v[84:87], v[76:79]
  ds_read_b128 v[80:83], v7 offset:30720
  ds_read_b128 v[84:87], v7 offset:31744
  s_waitcnt lgkmcnt(5)
  v_mfma_f32_16x16x32_bf16 v[56:59], a[52:55], v[88:91], v[56:59]
  v_mfma_f32_16x16x32_bf16 v[64:67], a[132:135], v[88:91], v[64:67]
  v_mfma_f32_16x16x32_bf16 v[72:75], a[212:215], v[88:91], v[72:75]
  s_waitcnt lgkmcnt(4)
  v_mfma_f32_16x16x32_bf16 v[60:63], a[52:55], v[92:95], v[60:63]
  v_mfma_f32_16x16x32_bf16 v[68:71], a[132:135], v[92:95], v[68:71]
  v_mfma_f32_16x16x32_bf16 v[76:79], a[212:215], v[92:95], v[76:79]
  ds_read_b128 v[88:91], v7 offset:32768
  ds_read_b128 v[92:95], v7 offset:33792
  s_waitcnt lgkmcnt(5)
  v_mfma_f32_16x16x32_bf16 v[56:59], a[56:59], v[96:99], v[56:59]
  v_mfma_f32_16x16x32_bf16 v[64:67], a[136:139], v[96:99], v[64:67]
  v_mfma_f32_16x16x32_bf16 v[72:75], a[216:219], v[96:99], v[72:75]
  s_waitcnt lgkmcnt(4)
  v_mfma_f32_16x16x32_bf16 v[60:63], a[56:59], v[100:103], v[60:63]
  v_mfma_f32_16x16x32_bf16 v[68:71], a[136:139], v[100:103], v[68:71]
  v_mfma_f32_16x16x32_bf16 v[76:79], a[216:219], v[100:103], v[76:79]
  ds_read_b128 v[96:99], v7 offset:34816
  ds_read_b128 v[100:103], v7 offset:35840
  s_waitcnt lgkmcnt(5)
  v_mfma_f32_16x16x32_bf16 v[56:59], a[60:63], v[80:83], v[56:59]
  v_mfma_f32_16x16x32_bf16 v[64:67], a[140:143], v[80:83], v[64:67]
  v_mfma_f32_16x16x32_bf16 v[72:75], a[220:223], v[80:83], v[72:75]
  s_waitcnt lgkmcnt(4)
  v_mfma_f32_16x16x32_bf16 v[60:63], a[60:63], v[84:87], v[60:63]
  v_mfma_f32_16x16x32_bf16 v[68:71], a[140:143], v[84:87], v[68:71]
  v_mfma_f32_16x16x32_bf16 v[76:79], a[220:223], v[84:87], v[76:79]
  ds_read_b128 v[80:83], v7 offset:36864
  ds_read_b128 v[84:87], v7 offset:37888
  s_waitcnt lgkmcnt(5)
  v_mfma_f32_16x16x32_bf16 v[56:59], a[64:67], v[88:91], v[56:59]
  v_mfma_f32_16x16x32_bf16 v[64:67], a[144:147], v[88:91], v[64:67]
  v_mfma_f32_16x16x32_bf16 v[72:75], a[224:227], v[88:91], v[72:75]
  s_waitcnt lgkmcnt(4)
  v_mfma_f32_16x16x32_bf16 v[60:63], a[64:67], v[92:95], v[60:63]
  v_mfma_f32_16x16x32_bf16 v[68:71], a[144:147], v[92:95], v[68:71]
  v_mfma_f32_16x16x32_bf16 v[76:79], a[224:227], v[92:95], v[76:79]
  ds_read_b128 v[88:91], v7 offset:38912
  ds_read_b128 v[92:95], v7 offset:39936
  s_waitcnt lgkmcnt(5)
  v_mfma_f32_16x16x32_bf16 v[56:59], a[68:71], v[96:99], v[56:59]
  v_mfma_f32_16x16x32_bf16 v[64:67], a[148:151], v[96:99], v[64:67]
  v_mfma_f32_16x16x32_bf16 v[72:75], a[228:231], v[96:99], v[72:75]
  s_waitcnt lgkmcnt(4)
  v_mfma_f32_16x16x32_bf16 v[60:63], a[68:71], v[100:103], v[60:63]
  v_mfma_f32_16x16x32_bf16 v[68:71], a[148:151], v[100:103], v[68:71]
  v_mfma_f32_16x16x32_bf16 v[76:79], a[228:231], v[100:103], v[76:79]
  s_waitcnt lgkmcnt(3)
  v_mfma_f32_16x16x32_bf16 v[56:59], a[72:75], v[80:83], v[56:59]
  v_mfma_f32_16x16x32_bf16 v[64:67], a[152:155], v[80:83], v[64:67]
  v_mfma_f32_16x16x32_bf16 v[72:75], a[232:235], v[80:83], v[72:75]
  s_waitcnt lgkmcnt(2)
  v_mfma_f32_16x16x32_bf16 v[60:63], a[72:75], v[84:87], v[60:63]
  v_mfma_f32_16x16x32_bf16 v[68:71], a[152:155], v[84:87], v[68:71]
  v_mfma_f32_16x16x32_bf16 v[76:79], a[232:235], v[84:87], v[76:79]
  s_waitcnt lgkmcnt(1)
  v_mfma_f32_16x16x32_bf16 v[56:59], a[76:79], v[88:91], v[56:59]
  v_mfma_f32_16x16x32_bf16 v[64:67], a[156:159], v[88:91], v[64:67]
  v_mfma_f32_16x16x32_bf16 v[72:75], a[236:239], v[88:91], v[72:75]
  s_waitcnt lgkmcnt(0)
  v_mfma_f32_16x16x32_bf16 v[60:63], a[76:79], v[92:95], v[60:63]
  v_mfma_f32_16x16x32_bf16 v[68:71], a[156:159], v[92:95], v[68:71]
  v_mfma_f32_16x16x32_bf16 v[76:79], a[236:239], v[92:95], v[76:79]
  s_cmp_ge_u32 s44, 4
  s_cbranch_scc1 EG_102
  s_nop 7
  s_mul_i32 s60, s44, 393216
  s_add_u32 s60, s60, s57
  s_add_u32 s62, s4, s60
  s_addc_u32 s63, s5, 0
  v_cvt_pk_bf16_f32 v104, v56, v57
  v_cvt_pk_bf16_f32 v105, v58, v59
  v_cvt_pk_bf16_f32 v106, v64, v65
  v_cvt_pk_bf16_f32 v107, v66, v67
  v_cvt_pk_bf16_f32 v108, v72, v73
  v_cvt_pk_bf16_f32 v109, v74, v75
  global_store_dwordx4 v8, v[104:107], s[62:63] sc1
  global_store_dwordx2 v9, v[108:109], s[62:63] sc1
  v_cvt_pk_bf16_f32 v112, v60, v61
  v_cvt_pk_bf16_f32 v113, v62, v63
  v_cvt_pk_bf16_f32 v114, v68, v69
  v_cvt_pk_bf16_f32 v115, v70, v71
  v_cvt_pk_bf16_f32 v116, v76, v77
  v_cvt_pk_bf16_f32 v117, v78, v79
  global_store_dwordx4 v10, v[112:115], s[62:63] sc1
  global_store_dwordx2 v11, v[116:117], s[62:63] sc1
  s_waitcnt vmcnt(0)
  s_barrier
  s_cmp_eq_u32 s44, -1
  s_cbranch_scc1 FS_103
  s_cmp_lg_u32 s3, 0
  s_cbranch_scc1 FS_103
  s_lshl_b32 s48, s44, 2
  s_add_u32 s48, s48, s58
  v_mov_b32 v5, s48
  v_mov_b32 v6, 1
  s_mov_b64 exec, 1
  global_store_dword v5, v6, s[4:5] sc1
  s_mov_b64 exec, -1
FS_103:
EG_102:
  s_mov_b32 s47, s46
  s_mov_b32 s46, s44
  s_mov_b32 s44, s52
  s_cmp_ge_u32 s44, 64
  s_cbranch_scc1 PROJ_fin1
  s_waitcnt vmcnt(0)
  s_barrier
  s_cmp_eq_u32 s47, -1
  s_cbranch_scc1 FS_104
  s_cmp_lg_u32 s3, 0
  s_cbranch_scc1 FS_104
  s_lshl_b32 s48, s47, 2
  s_add_u32 s48, s48, s58
  v_mov_b32 v5, s48
  v_mov_b32 v6, 1
  s_mov_b64 exec, 1
  global_store_dword v5, v6, s[4:5] sc1
  s_mov_b64 exec, -1
FS_104:
  s_add_u32 s52, s44, 1
  s_cmp_ge_u32 s52, 64
  s_cselect_b32 s54, s44, s52
  ds_read_b128 v[80:83], v3 offset:0
  ds_read_b128 v[84:87], v3 offset:1024
  ds_read_b128 v[88:91], v3 offset:2048
  ds_read_b128 v[92:95], v3 offset:3072
  s_mul_i32 s60, s46, 393216
  s_add_u32 s60, s60, s57
  s_add_u32 s62, s4, s60
  s_addc_u32 s63, s5, 0
  v_cvt_pk_bf16_f32 v104, v56, v57
  v_cvt_pk_bf16_f32 v105, v58, v59
  v_cvt_pk_bf16_f32 v106, v64, v65
  v_cvt_pk_bf16_f32 v107, v66, v67
  ds_read_b128 v[96:99], v3 offset:4096
  ds_read_b128 v[100:103], v3 offset:5120
  s_waitcnt lgkmcnt(5)
  v_mfma_f32_16x16x32_bf16 v[32:35], a[0:3], v[80:83], 0
  v_cvt_pk_bf16_f32 v108, v72, v73
  v_cvt_pk_bf16_f32 v109, v74, v75
  v_mfma_f32_16x16x32_bf16 v[40:43], a[80:83], v[80:83], 0
  global_store_dwordx4 v8, v[104:107], s[62:63] sc1
  v_mfma_f32_16x16x32_bf16 v[48:51], a[160:163], v[80:83], 0
  s_waitcnt lgkmcnt(4)
  v_mfma_f32_16x16x32_bf16 v[36:39], a[0:3], v[84:87], 0
  v_mfma_f32_16x16x32_bf16 v[44:47], a[80:83], v[84:87], 0
  global_store_dwordx2 v9, v[108:109], s[62:63] sc1
  v_mfma_f32_16x16x32_bf16 v[52:55], a[160:163], v[84:87], 0
  ds_read_b128 v[80:83], v3 offset:6144
  ds_read_b128 v[84:87], v3 offset:7168
  s_waitcnt lgkmcnt(5)
  v_mfma_f32_16x16x32_bf16 v[32:35], a[4:7], v[88:91], v[32:35]
  v_mfma_f32_16x16x32_bf16 v[40:43], a[84:87], v[88:91], v[40:43]
  v_cvt_pk_bf16_f32 v112, v60, v61
  v_cvt_pk_bf16_f32 v113, v62, v63
  v_mfma_f32_16x16x32_bf16 v[48:51], a[164:167], v[88:91], v[48:51]
  v_cvt_pk_bf16_f32 v114, v68, v69
  v_cvt_pk_bf16_f32 v115, v70, v71
  s_waitcnt lgkmcnt(4)
  v_mfma_f32_16x16x32_bf16 v[36:39], a[4:7], v[92:95], v[36:39]
  v_cvt_pk_bf16_f32 v116, v76, v77
  v_cvt_pk_bf16_f32 v117, v78, v79
  v_mfma_f32_16x16x32_bf16 v[44:47], a[84:87], v[92:95], v[44:47]
  global_store_dwordx4 v10, v[112:115], s[62:63] sc1
  v_mfma_f32_16x16x32_bf16 v[52:55], a[164:167], v[92:95], v[52:55]
  ds_read_b128 v[88:91], v3 offset:8192
  ds_read_b128 v[92:95], v3 offset:9216
  s_waitcnt lgkmcnt(5)
  v_mfma_f32_16x16x32_bf16 v[32:35], a[8:11], v[96:99], v[32:35]
  v_mfma_f32_16x16x32_bf16 v[40:43], a[88:91], v[96:99], v[40:43]
  global_store_dwordx2 v11, v[116:117], s[62:63] sc1
  v_mfma_f32_16x16x32_bf16 v[48:51], a[168:171], v[96:99], v[48:51]
  s_waitcnt lgkmcnt(4)
  v_mfma_f32_16x16x32_bf16 v[36:39], a[8:11], v[100:103], v[36:39]
  v_mfma_f32_16x16x32_bf16 v[44:47], a[88:91], v[100:103], v[44:47]
  s_mul_i32 s48, s54, 40960
  s_add_u32 s48, s48, s59
  v_mfma_f32_16x16x32_bf16 v[52:55], a[168:171], v[100:103], v[52:55]
  s_add_u32 s50, s4, s48
  s_addc_u32 s51, s5, 0
  ds_read_b128 v[96:99], v3 offset:10240
  ds_read_b128 v[100:103], v3 offset:11264
  s_waitcnt lgkmcnt(5)
  v_mfma_f32_16x16x32_bf16 v[32:35], a[12:15], v[80:83], v[32:35]
  s_add_u32 m0, s86, 40960
  s_nop 0
  v_mfma_f32_16x16x32_bf16 v[40:43], a[92:95], v[80:83], v[40:43]
  global_load_lds_dwordx4 v4, s[50:51] offset:0 sc1
  v_mfma_f32_16x16x32_bf16 v[48:51], a[172:175], v[80:83], v[48:51]
  s_waitcnt lgkmcnt(4)
  v_mfma_f32_16x16x32_bf16 v[36:39], a[12:15], v[84:87], v[36:39]
  v_mfma_f32_16x16x32_bf16 v[44:47], a[92:95], v[84:87], v[44:47]
  global_load_lds_dwordx4 v4, s[50:51] offset:1024 sc1
  v_mfma_f32_16x16x32_bf16 v[52:55], a[172:175], v[84:87], v[52:55]
  ds_read_b128 v[80:83], v3 offset:12288
  ds_read_b128 v[84:87], v3 offset:13312
  s_waitcnt lgkmcnt(5)
  v_mfma_f32_16x16x32_bf16 v[32:35], a[16:19], v[88:91], v[32:35]
  v_mfma_f32_16x16x32_bf16 v[40:43], a[96:99], v[88:91], v[40:43]
  global_load_lds_dwordx4 v4, s[50:51] offset:2048 sc1
  v_mfma_f32_16x16x32_bf16 v[48:51], a[176:179], v[88:91], v[48:51]
  s_waitcnt lgkmcnt(4)
  v_mfma_f32_16x16x32_bf16 v[36:39], a[16:19], v[92:95], v[36:39]
  v_mfma_f32_16x16x32_bf16 v[44:47], a[96:99], v[92:95], v[44:47]
  global_load_lds_dwordx4 v4, s[50:51] offset:3072 sc1
  v_mfma_f32_16x16x32_bf16 v[52:55], a[176:179], v[92:95], v[52:55]
  ds_read_b128 v[88:91], v3 offset:14336
  ds_read_b128 v[92:95], v3 offset:15360
  s_waitcnt lgkmcnt(5)
  v_mfma_f32_16x16x32_bf16 v[32:35], a[20:23], v[96:99], v[32:35]
  v_mfma_f32_16x16x32_bf16 v[40:43], a[100:103], v[96:99], v[40:43]
  s_add_u32 s50, s50, 4096
  s_addc_u32 s51, s51, 0
  v_mfma_f32_16x16x32_bf16 v[48:51], a[180:183], v[96:99], v[48:51]
  s_add_u32 m0, s86, 45056
  s_nop 0
  s_waitcnt lgkmcnt(4)
  v_mfma_f32_16x16x32_bf16 v[36:39], a[20:23], v[100:103], v[36:39]
  global_load_lds_dwordx4 v4, s[50:51] offset:0 sc1
  v_mfma_f32_16x16x32_bf16 v[44:47], a[100:103], v[100:103], v[44:47]
  v_mfma_f32_16x16x32_bf16 v[52:55], a[180:183], v[100:103], v[52:55]
  ds_read_b128 v[96:99], v3 offset:16384
  ds_read_b128 v[100:103], v3 offset:17408
  s_waitcnt lgkmcnt(5)
  v_mfma_f32_16x16x32_bf16 v[32:35], a[24:27], v[80:83], v[32:35]
  global_load_lds_dwordx4 v4, s[50:51] offset:1024 sc1
  v_mfma_f32_16x16x32_bf16 v[40:43], a[104:107], v[80:83], v[40:43]
  v_mfma_f32_16x16x32_bf16 v[48:51], a[184:187], v[80:83], v[48:51]
  s_waitcnt lgkmcnt(4)
  v_mfma_f32_16x16x32_bf16 v[36:39], a[24:27], v[84:87], v[36:39]
  global_load_lds_dwordx4 v4, s[50:51] offset:2048 sc1
  v_mfma_f32_16x16x32_bf16 v[44:47], a[104:107], v[84:87], v[44:47]
  v_mfma_f32_16x16x32_bf16 v[52:55], a[184:187], v[84:87], v[52:55]
  ds_read_b128 v[80:83], v3 offset:18432
  ds_read_b128 v[84:87], v3 offset:19456
  s_waitcnt lgkmcnt(5)
  v_mfma_f32_16x16x32_bf16 v[32:35], a[28:31], v[88:91], v[32:35]
  global_load_lds_dwordx4 v4, s[50:51] offset:3072 sc1
  v_mfma_f32_16x16x32_bf16 v[40:43], a[108:111], v[88:91], v[40:43]
  v_mfma_f32_16x16x32_bf16 v[48:51], a[188:191], v[88:91], v[48:51]
  s_waitcnt lgkmcnt(4)
  v_mfma_f32_16x16x32_bf16 v[36:39], a[28:31], v[92:95], v[36:39]
  s_add_u32 s50, s50, 4096
  s_addc_u32 s51, s51, 0
  v_mfma_f32_16x16x32_bf16 v[44:47], a[108:111], v[92:95], v[44:47]
  s_add_u32 m0, s86, 49152
  s_nop 0
  v_mfma_f32_16x16x32_bf16 v[52:55], a[188:191], v[92:95], v[52:55]
  global_load_lds_dwordx4 v4, s[50:51] offset:0 sc1
  ds_read_b128 v[88:91], v3 offset:20480
  ds_read_b128 v[92:95], v3 offset:21504
  s_waitcnt lgkmcnt(5)
  v_mfma_f32_16x16x32_bf16 v[32:35], a[32:35], v[96:99], v[32:35]
  v_mfma_f32_16x16x32_bf16 v[40:43], a[112:115], v[96:99], v[40:43]
  v_mfma_f32_16x16x32_bf16 v[48:51], a[192:195], v[96:99], v[48:51]
  global_load_lds_dwordx4 v4, s[50:51] offset:1024 sc1
  s_waitcnt lgkmcnt(4)
  v_mfma_f32_16x16x32_bf16 v[36:39], a[32:35], v[100:103], v[36:39]
  v_mfma_f32_16x16x32_bf16 v[44:47], a[112:115], v[100:103], v[44:47]
  v_mfma_f32_16x16x32_bf16 v[52:55], a[192:195], v[100:103], v[52:55]
  ds_read_b128 v[96:99], v3 offset:22528
  ds_read_b128 v[100:103], v3 offset:23552
  s_waitcnt lgkmcnt(5)
  v_mfma_f32_16x16x32_bf16 v[32:35], a[36:39], v[80:83], v[32:35]
  v_mfma_f32_16x16x32_bf16 v[40:43], a[116:119], v[80:83], v[40:43]
  v_mfma_f32_16x16x32_bf16 v[48:51], a[196:199], v[80:83], v[48:51]
  s_waitcnt lgkmcnt(4)
  v_mfma_f32_16x16x32_bf16 v[36:39], a[36:39], v[84:87], v[36:39]
  v_mfma_f32_16x16x32_bf16 v[44:47], a[116:119], v[84:87], v[44:47]
  v_mfma_f32_16x16x32_bf16 v[52:55], a[196:199], v[84:87], v[52:55]
  ds_read_b128 v[80:83], v3 offset:24576
  ds_read_b128 v[84:87], v3 offset:25600
  s_waitcnt lgkmcnt(5)
  v_mfma_f32_16x16x32_bf16 v[32:35], a[40:43], v[88:91], v[32:35]
  v_mfma_f32_16x16x32_bf16 v[40:43], a[120:123], v[88:91], v[40:43]
  v_mfma_f32_16x16x32_bf16 v[48:51], a[200:203], v[88:91], v[48:51]
  s_waitcnt lgkmcnt(4)
  v_mfma_f32_16x16x32_bf16 v[36:39], a[40:43], v[92:95], v[36:39]
  v_mfma_f32_16x16x32_bf16 v[44:47], a[120:123], v[92:95], v[44:47]
  v_mfma_f32_16x16x32_bf16 v[52:55], a[200:203], v[92:95], v[52:55]
  ds_read_b128 v[88:91], v3 offset:26624
  ds_read_b128 v[92:95], v3 offset:27648
  s_waitcnt lgkmcnt(5)
  v_mfma_f32_16x16x32_bf16 v[32:35], a[44:47], v[96:99], v[32:35]
  v_mfma_f32_16x16x32_bf16 v[40:43], a[124:127], v[96:99], v[40:43]
  v_mfma_f32_16x16x32_bf16 v[48:51], a[204:207], v[96:99], v[48:51]
  s_waitcnt lgkmcnt(4)
  v_mfma_f32_16x16x32_bf16 v[36:39], a[44:47], v[100:103], v[36:39]
  v_mfma_f32_16x16x32_bf16 v[44:47], a[124:127], v[100:103], v[44:47]
  v_mfma_f32_16x16x32_bf16 v[52:55], a[204:207], v[100:103], v[52:55]
  ds_read_b128 v[96:99], v3 offset:28672
  ds_read_b128 v[100:103], v3 offset:29696
  s_waitcnt lgkmcnt(5)
  v_mfma_f32_16x16x32_bf16 v[32:35], a[48:51], v[80:83], v[32:35]
  v_mfma_f32_16x16x32_bf16 v[40:43], a[128:131], v[80:83], v[40:43]
  v_mfma_f32_16x16x32_bf16 v[48:51], a[208:211], v[80:83], v[48:51]
  s_waitcnt lgkmcnt(4)
  v_mfma_f32_16x16x32_bf16 v[36:39], a[48:51], v[84:87], v[36:39]
  v_mfma_f32_16x16x32_bf16 v[44:47], a[128:131], v[84:87], v[44:47]
  v_mfma_f32_16x16x32_bf16 v[52:55], a[208:211], v[84:87], v[52:55]
  ds_read_b128 v[80:83], v3 offset:30720
  ds_read_b128 v[84:87], v3 offset:31744
  s_waitcnt lgkmcnt(5)
  v_mfma_f32_16x16x32_bf16 v[32:35], a[52:55], v[88:91], v[32:35]
  v_mfma_f32_16x16x32_bf16 v[40:43], a[132:135], v[88:91], v[40:43]
  v_mfma_f32_16x16x32_bf16 v[48:51], a[212:215], v[88:91], v[48:51]
  s_waitcnt lgkmcnt(4)
  v_mfma_f32_16x16x32_bf16 v[36:39], a[52:55], v[92:95], v[36:39]
  v_mfma_f32_16x16x32_bf16 v[44:47], a[132:135], v[92:95], v[44:47]
  v_mfma_f32_16x16x32_bf16 v[52:55], a[212:215], v[92:95], v[52:55]
  ds_read_b128 v[88:91], v3 offset:32768
  ds_read_b128 v[92:95], v3 offset:33792
  s_waitcnt lgkmcnt(5)
  v_mfma_f32_16x16x32_bf16 v[32:35], a[56:59], v[96:99], v[32:35]
  v_mfma_f32_16x16x32_bf16 v[40:43], a[136:139], v[96:99], v[40:43]
  v_mfma_f32_16x16x32_bf16 v[48:51], a[216:219], v[96:99], v[48:51]
  s_waitcnt lgkmcnt(4)
  v_mfma_f32_16x16x32_bf16 v[36:39], a[56:59], v[100:103], v[36:39]
  v_mfma_f32_16x16x32_bf16 v[44:47], a[136:139], v[100:103], v[44:47]
  v_mfma_f32_16x16x32_bf16 v[52:55], a[216:219], v[100:103], v[52:55]
  ds_read_b128 v[96:99], v3 offset:34816
  ds_read_b128 v[100:103], v3 offset:35840
  s_waitcnt lgkmcnt(5)
  v_mfma_f32_16x16x32_bf16 v[32:35], a[60:63], v[80:83], v[32:35]
  v_mfma_f32_16x16x32_bf16 v[40:43], a[140:143], v[80:83], v[40:43]
  v_mfma_f32_16x16x32_bf16 v[48:51], a[220:223], v[80:83], v[48:51]
  s_waitcnt lgkmcnt(4)
  v_mfma_f32_16x16x32_bf16 v[36:39], a[60:63], v[84:87], v[36:39]
  v_mfma_f32_16x16x32_bf16 v[44:47], a[140:143], v[84:87], v[44:47]
  v_mfma_f32_16x16x32_bf16 v[52:55], a[220:223], v[84:87], v[52:55]
  ds_read_b128 v[80:83], v3 offset:36864
  ds_read_b128 v[84:87], v3 offset:37888
  s_waitcnt lgkmcnt(5)
  v_mfma_f32_16x16x32_bf16 v[32:35], a[64:67], v[88:91], v[32:35]
  v_mfma_f32_16x16x32_bf16 v[40:43], a[144:147], v[88:91], v[40:43]
  v_mfma_f32_16x16x32_bf16 v[48:51], a[224:227], v[88:91], v[48:51]
  s_waitcnt lgkmcnt(4)
  v_mfma_f32_16x16x32_bf16 v[36:39], a[64:67], v[92:95], v[36:39]
  v_mfma_f32_16x16x32_bf16 v[44:47], a[144:147], v[92:95], v[44:47]
  v_mfma_f32_16x16x32_bf16 v[52:55], a[224:227], v[92:95], v[52:55]
  ds_read_b128 v[88:91], v3 offset:38912
  ds_read_b128 v[92:95], v3 offset:39936
  s_waitcnt lgkmcnt(5)
  v_mfma_f32_16x16x32_bf16 v[32:35], a[68:71], v[96:99], v[32:35]
  v_mfma_f32_16x16x32_bf16 v[40:43], a[148:151], v[96:99], v[40:43]
  v_mfma_f32_16x16x32_bf16 v[48:51], a[228:231], v[96:99], v[48:51]
  s_waitcnt lgkmcnt(4)
  v_mfma_f32_16x16x32_bf16 v[36:39], a[68:71], v[100:103], v[36:39]
  v_mfma_f32_16x16x32_bf16 v[44:47], a[148:151], v[100:103], v[44:47]
  v_mfma_f32_16x16x32_bf16 v[52:55], a[228:231], v[100:103], v[52:55]
  s_waitcnt lgkmcnt(3)
  v_mfma_f32_16x16x32_bf16 v[32:35], a[72:75], v[80:83], v[32:35]
  v_mfma_f32_16x16x32_bf16 v[40:43], a[152:155], v[80:83], v[40:43]
  v_mfma_f32_16x16x32_bf16 v[48:51], a[232:235], v[80:83], v[48:51]
  s_waitcnt lgkmcnt(2)
  v_mfma_f32_16x16x32_bf16 v[36:39], a[72:75], v[84:87], v[36:39]
  v_mfma_f32_16x16x32_bf16 v[44:47], a[152:155], v[84:87], v[44:47]
  v_mfma_f32_16x16x32_bf16 v[52:55], a[232:235], v[84:87], v[52:55]
  s_waitcnt lgkmcnt(1)
  v_mfma_f32_16x16x32_bf16 v[32:35], a[76:79], v[88:91], v[32:35]
  v_mfma_f32_16x16x32_bf16 v[40:43], a[156:159], v[88:91], v[40:43]
  v_mfma_f32_16x16x32_bf16 v[48:51], a[236:239], v[88:91], v[48:51]
  s_waitcnt lgkmcnt(0)
  v_mfma_f32_16x16x32_bf16 v[36:39], a[76:79], v[92:95], v[36:39]
  v_mfma_f32_16x16x32_bf16 v[44:47], a[156:159], v[92:95], v[44:47]
  v_mfma_f32_16x16x32_bf16 v[52:55], a[236:239], v[92:95], v[52:55]
  s_cmp_ge_u32 s44, 4
  s_cbranch_scc1 EG_105
  s_nop 7
  s_mul_i32 s60, s44, 393216
  s_add_u32 s60, s60, s57
  s_add_u32 s62, s4, s60
  s_addc_u32 s63, s5, 0
  v_cvt_pk_bf16_f32 v104, v32, v33
  v_cvt_pk_bf16_f32 v105, v34, v35
  v_cvt_pk_bf16_f32 v106, v40, v41
  v_cvt_pk_bf16_f32 v107, v42, v43
  v_cvt_pk_bf16_f32 v108, v48, v49
  v_cvt_pk_bf16_f32 v109, v50, v51
  global_store_dwordx4 v8, v[104:107], s[62:63] sc1
  global_store_dwordx2 v9, v[108:109], s[62:63] sc1
  v_cvt_pk_bf16_f32 v112, v36, v37
  v_cvt_pk_bf16_f32 v113, v38, v39
  v_cvt_pk_bf16_f32 v114, v44, v45
  v_cvt_pk_bf16_f32 v115, v46, v47
  v_cvt_pk_bf16_f32 v116, v52, v53
  v_cvt_pk_bf16_f32 v117, v54, v55
  global_store_dwordx4 v10, v[112:115], s[62:63] sc1
  global_store_dwordx2 v11, v[116:117], s[62:63] sc1
  s_waitcnt vmcnt(0)
  s_barrier
  s_cmp_eq_u32 s44, -1
  s_cbranch_scc1 FS_106
  s_cmp_lg_u32 s3, 0
  s_cbranch_scc1 FS_106
  s_lshl_b32 s48, s44, 2
  s_add_u32 s48, s48, s58
  v_mov_b32 v5, s48
  v_mov_b32 v6, 1
  s_mov_b64 exec, 1
  global_store_dword v5, v6, s[4:5] sc1
  s_mov_b64 exec, -1
FS_106:
EG_105:
  s_mov_b32 s47, s46
  s_mov_b32 s46, s44
  s_mov_b32 s44, s52
  s_cmp_lt_u32 s44, 64
  s_cbranch_scc1 PROJ_loop
PROJ_fin0:
  s_nop 7
  s_mul_i32 s60, s46, 393216
  s_add_u32 s60, s60, s57
  s_add_u32 s62, s4, s60
  s_addc_u32 s63, s5, 0
  v_cvt_pk_bf16_f32 v104, v32, v33
  v_cvt_pk_bf16_f32 v105, v34, v35
  v_cvt_pk_bf16_f32 v106, v40, v41
  v_cvt_pk_bf16_f32 v107, v42, v43
  v_cvt_pk_bf16_f32 v108, v48, v49
  v_cvt_pk_bf16_f32 v109, v50, v51
  global_store_dwordx4 v8, v[104:107], s[62:63] sc1
  global_store_dwordx2 v9, v[108:109], s[62:63] sc1
  v_cvt_pk_bf16_f32 v112, v36, v37
  v_cvt_pk_bf16_f32 v113, v38, v39
  v_cvt_pk_bf16_f32 v114, v44, v45
  v_cvt_pk_bf16_f32 v115, v46, v47
  v_cvt_pk_bf16_f32 v116, v52, v53
  v_cvt_pk_bf16_f32 v117, v54, v55
  global_store_dwordx4 v10, v[112:115], s[62:63] sc1
  global_store_dwordx2 v11, v[116:117], s[62:63] sc1
  s_branch PROJ_tail
PROJ_fin1:
  s_nop 7
  s_mul_i32 s60, s46, 393216
  s_add_u32 s60, s60, s57
  s_add_u32 s62, s4, s60
  s_addc_u32 s63, s5, 0
  v_cvt_pk_bf16_f32 v104, v56, v57
  v_cvt_pk_bf16_f32 v105, v58, v59
  v_cvt_pk_bf16_f32 v106, v64, v65
  v_cvt_pk_bf16_f32 v107, v66, v67
  v_cvt_pk_bf16_f32 v108, v72, v73
  v_cvt_pk_bf16_f32 v109, v74, v75
  global_store_dwordx4 v8, v[104:107], s[62:63] sc1
  global_store_dwordx2 v9, v[108:109], s[62:63] sc1
  v_cvt_pk_bf16_f32 v112, v60, v61
  v_cvt_pk_bf16_f32 v113, v62, v63
  v_cvt_pk_bf16_f32 v114, v68, v69
  v_cvt_pk_bf16_f32 v115, v70, v71
  v_cvt_pk_bf16_f32 v116, v76, v77
  v_cvt_pk_bf16_f32 v117, v78, v79
  global_store_dwordx4 v10, v[112:115], s[62:63] sc1
  global_store_dwordx2 v11, v[116:117], s[62:63] sc1
PROJ_tail:
  s_waitcnt vmcnt(0)
  s_barrier
  s_cmp_eq_u32 s47, -1
  s_cbranch_scc1 FS_107
  s_cmp_lg_u32 s3, 0
  s_cbranch_scc1 FS_107
  s_lshl_b32 s48, s47, 2
  s_add_u32 s48, s48, s58
  v_mov_b32 v5, s48
  v_mov_b32 v6, 1
  s_mov_b64 exec, 1
  global_store_dword v5, v6, s[4:5] sc1
  s_mov_b64 exec, -1
FS_107:
  s_cmp_eq_u32 s46, -1
  s_cbranch_scc1 FS_108
  s_cmp_lg_u32 s3, 0
  s_cbranch_scc1 FS_108
  s_lshl_b32 s48, s46, 2
  s_add_u32 s48, s48, s58
  v_mov_b32 v5, s48
  v_mov_b32 v6, 1
  s_mov_b64 exec, 1
  global_store_dword v5, v6, s[4:5] sc1
  s_mov_b64 exec, -1
FS_108:
PROJ_end:
  s_branch K2_ffn
K2_ug:
  s_load_dwordx2 s[12:13], s[0:1], 40
  s_and_b32 s42, s40, 31
  s_mov_b32 s44, 0
  v_add_u32 v240, 0, v0
  v_mul_u32_u24 v241, 6554, v240
  v_lshrrev_b32 v241, 19, v241
  v_mul_u32_u24 v242, 80, v241
  v_sub_u32 v242, v240, v242
  v_and_b32 v243, 7, v241
  v_lshlrev_b32 v243, 1, v243
  v_xor_b32 v242, v242, v243
  s_mov_b32 s90, 1280
  v_mul_lo_u32 v241, v241, s90
  v_lshl_add_u32 v24, v242, 4, v241
  v_add_u32 v240, 256, v0
  v_mul_u32_u24 v241, 6554, v240
  v_lshrrev_b32 v241, 19, v241
  v_mul_u32_u24 v242, 80, v241
  v_sub_u32 v242, v240, v242
  v_and_b32 v243, 7, v241
  v_lshlrev_b32 v243, 1, v243
  v_xor_b32 v242, v242, v243
  s_mov_b32 s90, 1280
  v_mul_lo_u32 v241, v241, s90
  v_lshl_add_u32 v25, v242, 4, v241
  v_add_u32 v240, 512, v0
  v_mul_u32_u24 v241, 6554, v240
  v_lshrrev_b32 v241, 19, v241
  v_mul_u32_u24 v242, 80, v241
  v_sub_u32 v242, v240, v242
  v_and_b32 v243, 7, v241
  v_lshlrev_b32 v243, 1, v243
  v_xor_b32 v242, v242, v243
  s_mov_b32 s90, 1280
  v_mul_lo_u32 v241, v241, s90
  v_lshl_add_u32 v26, v242, 4, v241
  v_add_u32 v240, 768, v0
  v_mul_u32_u24 v241, 6554, v240
  v_lshrrev_b32 v241, 19, v241
  v_mul_u32_u24 v242, 80, v241
  v_sub_u32 v242, v240, v242
  v_and_b32 v243, 7, v241
  v_lshlrev_b32 v243, 1, v243
  v_xor_b32 v242, v242, v243
  s_mov_b32 s90, 1280
  v_mul_lo_u32 v241, v241, s90
  v_lshl_add_u32 v27, v242, 4, v241
  v_add_u32 v240, 1024, v0
  v_mul_u32_u24 v241, 6554, v240
  v_lshrrev_b32 v241, 19, v241
  v_mul_u32_u24 v242, 80, v241
  v_sub_u32 v242, v240, v242
  v_and_b32 v243, 7, v241
  v_lshlrev_b32 v243, 1, v243
  v_xor_b32 v242, v242, v243
  s_mov_b32 s90, 1280
  v_mul_lo_u32 v241, v241, s90
  v_lshl_add_u32 v28, v242, 4, v241
  v_add_u32 v240, 1280, v0
  v_mul_u32_u24 v241, 6554, v240
  v_lshrrev_b32 v241, 19, v241
  v_mul_u32_u24 v242, 80, v241
  v_sub_u32 v242, v240, v242
  v_and_b32 v243, 7, v241
  v_lshlrev_b32 v243, 1, v243
  v_xor_b32 v242, v242, v243
  s_mov_b32 s90, 1280
  v_mul_lo_u32 v241, v241, s90
  v_lshl_add_u32 v29, v242, 4, v241
  v_add_u32 v240, 1536, v0
  v_mul_u32_u24 v241, 6554, v240
  v_lshrrev_b32 v241, 19, v241
  v_mul_u32_u24 v242, 80, v241
  v_sub_u32 v242, v240, v242
  v_and_b32 v243, 7, v241
  v_lshlrev_b32 v243, 1, v243
  v_xor_b32 v242, v242, v243
  s_mov_b32 s90, 1280
  v_mul_lo_u32 v241, v241, s90
  v_lshl_add_u32 v30, v242, 4, v241
  v_add_u32 v240, 1792, v0
  v_mul_u32_u24 v241, 6554, v240
  v_lshrrev_b32 v241, 19, v241
  v_mul_u32_u24 v242, 80, v241
  v_sub_u32 v242, v240, v242
  v_and_b32 v243, 7, v241
  v_lshlrev_b32 v243, 1, v243
  v_xor_b32 v242, v242, v243
  s_mov_b32 s90, 1280
  v_mul_lo_u32 v241, v241, s90
  v_lshl_add_u32 v31, v242, 4, v241
  v_add_u32 v240, 2048, v0
  v_mul_u32_u24 v241, 6554, v240
  v_lshrrev_b32 v241, 19, v241
  v_mul_u32_u24 v242, 80, v241
  v_sub_u32 v242, v240, v242
  v_and_b32 v243, 7, v241
  v_lshlrev_b32 v243, 1, v243
  v_xor_b32 v242, v242, v243
  s_mov_b32 s90, 1280
  v_mul_lo_u32 v241, v241, s90
  v_lshl_add_u32 v32, v242, 4, v241
  v_add_u32 v240, 2304, v0
  v_mul_u32_u24 v241, 6554, v240
  v_lshrrev_b32 v241, 19, v241
  v_mul_u32_u24 v242, 80, v241
  v_sub_u32 v242, v240, v242
  v_and_b32 v243, 7, v241
  v_lshlrev_b32 v243, 1, v243
  v_xor_b32 v242, v242, v243
  s_mov_b32 s90, 1280
  v_mul_lo_u32 v241, v241, s90
  v_lshl_add_u32 v33, v242, 4, v241
  s_mov_b32 s91, 1280
  s_mul_i32 s56, s3, 10
  v_lshrrev_b32 v240, 2, v1
  v_and_b32 v241, 7, v240
  v_xor_b32 v241, s56, v241
  v_lshlrev_b32 v241, 5, v241
  v_mad_u32_u24 v241, v240, s91, v241
  v_and_b32 v240, 3, v1
  v_lshl_add_u32 v36, v240, 3, v241
  s_add_u32 s56, s56, 1
  v_lshrrev_b32 v240, 2, v1
  v_and_b32 v241, 7, v240
  v_xor_b32 v241, s56, v241
  v_lshlrev_b32 v241, 5, v241
  v_mad_u32_u24 v241, v240, s91, v241
  v_and_b32 v240, 3, v1
  v_lshl_add_u32 v37, v240, 3, v241
  s_add_u32 s56, s56, 1
  v_lshrrev_b32 v240, 2, v1
  v_and_b32 v241, 7, v240
  v_xor_b32 v241, s56, v241
  v_lshlrev_b32 v241, 5, v241
  v_mad_u32_u24 v241, v240, s91, v241
  v_and_b32 v240, 3, v1
  v_lshl_add_u32 v38, v240, 3, v241
  s_add_u32 s56, s56, 1
  v_lshrrev_b32 v240, 2, v1
  v_and_b32 v241, 7, v240
  v_xor_b32 v241, s56, v241
  v_lshlrev_b32 v241, 5, v241
  v_mad_u32_u24 v241, v240, s91, v241
  v_and_b32 v240, 3, v1
  v_lshl_add_u32 v39, v240, 3, v241
  s_add_u32 s56, s56, 1
  v_lshrrev_b32 v240, 2, v1
  v_and_b32 v241, 7, v240
  v_xor_b32 v241, s56, v241
  v_lshlrev_b32 v241, 5, v241
  v_mad_u32_u24 v241, v240, s91, v241
  v_and_b32 v240, 3, v1
  v_lshl_add_u32 v40, v240, 3, v241
  s_add_u32 s56, s56, 1
  v_lshrrev_b32 v240, 2, v1
  v_and_b32 v241, 7, v240
  v_xor_b32 v241, s56, v241
  v_lshlrev_b32 v241, 5, v241
  v_mad_u32_u24 v241, v240, s91, v241
  v_and_b32 v240, 3, v1
  v_lshl_add_u32 v41, v240, 3, v241
  s_add_u32 s56, s56, 1
  v_lshrrev_b32 v240, 2, v1
  v_and_b32 v241, 7, v240
  v_xor_b32 v241, s56, v241
  v_lshlrev_b32 v241, 5, v241
  v_mad_u32_u24 v241, v240, s91, v241
  v_and_b32 v240, 3, v1
  v_lshl_add_u32 v42, v240, 3, v241
  s_add_u32 s56, s56, 1
  v_lshrrev_b32 v240, 2, v1
  v_and_b32 v241, 7, v240
  v_xor_b32 v241, s56, v241
  v_lshlrev_b32 v241, 5, v241
  v_mad_u32_u24 v241, v240, s91, v241
  v_and_b32 v240, 3, v1
  v_lshl_add_u32 v43, v240, 3, v241
  s_add_u32 s56, s56, 1
  v_lshrrev_b32 v240, 2, v1
  v_and_b32 v241, 7, v240
  v_xor_b32 v241, s56, v241
  v_lshlrev_b32 v241, 5, v241
  v_mad_u32_u24 v241, v240, s91, v241
  v_and_b32 v240, 3, v1
  v_lshl_add_u32 v44, v240, 3, v241
  s_add_u32 s56, s56, 1
  v_lshrrev_b32 v240, 2, v1
  v_and_b32 v241, 7, v240
  v_xor_b32 v241, s56, v241
  v_lshlrev_b32 v241, 5, v241
  v_mad_u32_u24 v241, v240, s91, v241
  v_and_b32 v240, 3, v1
  v_lshl_add_u32 v45, v240, 3, v241
  s_add_u32 s56, s56, 1
  s_waitcnt lgkmcnt(0)
  s_mul_i32 s48, s42, 245760
  s_add_u32 s34, s12, s48
  s_addc_u32 s35, s13, 0
  s_add_u32 s12, s34, 204800
  s_addc_u32 s13, s35, 0
  s_lshl_b32 s92, s3, 10
  s_add_u32 m0, s92, 0
  s_nop 0
  global_load_lds_dwordx4 v24, s[12:13]
  s_add_u32 m0, s92, 4096
  s_nop 0
  global_load_lds_dwordx4 v25, s[12:13]
  s_add_u32 m0, s92, 8192
  s_nop 0
  global_load_lds_dwordx4 v26, s[12:13]
  s_add_u32 m0, s92, 12288
  s_nop 0
  global_load_lds_dwordx4 v27, s[12:13]
  s_add_u32 m0, s92, 16384
  s_nop 0
  global_load_lds_dwordx4 v28, s[12:13]
  s_add_u32 m0, s92, 20480
  s_nop 0
  global_load_lds_dwordx4 v29, s[12:13]
  s_add_u32 m0, s92, 24576
  s_nop 0
  global_load_lds_dwordx4 v30, s[12:13]
  s_add_u32 m0, s92, 28672
  s_nop 0
  global_load_lds_dwordx4 v31, s[12:13]
  s_add_u32 m0, s92, 32768
  s_nop 0
  global_load_lds_dwordx4 v32, s[12:13]
  s_add_u32 m0, s92, 36864
  s_nop 0
  global_load_lds_dwordx4 v33, s[12:13]
  s_sub_u32 s12, s12, 40960
  s_subb_u32 s13, s13, 0
  s_add_u32 m0, s92, 40960
  s_nop 0
  global_load_lds_dwordx4 v24, s[12:13]
  s_add_u32 m0, s92, 45056
  s_nop 0
  global_load_lds_dwordx4 v25, s[12:13]
  s_add_u32 m0, s92, 49152
  s_nop 0
  global_load_lds_dwordx4 v26, s[12:13]
  s_add_u32 m0, s92, 53248
  s_nop 0
  global_load_lds_dwordx4 v27, s[12:13]
  s_add_u32 m0, s92, 57344
  s_nop 0
  global_load_lds_dwordx4 v28, s[12:13]
  s_add_u32 m0, s92, 61440
  s_nop 0
  global_load_lds_dwordx4 v29, s[12:13]
  s_add_u32 m0, s92, 65536
  s_nop 0
  global_load_lds_dwordx4 v30, s[12:13]
  s_add_u32 m0, s92, 69632
  s_nop 0
  global_load_lds_dwordx4 v31, s[12:13]
  s_add_u32 m0, s92, 73728
  s_nop 0
  global_load_lds_dwordx4 v32, s[12:13]
  s_add_u32 m0, s92, 77824
  s_nop 0
  global_load_lds_dwordx4 v33, s[12:13]
  s_sub_u32 s12, s12, 40960
  s_subb_u32 s13, s13, 0
  s_add_u32 m0, s92, 81920
  s_nop 0
  global_load_lds_dwordx4 v24, s[12:13]
  s_add_u32 m0, s92, 86016
  s_nop 0
  global_load_lds_dwordx4 v25, s[12:13]
  s_add_u32 m0, s92, 90112
  s_nop 0
  global_load_lds_dwordx4 v26, s[12:13]
  s_add_u32 m0, s92, 94208
  s_nop 0
  global_load_lds_dwordx4 v27, s[12:13]
  s_add_u32 m0, s92, 98304
  s_nop 0
  global_load_lds_dwordx4 v28, s[12:13]
  s_add_u32 m0, s92, 102400
  s_nop 0
  global_load_lds_dwordx4 v29, s[12:13]
  s_add_u32 m0, s92, 106496
  s_nop 0
  global_load_lds_dwordx4 v30, s[12:13]
  s_add_u32 m0, s92, 110592
  s_nop 0
  global_load_lds_dwordx4 v31, s[12:13]
  s_add_u32 m0, s92, 114688
  s_nop 0
  global_load_lds_dwordx4 v32, s[12:13]
  s_add_u32 m0, s92, 118784
  s_nop 0
  global_load_lds_dwordx4 v33, s[12:13]
  s_sub_u32 s12, s12, 40960
  s_subb_u32 s13, s13, 0
  s_add_u32 m0, s92, 122880
  s_nop 0
  global_load_lds_dwordx4 v24, s[12:13]
  s_add_u32 m0, s92, 126976
  s_nop 0
  global_load_lds_dwordx4 v25, s[12:13]
  s_add_u32 m0, s92, 131072
  s_nop 0
  global_load_lds_dwordx4 v26, s[12:13]
  s_add_u32 m0, s92, 135168
  s_nop 0
  global_load_lds_dwordx4 v27, s[12:13]
  s_add_u32 m0, s92, 139264
  s_nop 0
  global_load_lds_dwordx4 v28, s[12:13]
  s_add_u32 m0, s92, 143360
  s_nop 0
  global_load_lds_dwordx4 v29, s[12:13]
  s_add_u32 m0, s92, 147456
  s_nop 0
  global_load_lds_dwordx4 v30, s[12:13]
  s_add_u32 m0, s92, 151552
  s_nop 0
  global_load_lds_dwordx4 v31, s[12:13]
  s_add_u32 m0, s92, 155648
  s_nop 0
  global_load_lds_dwordx4 v32, s[12:13]
  s_add_u32 m0, s92, 159744
  s_nop 0
  global_load_lds_dwordx4 v33, s[12:13]
  s_sub_u32 s12, s12, 40960
  s_subb_u32 s13, s13, 0
  s_waitcnt vmcnt(30)
  s_waitcnt lgkmcnt(0)
  s_barrier
  v_add_u32 v48, 0, v36
  ds_read_b64_tr_b16 a[20:21], v48
  ds_read_b64_tr_b16 a[22:23], v48 offset:20480
  v_add_u32 v49, 0, v37
  ds_read_b64_tr_b16 a[44:45], v49
  ds_read_b64_tr_b16 a[46:47], v49 offset:20480
  v_add_u32 v50, 0, v38
  ds_read_b64_tr_b16 a[68:69], v50
  ds_read_b64_tr_b16 a[70:71], v50 offset:20480
  v_add_u32 v51, 0, v39
  ds_read_b64_tr_b16 a[92:93], v51
  ds_read_b64_tr_b16 a[94:95], v51 offset:20480
  v_add_u32 v48, 0, v40
  ds_read_b64_tr_b16 a[116:117], v48
  ds_read_b64_tr_b16 a[118:119], v48 offset:20480
  v_add_u32 v49, 0, v41
  ds_read_b64_tr_b16 a[140:141], v49
  ds_read_b64_tr_b16 a[142:143], v49 offset:20480
  v_add_u32 v50, 0, v42
  ds_read_b64_tr_b16 a[164:165], v50
  ds_read_b64_tr_b16 a[166:167], v50 offset:20480
  v_add_u32 v51, 0, v43
  ds_read_b64_tr_b16 a[188:189], v51
  ds_read_b64_tr_b16 a[190:191], v51 offset:20480
  v_add_u32 v48, 0, v44
  ds_read_b64_tr_b16 a[212:213], v48
  ds_read_b64_tr_b16 a[214:215], v48 offset:20480
  v_add_u32 v49, 0, v45
  ds_read_b64_tr_b16 a[236:237], v49
  ds_read_b64_tr_b16 a[238:239], v49 offset:20480
  s_waitcnt vmcnt(20)
  s_waitcnt lgkmcnt(0)
  s_barrier
  s_add_u32 m0, s92, 0
  s_nop 0
  global_load_lds_dwordx4 v24, s[12:13]
  s_add_u32 m0, s92, 4096
  s_nop 0
  global_load_lds_dwordx4 v25, s[12:13]
  s_add_u32 m0, s92, 8192
  s_nop 0
  global_load_lds_dwordx4 v26, s[12:13]
  s_add_u32 m0, s92, 12288
  s_nop 0
  global_load_lds_dwordx4 v27, s[12:13]
  s_add_u32 m0, s92, 16384
  s_nop 0
  global_load_lds_dwordx4 v28, s[12:13]
  s_add_u32 m0, s92, 20480
  s_nop 0
  global_load_lds_dwordx4 v29, s[12:13]
  s_add_u32 m0, s92, 24576
  s_nop 0
  global_load_lds_dwordx4 v30, s[12:13]
  s_add_u32 m0, s92, 28672
  s_nop 0
  global_load_lds_dwordx4 v31, s[12:13]
  s_add_u32 m0, s92, 32768
  s_nop 0
  global_load_lds_dwordx4 v32, s[12:13]
  s_add_u32 m0, s92, 36864
  s_nop 0
  global_load_lds_dwordx4 v33, s[12:13]
  s_sub_u32 s12, s12, 40960
  s_subb_u32 s13, s13, 0
  v_add_u32 v48, 40960, v36
  ds_read_b64_tr_b16 a[16:17], v48
  ds_read_b64_tr_b16 a[18:19], v48 offset:20480
  v_add_u32 v49, 40960, v37
  ds_read_b64_tr_b16 a[40:41], v49
  ds_read_b64_tr_b16 a[42:43], v49 offset:20480
  v_add_u32 v50, 40960, v38
  ds_read_b64_tr_b16 a[64:65], v50
  ds_read_b64_tr_b16 a[66:67], v50 offset:20480
  v_add_u32 v51, 40960, v39
  ds_read_b64_tr_b16 a[88:89], v51
  ds_read_b64_tr_b16 a[90:91], v51 offset:20480
  v_add_u32 v48, 40960, v40
  ds_read_b64_tr_b16 a[112:113], v48
  ds_read_b64_tr_b16 a[114:115], v48 offset:20480
  v_add_u32 v49, 40960, v41
  ds_read_b64_tr_b16 a[136:137], v49
  ds_read_b64_tr_b16 a[138:139], v49 offset:20480
  v_add_u32 v50, 40960, v42
  ds_read_b64_tr_b16 a[160:161], v50
  ds_read_b64_tr_b16 a[162:163], v50 offset:20480
  v_add_u32 v51, 40960, v43
  ds_read_b64_tr_b16 a[184:185], v51
  ds_read_b64_tr_b16 a[186:187], v51 offset:20480
  v_add_u32 v48, 40960, v44
  ds_read_b64_tr_b16 a[208:209], v48
  ds_read_b64_tr_b16 a[210:211], v48 offset:20480
  v_add_u32 v49, 40960, v45
  ds_read_b64_tr_b16 a[232:233], v49
  ds_read_b64_tr_b16 a[234:235], v49 offset:20480
  s_waitcnt vmcnt(20)
  s_waitcnt lgkmcnt(0)
  s_barrier
  s_add_u32 m0, s92, 40960
  s_nop 0
  global_load_lds_dwordx4 v24, s[12:13]
  s_add_u32 m0, s92, 45056
  s_nop 0
  global_load_lds_dwordx4 v25, s[12:13]
  s_add_u32 m0, s92, 49152
  s_nop 0
  global_load_lds_dwordx4 v26, s[12:13]
  s_add_u32 m0, s92, 53248
  s_nop 0
  global_load_lds_dwordx4 v27, s[12:13]
  s_add_u32 m0, s92, 57344
  s_nop 0
  global_load_lds_dwordx4 v28, s[12:13]
  s_add_u32 m0, s92, 61440
  s_nop 0
  global_load_lds_dwordx4 v29, s[12:13]
  s_add_u32 m0, s92, 65536
  s_nop 0
  global_load_lds_dwordx4 v30, s[12:13]
  s_add_u32 m0, s92, 69632
  s_nop 0
  global_load_lds_dwordx4 v31, s[12:13]
  s_add_u32 m0, s92, 73728
  s_nop 0
  global_load_lds_dwordx4 v32, s[12:13]
  s_add_u32 m0, s92, 77824
  s_nop 0
  global_load_lds_dwordx4 v33, s[12:13]
  s_sub_u32 s12, s12, 40960
  s_subb_u32 s13, s13, 0
  v_add_u32 v48, 81920, v36
  ds_read_b64_tr_b16 a[12:13], v48
  ds_read_b64_tr_b16 a[14:15], v48 offset:20480
  v_add_u32 v49, 81920, v37
  ds_read_b64_tr_b16 a[36:37], v49
  ds_read_b64_tr_b16 a[38:39], v49 offset:20480
  v_add_u32 v50, 81920, v38
  ds_read_b64_tr_b16 a[60:61], v50
  ds_read_b64_tr_b16 a[62:63], v50 offset:20480
  v_add_u32 v51, 81920, v39
  ds_read_b64_tr_b16 a[84:85], v51
  ds_read_b64_tr_b16 a[86:87], v51 offset:20480
  v_add_u32 v48, 81920, v40
  ds_read_b64_tr_b16 a[108:109], v48
  ds_read_b64_tr_b16 a[110:111], v48 offset:20480
  v_add_u32 v49, 81920, v41
  ds_read_b64_tr_b16 a[132:133], v49
  ds_read_b64_tr_b16 a[134:135], v49 offset:20480
  v_add_u32 v50, 81920, v42
  ds_read_b64_tr_b16 a[156:157], v50
  ds_read_b64_tr_b16 a[158:159], v50 offset:20480
  v_add_u32 v51, 81920, v43
  ds_read_b64_tr_b16 a[180:181], v51
  ds_read_b64_tr_b16 a[182:183], v51 offset:20480
  v_add_u32 v48, 81920, v44
  ds_read_b64_tr_b16 a[204:205], v48
  ds_read_b64_tr_b16 a[206:207], v48 offset:20480
  v_add_u32 v49, 81920, v45
  ds_read_b64_tr_b16 a[228:229], v49
  ds_read_b64_tr_b16 a[230:231], v49 offset:20480
  s_waitcnt vmcnt(20)
  s_waitcnt lgkmcnt(0)
  s_barrier
  v_add_u32 v48, 122880, v36
  ds_read_b64_tr_b16 a[8:9], v48
  ds_read_b64_tr_b16 a[10:11], v48 offset:20480
  v_add_u32 v49, 122880, v37
  ds_read_b64_tr_b16 a[32:33], v49
  ds_read_b64_tr_b16 a[34:35], v49 offset:20480
  v_add_u32 v50, 122880, v38
  ds_read_b64_tr_b16 a[56:57], v50
  ds_read_b64_tr_b16 a[58:59], v50 offset:20480
  v_add_u32 v51, 122880, v39
  ds_read_b64_tr_b16 a[80:81], v51
  ds_read_b64_tr_b16 a[82:83], v51 offset:20480
  v_add_u32 v48, 122880, v40
  ds_read_b64_tr_b16 a[104:105], v48
  ds_read_b64_tr_b16 a[106:107], v48 offset:20480
  v_add_u32 v49, 122880, v41
  ds_read_b64_tr_b16 a[128:129], v49
  ds_read_b64_tr_b16 a[130:131], v49 offset:20480
  v_add_u32 v50, 122880, v42
  ds_read_b64_tr_b16 a[152:153], v50
  ds_read_b64_tr_b16 a[154:155], v50 offset:20480
  v_add_u32 v51, 122880, v43
  ds_read_b64_tr_b16 a[176:177], v51
  ds_read_b64_tr_b16 a[178:179], v51 offset:20480
  v_add_u32 v48, 122880, v44
  ds_read_b64_tr_b16 a[200:201], v48
  ds_read_b64_tr_b16 a[202:203], v48 offset:20480
  v_add_u32 v49, 122880, v45
  ds_read_b64_tr_b16 a[224:225], v49
  ds_read_b64_tr_b16 a[226:227], v49 offset:20480
  s_waitcnt vmcnt(10)
  s_waitcnt lgkmcnt(0)
  s_barrier
  v_add_u32 v48, 0, v36
  ds_read_b64_tr_b16 a[4:5], v48
  ds_read_b64_tr_b16 a[6:7], v48 offset:20480
  v_add_u32 v49, 0, v37
  ds_read_b64_tr_b16 a[28:29], v49
  ds_read_b64_tr_b16 a[30:31], v49 offset:20480
  v_add_u32 v50, 0, v38
  ds_read_b64_tr_b16 a[52:53], v50
  ds_read_b64_tr_b16 a[54:55], v50 offset:20480
  v_add_u32 v51, 0, v39
  ds_read_b64_tr_b16 a[76:77], v51
  ds_read_b64_tr_b16 a[78:79], v51 offset:20480
  v_add_u32 v48, 0, v40
  ds_read_b64_tr_b16 a[100:101], v48
  ds_read_b64_tr_b16 a[102:103], v48 offset:20480
  v_add_u32 v49, 0, v41
  ds_read_b64_tr_b16 a[124:125], v49
  ds_read_b64_tr_b16 a[126:127], v49 offset:20480
  v_add_u32 v50, 0, v42
  ds_read_b64_tr_b16 a[148:149], v50
  ds_read_b64_tr_b16 a[150:151], v50 offset:20480
  v_add_u32 v51, 0, v43
  ds_read_b64_tr_b16 a[172:173], v51
  ds_read_b64_tr_b16 a[174:175], v51 offset:20480
  v_add_u32 v48, 0, v44
  ds_read_b64_tr_b16 a[196:197], v48
  ds_read_b64_tr_b16 a[198:199], v48 offset:20480
  v_add_u32 v49, 0, v45
  ds_read_b64_tr_b16 a[220:221], v49
  ds_read_b64_tr_b16 a[222:223], v49 offset:20480
  s_waitcnt vmcnt(0)
  s_waitcnt lgkmcnt(0)
  s_barrier
  v_add_u32 v48, 40960, v36
  ds_read_b64_tr_b16 a[0:1], v48
  ds_read_b64_tr_b16 a[2:3], v48 offset:20480
  v_add_u32 v49, 40960, v37
  ds_read_b64_tr_b16 a[24:25], v49
  ds_read_b64_tr_b16 a[26:27], v49 offset:20480
  v_add_u32 v50, 40960, v38
  ds_read_b64_tr_b16 a[48:49], v50
  ds_read_b64_tr_b16 a[50:51], v50 offset:20480
  v_add_u32 v51, 40960, v39
  ds_read_b64_tr_b16 a[72:73], v51
  ds_read_b64_tr_b16 a[74:75], v51 offset:20480
  v_add_u32 v48, 40960, v40
  ds_read_b64_tr_b16 a[96:97], v48
  ds_read_b64_tr_b16 a[98:99], v48 offset:20480
  v_add_u32 v49, 40960, v41
  ds_read_b64_tr_b16 a[120:121], v49
  ds_read_b64_tr_b16 a[122:123], v49 offset:20480
  v_add_u32 v50, 40960, v42
  ds_read_b64_tr_b16 a[144:145], v50
  ds_read_b64_tr_b16 a[146:147], v50 offset:20480
  v_add_u32 v51, 40960, v43
  ds_read_b64_tr_b16 a[168:169], v51
  ds_read_b64_tr_b16 a[170:171], v51 offset:20480
  v_add_u32 v48, 40960, v44
  ds_read_b64_tr_b16 a[192:193], v48
  ds_read_b64_tr_b16 a[194:195], v48 offset:20480
  v_add_u32 v49, 40960, v45
  ds_read_b64_tr_b16 a[216:217], v49
  ds_read_b64_tr_b16 a[218:219], v49 offset:20480
  s_waitcnt lgkmcnt(0)
  s_barrier
  s_mul_i32 s57, s42, 40960
  s_mul_i32 s48, s3, 10240
  s_add_u32 s57, s57, s48
  s_add_u32 s57, s57, 0x9000000
  v_lshlrev_b32 v8, 4, v1
  v_add_u32 v9, 4096, v8
  v_add_u32 v10, 8192, v8
  s_lshl_b32 s58, s42, 8
  s_add_u32 s48, s58, 0x1364000
  s_add_u32 s58, s58, 0x1366000
  v_lshlrev_b32 v11, 2, v1
  v_add_u32 v11, s48, v11
  s_mul_i32 s59, s42, 12288
  s_add_u32 s59, s59, 0x7800000
  s_mov_b64 s[84:85], 0
  v_mov_b32 v20, 32
IW_109:
  global_load_dword v21, v20, s[6:7] sc1
  s_waitcnt vmcnt(0)
  v_cmp_ne_u32 vcc, 64, v21
  s_cbranch_vccz ID_110
  s_sleep 24
  s_add_u32 s66, s66, 1
  s_cmp_lt_u32 s66, 0x200000
  s_cbranch_scc1 IW_109
  s_endpgm
ID_110:
  v_lshlrev_b32 v3, 4, v1
  v_add_u32 v7, 12288, v3
  s_mul_i32 s86, s3, 3072
  v_add_u32 v4, s86, v3
  s_mov_b32 s46, -1
  s_mov_b32 s47, -1
  s_cmp_ge_u32 s44, 64
  s_cbranch_scc1 UG_end
MW_111:
  s_bitcmp1_b64 s[84:85], s44
  s_cbranch_scc1 MD_112
  global_load_dword v20, v11, s[4:5] offset:0 sc1
  s_waitcnt vmcnt(0)
  v_cmp_eq_u32 s[84:85], 1, v20
  s_nop 1
  s_bitcmp1_b64 s[84:85], s44
  s_cbranch_scc1 MD_112
  s_sleep 8
  s_add_u32 s66, s66, 1
  s_cmp_lt_u32 s66, 0x200000
  s_cbranch_scc1 MW_111
  s_endpgm
MD_112:
  s_mul_i32 s48, s44, 393216
  s_add_u32 s48, s48, s59
  s_add_u32 s50, s4, s48
  s_addc_u32 s51, s5, 0
  s_add_u32 m0, s86, 0
  s_nop 0
  global_load_lds_dwordx4 v4, s[50:51] offset:0 sc1
  global_load_lds_dwordx4 v4, s[50:51] offset:1024 sc1
  global_load_lds_dwordx4 v4, s[50:51] offset:2048 sc1
  s_waitcnt vmcnt(0)
  s_barrier
  s_add_u32 s52, s44, 1
  s_cmp_ge_u32 s52, 64
  s_cselect_b32 s54, s44, s52
  ds_read_b128 v[184:187], v3 offset:0
  ds_read_b128 v[188:191], v3 offset:6144
  ds_read_b128 v[192:195], v3 offset:1024
  ds_read_b128 v[196:199], v3 offset:7168
  ds_read_b128 v[200:203], v3 offset:2048
  ds_read_b128 v[204:207], v3 offset:8192
  s_waitcnt lgkmcnt(5)
  v_mfma_f32_16x16x32_bf16 v[24:27], v[184:187], a[0:3], 0
  v_mfma_f32_16x16x32_bf16 v[32:35], v[184:187], a[24:27], 0
  v_mfma_f32_16x16x32_bf16 v[40:43], v[184:187], a[48:51], 0
  v_mfma_f32_16x16x32_bf16 v[48:51], v[184:187], a[72:75], 0
  v_mfma_f32_16x16x32_bf16 v[56:59], v[184:187], a[96:99], 0
  v_mfma_f32_16x16x32_bf16 v[64:67], v[184:187], a[120:123], 0
  v_mfma_f32_16x16x32_bf16 v[72:75], v[184:187], a[144:147], 0
  v_mfma_f32_16x16x32_bf16 v[80:83], v[184:187], a[168:171], 0
  v_mfma_f32_16x16x32_bf16 v[88:91], v[184:187], a[192:195], 0
  v_mfma_f32_16x16x32_bf16 v[96:99], v[184:187], a[216:219], 0
  s_waitcnt lgkmcnt(4)
  v_mfma_f32_16x16x32_bf16 v[28:31], v[188:191], a[0:3], 0
  v_mfma_f32_16x16x32_bf16 v[36:39], v[188:191], a[24:27], 0
  v_mfma_f32_16x16x32_bf16 v[44:47], v[188:191], a[48:51], 0
  v_mfma_f32_16x16x32_bf16 v[52:55], v[188:191], a[72:75], 0
  v_mfma_f32_16x16x32_bf16 v[60:63], v[188:191], a[96:99], 0
  v_mfma_f32_16x16x32_bf16 v[68:71], v[188:191], a[120:123], 0
  v_mfma_f32_16x16x32_bf16 v[76:79], v[188:191], a[144:147], 0
  v_mfma_f32_16x16x32_bf16 v[84:87], v[188:191], a[168:171], 0
  v_mfma_f32_16x16x32_bf16 v[92:95], v[188:191], a[192:195], 0
  v_mfma_f32_16x16x32_bf16 v[100:103], v[188:191], a[216:219], 0
  ds_read_b128 v[184:187], v3 offset:3072
  ds_read_b128 v[188:191], v3 offset:9216
  s_waitcnt lgkmcnt(5)
  v_mfma_f32_16x16x32_bf16 v[24:27], v[192:195], a[4:7], v[24:27]
  v_mfma_f32_16x16x32_bf16 v[32:35], v[192:195], a[28:31], v[32:35]
  v_mfma_f32_16x16x32_bf16 v[40:43], v[192:195], a[52:55], v[40:43]
  v_mfma_f32_16x16x32_bf16 v[48:51], v[192:195], a[76:79], v[48:51]
  v_mfma_f32_16x16x32_bf16 v[56:59], v[192:195], a[100:103], v[56:59]
  v_mfma_f32_16x16x32_bf16 v[64:67], v[192:195], a[124:127], v[64:67]
  v_mfma_f32_16x16x32_bf16 v[72:75], v[192:195], a[148:151], v[72:75]
  v_mfma_f32_16x16x32_bf16 v[80:83], v[192:195], a[172:175], v[80:83]
  v_mfma_f32_16x16x32_bf16 v[88:91], v[192:195], a[196:199], v[88:91]
  v_mfma_f32_16x16x32_bf16 v[96:99], v[192:195], a[220:223], v[96:99]
  s_waitcnt lgkmcnt(4)
  v_mfma_f32_16x16x32_bf16 v[28:31], v[196:199], a[4:7], v[28:31]
  v_mfma_f32_16x16x32_bf16 v[36:39], v[196:199], a[28:31], v[36:39]
  v_mfma_f32_16x16x32_bf16 v[44:47], v[196:199], a[52:55], v[44:47]
  v_mfma_f32_16x16x32_bf16 v[52:55], v[196:199], a[76:79], v[52:55]
  v_mfma_f32_16x16x32_bf16 v[60:63], v[196:199], a[100:103], v[60:63]
  v_mfma_f32_16x16x32_bf16 v[68:71], v[196:199], a[124:127], v[68:71]
  v_mfma_f32_16x16x32_bf16 v[76:79], v[196:199], a[148:151], v[76:79]
  v_mfma_f32_16x16x32_bf16 v[84:87], v[196:199], a[172:175], v[84:87]
  v_mfma_f32_16x16x32_bf16 v[92:95], v[196:199], a[196:199], v[92:95]
  v_mfma_f32_16x16x32_bf16 v[100:103], v[196:199], a[220:223], v[100:103]
  ds_read_b128 v[192:195], v3 offset:4096
  ds_read_b128 v[196:199], v3 offset:10240
  s_waitcnt lgkmcnt(5)
  v_mfma_f32_16x16x32_bf16 v[24:27], v[200:203], a[8:11], v[24:27]
  v_mfma_f32_16x16x32_bf16 v[32:35], v[200:203], a[32:35], v[32:35]
  v_mfma_f32_16x16x32_bf16 v[40:43], v[200:203], a[56:59], v[40:43]
  v_mfma_f32_16x16x32_bf16 v[48:51], v[200:203], a[80:83], v[48:51]
  v_mfma_f32_16x16x32_bf16 v[56:59], v[200:203], a[104:107], v[56:59]
  v_mfma_f32_16x16x32_bf16 v[64:67], v[200:203], a[128:131], v[64:67]
  v_mfma_f32_16x16x32_bf16 v[72:75], v[200:203], a[152:155], v[72:75]
  v_mfma_f32_16x16x32_bf16 v[80:83], v[200:203], a[176:179], v[80:83]
  v_mfma_f32_16x16x32_bf16 v[88:91], v[200:203], a[200:203], v[88:91]
  v_mfma_f32_16x16x32_bf16 v[96:99], v[200:203], a[224:227], v[96:99]
  s_waitcnt lgkmcnt(4)
  v_mfma_f32_16x16x32_bf16 v[28:31], v[204:207], a[8:11], v[28:31]
  v_mfma_f32_16x16x32_bf16 v[36:39], v[204:207], a[32:35], v[36:39]
  v_mfma_f32_16x16x32_bf16 v[44:47], v[204:207], a[56:59], v[44:47]
  v_mfma_f32_16x16x32_bf16 v[52:55], v[204:207], a[80:83], v[52:55]
  v_mfma_f32_16x16x32_bf16 v[60:63], v[204:207], a[104:107], v[60:63]
  v_mfma_f32_16x16x32_bf16 v[68:71], v[204:207], a[128:131], v[68:71]
  v_mfma_f32_16x16x32_bf16 v[76:79], v[204:207], a[152:155], v[76:79]
  v_mfma_f32_16x16x32_bf16 v[84:87], v[204:207], a[176:179], v[84:87]
  v_mfma_f32_16x16x32_bf16 v[92:95], v[204:207], a[200:203], v[92:95]
  v_mfma_f32_16x16x32_bf16 v[100:103], v[204:207], a[224:227], v[100:103]
  ds_read_b128 v[200:203], v3 offset:5120
  ds_read_b128 v[204:207], v3 offset:11264
  s_waitcnt lgkmcnt(5)
  v_mfma_f32_16x16x32_bf16 v[24:27], v[184:187], a[12:15], v[24:27]
  v_mfma_f32_16x16x32_bf16 v[32:35], v[184:187], a[36:39], v[32:35]
  v_mfma_f32_16x16x32_bf16 v[40:43], v[184:187], a[60:63], v[40:43]
  v_mfma_f32_16x16x32_bf16 v[48:51], v[184:187], a[84:87], v[48:51]
  v_mfma_f32_16x16x32_bf16 v[56:59], v[184:187], a[108:111], v[56:59]
  v_mfma_f32_16x16x32_bf16 v[64:67], v[184:187], a[132:135], v[64:67]
  v_mfma_f32_16x16x32_bf16 v[72:75], v[184:187], a[156:159], v[72:75]
  v_mfma_f32_16x16x32_bf16 v[80:83], v[184:187], a[180:183], v[80:83]
  v_mfma_f32_16x16x32_bf16 v[88:91], v[184:187], a[204:207], v[88:91]
  v_mfma_f32_16x16x32_bf16 v[96:99], v[184:187], a[228:231], v[96:99]
  s_waitcnt lgkmcnt(4)
  v_mfma_f32_16x16x32_bf16 v[28:31], v[188:191], a[12:15], v[28:31]
  v_mfma_f32_16x16x32_bf16 v[36:39], v[188:191], a[36:39], v[36:39]
  v_mfma_f32_16x16x32_bf16 v[44:47], v[188:191], a[60:63], v[44:47]
  v_mfma_f32_16x16x32_bf16 v[52:55], v[188:191], a[84:87], v[52:55]
  v_mfma_f32_16x16x32_bf16 v[60:63], v[188:191], a[108:111], v[60:63]
  v_mfma_f32_16x16x32_bf16 v[68:71], v[188:191], a[132:135], v[68:71]
  v_mfma_f32_16x16x32_bf16 v[76:79], v[188:191], a[156:159], v[76:79]
  v_mfma_f32_16x16x32_bf16 v[84:87], v[188:191], a[180:183], v[84:87]
  v_mfma_f32_16x16x32_bf16 v[92:95], v[188:191], a[204:207], v[92:95]
  v_mfma_f32_16x16x32_bf16 v[100:103], v[188:191], a[228:231], v[100:103]
  s_waitcnt lgkmcnt(3)
  v_mfma_f32_16x16x32_bf16 v[24:27], v[192:195], a[16:19], v[24:27]
  v_mfma_f32_16x16x32_bf16 v[32:35], v[192:195], a[40:43], v[32:35]
  v_mfma_f32_16x16x32_bf16 v[40:43], v[192:195], a[64:67], v[40:43]
  v_mfma_f32_16x16x32_bf16 v[48:51], v[192:195], a[88:91], v[48:51]
  v_mfma_f32_16x16x32_bf16 v[56:59], v[192:195], a[112:115], v[56:59]
  v_mfma_f32_16x16x32_bf16 v[64:67], v[192:195], a[136:139], v[64:67]
  v_mfma_f32_16x16x32_bf16 v[72:75], v[192:195], a[160:163], v[72:75]
  v_mfma_f32_16x16x32_bf16 v[80:83], v[192:195], a[184:187], v[80:83]
  v_mfma_f32_16x16x32_bf16 v[88:91], v[192:195], a[208:211], v[88:91]
  v_mfma_f32_16x16x32_bf16 v[96:99], v[192:195], a[232:235], v[96:99]
  s_waitcnt lgkmcnt(2)
  v_mfma_f32_16x16x32_bf16 v[28:31], v[196:199], a[16:19], v[28:31]
  v_mfma_f32_16x16x32_bf16 v[36:39], v[196:199], a[40:43], v[36:39]
  v_mfma_f32_16x16x32_bf16 v[44:47], v[196:199], a[64:67], v[44:47]
  v_mfma_f32_16x16x32_bf16 v[52:55], v[196:199], a[88:91], v[52:55]
  v_mfma_f32_16x16x32_bf16 v[60:63], v[196:199], a[112:115], v[60:63]
  v_mfma_f32_16x16x32_bf16 v[68:71], v[196:199], a[136:139], v[68:71]
  v_mfma_f32_16x16x32_bf16 v[76:79], v[196:199], a[160:163], v[76:79]
  v_mfma_f32_16x16x32_bf16 v[84:87], v[196:199], a[184:187], v[84:87]
  v_mfma_f32_16x16x32_bf16 v[92:95], v[196:199], a[208:211], v[92:95]
  v_mfma_f32_16x16x32_bf16 v[100:103], v[196:199], a[232:235], v[100:103]
  s_waitcnt lgkmcnt(1)
  v_mfma_f32_16x16x32_bf16 v[24:27], v[200:203], a[20:23], v[24:27]
  v_mfma_f32_16x16x32_bf16 v[32:35], v[200:203], a[44:47], v[32:35]
  v_mfma_f32_16x16x32_bf16 v[40:43], v[200:203], a[68:71], v[40:43]
  v_mfma_f32_16x16x32_bf16 v[48:51], v[200:203], a[92:95], v[48:51]
  v_mfma_f32_16x16x32_bf16 v[56:59], v[200:203], a[116:119], v[56:59]
  v_mfma_f32_16x16x32_bf16 v[64:67], v[200:203], a[140:143], v[64:67]
  v_mfma_f32_16x16x32_bf16 v[72:75], v[200:203], a[164:167], v[72:75]
  v_mfma_f32_16x16x32_bf16 v[80:83], v[200:203], a[188:191], v[80:83]
  v_mfma_f32_16x16x32_bf16 v[88:91], v[200:203], a[212:215], v[88:91]
  v_mfma_f32_16x16x32_bf16 v[96:99], v[200:203], a[236:239], v[96:99]
  s_waitcnt lgkmcnt(0)
  v_mfma_f32_16x16x32_bf16 v[28:31], v[204:207], a[20:23], v[28:31]
  v_mfma_f32_16x16x32_bf16 v[36:39], v[204:207], a[44:47], v[36:39]
  v_mfma_f32_16x16x32_bf16 v[44:47], v[204:207], a[68:71], v[44:47]
  v_mfma_f32_16x16x32_bf16 v[52:55], v[204:207], a[92:95], v[52:55]
  v_mfma_f32_16x16x32_bf16 v[60:63], v[204:207], a[116:119], v[60:63]
  v_mfma_f32_16x16x32_bf16 v[68:71], v[204:207], a[140:143], v[68:71]
  v_mfma_f32_16x16x32_bf16 v[76:79], v[204:207], a[164:167], v[76:79]
  v_mfma_f32_16x16x32_bf16 v[84:87], v[204:207], a[188:191], v[84:87]
  v_mfma_f32_16x16x32_bf16 v[92:95], v[204:207], a[212:215], v[92:95]
  v_mfma_f32_16x16x32_bf16 v[100:103], v[204:207], a[236:239], v[100:103]
  s_nop 7
  s_mul_i32 s60, s44, 1310720
  s_add_u32 s60, s60, s57
  s_add_u32 s62, s4, s60
  s_addc_u32 s63, s5, 0
  v_cvt_pk_bf16_f32 v208, v24, v25
  v_cvt_pk_bf16_f32 v209, v26, v27
  v_cvt_pk_bf16_f32 v210, v28, v29
  v_cvt_pk_bf16_f32 v211, v30, v31
  global_store_dwordx4 v8, v[208:211], s[62:63] offset:0 sc1
  v_cvt_pk_bf16_f32 v212, v32, v33
  v_cvt_pk_bf16_f32 v213, v34, v35
  v_cvt_pk_bf16_f32 v214, v36, v37
  v_cvt_pk_bf16_f32 v215, v38, v39
  global_store_dwordx4 v8, v[212:215], s[62:63] offset:1024 sc1
  v_cvt_pk_bf16_f32 v216, v40, v41
  v_cvt_pk_bf16_f32 v217, v42, v43
  v_cvt_pk_bf16_f32 v218, v44, v45
  v_cvt_pk_bf16_f32 v219, v46, v47
  global_store_dwordx4 v8, v[216:219], s[62:63] offset:2048 sc1
  v_cvt_pk_bf16_f32 v220, v48, v49
  v_cvt_pk_bf16_f32 v221, v50, v51
  v_cvt_pk_bf16_f32 v222, v52, v53
  v_cvt_pk_bf16_f32 v223, v54, v55
  global_store_dwordx4 v8, v[220:223], s[62:63] offset:3072 sc1
  v_cvt_pk_bf16_f32 v208, v56, v57
  v_cvt_pk_bf16_f32 v209, v58, v59
  v_cvt_pk_bf16_f32 v210, v60, v61
  v_cvt_pk_bf16_f32 v211, v62, v63
  global_store_dwordx4 v9, v[208:211], s[62:63] offset:0 sc1
  v_cvt_pk_bf16_f32 v212, v64, v65
  v_cvt_pk_bf16_f32 v213, v66, v67
  v_cvt_pk_bf16_f32 v214, v68, v69
  v_cvt_pk_bf16_f32 v215, v70, v71
  global_store_dwordx4 v9, v[212:215], s[62:63] offset:1024 sc1
  v_cvt_pk_bf16_f32 v216, v72, v73
  v_cvt_pk_bf16_f32 v217, v74, v75
  v_cvt_pk_bf16_f32 v218, v76, v77
  v_cvt_pk_bf16_f32 v219, v78, v79
  global_store_dwordx4 v9, v[216:219], s[62:63] offset:2048 sc1
  v_cvt_pk_bf16_f32 v220, v80, v81
  v_cvt_pk_bf16_f32 v221, v82, v83
  v_cvt_pk_bf16_f32 v222, v84, v85
  v_cvt_pk_bf16_f32 v223, v86, v87
  global_store_dwordx4 v9, v[220:223], s[62:63] offset:3072 sc1
  v_cvt_pk_bf16_f32 v208, v88, v89
  v_cvt_pk_bf16_f32 v209, v90, v91
  v_cvt_pk_bf16_f32 v210, v92, v93
  v_cvt_pk_bf16_f32 v211, v94, v95
  global_store_dwordx4 v10, v[208:211], s[62:63] offset:0 sc1
  v_cvt_pk_bf16_f32 v212, v96, v97
  v_cvt_pk_bf16_f32 v213, v98, v99
  v_cvt_pk_bf16_f32 v214, v100, v101
  v_cvt_pk_bf16_f32 v215, v102, v103
  global_store_dwordx4 v10, v[212:215], s[62:63] offset:1024 sc1
  s_waitcnt vmcnt(0)
  s_barrier
  s_cmp_eq_u32 s44, -1
  s_cbranch_scc1 FS_113
  s_cmp_lg_u32 s3, 0
  s_cbranch_scc1 FS_113
  s_lshl_b32 s48, s44, 2
  s_add_u32 s48, s48, s58
  v_mov_b32 v5, s48
  v_mov_b32 v6, 1
  s_mov_b64 exec, 1
  global_store_dword v5, v6, s[4:5] sc1
  s_mov_b64 exec, -1
FS_113:
MW_114:
  s_bitcmp1_b64 s[84:85], s54
  s_cbranch_scc1 MD_115
  global_load_dword v20, v11, s[4:5] offset:0 sc1
  s_waitcnt vmcnt(0)
  v_cmp_eq_u32 s[84:85], 1, v20
  s_nop 1
  s_bitcmp1_b64 s[84:85], s54
  s_cbranch_scc1 MD_115
  s_sleep 8
  s_add_u32 s66, s66, 1
  s_cmp_lt_u32 s66, 0x200000
  s_cbranch_scc1 MW_114
  s_endpgm
MD_115:
  s_mul_i32 s48, s54, 393216
  s_add_u32 s48, s48, s59
  s_add_u32 s50, s4, s48
  s_addc_u32 s51, s5, 0
  s_add_u32 m0, s86, 12288
  s_nop 0
  global_load_lds_dwordx4 v4, s[50:51] offset:0 sc1
  global_load_lds_dwordx4 v4, s[50:51] offset:1024 sc1
  global_load_lds_dwordx4 v4, s[50:51] offset:2048 sc1
  s_mov_b32 s47, s46
  s_mov_b32 s46, s44
  s_mov_b32 s44, s52
  s_cmp_ge_u32 s44, 64
  s_cbranch_scc1 UG_fin0
UG_loop:
  s_waitcnt vmcnt(0)
  s_barrier
  s_cmp_eq_u32 s47, -1
  s_cbranch_scc1 FS_116
  s_cmp_lg_u32 s3, 0
  s_cbranch_scc1 FS_116
  s_lshl_b32 s48, s47, 2
  s_add_u32 s48, s48, s58
  v_mov_b32 v5, s48
  v_mov_b32 v6, 1
  s_mov_b64 exec, 1
  global_store_dword v5, v6, s[4:5] sc1
  s_mov_b64 exec, -1
FS_116:
  s_add_u32 s52, s44, 1
  s_cmp_ge_u32 s52, 64
  s_cselect_b32 s54, s44, s52
MW_117:
  s_bitcmp1_b64 s[84:85], s54
  s_cbranch_scc1 MD_118
  global_load_dword v20, v11, s[4:5] offset:0 sc1
  s_waitcnt vmcnt(0)
  v_cmp_eq_u32 s[84:85], 1, v20
  s_nop 1
  s_bitcmp1_b64 s[84:85], s54
  s_cbranch_scc1 MD_118
  s_sleep 8
  s_add_u32 s66, s66, 1
  s_cmp_lt_u32 s66, 0x200000
  s_cbranch_scc1 MW_117
  s_endpgm
MD_118:
  ds_read_b128 v[184:187], v7 offset:0
  ds_read_b128 v[188:191], v7 offset:6144
  ds_read_b128 v[192:195], v7 offset:1024
  ds_read_b128 v[196:199], v7 offset:7168
  s_mul_i32 s60, s46, 1310720
  s_add_u32 s60, s60, s57
  s_add_u32 s62, s4, s60
  s_addc_u32 s63, s5, 0
  v_cvt_pk_bf16_f32 v208, v24, v25
  v_cvt_pk_bf16_f32 v209, v26, v27
  v_cvt_pk_bf16_f32 v210, v28, v29
  v_cvt_pk_bf16_f32 v211, v30, v31
  ds_read_b128 v[200:203], v7 offset:2048
  ds_read_b128 v[204:207], v7 offset:8192
  s_waitcnt lgkmcnt(5)
  v_mfma_f32_16x16x32_bf16 v[104:107], v[184:187], a[0:3], 0
  global_store_dwordx4 v8, v[208:211], s[62:63] offset:0 sc1
  v_mfma_f32_16x16x32_bf16 v[112:115], v[184:187], a[24:27], 0
  v_mfma_f32_16x16x32_bf16 v[120:123], v[184:187], a[48:51], 0
  v_mfma_f32_16x16x32_bf16 v[128:131], v[184:187], a[72:75], 0
  v_cvt_pk_bf16_f32 v212, v32, v33
  v_cvt_pk_bf16_f32 v213, v34, v35
  v_mfma_f32_16x16x32_bf16 v[136:139], v[184:187], a[96:99], 0
  v_cvt_pk_bf16_f32 v214, v36, v37
  v_cvt_pk_bf16_f32 v215, v38, v39
  v_mfma_f32_16x16x32_bf16 v[144:147], v[184:187], a[120:123], 0
  global_store_dwordx4 v8, v[212:215], s[62:63] offset:1024 sc1
  v_mfma_f32_16x16x32_bf16 v[152:155], v[184:187], a[144:147], 0
  v_mfma_f32_16x16x32_bf16 v[160:163], v[184:187], a[168:171], 0
  v_mfma_f32_16x16x32_bf16 v[168:171], v[184:187], a[192:195], 0
  v_cvt_pk_bf16_f32 v216, v40, v41
  v_cvt_pk_bf16_f32 v217, v42, v43
  v_mfma_f32_16x16x32_bf16 v[176:179], v[184:187], a[216:219], 0
  v_cvt_pk_bf16_f32 v218, v44, v45
  v_cvt_pk_bf16_f32 v219, v46, v47
  s_waitcnt lgkmcnt(4)
  v_mfma_f32_16x16x32_bf16 v[108:111], v[188:191], a[0:3], 0
  global_store_dwordx4 v8, v[216:219], s[62:63] offset:2048 sc1
  v_mfma_f32_16x16x32_bf16 v[116:119], v[188:191], a[24:27], 0
  v_mfma_f32_16x16x32_bf16 v[124:127], v[188:191], a[48:51], 0
  v_mfma_f32_16x16x32_bf16 v[132:135], v[188:191], a[72:75], 0
  v_cvt_pk_bf16_f32 v220, v48, v49
  v_cvt_pk_bf16_f32 v221, v50, v51
  v_mfma_f32_16x16x32_bf16 v[140:143], v[188:191], a[96:99], 0
  v_cvt_pk_bf16_f32 v222, v52, v53
  v_cvt_pk_bf16_f32 v223, v54, v55
  v_mfma_f32_16x16x32_bf16 v[148:151], v[188:191], a[120:123], 0
  global_store_dwordx4 v8, v[220:223], s[62:63] offset:3072 sc1
  v_mfma_f32_16x16x32_bf16 v[156:159], v[188:191], a[144:147], 0
  v_mfma_f32_16x16x32_bf16 v[164:167], v[188:191], a[168:171], 0
  v_mfma_f32_16x16x32_bf16 v[172:175], v[188:191], a[192:195], 0
  v_cvt_pk_bf16_f32 v208, v56, v57
  v_cvt_pk_bf16_f32 v209, v58, v59
  v_mfma_f32_16x16x32_bf16 v[180:183], v[188:191], a[216:219], 0
  v_cvt_pk_bf16_f32 v210, v60, v61
  v_cvt_pk_bf16_f32 v211, v62, v63
  ds_read_b128 v[184:187], v7 offset:3072
  ds_read_b128 v[188:191], v7 offset:9216
  s_waitcnt lgkmcnt(5)
  v_mfma_f32_16x16x32_bf16 v[104:107], v[192:195], a[4:7], v[104:107]
  global_store_dwordx4 v9, v[208:211], s[62:63] offset:0 sc1
  v_mfma_f32_16x16x32_bf16 v[112:115], v[192:195], a[28:31], v[112:115]
  v_mfma_f32_16x16x32_bf16 v[120:123], v[192:195], a[52:55], v[120:123]
  v_mfma_f32_16x16x32_bf16 v[128:131], v[192:195], a[76:79], v[128:131]
  v_cvt_pk_bf16_f32 v212, v64, v65
  v_cvt_pk_bf16_f32 v213, v66, v67
  v_mfma_f32_16x16x32_bf16 v[136:139], v[192:195], a[100:103], v[136:139]
  v_cvt_pk_bf16_f32 v214, v68, v69
  v_cvt_pk_bf16_f32 v215, v70, v71
  v_mfma_f32_16x16x32_bf16 v[144:147], v[192:195], a[124:127], v[144:147]
  global_store_dwordx4 v9, v[212:215], s[62:63] offset:1024 sc1
  v_mfma_f32_16x16x32_bf16 v[152:155], v[192:195], a[148:151], v[152:155]
  v_mfma_f32_16x16x32_bf16 v[160:163], v[192:195], a[172:175], v[160:163]
  v_mfma_f32_16x16x32_bf16 v[168:171], v[192:195], a[196:199], v[168:171]
  v_cvt_pk_bf16_f32 v216, v72, v73
  v_cvt_pk_bf16_f32 v217, v74, v75
  v_mfma_f32_16x16x32_bf16 v[176:179], v[192:195], a[220:223], v[176:179]
  v_cvt_pk_bf16_f32 v218, v76, v77
  v_cvt_pk_bf16_f32 v219, v78, v79
  s_waitcnt lgkmcnt(4)
  v_mfma_f32_16x16x32_bf16 v[108:111], v[196:199], a[4:7], v[108:111]
  global_store_dwordx4 v9, v[216:219], s[62:63] offset:2048 sc1
  v_mfma_f32_16x16x32_bf16 v[116:119], v[196:199], a[28:31], v[116:119]
  v_mfma_f32_16x16x32_bf16 v[124:127], v[196:199], a[52:55], v[124:127]
  v_mfma_f32_16x16x32_bf16 v[132:135], v[196:199], a[76:79], v[132:135]
  v_cvt_pk_bf16_f32 v220, v80, v81
  v_cvt_pk_bf16_f32 v221, v82, v83
  v_mfma_f32_16x16x32_bf16 v[140:143], v[196:199], a[100:103], v[140:143]
  v_cvt_pk_bf16_f32 v222, v84, v85
  v_cvt_pk_bf16_f32 v223, v86, v87
  v_mfma_f32_16x16x32_bf16 v[148:151], v[196:199], a[124:127], v[148:151]
  global_store_dwordx4 v9, v[220:223], s[62:63] offset:3072 sc1
  v_mfma_f32_16x16x32_bf16 v[156:159], v[196:199], a[148:151], v[156:159]
  v_mfma_f32_16x16x32_bf16 v[164:167], v[196:199], a[172:175], v[164:167]
  v_mfma_f32_16x16x32_bf16 v[172:175], v[196:199], a[196:199], v[172:175]
  v_cvt_pk_bf16_f32 v208, v88, v89
  v_cvt_pk_bf16_f32 v209, v90, v91
  v_mfma_f32_16x16x32_bf16 v[180:183], v[196:199], a[220:223], v[180:183]
  v_cvt_pk_bf16_f32 v210, v92, v93
  v_cvt_pk_bf16_f32 v211, v94, v95
  ds_read_b128 v[192:195], v7 offset:4096
  ds_read_b128 v[196:199], v7 offset:10240
  s_waitcnt lgkmcnt(5)
  v_mfma_f32_16x16x32_bf16 v[104:107], v[200:203], a[8:11], v[104:107]
  global_store_dwordx4 v10, v[208:211], s[62:63] offset:0 sc1
  v_mfma_f32_16x16x32_bf16 v[112:115], v[200:203], a[32:35], v[112:115]
  v_mfma_f32_16x16x32_bf16 v[120:123], v[200:203], a[56:59], v[120:123]
  v_mfma_f32_16x16x32_bf16 v[128:131], v[200:203], a[80:83], v[128:131]
  v_cvt_pk_bf16_f32 v212, v96, v97
  v_cvt_pk_bf16_f32 v213, v98, v99
  v_mfma_f32_16x16x32_bf16 v[136:139], v[200:203], a[104:107], v[136:139]
  v_cvt_pk_bf16_f32 v214, v100, v101
  v_cvt_pk_bf16_f32 v215, v102, v103
  v_mfma_f32_16x16x32_bf16 v[144:147], v[200:203], a[128:131], v[144:147]
  global_store_dwordx4 v10, v[212:215], s[62:63] offset:1024 sc1
  v_mfma_f32_16x16x32_bf16 v[152:155], v[200:203], a[152:155], v[152:155]
  v_mfma_f32_16x16x32_bf16 v[160:163], v[200:203], a[176:179], v[160:163]
  v_mfma_f32_16x16x32_bf16 v[168:171], v[200:203], a[200:203], v[168:171]
  s_mul_i32 s48, s54, 393216
  s_add_u32 s48, s48, s59
  v_mfma_f32_16x16x32_bf16 v[176:179], v[200:203], a[224:227], v[176:179]
  s_add_u32 s50, s4, s48
  s_addc_u32 s51, s5, 0
  s_waitcnt lgkmcnt(4)
  v_mfma_f32_16x16x32_bf16 v[108:111], v[204:207], a[8:11], v[108:111]
  s_add_u32 m0, s86, 0
  s_nop 0
  v_mfma_f32_16x16x32_bf16 v[116:119], v[204:207], a[32:35], v[116:119]
  global_load_lds_dwordx4 v4, s[50:51] offset:0 sc1
  v_mfma_f32_16x16x32_bf16 v[124:127], v[204:207], a[56:59], v[124:127]
  v_mfma_f32_16x16x32_bf16 v[132:135], v[204:207], a[80:83], v[132:135]
  v_mfma_f32_16x16x32_bf16 v[140:143], v[204:207], a[104:107], v[140:143]
  global_load_lds_dwordx4 v4, s[50:51] offset:1024 sc1
  v_mfma_f32_16x16x32_bf16 v[148:151], v[204:207], a[128:131], v[148:151]
  v_mfma_f32_16x16x32_bf16 v[156:159], v[204:207], a[152:155], v[156:159]
  v_mfma_f32_16x16x32_bf16 v[164:167], v[204:207], a[176:179], v[164:167]
  global_load_lds_dwordx4 v4, s[50:51] offset:2048 sc1
  v_mfma_f32_16x16x32_bf16 v[172:175], v[204:207], a[200:203], v[172:175]
  v_mfma_f32_16x16x32_bf16 v[180:183], v[204:207], a[224:227], v[180:183]
  ds_read_b128 v[200:203], v7 offset:5120
  ds_read_b128 v[204:207], v7 offset:11264
  s_waitcnt lgkmcnt(5)
  v_mfma_f32_16x16x32_bf16 v[104:107], v[184:187], a[12:15], v[104:107]
  v_mfma_f32_16x16x32_bf16 v[112:115], v[184:187], a[36:39], v[112:115]
  v_mfma_f32_16x16x32_bf16 v[120:123], v[184:187], a[60:63], v[120:123]
  v_mfma_f32_16x16x32_bf16 v[128:131], v[184:187], a[84:87], v[128:131]
  v_mfma_f32_16x16x32_bf16 v[136:139], v[184:187], a[108:111], v[136:139]
  v_mfma_f32_16x16x32_bf16 v[144:147], v[184:187], a[132:135], v[144:147]
  v_mfma_f32_16x16x32_bf16 v[152:155], v[184:187], a[156:159], v[152:155]
  v_mfma_f32_16x16x32_bf16 v[160:163], v[184:187], a[180:183], v[160:163]
  v_mfma_f32_16x16x32_bf16 v[168:171], v[184:187], a[204:207], v[168:171]
  v_mfma_f32_16x16x32_bf16 v[176:179], v[184:187], a[228:231], v[176:179]
  s_waitcnt lgkmcnt(4)
  v_mfma_f32_16x16x32_bf16 v[108:111], v[188:191], a[12:15], v[108:111]
  v_mfma_f32_16x16x32_bf16 v[116:119], v[188:191], a[36:39], v[116:119]
  v_mfma_f32_16x16x32_bf16 v[124:127], v[188:191], a[60:63], v[124:127]
  v_mfma_f32_16x16x32_bf16 v[132:135], v[188:191], a[84:87], v[132:135]
  v_mfma_f32_16x16x32_bf16 v[140:143], v[188:191], a[108:111], v[140:143]
  v_mfma_f32_16x16x32_bf16 v[148:151], v[188:191], a[132:135], v[148:151]
  v_mfma_f32_16x16x32_bf16 v[156:159], v[188:191], a[156:159], v[156:159]
  v_mfma_f32_16x16x32_bf16 v[164:167], v[188:191], a[180:183], v[164:167]
  v_mfma_f32_16x16x32_bf16 v[172:175], v[188:191], a[204:207], v[172:175]
  v_mfma_f32_16x16x32_bf16 v[180:183], v[188:191], a[228:231], v[180:183]
  s_waitcnt lgkmcnt(3)
  v_mfma_f32_16x16x32_bf16 v[104:107], v[192:195], a[16:19], v[104:107]
  v_mfma_f32_16x16x32_bf16 v[112:115], v[192:195], a[40:43], v[112:115]
  v_mfma_f32_16x16x32_bf16 v[120:123], v[192:195], a[64:67], v[120:123]
  v_mfma_f32_16x16x32_bf16 v[128:131], v[192:195], a[88:91], v[128:131]
  v_mfma_f32_16x16x32_bf16 v[136:139], v[192:195], a[112:115], v[136:139]
  v_mfma_f32_16x16x32_bf16 v[144:147], v[192:195], a[136:139], v[144:147]
  v_mfma_f32_16x16x32_bf16 v[152:155], v[192:195], a[160:163], v[152:155]
  v_mfma_f32_16x16x32_bf16 v[160:163], v[192:195], a[184:187], v[160:163]
  v_mfma_f32_16x16x32_bf16 v[168:171], v[192:195], a[208:211], v[168:171]
  v_mfma_f32_16x16x32_bf16 v[176:179], v[192:195], a[232:235], v[176:179]
  s_waitcnt lgkmcnt(2)
  v_mfma_f32_16x16x32_bf16 v[108:111], v[196:199], a[16:19], v[108:111]
  v_mfma_f32_16x16x32_bf16 v[116:119], v[196:199], a[40:43], v[116:119]
  v_mfma_f32_16x16x32_bf16 v[124:127], v[196:199], a[64:67], v[124:127]
  v_mfma_f32_16x16x32_bf16 v[132:135], v[196:199], a[88:91], v[132:135]
  v_mfma_f32_16x16x32_bf16 v[140:143], v[196:199], a[112:115], v[140:143]
  v_mfma_f32_16x16x32_bf16 v[148:151], v[196:199], a[136:139], v[148:151]
  v_mfma_f32_16x16x32_bf16 v[156:159], v[196:199], a[160:163], v[156:159]
  v_mfma_f32_16x16x32_bf16 v[164:167], v[196:199], a[184:187], v[164:167]
  v_mfma_f32_16x16x32_bf16 v[172:175], v[196:199], a[208:211], v[172:175]
  v_mfma_f32_16x16x32_bf16 v[180:183], v[196:199], a[232:235], v[180:183]
  s_waitcnt lgkmcnt(1)
  v_mfma_f32_16x16x32_bf16 v[104:107], v[200:203], a[20:23], v[104:107]
  v_mfma_f32_16x16x32_bf16 v[112:115], v[200:203], a[44:47], v[112:115]
  v_mfma_f32_16x16x32_bf16 v[120:123], v[200:203], a[68:71], v[120:123]
  v_mfma_f32_16x16x32_bf16 v[128:131], v[200:203], a[92:95], v[128:131]
  v_mfma_f32_16x16x32_bf16 v[136:139], v[200:203], a[116:119], v[136:139]
  v_mfma_f32_16x16x32_bf16 v[144:147], v[200:203], a[140:143], v[144:147]
  v_mfma_f32_16x16x32_bf16 v[152:155], v[200:203], a[164:167], v[152:155]
  v_mfma_f32_16x16x32_bf16 v[160:163], v[200:203], a[188:191], v[160:163]
  v_mfma_f32_16x16x32_bf16 v[168:171], v[200:203], a[212:215], v[168:171]
  v_mfma_f32_16x16x32_bf16 v[176:179], v[200:203], a[236:239], v[176:179]
  s_waitcnt lgkmcnt(0)
  v_mfma_f32_16x16x32_bf16 v[108:111], v[204:207], a[20:23], v[108:111]
  v_mfma_f32_16x16x32_bf16 v[116:119], v[204:207], a[44:47], v[116:119]
  v_mfma_f32_16x16x32_bf16 v[124:127], v[204:207], a[68:71], v[124:127]
  v_mfma_f32_16x16x32_bf16 v[132:135], v[204:207], a[92:95], v[132:135]
  v_mfma_f32_16x16x32_bf16 v[140:143], v[204:207], a[116:119], v[140:143]
  v_mfma_f32_16x16x32_bf16 v[148:151], v[204:207], a[140:143], v[148:151]
  v_mfma_f32_16x16x32_bf16 v[156:159], v[204:207], a[164:167], v[156:159]
  v_mfma_f32_16x16x32_bf16 v[164:167], v[204:207], a[188:191], v[164:167]
  v_mfma_f32_16x16x32_bf16 v[172:175], v[204:207], a[212:215], v[172:175]
  v_mfma_f32_16x16x32_bf16 v[180:183], v[204:207], a[236:239], v[180:183]
  s_cmp_ge_u32 s44, 4
  s_cbranch_scc1 EG_119
  s_nop 7
  s_mul_i32 s60, s44, 1310720
  s_add_u32 s60, s60, s57
  s_add_u32 s62, s4, s60
  s_addc_u32 s63, s5, 0
  v_cvt_pk_bf16_f32 v208, v104, v105
  v_cvt_pk_bf16_f32 v209, v106, v107
  v_cvt_pk_bf16_f32 v210, v108, v109
  v_cvt_pk_bf16_f32 v211, v110, v111
  global_store_dwordx4 v8, v[208:211], s[62:63] offset:0 sc1
  v_cvt_pk_bf16_f32 v212, v112, v113
  v_cvt_pk_bf16_f32 v213, v114, v115
  v_cvt_pk_bf16_f32 v214, v116, v117
  v_cvt_pk_bf16_f32 v215, v118, v119
  global_store_dwordx4 v8, v[212:215], s[62:63] offset:1024 sc1
  v_cvt_pk_bf16_f32 v216, v120, v121
  v_cvt_pk_bf16_f32 v217, v122, v123
  v_cvt_pk_bf16_f32 v218, v124, v125
  v_cvt_pk_bf16_f32 v219, v126, v127
  global_store_dwordx4 v8, v[216:219], s[62:63] offset:2048 sc1
  v_cvt_pk_bf16_f32 v220, v128, v129
  v_cvt_pk_bf16_f32 v221, v130, v131
  v_cvt_pk_bf16_f32 v222, v132, v133
  v_cvt_pk_bf16_f32 v223, v134, v135
  global_store_dwordx4 v8, v[220:223], s[62:63] offset:3072 sc1
  v_cvt_pk_bf16_f32 v208, v136, v137
  v_cvt_pk_bf16_f32 v209, v138, v139
  v_cvt_pk_bf16_f32 v210, v140, v141
  v_cvt_pk_bf16_f32 v211, v142, v143
  global_store_dwordx4 v9, v[208:211], s[62:63] offset:0 sc1
  v_cvt_pk_bf16_f32 v212, v144, v145
  v_cvt_pk_bf16_f32 v213, v146, v147
  v_cvt_pk_bf16_f32 v214, v148, v149
  v_cvt_pk_bf16_f32 v215, v150, v151
  global_store_dwordx4 v9, v[212:215], s[62:63] offset:1024 sc1
  v_cvt_pk_bf16_f32 v216, v152, v153
  v_cvt_pk_bf16_f32 v217, v154, v155
  v_cvt_pk_bf16_f32 v218, v156, v157
  v_cvt_pk_bf16_f32 v219, v158, v159
  global_store_dwordx4 v9, v[216:219], s[62:63] offset:2048 sc1
  v_cvt_pk_bf16_f32 v220, v160, v161
  v_cvt_pk_bf16_f32 v221, v162, v163
  v_cvt_pk_bf16_f32 v222, v164, v165
  v_cvt_pk_bf16_f32 v223, v166, v167
  global_store_dwordx4 v9, v[220:223], s[62:63] offset:3072 sc1
  v_cvt_pk_bf16_f32 v208, v168, v169
  v_cvt_pk_bf16_f32 v209, v170, v171
  v_cvt_pk_bf16_f32 v210, v172, v173
  v_cvt_pk_bf16_f32 v211, v174, v175
  global_store_dwordx4 v10, v[208:211], s[62:63] offset:0 sc1
  v_cvt_pk_bf16_f32 v212, v176, v177
  v_cvt_pk_bf16_f32 v213, v178, v179
  v_cvt_pk_bf16_f32 v214, v180, v181
  v_cvt_pk_bf16_f32 v215, v182, v183
  global_store_dwordx4 v10, v[212:215], s[62:63] offset:1024 sc1
  s_waitcnt vmcnt(0)
  s_barrier
  s_cmp_eq_u32 s44, -1
  s_cbranch_scc1 FS_120
  s_cmp_lg_u32 s3, 0
  s_cbranch_scc1 FS_120
  s_lshl_b32 s48, s44, 2
  s_add_u32 s48, s48, s58
  v_mov_b32 v5, s48
  v_mov_b32 v6, 1
  s_mov_b64 exec, 1
  global_store_dword v5, v6, s[4:5] sc1
  s_mov_b64 exec, -1
FS_120:
EG_119:
  s_mov_b32 s47, s46
  s_mov_b32 s46, s44
  s_mov_b32 s44, s52
  s_cmp_ge_u32 s44, 64
  s_cbranch_scc1 UG_fin1
  s_waitcnt vmcnt(0)
  s_barrier
  s_cmp_eq_u32 s47, -1
  s_cbranch_scc1 FS_121
  s_cmp_lg_u32 s3, 0
  s_cbranch_scc1 FS_121
  s_lshl_b32 s48, s47, 2
  s_add_u32 s48, s48, s58
  v_mov_b32 v5, s48
  v_mov_b32 v6, 1
  s_mov_b64 exec, 1
  global_store_dword v5, v6, s[4:5] sc1
  s_mov_b64 exec, -1
FS_121:
  s_add_u32 s52, s44, 1
  s_cmp_ge_u32 s52, 64
  s_cselect_b32 s54, s44, s52
MW_122:
  s_bitcmp1_b64 s[84:85], s54
  s_cbranch_scc1 MD_123
  global_load_dword v20, v11, s[4:5] offset:0 sc1
  s_waitcnt vmcnt(0)
  v_cmp_eq_u32 s[84:85], 1, v20
  s_nop 1
  s_bitcmp1_b64 s[84:85], s54
  s_cbranch_scc1 MD_123
  s_sleep 8
  s_add_u32 s66, s66, 1
  s_cmp_lt_u32 s66, 0x200000
  s_cbranch_scc1 MW_122
  s_endpgm
MD_123:
  ds_read_b128 v[184:187], v3 offset:0
  ds_read_b128 v[188:191], v3 offset:6144
  ds_read_b128 v[192:195], v3 offset:1024
  ds_read_b128 v[196:199], v3 offset:7168
  s_mul_i32 s60, s46, 1310720
  s_add_u32 s60, s60, s57
  s_add_u32 s62, s4, s60
  s_addc_u32 s63, s5, 0
  v_cvt_pk_bf16_f32 v208, v104, v105
  v_cvt_pk_bf16_f32 v209, v106, v107
  v_cvt_pk_bf16_f32 v210, v108, v109
  v_cvt_pk_bf16_f32 v211, v110, v111
  ds_read_b128 v[200:203], v3 offset:2048
  ds_read_b128 v[204:207], v3 offset:8192
  s_waitcnt lgkmcnt(5)
  v_mfma_f32_16x16x32_bf16 v[24:27], v[184:187], a[0:3], 0
  global_store_dwordx4 v8, v[208:211], s[62:63] offset:0 sc1
  v_mfma_f32_16x16x32_bf16 v[32:35], v[184:187], a[24:27], 0
  v_mfma_f32_16x16x32_bf16 v[40:43], v[184:187], a[48:51], 0
  v_mfma_f32_16x16x32_bf16 v[48:51], v[184:187], a[72:75], 0
  v_cvt_pk_bf16_f32 v212, v112, v113
  v_cvt_pk_bf16_f32 v213, v114, v115
  v_mfma_f32_16x16x32_bf16 v[56:59], v[184:187], a[96:99], 0
  v_cvt_pk_bf16_f32 v214, v116, v117
  v_cvt_pk_bf16_f32 v215, v118, v119
  v_mfma_f32_16x16x32_bf16 v[64:67], v[184:187], a[120:123], 0
  global_store_dwordx4 v8, v[212:215], s[62:63] offset:1024 sc1
  v_mfma_f32_16x16x32_bf16 v[72:75], v[184:187], a[144:147], 0
  v_mfma_f32_16x16x32_bf16 v[80:83], v[184:187], a[168:171], 0
  v_mfma_f32_16x16x32_bf16 v[88:91], v[184:187], a[192:195], 0
  v_cvt_pk_bf16_f32 v216, v120, v121
  v_cvt_pk_bf16_f32 v217, v122, v123
  v_mfma_f32_16x16x32_bf16 v[96:99], v[184:187], a[216:219], 0
  v_cvt_pk_bf16_f32 v218, v124, v125
  v_cvt_pk_bf16_f32 v219, v126, v127
  s_waitcnt lgkmcnt(4)
  v_mfma_f32_16x16x32_bf16 v[28:31], v[188:191], a[0:3], 0
  global_store_dwordx4 v8, v[216:219], s[62:63] offset:2048 sc1
  v_mfma_f32_16x16x32_bf16 v[36:39], v[188:191], a[24:27], 0
  v_mfma_f32_16x16x32_bf16 v[44:47], v[188:191], a[48:51], 0
  v_mfma_f32_16x16x32_bf16 v[52:55], v[188:191], a[72:75], 0
  v_cvt_pk_bf16_f32 v220, v128, v129
  v_cvt_pk_bf16_f32 v221, v130, v131
  v_mfma_f32_16x16x32_bf16 v[60:63], v[188:191], a[96:99], 0
  v_cvt_pk_bf16_f32 v222, v132, v133
  v_cvt_pk_bf16_f32 v223, v134, v135
  v_mfma_f32_16x16x32_bf16 v[68:71], v[188:191], a[120:123], 0
  global_store_dwordx4 v8, v[220:223], s[62:63] offset:3072 sc1
  v_mfma_f32_16x16x32_bf16 v[76:79], v[188:191], a[144:147], 0
  v_mfma_f32_16x16x32_bf16 v[84:87], v[188:191], a[168:171], 0
  v_mfma_f32_16x16x32_bf16 v[92:95], v[188:191], a[192:195], 0
  v_cvt_pk_bf16_f32 v208, v136, v137
  v_cvt_pk_bf16_f32 v209, v138, v139
  v_mfma_f32_16x16x32_bf16 v[100:103], v[188:191], a[216:219], 0
  v_cvt_pk_bf16_f32 v210, v140, v141
  v_cvt_pk_bf16_f32 v211, v142, v143
  ds_read_b128 v[184:187], v3 offset:3072
  ds_read_b128 v[188:191], v3 offset:9216
  s_waitcnt lgkmcnt(5)
  v_mfma_f32_16x16x32_bf16 v[24:27], v[192:195], a[4:7], v[24:27]
  global_store_dwordx4 v9, v[208:211], s[62:63] offset:0 sc1
  v_mfma_f32_16x16x32_bf16 v[32:35], v[192:195], a[28:31], v[32:35]
  v_mfma_f32_16x16x32_bf16 v[40:43], v[192:195], a[52:55], v[40:43]
  v_mfma_f32_16x16x32_bf16 v[48:51], v[192:195], a[76:79], v[48:51]
  v_cvt_pk_bf16_f32 v212, v144, v145
  v_cvt_pk_bf16_f32 v213, v146, v147
  v_mfma_f32_16x16x32_bf16 v[56:59], v[192:195], a[100:103], v[56:59]
  v_cvt_pk_bf16_f32 v214, v148, v149
  v_cvt_pk_bf16_f32 v215, v150, v151
  v_mfma_f32_16x16x32_bf16 v[64:67], v[192:195], a[124:127], v[64:67]
  global_store_dwordx4 v9, v[212:215], s[62:63] offset:1024 sc1
  v_mfma_f32_16x16x32_bf16 v[72:75], v[192:195], a[148:151], v[72:75]
  v_mfma_f32_16x16x32_bf16 v[80:83], v[192:195], a[172:175], v[80:83]
  v_mfma_f32_16x16x32_bf16 v[88:91], v[192:195], a[196:199], v[88:91]
  v_cvt_pk_bf16_f32 v216, v152, v153
  v_cvt_pk_bf16_f32 v217, v154, v155
  v_mfma_f32_16x16x32_bf16 v[96:99], v[192:195], a[220:223], v[96:99]
  v_cvt_pk_bf16_f32 v218, v156, v157
  v_cvt_pk_bf16_f32 v219, v158, v159
  s_waitcnt lgkmcnt(4)
  v_mfma_f32_16x16x32_bf16 v[28:31], v[196:199], a[4:7], v[28:31]
  global_store_dwordx4 v9, v[216:219], s[62:63] offset:2048 sc1
  v_mfma_f32_16x16x32_bf16 v[36:39], v[196:199], a[28:31], v[36:39]
  v_mfma_f32_16x16x32_bf16 v[44:47], v[196:199], a[52:55], v[44:47]
  v_mfma_f32_16x16x32_bf16 v[52:55], v[196:199], a[76:79], v[52:55]
  v_cvt_pk_bf16_f32 v220, v160, v161
  v_cvt_pk_bf16_f32 v221, v162, v163
  v_mfma_f32_16x16x32_bf16 v[60:63], v[196:199], a[100:103], v[60:63]
  v_cvt_pk_bf16_f32 v222, v164, v165
  v_cvt_pk_bf16_f32 v223, v166, v167
  v_mfma_f32_16x16x32_bf16 v[68:71], v[196:199], a[124:127], v[68:71]
  global_store_dwordx4 v9, v[220:223], s[62:63] offset:3072 sc1
  v_mfma_f32_16x16x32_bf16 v[76:79], v[196:199], a[148:151], v[76:79]
  v_mfma_f32_16x16x32_bf16 v[84:87], v[196:199], a[172:175], v[84:87]
  v_mfma_f32_16x16x32_bf16 v[92:95], v[196:199], a[196:199], v[92:95]
  v_cvt_pk_bf16_f32 v208, v168, v169
  v_cvt_pk_bf16_f32 v209, v170, v171
  v_mfma_f32_16x16x32_bf16 v[100:103], v[196:199], a[220:223], v[100:103]
  v_cvt_pk_bf16_f32 v210, v172, v173
  v_cvt_pk_bf16_f32 v211, v174, v175
  ds_read_b128 v[192:195], v3 offset:4096
  ds_read_b128 v[196:199], v3 offset:10240
  s_waitcnt lgkmcnt(5)
  v_mfma_f32_16x16x32_bf16 v[24:27], v[200:203], a[8:11], v[24:27]
  global_store_dwordx4 v10, v[208:211], s[62:63] offset:0 sc1
  v_mfma_f32_16x16x32_bf16 v[32:35], v[200:203], a[32:35], v[32:35]
  v_mfma_f32_16x16x32_bf16 v[40:43], v[200:203], a[56:59], v[40:43]
  v_mfma_f32_16x16x32_bf16 v[48:51], v[200:203], a[80:83], v[48:51]
  v_cvt_pk_bf16_f32 v212, v176, v177
  v_cvt_pk_bf16_f32 v213, v178, v179
  v_mfma_f32_16x16x32_bf16 v[56:59], v[200:203], a[104:107], v[56:59]
  v_cvt_pk_bf16_f32 v214, v180, v181
  v_cvt_pk_bf16_f32 v215, v182, v183
  v_mfma_f32_16x16x32_bf16 v[64:67], v[200:203], a[128:131], v[64:67]
  global_store_dwordx4 v10, v[212:215], s[62:63] offset:1024 sc1
  v_mfma_f32_16x16x32_bf16 v[72:75], v[200:203], a[152:155], v[72:75]
  v_mfma_f32_16x16x32_bf16 v[80:83], v[200:203], a[176:179], v[80:83]
  v_mfma_f32_16x16x32_bf16 v[88:91], v[200:203], a[200:203], v[88:91]
  s_mul_i32 s48, s54, 393216
  s_add_u32 s48, s48, s59
  v_mfma_f32_16x16x32_bf16 v[96:99], v[200:203], a[224:227], v[96:99]
  s_add_u32 s50, s4, s48
  s_addc_u32 s51, s5, 0
  s_waitcnt lgkmcnt(4)
  v_mfma_f32_16x16x32_bf16 v[28:31], v[204:207], a[8:11], v[28:31]
  s_add_u32 m0, s86, 12288
  s_nop 0
  v_mfma_f32_16x16x32_bf16 v[36:39], v[204:207], a[32:35], v[36:39]
  global_load_lds_dwordx4 v4, s[50:51] offset:0 sc1
  v_mfma_f32_16x16x32_bf16 v[44:47], v[204:207], a[56:59], v[44:47]
  v_mfma_f32_16x16x32_bf16 v[52:55], v[204:207], a[80:83], v[52:55]
  v_mfma_f32_16x16x32_bf16 v[60:63], v[204:207], a[104:107], v[60:63]
  global_load_lds_dwordx4 v4, s[50:51] offset:1024 sc1
  v_mfma_f32_16x16x32_bf16 v[68:71], v[204:207], a[128:131], v[68:71]
  v_mfma_f32_16x16x32_bf16 v[76:79], v[204:207], a[152:155], v[76:79]
  v_mfma_f32_16x16x32_bf16 v[84:87], v[204:207], a[176:179], v[84:87]
  global_load_lds_dwordx4 v4, s[50:51] offset:2048 sc1
  v_mfma_f32_16x16x32_bf16 v[92:95], v[204:207], a[200:203], v[92:95]
  v_mfma_f32_16x16x32_bf16 v[100:103], v[204:207], a[224:227], v[100:103]
  ds_read_b128 v[200:203], v3 offset:5120
  ds_read_b128 v[204:207], v3 offset:11264
  s_waitcnt lgkmcnt(5)
  v_mfma_f32_16x16x32_bf16 v[24:27], v[184:187], a[12:15], v[24:27]
  v_mfma_f32_16x16x32_bf16 v[32:35], v[184:187], a[36:39], v[32:35]
  v_mfma_f32_16x16x32_bf16 v[40:43], v[184:187], a[60:63], v[40:43]
  v_mfma_f32_16x16x32_bf16 v[48:51], v[184:187], a[84:87], v[48:51]
  v_mfma_f32_16x16x32_bf16 v[56:59], v[184:187], a[108:111], v[56:59]
  v_mfma_f32_16x16x32_bf16 v[64:67], v[184:187], a[132:135], v[64:67]
  v_mfma_f32_16x16x32_bf16 v[72:75], v[184:187], a[156:159], v[72:75]
  v_mfma_f32_16x16x32_bf16 v[80:83], v[184:187], a[180:183], v[80:83]
  v_mfma_f32_16x16x32_bf16 v[88:91], v[184:187], a[204:207], v[88:91]
  v_mfma_f32_16x16x32_bf16 v[96:99], v[184:187], a[228:231], v[96:99]
  s_waitcnt lgkmcnt(4)
  v_mfma_f32_16x16x32_bf16 v[28:31], v[188:191], a[12:15], v[28:31]
  v_mfma_f32_16x16x32_bf16 v[36:39], v[188:191], a[36:39], v[36:39]
  v_mfma_f32_16x16x32_bf16 v[44:47], v[188:191], a[60:63], v[44:47]
  v_mfma_f32_16x16x32_bf16 v[52:55], v[188:191], a[84:87], v[52:55]
  v_mfma_f32_16x16x32_bf16 v[60:63], v[188:191], a[108:111], v[60:63]
  v_mfma_f32_16x16x32_bf16 v[68:71], v[188:191], a[132:135], v[68:71]
  v_mfma_f32_16x16x32_bf16 v[76:79], v[188:191], a[156:159], v[76:79]
  v_mfma_f32_16x16x32_bf16 v[84:87], v[188:191], a[180:183], v[84:87]
  v_mfma_f32_16x16x32_bf16 v[92:95], v[188:191], a[204:207], v[92:95]
  v_mfma_f32_16x16x32_bf16 v[100:103], v[188:191], a[228:231], v[100:103]
  s_waitcnt lgkmcnt(3)
  v_mfma_f32_16x16x32_bf16 v[24:27], v[192:195], a[16:19], v[24:27]
  v_mfma_f32_16x16x32_bf16 v[32:35], v[192:195], a[40:43], v[32:35]
  v_mfma_f32_16x16x32_bf16 v[40:43], v[192:195], a[64:67], v[40:43]
  v_mfma_f32_16x16x32_bf16 v[48:51], v[192:195], a[88:91], v[48:51]
  v_mfma_f32_16x16x32_bf16 v[56:59], v[192:195], a[112:115], v[56:59]
  v_mfma_f32_16x16x32_bf16 v[64:67], v[192:195], a[136:139], v[64:67]
  v_mfma_f32_16x16x32_bf16 v[72:75], v[192:195], a[160:163], v[72:75]
  v_mfma_f32_16x16x32_bf16 v[80:83], v[192:195], a[184:187], v[80:83]
  v_mfma_f32_16x16x32_bf16 v[88:91], v[192:195], a[208:211], v[88:91]
  v_mfma_f32_16x16x32_bf16 v[96:99], v[192:195], a[232:235], v[96:99]
  s_waitcnt lgkmcnt(2)
  v_mfma_f32_16x16x32_bf16 v[28:31], v[196:199], a[16:19], v[28:31]
  v_mfma_f32_16x16x32_bf16 v[36:39], v[196:199], a[40:43], v[36:39]
  v_mfma_f32_16x16x32_bf16 v[44:47], v[196:199], a[64:67], v[44:47]
  v_mfma_f32_16x16x32_bf16 v[52:55], v[196:199], a[88:91], v[52:55]
  v_mfma_f32_16x16x32_bf16 v[60:63], v[196:199], a[112:115], v[60:63]
  v_mfma_f32_16x16x32_bf16 v[68:71], v[196:199], a[136:139], v[68:71]
  v_mfma_f32_16x16x32_bf16 v[76:79], v[196:199], a[160:163], v[76:79]
  v_mfma_f32_16x16x32_bf16 v[84:87], v[196:199], a[184:187], v[84:87]
  v_mfma_f32_16x16x32_bf16 v[92:95], v[196:199], a[208:211], v[92:95]
  v_mfma_f32_16x16x32_bf16 v[100:103], v[196:199], a[232:235], v[100:103]
  s_waitcnt lgkmcnt(1)
  v_mfma_f32_16x16x32_bf16 v[24:27], v[200:203], a[20:23], v[24:27]
  v_mfma_f32_16x16x32_bf16 v[32:35], v[200:203], a[44:47], v[32:35]
  v_mfma_f32_16x16x32_bf16 v[40:43], v[200:203], a[68:71], v[40:43]
  v_mfma_f32_16x16x32_bf16 v[48:51], v[200:203], a[92:95], v[48:51]
  v_mfma_f32_16x16x32_bf16 v[56:59], v[200:203], a[116:119], v[56:59]
  v_mfma_f32_16x16x32_bf16 v[64:67], v[200:203], a[140:143], v[64:67]
  v_mfma_f32_16x16x32_bf16 v[72:75], v[200:203], a[164:167], v[72:75]
  v_mfma_f32_16x16x32_bf16 v[80:83], v[200:203], a[188:191], v[80:83]
  v_mfma_f32_16x16x32_bf16 v[88:91], v[200:203], a[212:215], v[88:91]
  v_mfma_f32_16x16x32_bf16 v[96:99], v[200:203], a[236:239], v[96:99]
  s_waitcnt lgkmcnt(0)
  v_mfma_f32_16x16x32_bf16 v[28:31], v[204:207], a[20:23], v[28:31]
  v_mfma_f32_16x16x32_bf16 v[36:39], v[204:207], a[44:47], v[36:39]
  v_mfma_f32_16x16x32_bf16 v[44:47], v[204:207], a[68:71], v[44:47]
  v_mfma_f32_16x16x32_bf16 v[52:55], v[204:207], a[92:95], v[52:55]
  v_mfma_f32_16x16x32_bf16 v[60:63], v[204:207], a[116:119], v[60:63]
  v_mfma_f32_16x16x32_bf16 v[68:71], v[204:207], a[140:143], v[68:71]
  v_mfma_f32_16x16x32_bf16 v[76:79], v[204:207], a[164:167], v[76:79]
  v_mfma_f32_16x16x32_bf16 v[84:87], v[204:207], a[188:191], v[84:87]
  v_mfma_f32_16x16x32_bf16 v[92:95], v[204:207], a[212:215], v[92:95]
  v_mfma_f32_16x16x32_bf16 v[100:103], v[204:207], a[236:239], v[100:103]
  s_cmp_ge_u32 s44, 4
  s_cbranch_scc1 EG_124
  s_nop 7
  s_mul_i32 s60, s44, 1310720
  s_add_u32 s60, s60, s57
  s_add_u32 s62, s4, s60
  s_addc_u32 s63, s5, 0
  v_cvt_pk_bf16_f32 v208, v24, v25
  v_cvt_pk_bf16_f32 v209, v26, v27
  v_cvt_pk_bf16_f32 v210, v28, v29
  v_cvt_pk_bf16_f32 v211, v30, v31
  global_store_dwordx4 v8, v[208:211], s[62:63] offset:0 sc1
  v_cvt_pk_bf16_f32 v212, v32, v33
  v_cvt_pk_bf16_f32 v213, v34, v35
  v_cvt_pk_bf16_f32 v214, v36, v37
  v_cvt_pk_bf16_f32 v215, v38, v39
  global_store_dwordx4 v8, v[212:215], s[62:63] offset:1024 sc1
  v_cvt_pk_bf16_f32 v216, v40, v41
  v_cvt_pk_bf16_f32 v217, v42, v43
  v_cvt_pk_bf16_f32 v218, v44, v45
  v_cvt_pk_bf16_f32 v219, v46, v47
  global_store_dwordx4 v8, v[216:219], s[62:63] offset:2048 sc1
  v_cvt_pk_bf16_f32 v220, v48, v49
  v_cvt_pk_bf16_f32 v221, v50, v51
  v_cvt_pk_bf16_f32 v222, v52, v53
  v_cvt_pk_bf16_f32 v223, v54, v55
  global_store_dwordx4 v8, v[220:223], s[62:63] offset:3072 sc1
  v_cvt_pk_bf16_f32 v208, v56, v57
  v_cvt_pk_bf16_f32 v209, v58, v59
  v_cvt_pk_bf16_f32 v210, v60, v61
  v_cvt_pk_bf16_f32 v211, v62, v63
  global_store_dwordx4 v9, v[208:211], s[62:63] offset:0 sc1
  v_cvt_pk_bf16_f32 v212, v64, v65
  v_cvt_pk_bf16_f32 v213, v66, v67
  v_cvt_pk_bf16_f32 v214, v68, v69
  v_cvt_pk_bf16_f32 v215, v70, v71
  global_store_dwordx4 v9, v[212:215], s[62:63] offset:1024 sc1
  v_cvt_pk_bf16_f32 v216, v72, v73
  v_cvt_pk_bf16_f32 v217, v74, v75
  v_cvt_pk_bf16_f32 v218, v76, v77
  v_cvt_pk_bf16_f32 v219, v78, v79
  global_store_dwordx4 v9, v[216:219], s[62:63] offset:2048 sc1
  v_cvt_pk_bf16_f32 v220, v80, v81
  v_cvt_pk_bf16_f32 v221, v82, v83
  v_cvt_pk_bf16_f32 v222, v84, v85
  v_cvt_pk_bf16_f32 v223, v86, v87
  global_store_dwordx4 v9, v[220:223], s[62:63] offset:3072 sc1
  v_cvt_pk_bf16_f32 v208, v88, v89
  v_cvt_pk_bf16_f32 v209, v90, v91
  v_cvt_pk_bf16_f32 v210, v92, v93
  v_cvt_pk_bf16_f32 v211, v94, v95
  global_store_dwordx4 v10, v[208:211], s[62:63] offset:0 sc1
  v_cvt_pk_bf16_f32 v212, v96, v97
  v_cvt_pk_bf16_f32 v213, v98, v99
  v_cvt_pk_bf16_f32 v214, v100, v101
  v_cvt_pk_bf16_f32 v215, v102, v103
  global_store_dwordx4 v10, v[212:215], s[62:63] offset:1024 sc1
  s_waitcnt vmcnt(0)
  s_barrier
  s_cmp_eq_u32 s44, -1
  s_cbranch_scc1 FS_125
  s_cmp_lg_u32 s3, 0
  s_cbranch_scc1 FS_125
  s_lshl_b32 s48, s44, 2
  s_add_u32 s48, s48, s58
  v_mov_b32 v5, s48
  v_mov_b32 v6, 1
  s_mov_b64 exec, 1
  global_store_dword v5, v6, s[4:5] sc1
  s_mov_b64 exec, -1
FS_125:
EG_124:
  s_mov_b32 s47, s46
  s_mov_b32 s46, s44
  s_mov_b32 s44, s52
  s_cmp_lt_u32 s44, 64
  s_cbranch_scc1 UG_loop
UG_fin0:
  s_nop 7
  s_mul_i32 s60, s46, 1310720
  s_add_u32 s60, s60, s57
  s_add_u32 s62, s4, s60
  s_addc_u32 s63, s5, 0
  v_cvt_pk_bf16_f32 v208, v24, v25
  v_cvt_pk_bf16_f32 v209, v26, v27
  v_cvt_pk_bf16_f32 v210, v28, v29
  v_cvt_pk_bf16_f32 v211, v30, v31
  global_store_dwordx4 v8, v[208:211], s[62:63] offset:0 sc1
  v_cvt_pk_bf16_f32 v212, v32, v33
  v_cvt_pk_bf16_f32 v213, v34, v35
  v_cvt_pk_bf16_f32 v214, v36, v37
  v_cvt_pk_bf16_f32 v215, v38, v39
  global_store_dwordx4 v8, v[212:215], s[62:63] offset:1024 sc1
  v_cvt_pk_bf16_f32 v216, v40, v41
  v_cvt_pk_bf16_f32 v217, v42, v43
  v_cvt_pk_bf16_f32 v218, v44, v45
  v_cvt_pk_bf16_f32 v219, v46, v47
  global_store_dwordx4 v8, v[216:219], s[62:63] offset:2048 sc1
  v_cvt_pk_bf16_f32 v220, v48, v49
  v_cvt_pk_bf16_f32 v221, v50, v51
  v_cvt_pk_bf16_f32 v222, v52, v53
  v_cvt_pk_bf16_f32 v223, v54, v55
  global_store_dwordx4 v8, v[220:223], s[62:63] offset:3072 sc1
  v_cvt_pk_bf16_f32 v208, v56, v57
  v_cvt_pk_bf16_f32 v209, v58, v59
  v_cvt_pk_bf16_f32 v210, v60, v61
  v_cvt_pk_bf16_f32 v211, v62, v63
  global_store_dwordx4 v9, v[208:211], s[62:63] offset:0 sc1
  v_cvt_pk_bf16_f32 v212, v64, v65
  v_cvt_pk_bf16_f32 v213, v66, v67
  v_cvt_pk_bf16_f32 v214, v68, v69
  v_cvt_pk_bf16_f32 v215, v70, v71
  global_store_dwordx4 v9, v[212:215], s[62:63] offset:1024 sc1
  v_cvt_pk_bf16_f32 v216, v72, v73
  v_cvt_pk_bf16_f32 v217, v74, v75
  v_cvt_pk_bf16_f32 v218, v76, v77
  v_cvt_pk_bf16_f32 v219, v78, v79
  global_store_dwordx4 v9, v[216:219], s[62:63] offset:2048 sc1
  v_cvt_pk_bf16_f32 v220, v80, v81
  v_cvt_pk_bf16_f32 v221, v82, v83
  v_cvt_pk_bf16_f32 v222, v84, v85
  v_cvt_pk_bf16_f32 v223, v86, v87
  global_store_dwordx4 v9, v[220:223], s[62:63] offset:3072 sc1
  v_cvt_pk_bf16_f32 v208, v88, v89
  v_cvt_pk_bf16_f32 v209, v90, v91
  v_cvt_pk_bf16_f32 v210, v92, v93
  v_cvt_pk_bf16_f32 v211, v94, v95
  global_store_dwordx4 v10, v[208:211], s[62:63] offset:0 sc1
  v_cvt_pk_bf16_f32 v212, v96, v97
  v_cvt_pk_bf16_f32 v213, v98, v99
  v_cvt_pk_bf16_f32 v214, v100, v101
  v_cvt_pk_bf16_f32 v215, v102, v103
  global_store_dwordx4 v10, v[212:215], s[62:63] offset:1024 sc1
  s_branch UG_tail
UG_fin1:
  s_nop 7
  s_mul_i32 s60, s46, 1310720
  s_add_u32 s60, s60, s57
  s_add_u32 s62, s4, s60
  s_addc_u32 s63, s5, 0
  v_cvt_pk_bf16_f32 v208, v104, v105
  v_cvt_pk_bf16_f32 v209, v106, v107
  v_cvt_pk_bf16_f32 v210, v108, v109
  v_cvt_pk_bf16_f32 v211, v110, v111
  global_store_dwordx4 v8, v[208:211], s[62:63] offset:0 sc1
  v_cvt_pk_bf16_f32 v212, v112, v113
  v_cvt_pk_bf16_f32 v213, v114, v115
  v_cvt_pk_bf16_f32 v214, v116, v117
  v_cvt_pk_bf16_f32 v215, v118, v119
  global_store_dwordx4 v8, v[212:215], s[62:63] offset:1024 sc1
  v_cvt_pk_bf16_f32 v216, v120, v121
  v_cvt_pk_bf16_f32 v217, v122, v123
  v_cvt_pk_bf16_f32 v218, v124, v125
  v_cvt_pk_bf16_f32 v219, v126, v127
  global_store_dwordx4 v8, v[216:219], s[62:63] offset:2048 sc1
  v_cvt_pk_bf16_f32 v220, v128, v129
  v_cvt_pk_bf16_f32 v221, v130, v131
  v_cvt_pk_bf16_f32 v222, v132, v133
  v_cvt_pk_bf16_f32 v223, v134, v135
  global_store_dwordx4 v8, v[220:223], s[62:63] offset:3072 sc1
  v_cvt_pk_bf16_f32 v208, v136, v137
  v_cvt_pk_bf16_f32 v209, v138, v139
  v_cvt_pk_bf16_f32 v210, v140, v141
  v_cvt_pk_bf16_f32 v211, v142, v143
  global_store_dwordx4 v9, v[208:211], s[62:63] offset:0 sc1
  v_cvt_pk_bf16_f32 v212, v144, v145
  v_cvt_pk_bf16_f32 v213, v146, v147
  v_cvt_pk_bf16_f32 v214, v148, v149
  v_cvt_pk_bf16_f32 v215, v150, v151
  global_store_dwordx4 v9, v[212:215], s[62:63] offset:1024 sc1
  v_cvt_pk_bf16_f32 v216, v152, v153
  v_cvt_pk_bf16_f32 v217, v154, v155
  v_cvt_pk_bf16_f32 v218, v156, v157
  v_cvt_pk_bf16_f32 v219, v158, v159
  global_store_dwordx4 v9, v[216:219], s[62:63] offset:2048 sc1
  v_cvt_pk_bf16_f32 v220, v160, v161
  v_cvt_pk_bf16_f32 v221, v162, v163
  v_cvt_pk_bf16_f32 v222, v164, v165
  v_cvt_pk_bf16_f32 v223, v166, v167
  global_store_dwordx4 v9, v[220:223], s[62:63] offset:3072 sc1
  v_cvt_pk_bf16_f32 v208, v168, v169
  v_cvt_pk_bf16_f32 v209, v170, v171
  v_cvt_pk_bf16_f32 v210, v172, v173
  v_cvt_pk_bf16_f32 v211, v174, v175
  global_store_dwordx4 v10, v[208:211], s[62:63] offset:0 sc1
  v_cvt_pk_bf16_f32 v212, v176, v177
  v_cvt_pk_bf16_f32 v213, v178, v179
  v_cvt_pk_bf16_f32 v214, v180, v181
  v_cvt_pk_bf16_f32 v215, v182, v183
  global_store_dwordx4 v10, v[212:215], s[62:63] offset:1024 sc1
UG_tail:
  s_waitcnt vmcnt(0)
  s_barrier
  s_cmp_eq_u32 s47, -1
  s_cbranch_scc1 FS_126
  s_cmp_lg_u32 s3, 0
  s_cbranch_scc1 FS_126
  s_lshl_b32 s48, s47, 2
  s_add_u32 s48, s48, s58
  v_mov_b32 v5, s48
  v_mov_b32 v6, 1
  s_mov_b64 exec, 1
  global_store_dword v5, v6, s[4:5] sc1
  s_mov_b64 exec, -1
FS_126:
  s_cmp_eq_u32 s46, -1
  s_cbranch_scc1 FS_127
  s_cmp_lg_u32 s3, 0
  s_cbranch_scc1 FS_127
  s_lshl_b32 s48, s46, 2
  s_add_u32 s48, s48, s58
  v_mov_b32 v5, s48
  v_mov_b32 v6, 1
  s_mov_b64 exec, 1
  global_store_dword v5, v6, s[4:5] sc1
  s_mov_b64 exec, -1
FS_127:
UG_end:
K2_ffn:
  s_cmp_ge_u32 s40, 120
  s_cbranch_scc1 FFN1_end
  s_load_dwordx4 s[8:11], s[0:1], 64
  s_mul_i32 s44, s40, 5462
  s_lshr_b32 s44, s44, 16
  s_mul_i32 s48, s44, 12
  s_sub_u32 s42, s40, s48
  v_add_u32 v20, 0, v0
  v_lshrrev_b32 v21, 4, v20
  v_and_b32 v22, 15, v20
  v_and_b32 v23, 7, v21
  v_lshlrev_b32 v23, 1, v23
  v_xor_b32 v22, v22, v23
  s_mov_b32 s90, 3072
  v_mul_lo_u32 v21, v21, s90
  v_lshl_add_u32 v8, v22, 4, v21
  v_add_u32 v20, 256, v0
  v_lshrrev_b32 v21, 4, v20
  v_and_b32 v22, 15, v20
  v_and_b32 v23, 7, v21
  v_lshlrev_b32 v23, 1, v23
  v_xor_b32 v22, v22, v23
  s_mov_b32 s90, 3072
  v_mul_lo_u32 v21, v21, s90
  v_lshl_add_u32 v9, v22, 4, v21
  s_mov_b32 s91, 256
  s_lshl_b32 s56, s3, 1
  v_lshrrev_b32 v20, 2, v1
  v_and_b32 v21, 7, v20
  v_xor_b32 v21, s56, v21
  v_lshlrev_b32 v21, 5, v21
  v_mad_u32_u24 v21, v20, s91, v21
  v_and_b32 v20, 3, v1
  v_lshl_add_u32 v12, v20, 3, v21
  s_add_u32 s56, s56, 1
  v_lshrrev_b32 v20, 2, v1
  v_and_b32 v21, 7, v20
  v_xor_b32 v21, s56, v21
  v_lshlrev_b32 v21, 5, v21
  v_mad_u32_u24 v21, v20, s91, v21
  v_and_b32 v20, 3, v1
  v_lshl_add_u32 v13, v20, 3, v21
  s_waitcnt lgkmcnt(0)
  s_lshl_b32 s48, s42, 8
  s_add_u32 s8, s8, s48
  s_addc_u32 s9, s9, 0
  s_add_u32 s10, s10, s48
  s_addc_u32 s11, s11, 0
  s_lshl_b32 s92, s3, 10
  s_add_u32 m0, s92, 0
  s_nop 0
  global_load_lds_dwordx4 v8, s[8:9]
  s_add_u32 m0, s92, 4096
  s_nop 0
  global_load_lds_dwordx4 v9, s[8:9]
  s_add_u32 s8, s8, 98304
  s_addc_u32 s9, s9, 0
  s_add_u32 m0, s92, 8192
  s_nop 0
  global_load_lds_dwordx4 v8, s[10:11]
  s_add_u32 m0, s92, 12288
  s_nop 0
  global_load_lds_dwordx4 v9, s[10:11]
  s_add_u32 s10, s10, 98304
  s_addc_u32 s11, s11, 0
  s_add_u32 m0, s92, 16384
  s_nop 0
  global_load_lds_dwordx4 v8, s[8:9]
  s_add_u32 m0, s92, 20480
  s_nop 0
  global_load_lds_dwordx4 v9, s[8:9]
  s_add_u32 s8, s8, 98304
  s_addc_u32 s9, s9, 0
  s_add_u32 m0, s92, 24576
  s_nop 0
  global_load_lds_dwordx4 v8, s[10:11]
  s_add_u32 m0, s92, 28672
  s_nop 0
  global_load_lds_dwordx4 v9, s[10:11]
  s_add_u32 s10, s10, 98304
  s_addc_u32 s11, s11, 0
  s_add_u32 m0, s92, 32768
  s_nop 0
  global_load_lds_dwordx4 v8, s[8:9]
  s_add_u32 m0, s92, 36864
  s_nop 0
  global_load_lds_dwordx4 v9, s[8:9]
  s_add_u32 s8, s8, 98304
  s_addc_u32 s9, s9, 0
  s_add_u32 m0, s92, 40960
  s_nop 0
  global_load_lds_dwordx4 v8, s[10:11]
  s_add_u32 m0, s92, 45056
  s_nop 0
  global_load_lds_dwordx4 v9, s[10:11]
  s_add_u32 s10, s10, 98304
  s_addc_u32 s11, s11, 0
  s_add_u32 m0, s92, 49152
  s_nop 0
  global_load_lds_dwordx4 v8, s[8:9]
  s_add_u32 m0, s92, 53248
  s_nop 0
  global_load_lds_dwordx4 v9, s[8:9]
  s_add_u32 s8, s8, 98304
  s_addc_u32 s9, s9, 0
  s_add_u32 m0, s92, 57344
  s_nop 0
  global_load_lds_dwordx4 v8, s[10:11]
  s_add_u32 m0, s92, 61440
  s_nop 0
  global_load_lds_dwordx4 v9, s[10:11]
  s_add_u32 s10, s10, 98304
  s_addc_u32 s11, s11, 0
  s_add_u32 m0, s92, 65536
  s_nop 0
  global_load_lds_dwordx4 v8, s[8:9]
  s_add_u32 m0, s92, 69632
  s_nop 0
  global_load_lds_dwordx4 v9, s[8:9]
  s_add_u32 s8, s8, 98304
  s_addc_u32 s9, s9, 0
  s_add_u32 m0, s92, 73728
  s_nop 0
  global_load_lds_dwordx4 v8, s[10:11]
  s_add_u32 m0, s92, 77824
  s_nop 0
  global_load_lds_dwordx4 v9, s[10:11]
  s_add_u32 s10, s10, 98304
  s_addc_u32 s11, s11, 0
  s_add_u32 m0, s92, 81920
  s_nop 0
  global_load_lds_dwordx4 v8, s[8:9]
  s_add_u32 m0, s92, 86016
  s_nop 0
  global_load_lds_dwordx4 v9, s[8:9]
  s_add_u32 s8, s8, 98304
  s_addc_u32 s9, s9, 0
  s_add_u32 m0, s92, 90112
  s_nop 0
  global_load_lds_dwordx4 v8, s[10:11]
  s_add_u32 m0, s92, 94208
  s_nop 0
  global_load_lds_dwordx4 v9, s[10:11]
  s_add_u32 s10, s10, 98304
  s_addc_u32 s11, s11, 0
  s_add_u32 m0, s92, 98304
  s_nop 0
  global_load_lds_dwordx4 v8, s[8:9]
  s_add_u32 m0, s92, 102400
  s_nop 0
  global_load_lds_dwordx4 v9, s[8:9]
  s_add_u32 s8, s8, 98304
  s_addc_u32 s9, s9, 0
  s_add_u32 m0, s92, 106496
  s_nop 0
  global_load_lds_dwordx4 v8, s[10:11]
  s_add_u32 m0, s92, 110592
  s_nop 0
  global_load_lds_dwordx4 v9, s[10:11]
  s_add_u32 s10, s10, 98304
  s_addc_u32 s11, s11, 0
  s_add_u32 m0, s92, 114688
  s_nop 0
  global_load_lds_dwordx4 v8, s[8:9]
  s_add_u32 m0, s92, 118784
  s_nop 0
  global_load_lds_dwordx4 v9, s[8:9]
  s_add_u32 s8, s8, 98304
  s_addc_u32 s9, s9, 0
  s_add_u32 m0, s92, 122880
  s_nop 0
  global_load_lds_dwordx4 v8, s[10:11]
  s_add_u32 m0, s92, 126976
  s_nop 0
  global_load_lds_dwordx4 v9, s[10:11]
  s_add_u32 s10, s10, 98304
  s_addc_u32 s11, s11, 0
  s_add_u32 m0, s92, 131072
  s_nop 0
  global_load_lds_dwordx4 v8, s[8:9]
  s_add_u32 m0, s92, 135168
  s_nop 0
  global_load_lds_dwordx4 v9, s[8:9]
  s_add_u32 s8, s8, 98304
  s_addc_u32 s9, s9, 0
  s_add_u32 m0, s92, 139264
  s_nop 0
  global_load_lds_dwordx4 v8, s[10:11]
  s_add_u32 m0, s92, 143360
  s_nop 0
  global_load_lds_dwordx4 v9, s[10:11]
  s_add_u32 s10, s10, 98304
  s_addc_u32 s11, s11, 0
  s_add_u32 m0, s92, 147456
  s_nop 0
  global_load_lds_dwordx4 v8, s[8:9]
  s_add_u32 m0, s92, 151552
  s_nop 0
  global_load_lds_dwordx4 v9, s[8:9]
  s_add_u32 s8, s8, 98304
  s_addc_u32 s9, s9, 0
  s_add_u32 m0, s92, 155648
  s_nop 0
  global_load_lds_dwordx4 v8, s[10:11]
  s_add_u32 m0, s92, 159744
  s_nop 0
  global_load_lds_dwordx4 v9, s[10:11]
  s_add_u32 s10, s10, 98304
  s_addc_u32 s11, s11, 0
  s_waitcnt vmcnt(36)
  s_waitcnt lgkmcnt(0)
  s_barrier
  v_add_u32 v16, 0, v12
  ds_read_b64_tr_b16 v[192:193], v16
  ds_read_b64_tr_b16 v[194:195], v16 offset:4096
  v_add_u32 v17, 0, v13
  ds_read_b64_tr_b16 a[16:17], v17
  ds_read_b64_tr_b16 a[18:19], v17 offset:4096
  v_add_u32 v18, 8192, v12
  ds_read_b64_tr_b16 a[96:97], v18
  ds_read_b64_tr_b16 a[98:99], v18 offset:4096
  v_add_u32 v19, 8192, v13
  ds_read_b64_tr_b16 a[176:177], v19
  ds_read_b64_tr_b16 a[178:179], v19 offset:4096
  s_waitcnt vmcnt(32)
  s_waitcnt lgkmcnt(0)
  s_barrier
  s_add_u32 m0, s92, 0
  s_nop 0
  global_load_lds_dwordx4 v8, s[8:9]
  s_add_u32 m0, s92, 4096
  s_nop 0
  global_load_lds_dwordx4 v9, s[8:9]
  s_add_u32 s8, s8, 98304
  s_addc_u32 s9, s9, 0
  s_add_u32 m0, s92, 8192
  s_nop 0
  global_load_lds_dwordx4 v8, s[10:11]
  s_add_u32 m0, s92, 12288
  s_nop 0
  global_load_lds_dwordx4 v9, s[10:11]
  s_add_u32 s10, s10, 98304
  s_addc_u32 s11, s11, 0
  v_add_u32 v16, 16384, v12
  ds_read_b64_tr_b16 v[196:197], v16
  ds_read_b64_tr_b16 v[198:199], v16 offset:4096
  v_add_u32 v17, 16384, v13
  ds_read_b64_tr_b16 a[20:21], v17
  ds_read_b64_tr_b16 a[22:23], v17 offset:4096
  v_add_u32 v18, 24576, v12
  ds_read_b64_tr_b16 a[100:101], v18
  ds_read_b64_tr_b16 a[102:103], v18 offset:4096
  v_add_u32 v19, 24576, v13
  ds_read_b64_tr_b16 a[180:181], v19
  ds_read_b64_tr_b16 a[182:183], v19 offset:4096
  s_waitcnt vmcnt(32)
  s_waitcnt lgkmcnt(0)
  s_barrier
  s_add_u32 m0, s92, 16384
  s_nop 0
  global_load_lds_dwordx4 v8, s[8:9]
  s_add_u32 m0, s92, 20480
  s_nop 0
  global_load_lds_dwordx4 v9, s[8:9]
  s_add_u32 s8, s8, 98304
  s_addc_u32 s9, s9, 0
  s_add_u32 m0, s92, 24576
  s_nop 0
  global_load_lds_dwordx4 v8, s[10:11]
  s_add_u32 m0, s92, 28672
  s_nop 0
  global_load_lds_dwordx4 v9, s[10:11]
  s_add_u32 s10, s10, 98304
  s_addc_u32 s11, s11, 0
  v_add_u32 v16, 32768, v12
  ds_read_b64_tr_b16 v[200:201], v16
  ds_read_b64_tr_b16 v[202:203], v16 offset:4096
  v_add_u32 v17, 32768, v13
  ds_read_b64_tr_b16 a[24:25], v17
  ds_read_b64_tr_b16 a[26:27], v17 offset:4096
  v_add_u32 v18, 40960, v12
  ds_read_b64_tr_b16 a[104:105], v18
  ds_read_b64_tr_b16 a[106:107], v18 offset:4096
  v_add_u32 v19, 40960, v13
  ds_read_b64_tr_b16 a[184:185], v19
  ds_read_b64_tr_b16 a[186:187], v19 offset:4096
  s_waitcnt vmcnt(32)
  s_waitcnt lgkmcnt(0)
  s_barrier
  s_add_u32 m0, s92, 32768
  s_nop 0
  global_load_lds_dwordx4 v8, s[8:9]
  s_add_u32 m0, s92, 36864
  s_nop 0
  global_load_lds_dwordx4 v9, s[8:9]
  s_add_u32 s8, s8, 98304
  s_addc_u32 s9, s9, 0
  s_add_u32 m0, s92, 40960
  s_nop 0
  global_load_lds_dwordx4 v8, s[10:11]
  s_add_u32 m0, s92, 45056
  s_nop 0
  global_load_lds_dwordx4 v9, s[10:11]
  s_add_u32 s10, s10, 98304
  s_addc_u32 s11, s11, 0
  v_add_u32 v16, 49152, v12
  ds_read_b64_tr_b16 v[204:205], v16
  ds_read_b64_tr_b16 v[206:207], v16 offset:4096
  v_add_u32 v17, 49152, v13
  ds_read_b64_tr_b16 a[28:29], v17
  ds_read_b64_tr_b16 a[30:31], v17 offset:4096
  v_add_u32 v18, 57344, v12
  ds_read_b64_tr_b16 a[108:109], v18
  ds_read_b64_tr_b16 a[110:111], v18 offset:4096
  v_add_u32 v19, 57344, v13
  ds_read_b64_tr_b16 a[188:189], v19
  ds_read_b64_tr_b16 a[190:191], v19 offset:4096
  s_waitcnt vmcnt(32)
  s_waitcnt lgkmcnt(0)
  s_barrier
  s_add_u32 m0, s92, 49152
  s_nop 0
  global_load_lds_dwordx4 v8, s[8:9]
  s_add_u32 m0, s92, 53248
  s_nop 0
  global_load_lds_dwordx4 v9, s[8:9]
  s_add_u32 s8, s8, 98304
  s_addc_u32 s9, s9, 0
  s_add_u32 m0, s92, 57344
  s_nop 0
  global_load_lds_dwordx4 v8, s[10:11]
  s_add_u32 m0, s92, 61440
  s_nop 0
  global_load_lds_dwordx4 v9, s[10:11]
  s_add_u32 s10, s10, 98304
  s_addc_u32 s11, s11, 0
  v_add_u32 v16, 65536, v12
  ds_read_b64_tr_b16 v[208:209], v16
  ds_read_b64_tr_b16 v[210:211], v16 offset:4096
  v_add_u32 v17, 65536, v13
  ds_read_b64_tr_b16 a[32:33], v17
  ds_read_b64_tr_b16 a[34:35], v17 offset:4096
  v_add_u32 v18, 73728, v12
  ds_read_b64_tr_b16 a[112:113], v18
  ds_read_b64_tr_b16 a[114:115], v18 offset:4096
  v_add_u32 v19, 73728, v13
  ds_read_b64_tr_b16 a[192:193], v19
  ds_read_b64_tr_b16 a[194:195], v19 offset:4096
  s_waitcnt vmcnt(32)
  s_waitcnt lgkmcnt(0)
  s_barrier
  s_add_u32 m0, s92, 65536
  s_nop 0
  global_load_lds_dwordx4 v8, s[8:9]
  s_add_u32 m0, s92, 69632
  s_nop 0
  global_load_lds_dwordx4 v9, s[8:9]
  s_add_u32 s8, s8, 98304
  s_addc_u32 s9, s9, 0
  s_add_u32 m0, s92, 73728
  s_nop 0
  global_load_lds_dwordx4 v8, s[10:11]
  s_add_u32 m0, s92, 77824
  s_nop 0
  global_load_lds_dwordx4 v9, s[10:11]
  s_add_u32 s10, s10, 98304
  s_addc_u32 s11, s11, 0
  v_add_u32 v16, 81920, v12
  ds_read_b64_tr_b16 v[212:213], v16
  ds_read_b64_tr_b16 v[214:215], v16 offset:4096
  v_add_u32 v17, 81920, v13
  ds_read_b64_tr_b16 a[36:37], v17
  ds_read_b64_tr_b16 a[38:39], v17 offset:4096
  v_add_u32 v18, 90112, v12
  ds_read_b64_tr_b16 a[116:117], v18
  ds_read_b64_tr_b16 a[118:119], v18 offset:4096
  v_add_u32 v19, 90112, v13
  ds_read_b64_tr_b16 a[196:197], v19
  ds_read_b64_tr_b16 a[198:199], v19 offset:4096
  s_waitcnt vmcnt(32)
  s_waitcnt lgkmcnt(0)
  s_barrier
  s_add_u32 m0, s92, 81920
  s_nop 0
  global_load_lds_dwordx4 v8, s[8:9]
  s_add_u32 m0, s92, 86016
  s_nop 0
  global_load_lds_dwordx4 v9, s[8:9]
  s_add_u32 s8, s8, 98304
  s_addc_u32 s9, s9, 0
  s_add_u32 m0, s92, 90112
  s_nop 0
  global_load_lds_dwordx4 v8, s[10:11]
  s_add_u32 m0, s92, 94208
  s_nop 0
  global_load_lds_dwordx4 v9, s[10:11]
  s_add_u32 s10, s10, 98304
  s_addc_u32 s11, s11, 0
  v_add_u32 v16, 98304, v12
  ds_read_b64_tr_b16 v[216:217], v16
  ds_read_b64_tr_b16 v[218:219], v16 offset:4096
  v_add_u32 v17, 98304, v13
  ds_read_b64_tr_b16 a[40:41], v17
  ds_read_b64_tr_b16 a[42:43], v17 offset:4096
  v_add_u32 v18, 106496, v12
  ds_read_b64_tr_b16 a[120:121], v18
  ds_read_b64_tr_b16 a[122:123], v18 offset:4096
  v_add_u32 v19, 106496, v13
  ds_read_b64_tr_b16 a[200:201], v19
  ds_read_b64_tr_b16 a[202:203], v19 offset:4096
  s_waitcnt vmcnt(32)
  s_waitcnt lgkmcnt(0)
  s_barrier
  s_add_u32 m0, s92, 98304
  s_nop 0
  global_load_lds_dwordx4 v8, s[8:9]
  s_add_u32 m0, s92, 102400
  s_nop 0
  global_load_lds_dwordx4 v9, s[8:9]
  s_add_u32 s8, s8, 98304
  s_addc_u32 s9, s9, 0
  s_add_u32 m0, s92, 106496
  s_nop 0
  global_load_lds_dwordx4 v8, s[10:11]
  s_add_u32 m0, s92, 110592
  s_nop 0
  global_load_lds_dwordx4 v9, s[10:11]
  s_add_u32 s10, s10, 98304
  s_addc_u32 s11, s11, 0
  v_add_u32 v16, 114688, v12
  ds_read_b64_tr_b16 v[220:221], v16
  ds_read_b64_tr_b16 v[222:223], v16 offset:4096
  v_add_u32 v17, 114688, v13
  ds_read_b64_tr_b16 a[44:45], v17
  ds_read_b64_tr_b16 a[46:47], v17 offset:4096
  v_add_u32 v18, 122880, v12
  ds_read_b64_tr_b16 a[124:125], v18
  ds_read_b64_tr_b16 a[126:127], v18 offset:4096
  v_add_u32 v19, 122880, v13
  ds_read_b64_tr_b16 a[204:205], v19
  ds_read_b64_tr_b16 a[206:207], v19 offset:4096
  s_waitcnt vmcnt(32)
  s_waitcnt lgkmcnt(0)
  s_barrier
  s_add_u32 m0, s92, 114688
  s_nop 0
  global_load_lds_dwordx4 v8, s[8:9]
  s_add_u32 m0, s92, 118784
  s_nop 0
  global_load_lds_dwordx4 v9, s[8:9]
  s_add_u32 s8, s8, 98304
  s_addc_u32 s9, s9, 0
  s_add_u32 m0, s92, 122880
  s_nop 0
  global_load_lds_dwordx4 v8, s[10:11]
  s_add_u32 m0, s92, 126976
  s_nop 0
  global_load_lds_dwordx4 v9, s[10:11]
  s_add_u32 s10, s10, 98304
  s_addc_u32 s11, s11, 0
  v_add_u32 v16, 131072, v12
  ds_read_b64_tr_b16 v[224:225], v16
  ds_read_b64_tr_b16 v[226:227], v16 offset:4096
  v_add_u32 v17, 131072, v13
  ds_read_b64_tr_b16 a[48:49], v17
  ds_read_b64_tr_b16 a[50:51], v17 offset:4096
  v_add_u32 v18, 139264, v12
  ds_read_b64_tr_b16 a[128:129], v18
  ds_read_b64_tr_b16 a[130:131], v18 offset:4096
  v_add_u32 v19, 139264, v13
  ds_read_b64_tr_b16 a[208:209], v19
  ds_read_b64_tr_b16 a[210:211], v19 offset:4096
  s_waitcnt vmcnt(32)
  s_waitcnt lgkmcnt(0)
  s_barrier
  s_add_u32 m0, s92, 131072
  s_nop 0
  global_load_lds_dwordx4 v8, s[8:9]
  s_add_u32 m0, s92, 135168
  s_nop 0
  global_load_lds_dwordx4 v9, s[8:9]
  s_add_u32 s8, s8, 98304
  s_addc_u32 s9, s9, 0
  s_add_u32 m0, s92, 139264
  s_nop 0
  global_load_lds_dwordx4 v8, s[10:11]
  s_add_u32 m0, s92, 143360
  s_nop 0
  global_load_lds_dwordx4 v9, s[10:11]
  s_add_u32 s10, s10, 98304
  s_addc_u32 s11, s11, 0
  v_add_u32 v16, 147456, v12
  ds_read_b64_tr_b16 v[228:229], v16
  ds_read_b64_tr_b16 v[230:231], v16 offset:4096
  v_add_u32 v17, 147456, v13
  ds_read_b64_tr_b16 a[52:53], v17
  ds_read_b64_tr_b16 a[54:55], v17 offset:4096
  v_add_u32 v18, 155648, v12
  ds_read_b64_tr_b16 a[132:133], v18
  ds_read_b64_tr_b16 a[134:135], v18 offset:4096
  v_add_u32 v19, 155648, v13
  ds_read_b64_tr_b16 a[212:213], v19
  ds_read_b64_tr_b16 a[214:215], v19 offset:4096
  s_waitcnt vmcnt(32)
  s_waitcnt lgkmcnt(0)
  s_barrier
  s_add_u32 m0, s92, 147456
  s_nop 0
  global_load_lds_dwordx4 v8, s[8:9]
  s_add_u32 m0, s92, 151552
  s_nop 0
  global_load_lds_dwordx4 v9, s[8:9]
  s_add_u32 s8, s8, 98304
  s_addc_u32 s9, s9, 0
  s_add_u32 m0, s92, 155648
  s_nop 0
  global_load_lds_dwordx4 v8, s[10:11]
  s_add_u32 m0, s92, 159744
  s_nop 0
  global_load_lds_dwordx4 v9, s[10:11]
  s_add_u32 s10, s10, 98304
  s_addc_u32 s11, s11, 0
  v_add_u32 v16, 0, v12
  ds_read_b64_tr_b16 v[232:233], v16
  ds_read_b64_tr_b16 v[234:235], v16 offset:4096
  v_add_u32 v17, 0, v13
  ds_read_b64_tr_b16 a[56:57], v17
  ds_read_b64_tr_b16 a[58:59], v17 offset:4096
  v_add_u32 v18, 8192, v12
  ds_read_b64_tr_b16 a[136:137], v18
  ds_read_b64_tr_b16 a[138:139], v18 offset:4096
  v_add_u32 v19, 8192, v13
  ds_read_b64_tr_b16 a[216:217], v19
  ds_read_b64_tr_b16 a[218:219], v19 offset:4096
  s_waitcnt vmcnt(32)
  s_waitcnt lgkmcnt(0)
  s_barrier
  v_add_u32 v16, 16384, v12
  ds_read_b64_tr_b16 v[236:237], v16
  ds_read_b64_tr_b16 v[238:239], v16 offset:4096
  v_add_u32 v17, 16384, v13
  ds_read_b64_tr_b16 a[60:61], v17
  ds_read_b64_tr_b16 a[62:63], v17 offset:4096
  v_add_u32 v18, 24576, v12
  ds_read_b64_tr_b16 a[140:141], v18
  ds_read_b64_tr_b16 a[142:143], v18 offset:4096
  v_add_u32 v19, 24576, v13
  ds_read_b64_tr_b16 a[220:221], v19
  ds_read_b64_tr_b16 a[222:223], v19 offset:4096
  s_waitcnt vmcnt(28)
  s_waitcnt lgkmcnt(0)
  s_barrier
  v_add_u32 v16, 32768, v12
  ds_read_b64_tr_b16 v[240:241], v16
  ds_read_b64_tr_b16 v[242:243], v16 offset:4096
  v_add_u32 v17, 32768, v13
  ds_read_b64_tr_b16 a[64:65], v17
  ds_read_b64_tr_b16 a[66:67], v17 offset:4096
  v_add_u32 v18, 40960, v12
  ds_read_b64_tr_b16 a[144:145], v18
  ds_read_b64_tr_b16 a[146:147], v18 offset:4096
  v_add_u32 v19, 40960, v13
  ds_read_b64_tr_b16 a[224:225], v19
  ds_read_b64_tr_b16 a[226:227], v19 offset:4096
  s_waitcnt vmcnt(24)
  s_waitcnt lgkmcnt(0)
  s_barrier
  v_add_u32 v16, 49152, v12
  ds_read_b64_tr_b16 v[244:245], v16
  ds_read_b64_tr_b16 v[246:247], v16 offset:4096
  v_add_u32 v17, 49152, v13
  ds_read_b64_tr_b16 a[68:69], v17
  ds_read_b64_tr_b16 a[70:71], v17 offset:4096
  v_add_u32 v18, 57344, v12
  ds_read_b64_tr_b16 a[148:149], v18
  ds_read_b64_tr_b16 a[150:151], v18 offset:4096
  v_add_u32 v19, 57344, v13
  ds_read_b64_tr_b16 a[228:229], v19
  ds_read_b64_tr_b16 a[230:231], v19 offset:4096
  s_waitcnt vmcnt(20)
  s_waitcnt lgkmcnt(0)
  s_barrier
  v_add_u32 v16, 65536, v12
  ds_read_b64_tr_b16 v[248:249], v16
  ds_read_b64_tr_b16 v[250:251], v16 offset:4096
  v_add_u32 v17, 65536, v13
  ds_read_b64_tr_b16 a[72:73], v17
  ds_read_b64_tr_b16 a[74:75], v17 offset:4096
  v_add_u32 v18, 73728, v12
  ds_read_b64_tr_b16 a[152:153], v18
  ds_read_b64_tr_b16 a[154:155], v18 offset:4096
  v_add_u32 v19, 73728, v13
  ds_read_b64_tr_b16 a[232:233], v19
  ds_read_b64_tr_b16 a[234:235], v19 offset:4096
  s_waitcnt vmcnt(16)
  s_waitcnt lgkmcnt(0)
  s_barrier
  v_add_u32 v16, 81920, v12
  ds_read_b64_tr_b16 v[252:253], v16
  ds_read_b64_tr_b16 v[254:255], v16 offset:4096
  v_add_u32 v17, 81920, v13
  ds_read_b64_tr_b16 a[76:77], v17
  ds_read_b64_tr_b16 a[78:79], v17 offset:4096
  v_add_u32 v18, 90112, v12
  ds_read_b64_tr_b16 a[156:157], v18
  ds_read_b64_tr_b16 a[158:159], v18 offset:4096
  v_add_u32 v19, 90112, v13
  ds_read_b64_tr_b16 a[236:237], v19
  ds_read_b64_tr_b16 a[238:239], v19 offset:4096
  s_waitcnt vmcnt(12)
  s_waitcnt lgkmcnt(0)
  s_barrier
  v_add_u32 v16, 98304, v12
  ds_read_b64_tr_b16 a[0:1], v16
  ds_read_b64_tr_b16 a[2:3], v16 offset:4096
  v_add_u32 v17, 98304, v13
  ds_read_b64_tr_b16 a[80:81], v17
  ds_read_b64_tr_b16 a[82:83], v17 offset:4096
  v_add_u32 v18, 106496, v12
  ds_read_b64_tr_b16 a[160:161], v18
  ds_read_b64_tr_b16 a[162:163], v18 offset:4096
  v_add_u32 v19, 106496, v13
  ds_read_b64_tr_b16 a[240:241], v19
  ds_read_b64_tr_b16 a[242:243], v19 offset:4096
  s_waitcnt vmcnt(8)
  s_waitcnt lgkmcnt(0)
  s_barrier
  v_add_u32 v16, 114688, v12
  ds_read_b64_tr_b16 a[4:5], v16
  ds_read_b64_tr_b16 a[6:7], v16 offset:4096
  v_add_u32 v17, 114688, v13
  ds_read_b64_tr_b16 a[84:85], v17
  ds_read_b64_tr_b16 a[86:87], v17 offset:4096
  v_add_u32 v18, 122880, v12
  ds_read_b64_tr_b16 a[164:165], v18
  ds_read_b64_tr_b16 a[166:167], v18 offset:4096
  v_add_u32 v19, 122880, v13
  ds_read_b64_tr_b16 a[244:245], v19
  ds_read_b64_tr_b16 a[246:247], v19 offset:4096
  s_waitcnt vmcnt(4)
  s_waitcnt lgkmcnt(0)
  s_barrier
  v_add_u32 v16, 131072, v12
  ds_read_b64_tr_b16 a[8:9], v16
  ds_read_b64_tr_b16 a[10:11], v16 offset:4096
  v_add_u32 v17, 131072, v13
  ds_read_b64_tr_b16 a[88:89], v17
  ds_read_b64_tr_b16 a[90:91], v17 offset:4096
  v_add_u32 v18, 139264, v12
  ds_read_b64_tr_b16 a[168:169], v18
  ds_read_b64_tr_b16 a[170:171], v18 offset:4096
  v_add_u32 v19, 139264, v13
  ds_read_b64_tr_b16 a[248:249], v19
  ds_read_b64_tr_b16 a[250:251], v19 offset:4096
  s_waitcnt vmcnt(0)
  s_waitcnt lgkmcnt(0)
  s_barrier
  v_add_u32 v16, 147456, v12
  ds_read_b64_tr_b16 a[12:13], v16
  ds_read_b64_tr_b16 a[14:15], v16 offset:4096
  v_add_u32 v17, 147456, v13
  ds_read_b64_tr_b16 a[92:93], v17
  ds_read_b64_tr_b16 a[94:95], v17 offset:4096
  v_add_u32 v18, 155648, v12
  ds_read_b64_tr_b16 a[172:173], v18
  ds_read_b64_tr_b16 a[174:175], v18 offset:4096
  v_add_u32 v19, 155648, v13
  ds_read_b64_tr_b16 a[252:253], v19
  ds_read_b64_tr_b16 a[254:255], v19 offset:4096
  s_waitcnt lgkmcnt(0)
  s_barrier
  s_lshl_b32 s48, s42, 2
  s_add_u32 s48, s48, s3
  s_lshl_b32 s48, s48, 10
  v_lshlrev_b32 v8, 4, v1
  v_add_u32 v8, s48, v8
  v_add_u32 v9, 49152, v8
  s_lshl_b32 s58, s42, 2
  s_add_u32 s58, s58, 0x1368000
  s_mov_b32 s57, 0xbfb8aa3b
  s_mov_b32 s59, 0x0
  v_lshlrev_b32 v3, 4, v1
  v_add_u32 v7, 40960, v3
  s_mul_i32 s86, s3, 10240
  v_add_u32 v4, s86, v3
  s_mov_b32 s46, -1
  s_mov_b32 s47, -1
  s_cmp_ge_u32 s44, 64
  s_cbranch_scc1 FFN1_end
  s_mul_i32 s48, s44, 40960
  s_add_u32 s48, s48, s59
  s_add_u32 s50, s4, s48
  s_addc_u32 s51, s5, 0
  s_add_u32 m0, s86, 0
  s_nop 0
  global_load_lds_dwordx4 v4, s[50:51] offset:0 sc1
  global_load_lds_dwordx4 v4, s[50:51] offset:1024 sc1
  global_load_lds_dwordx4 v4, s[50:51] offset:2048 sc1
  global_load_lds_dwordx4 v4, s[50:51] offset:3072 sc1
  s_add_u32 s50, s50, 4096
  s_addc_u32 s51, s51, 0
  s_add_u32 m0, s86, 4096
  s_nop 0
  global_load_lds_dwordx4 v4, s[50:51] offset:0 sc1
  global_load_lds_dwordx4 v4, s[50:51] offset:1024 sc1
  global_load_lds_dwordx4 v4, s[50:51] offset:2048 sc1
  global_load_lds_dwordx4 v4, s[50:51] offset:3072 sc1
  s_add_u32 s50, s50, 4096
  s_addc_u32 s51, s51, 0
  s_add_u32 m0, s86, 8192
  s_nop 0
  global_load_lds_dwordx4 v4, s[50:51] offset:0 sc1
  global_load_lds_dwordx4 v4, s[50:51] offset:1024 sc1
  s_waitcnt vmcnt(0)
  s_barrier
  s_add_u32 s52, s44, 10
  s_cmp_ge_u32 s52, 64
  s_cselect_b32 s54, s44, s52
  ds_read_b128 v[96:99], v3 offset:0
  ds_read_b128 v[100:103], v3 offset:1024
  ds_read_b128 v[104:107], v3 offset:2048
  ds_read_b128 v[108:111], v3 offset:3072
  ds_read_b128 v[112:115], v3 offset:4096
  ds_read_b128 v[116:119], v3 offset:5120
  s_waitcnt lgkmcnt(5)
  v_mfma_f32_16x16x32_bf16 v[32:35], v[192:195], v[96:99], 0
  s_mul_i32 s48, s54, 40960
  s_add_u32 s48, s48, s59
  v_mfma_f32_16x16x32_bf16 v[40:43], a[16:19], v[96:99], 0
  s_add_u32 s50, s4, s48
  s_addc_u32 s51, s5, 0
  v_mfma_f32_16x16x32_bf16 v[48:51], a[96:99], v[96:99], 0
  s_add_u32 m0, s86, 40960
  s_nop 0
  v_mfma_f32_16x16x32_bf16 v[56:59], a[176:179], v[96:99], 0
  global_load_lds_dwordx4 v4, s[50:51] offset:0 sc1
  s_waitcnt lgkmcnt(4)
  v_mfma_f32_16x16x32_bf16 v[36:39], v[192:195], v[100:103], 0
  v_mfma_f32_16x16x32_bf16 v[44:47], a[16:19], v[100:103], 0
  v_mfma_f32_16x16x32_bf16 v[52:55], a[96:99], v[100:103], 0
  global_load_lds_dwordx4 v4, s[50:51] offset:1024 sc1
  v_mfma_f32_16x16x32_bf16 v[60:63], a[176:179], v[100:103], 0
  ds_read_b128 v[96:99], v3 offset:6144
  ds_read_b128 v[100:103], v3 offset:7168
  s_waitcnt lgkmcnt(5)
  v_mfma_f32_16x16x32_bf16 v[32:35], v[196:199], v[104:107], v[32:35]
  v_mfma_f32_16x16x32_bf16 v[40:43], a[20:23], v[104:107], v[40:43]
  global_load_lds_dwordx4 v4, s[50:51] offset:2048 sc1
  v_mfma_f32_16x16x32_bf16 v[48:51], a[100:103], v[104:107], v[48:51]
  v_mfma_f32_16x16x32_bf16 v[56:59], a[180:183], v[104:107], v[56:59]
  s_waitcnt lgkmcnt(4)
  v_mfma_f32_16x16x32_bf16 v[36:39], v[196:199], v[108:111], v[36:39]
  global_load_lds_dwordx4 v4, s[50:51] offset:3072 sc1
  v_mfma_f32_16x16x32_bf16 v[44:47], a[20:23], v[108:111], v[44:47]
  v_mfma_f32_16x16x32_bf16 v[52:55], a[100:103], v[108:111], v[52:55]
  v_mfma_f32_16x16x32_bf16 v[60:63], a[180:183], v[108:111], v[60:63]
  s_add_u32 s50, s50, 4096
  s_addc_u32 s51, s51, 0
  ds_read_b128 v[104:107], v3 offset:8192
  ds_read_b128 v[108:111], v3 offset:9216
  s_waitcnt lgkmcnt(5)
  v_mfma_f32_16x16x32_bf16 v[32:35], v[200:203], v[112:115], v[32:35]
  s_add_u32 m0, s86, 45056
  s_nop 0
  v_mfma_f32_16x16x32_bf16 v[40:43], a[24:27], v[112:115], v[40:43]
  global_load_lds_dwordx4 v4, s[50:51] offset:0 sc1
  v_mfma_f32_16x16x32_bf16 v[48:51], a[104:107], v[112:115], v[48:51]
  v_mfma_f32_16x16x32_bf16 v[56:59], a[184:187], v[112:115], v[56:59]
  s_waitcnt lgkmcnt(4)
  v_mfma_f32_16x16x32_bf16 v[36:39], v[200:203], v[116:119], v[36:39]
  global_load_lds_dwordx4 v4, s[50:51] offset:1024 sc1
  v_mfma_f32_16x16x32_bf16 v[44:47], a[24:27], v[116:119], v[44:47]
  v_mfma_f32_16x16x32_bf16 v[52:55], a[104:107], v[116:119], v[52:55]
  v_mfma_f32_16x16x32_bf16 v[60:63], a[184:187], v[116:119], v[60:63]
  global_load_lds_dwordx4 v4, s[50:51] offset:2048 sc1
  ds_read_b128 v[112:115], v3 offset:10240
  ds_read_b128 v[116:119], v3 offset:11264
  s_waitcnt lgkmcnt(5)
  v_mfma_f32_16x16x32_bf16 v[32:35], v[204:207], v[96:99], v[32:35]
  v_mfma_f32_16x16x32_bf16 v[40:43], a[28:31], v[96:99], v[40:43]
  v_mfma_f32_16x16x32_bf16 v[48:51], a[108:111], v[96:99], v[48:51]
  global_load_lds_dwordx4 v4, s[50:51] offset:3072 sc1
  v_mfma_f32_16x16x32_bf16 v[56:59], a[188:191], v[96:99], v[56:59]
  s_waitcnt lgkmcnt(4)
  v_mfma_f32_16x16x32_bf16 v[36:39], v[204:207], v[100:103], v[36:39]
  v_mfma_f32_16x16x32_bf16 v[44:47], a[28:31], v[100:103], v[44:47]
  s_add_u32 s50, s50, 4096
  s_addc_u32 s51, s51, 0
  v_mfma_f32_16x16x32_bf16 v[52:55], a[108:111], v[100:103], v[52:55]
  s_add_u32 m0, s86, 49152
  s_nop 0
  v_mfma_f32_16x16x32_bf16 v[60:63], a[188:191], v[100:103], v[60:63]
  global_load_lds_dwordx4 v4, s[50:51] offset:0 sc1
  ds_read_b128 v[96:99], v3 offset:12288
  ds_read_b128 v[100:103], v3 offset:13312
  s_waitcnt lgkmcnt(5)
  v_mfma_f32_16x16x32_bf16 v[32:35], v[208:211], v[104:107], v[32:35]
  v_mfma_f32_16x16x32_bf16 v[40:43], a[32:35], v[104:107], v[40:43]
  v_mfma_f32_16x16x32_bf16 v[48:51], a[112:115], v[104:107], v[48:51]
  global_load_lds_dwordx4 v4, s[50:51] offset:1024 sc1
  v_mfma_f32_16x16x32_bf16 v[56:59], a[192:195], v[104:107], v[56:59]
  s_waitcnt lgkmcnt(4)
  v_mfma_f32_16x16x32_bf16 v[36:39], v[208:211], v[108:111], v[36:39]
  v_mfma_f32_16x16x32_bf16 v[44:47], a[32:35], v[108:111], v[44:47]
  v_mfma_f32_16x16x32_bf16 v[52:55], a[112:115], v[108:111], v[52:55]
  v_mfma_f32_16x16x32_bf16 v[60:63], a[192:195], v[108:111], v[60:63]
  ds_read_b128 v[104:107], v3 offset:14336
  ds_read_b128 v[108:111], v3 offset:15360
  s_waitcnt lgkmcnt(5)
  v_mfma_f32_16x16x32_bf16 v[32:35], v[212:215], v[112:115], v[32:35]
  v_mfma_f32_16x16x32_bf16 v[40:43], a[36:39], v[112:115], v[40:43]
  v_mfma_f32_16x16x32_bf16 v[48:51], a[116:119], v[112:115], v[48:51]
  v_mfma_f32_16x16x32_bf16 v[56:59], a[196:199], v[112:115], v[56:59]
  s_waitcnt lgkmcnt(4)
  v_mfma_f32_16x16x32_bf16 v[36:39], v[212:215], v[116:119], v[36:39]
  v_mfma_f32_16x16x32_bf16 v[44:47], a[36:39], v[116:119], v[44:47]
  v_mfma_f32_16x16x32_bf16 v[52:55], a[116:119], v[116:119], v[52:55]
  v_mfma_f32_16x16x32_bf16 v[60:63], a[196:199], v[116:119], v[60:63]
  ds_read_b128 v[112:115], v3 offset:16384
  ds_read_b128 v[116:119], v3 offset:17408
  s_waitcnt lgkmcnt(5)
  v_mfma_f32_16x16x32_bf16 v[32:35], v[216:219], v[96:99], v[32:35]
  v_mfma_f32_16x16x32_bf16 v[40:43], a[40:43], v[96:99], v[40:43]
  v_mfma_f32_16x16x32_bf16 v[48:51], a[120:123], v[96:99], v[48:51]
  v_mfma_f32_16x16x32_bf16 v[56:59], a[200:203], v[96:99], v[56:59]
  s_waitcnt lgkmcnt(4)
  v_mfma_f32_16x16x32_bf16 v[36:39], v[216:219], v[100:103], v[36:39]
  v_mfma_f32_16x16x32_bf16 v[44:47], a[40:43], v[100:103], v[44:47]
  v_mfma_f32_16x16x32_bf16 v[52:55], a[120:123], v[100:103], v[52:55]
  v_mfma_f32_16x16x32_bf16 v[60:63], a[200:203], v[100:103], v[60:63]
  ds_read_b128 v[96:99], v3 offset:18432
  ds_read_b128 v[100:103], v3 offset:19456
  s_waitcnt lgkmcnt(5)
  v_mfma_f32_16x16x32_bf16 v[32:35], v[220:223], v[104:107], v[32:35]
  v_mfma_f32_16x16x32_bf16 v[40:43], a[44:47], v[104:107], v[40:43]
  v_mfma_f32_16x16x32_bf16 v[48:51], a[124:127], v[104:107], v[48:51]
  v_mfma_f32_16x16x32_bf16 v[56:59], a[204:207], v[104:107], v[56:59]
  s_waitcnt lgkmcnt(4)
  v_mfma_f32_16x16x32_bf16 v[36:39], v[220:223], v[108:111], v[36:39]
  v_mfma_f32_16x16x32_bf16 v[44:47], a[44:47], v[108:111], v[44:47]
  v_mfma_f32_16x16x32_bf16 v[52:55], a[124:127], v[108:111], v[52:55]
  v_mfma_f32_16x16x32_bf16 v[60:63], a[204:207], v[108:111], v[60:63]
  ds_read_b128 v[104:107], v3 offset:20480
  ds_read_b128 v[108:111], v3 offset:21504
  s_waitcnt lgkmcnt(5)
  v_mfma_f32_16x16x32_bf16 v[32:35], v[224:227], v[112:115], v[32:35]
  v_mfma_f32_16x16x32_bf16 v[40:43], a[48:51], v[112:115], v[40:43]
  v_mfma_f32_16x16x32_bf16 v[48:51], a[128:131], v[112:115], v[48:51]
  v_mfma_f32_16x16x32_bf16 v[56:59], a[208:211], v[112:115], v[56:59]
  s_waitcnt lgkmcnt(4)
  v_mfma_f32_16x16x32_bf16 v[36:39], v[224:227], v[116:119], v[36:39]
  v_mfma_f32_16x16x32_bf16 v[44:47], a[48:51], v[116:119], v[44:47]
  v_mfma_f32_16x16x32_bf16 v[52:55], a[128:131], v[116:119], v[52:55]
  v_mfma_f32_16x16x32_bf16 v[60:63], a[208:211], v[116:119], v[60:63]
  ds_read_b128 v[112:115], v3 offset:22528
  ds_read_b128 v[116:119], v3 offset:23552
  s_waitcnt lgkmcnt(5)
  v_mfma_f32_16x16x32_bf16 v[32:35], v[228:231], v[96:99], v[32:35]
  v_mfma_f32_16x16x32_bf16 v[40:43], a[52:55], v[96:99], v[40:43]
  v_mfma_f32_16x16x32_bf16 v[48:51], a[132:135], v[96:99], v[48:51]
  v_mfma_f32_16x16x32_bf16 v[56:59], a[212:215], v[96:99], v[56:59]
  s_waitcnt lgkmcnt(4)
  v_mfma_f32_16x16x32_bf16 v[36:39], v[228:231], v[100:103], v[36:39]
  v_mfma_f32_16x16x32_bf16 v[44:47], a[52:55], v[100:103], v[44:47]
  v_mfma_f32_16x16x32_bf16 v[52:55], a[132:135], v[100:103], v[52:55]
  v_mfma_f32_16x16x32_bf16 v[60:63], a[212:215], v[100:103], v[60:63]
  ds_read_b128 v[96:99], v3 offset:24576
  ds_read_b128 v[100:103], v3 offset:25600
  s_waitcnt lgkmcnt(5)
  v_mfma_f32_16x16x32_bf16 v[32:35], v[232:235], v[104:107], v[32:35]
  v_mfma_f32_16x16x32_bf16 v[40:43], a[56:59], v[104:107], v[40:43]
  v_mfma_f32_16x16x32_bf16 v[48:51], a[136:139], v[104:107], v[48:51]
  v_mfma_f32_16x16x32_bf16 v[56:59], a[216:219], v[104:107], v[56:59]
  s_waitcnt lgkmcnt(4)
  v_mfma_f32_16x16x32_bf16 v[36:39], v[232:235], v[108:111], v[36:39]
  v_mfma_f32_16x16x32_bf16 v[44:47], a[56:59], v[108:111], v[44:47]
  v_mfma_f32_16x16x32_bf16 v[52:55], a[136:139], v[108:111], v[52:55]
  v_mfma_f32_16x16x32_bf16 v[60:63], a[216:219], v[108:111], v[60:63]
  ds_read_b128 v[104:107], v3 offset:26624
  ds_read_b128 v[108:111], v3 offset:27648
  s_waitcnt lgkmcnt(5)
  v_mfma_f32_16x16x32_bf16 v[32:35], v[236:239], v[112:115], v[32:35]
  v_mfma_f32_16x16x32_bf16 v[40:43], a[60:63], v[112:115], v[40:43]
  v_mfma_f32_16x16x32_bf16 v[48:51], a[140:143], v[112:115], v[48:51]
  v_mfma_f32_16x16x32_bf16 v[56:59], a[220:223], v[112:115], v[56:59]
  s_waitcnt lgkmcnt(4)
  v_mfma_f32_16x16x32_bf16 v[36:39], v[236:239], v[116:119], v[36:39]
  v_mfma_f32_16x16x32_bf16 v[44:47], a[60:63], v[116:119], v[44:47]
  v_mfma_f32_16x16x32_bf16 v[52:55], a[140:143], v[116:119], v[52:55]
  v_mfma_f32_16x16x32_bf16 v[60:63], a[220:223], v[116:119], v[60:63]
  ds_read_b128 v[112:115], v3 offset:28672
  ds_read_b128 v[116:119], v3 offset:29696
  s_waitcnt lgkmcnt(5)
  v_mfma_f32_16x16x32_bf16 v[32:35], v[240:243], v[96:99], v[32:35]
  v_mfma_f32_16x16x32_bf16 v[40:43], a[64:67], v[96:99], v[40:43]
  v_mfma_f32_16x16x32_bf16 v[48:51], a[144:147], v[96:99], v[48:51]
  v_mfma_f32_16x16x32_bf16 v[56:59], a[224:227], v[96:99], v[56:59]
  s_waitcnt lgkmcnt(4)
  v_mfma_f32_16x16x32_bf16 v[36:39], v[240:243], v[100:103], v[36:39]
  v_mfma_f32_16x16x32_bf16 v[44:47], a[64:67], v[100:103], v[44:47]
  v_mfma_f32_16x16x32_bf16 v[52:55], a[144:147], v[100:103], v[52:55]
  v_mfma_f32_16x16x32_bf16 v[60:63], a[224:227], v[100:103], v[60:63]
  ds_read_b128 v[96:99], v3 offset:30720
  ds_read_b128 v[100:103], v3 offset:31744
  s_waitcnt lgkmcnt(5)
  v_mfma_f32_16x16x32_bf16 v[32:35], v[244:247], v[104:107], v[32:35]
  v_mfma_f32_16x16x32_bf16 v[40:43], a[68:71], v[104:107], v[40:43]
  v_mfma_f32_16x16x32_bf16 v[48:51], a[148:151], v[104:107], v[48:51]
  v_mfma_f32_16x16x32_bf16 v[56:59], a[228:231], v[104:107], v[56:59]
  s_waitcnt lgkmcnt(4)
  v_mfma_f32_16x16x32_bf16 v[36:39], v[244:247], v[108:111], v[36:39]
  v_mfma_f32_16x16x32_bf16 v[44:47], a[68:71], v[108:111], v[44:47]
  v_mfma_f32_16x16x32_bf16 v[52:55], a[148:151], v[108:111], v[52:55]
  v_mfma_f32_16x16x32_bf16 v[60:63], a[228:231], v[108:111], v[60:63]
  ds_read_b128 v[104:107], v3 offset:32768
  ds_read_b128 v[108:111], v3 offset:33792
  s_waitcnt lgkmcnt(5)
  v_mfma_f32_16x16x32_bf16 v[32:35], v[248:251], v[112:115], v[32:35]
  v_mfma_f32_16x16x32_bf16 v[40:43], a[72:75], v[112:115], v[40:43]
  v_mfma_f32_16x16x32_bf16 v[48:51], a[152:155], v[112:115], v[48:51]
  v_mfma_f32_16x16x32_bf16 v[56:59], a[232:235], v[112:115], v[56:59]
  s_waitcnt lgkmcnt(4)
  v_mfma_f32_16x16x32_bf16 v[36:39], v[248:251], v[116:119], v[36:39]
  v_mfma_f32_16x16x32_bf16 v[44:47], a[72:75], v[116:119], v[44:47]
  v_mfma_f32_16x16x32_bf16 v[52:55], a[152:155], v[116:119], v[52:55]
  v_mfma_f32_16x16x32_bf16 v[60:63], a[232:235], v[116:119], v[60:63]
  ds_read_b128 v[112:115], v3 offset:34816
  ds_read_b128 v[116:119], v3 offset:35840
  s_waitcnt lgkmcnt(5)
  v_mfma_f32_16x16x32_bf16 v[32:35], v[252:255], v[96:99], v[32:35]
  v_mfma_f32_16x16x32_bf16 v[40:43], a[76:79], v[96:99], v[40:43]
  v_mfma_f32_16x16x32_bf16 v[48:51], a[156:159], v[96:99], v[48:51]
  v_mfma_f32_16x16x32_bf16 v[56:59], a[236:239], v[96:99], v[56:59]
  s_waitcnt lgkmcnt(4)
  v_mfma_f32_16x16x32_bf16 v[36:39], v[252:255], v[100:103], v[36:39]
  v_mfma_f32_16x16x32_bf16 v[44:47], a[76:79], v[100:103], v[44:47]
  v_mfma_f32_16x16x32_bf16 v[52:55], a[156:159], v[100:103], v[52:55]
  v_mfma_f32_16x16x32_bf16 v[60:63], a[236:239], v[100:103], v[60:63]
  ds_read_b128 v[96:99], v3 offset:36864
  ds_read_b128 v[100:103], v3 offset:37888
  s_waitcnt lgkmcnt(5)
  v_mfma_f32_16x16x32_bf16 v[32:35], a[0:3], v[104:107], v[32:35]
  v_mfma_f32_16x16x32_bf16 v[40:43], a[80:83], v[104:107], v[40:43]
  v_mfma_f32_16x16x32_bf16 v[48:51], a[160:163], v[104:107], v[48:51]
  v_mfma_f32_16x16x32_bf16 v[56:59], a[240:243], v[104:107], v[56:59]
  s_waitcnt lgkmcnt(4)
  v_mfma_f32_16x16x32_bf16 v[36:39], a[0:3], v[108:111], v[36:39]
  v_mfma_f32_16x16x32_bf16 v[44:47], a[80:83], v[108:111], v[44:47]
  v_mfma_f32_16x16x32_bf16 v[52:55], a[160:163], v[108:111], v[52:55]
  v_mfma_f32_16x16x32_bf16 v[60:63], a[240:243], v[108:111], v[60:63]
  ds_read_b128 v[104:107], v3 offset:38912
  ds_read_b128 v[108:111], v3 offset:39936
  s_waitcnt lgkmcnt(5)
  v_mfma_f32_16x16x32_bf16 v[32:35], a[4:7], v[112:115], v[32:35]
  v_mfma_f32_16x16x32_bf16 v[40:43], a[84:87], v[112:115], v[40:43]
  v_mfma_f32_16x16x32_bf16 v[48:51], a[164:167], v[112:115], v[48:51]
  v_mfma_f32_16x16x32_bf16 v[56:59], a[244:247], v[112:115], v[56:59]
  s_waitcnt lgkmcnt(4)
  v_mfma_f32_16x16x32_bf16 v[36:39], a[4:7], v[116:119], v[36:39]
  v_mfma_f32_16x16x32_bf16 v[44:47], a[84:87], v[116:119], v[44:47]
  v_mfma_f32_16x16x32_bf16 v[52:55], a[164:167], v[116:119], v[52:55]
  v_mfma_f32_16x16x32_bf16 v[60:63], a[244:247], v[116:119], v[60:63]
  s_waitcnt lgkmcnt(3)
  v_mfma_f32_16x16x32_bf16 v[32:35], a[8:11], v[96:99], v[32:35]
  v_mfma_f32_16x16x32_bf16 v[40:43], a[88:91], v[96:99], v[40:43]
  v_mfma_f32_16x16x32_bf16 v[48:51], a[168:171], v[96:99], v[48:51]
  v_mfma_f32_16x16x32_bf16 v[56:59], a[248:251], v[96:99], v[56:59]
  s_waitcnt lgkmcnt(2)
  v_mfma_f32_16x16x32_bf16 v[36:39], a[8:11], v[100:103], v[36:39]
  v_mfma_f32_16x16x32_bf16 v[44:47], a[88:91], v[100:103], v[44:47]
  v_mfma_f32_16x16x32_bf16 v[52:55], a[168:171], v[100:103], v[52:55]
  v_mfma_f32_16x16x32_bf16 v[60:63], a[248:251], v[100:103], v[60:63]
  s_waitcnt lgkmcnt(1)
  v_mfma_f32_16x16x32_bf16 v[32:35], a[12:15], v[104:107], v[32:35]
  v_mfma_f32_16x16x32_bf16 v[40:43], a[92:95], v[104:107], v[40:43]
  v_mfma_f32_16x16x32_bf16 v[48:51], a[172:175], v[104:107], v[48:51]
  v_mfma_f32_16x16x32_bf16 v[56:59], a[252:255], v[104:107], v[56:59]
  s_waitcnt lgkmcnt(0)
  v_mfma_f32_16x16x32_bf16 v[36:39], a[12:15], v[108:111], v[36:39]
  v_mfma_f32_16x16x32_bf16 v[44:47], a[92:95], v[108:111], v[44:47]
  v_mfma_f32_16x16x32_bf16 v[52:55], a[172:175], v[108:111], v[52:55]
  v_mfma_f32_16x16x32_bf16 v[60:63], a[252:255], v[108:111], v[60:63]
  s_mov_b32 s47, s46
  s_mov_b32 s46, s44
  s_mov_b32 s44, s52
  s_cmp_ge_u32 s44, 64
  s_cbranch_scc1 FFN1_fin0
FFN1_loop:
  s_waitcnt vmcnt(0)
  s_barrier
  s_cmp_eq_u32 s47, -1
  s_cbranch_scc1 FS_128
  s_cmp_lg_u32 s3, 0
  s_cbranch_scc1 FS_128
  s_lshl_b32 s48, s47, 6
  s_add_u32 s48, s48, s58
  v_mov_b32 v5, s48
  v_mov_b32 v6, 1
  s_mov_b64 exec, 1
  global_store_dword v5, v6, s[4:5] sc1
  s_mov_b64 exec, -1
FS_128:
  s_add_u32 s52, s44, 10
  s_cmp_ge_u32 s52, 64
  s_cselect_b32 s54, s44, s52
  ds_read_b128 v[96:99], v7 offset:0
  ds_read_b128 v[100:103], v7 offset:1024
  ds_read_b128 v[104:107], v7 offset:2048
  ds_read_b128 v[108:111], v7 offset:3072
  s_mul_i32 s60, s46, 98304
  s_add_u32 s60, s60, 0x300000
  s_add_u32 s62, s4, s60
  s_addc_u32 s63, s5, 0
  v_mul_f32 v128, s57, v32
  v_mul_f32 v129, s57, v33
  v_mul_f32 v130, s57, v34
  v_mul_f32 v131, s57, v35
  ds_read_b128 v[112:115], v7 offset:4096
  ds_read_b128 v[116:119], v7 offset:5120
  s_waitcnt lgkmcnt(5)
  v_mfma_f32_16x16x32_bf16 v[64:67], v[192:195], v[96:99], 0
  v_exp_f32 v128, v128
  v_exp_f32 v129, v129
  v_mfma_f32_16x16x32_bf16 v[72:75], a[16:19], v[96:99], 0
  v_exp_f32 v130, v130
  v_exp_f32 v131, v131
  v_mfma_f32_16x16x32_bf16 v[80:83], a[96:99], v[96:99], 0
  v_mul_f32 v32, v32, v48
  v_mul_f32 v33, v33, v49
  v_mfma_f32_16x16x32_bf16 v[88:91], a[176:179], v[96:99], 0
  v_mul_f32 v34, v34, v50
  v_mul_f32 v35, v35, v51
  s_waitcnt lgkmcnt(4)
  v_mfma_f32_16x16x32_bf16 v[68:71], v[192:195], v[100:103], 0
  v_add_f32 v128, 1.0, v128
  v_add_f32 v129, 1.0, v129
  v_mfma_f32_16x16x32_bf16 v[76:79], a[16:19], v[100:103], 0
  v_add_f32 v130, 1.0, v130
  v_add_f32 v131, 1.0, v131
  v_mfma_f32_16x16x32_bf16 v[84:87], a[96:99], v[100:103], 0
  v_rcp_f32 v128, v128
  v_rcp_f32 v129, v129
  v_mfma_f32_16x16x32_bf16 v[92:95], a[176:179], v[100:103], 0
  v_rcp_f32 v130, v130
  v_rcp_f32 v131, v131
  ds_read_b128 v[96:99], v7 offset:6144
  ds_read_b128 v[100:103], v7 offset:7168
  s_waitcnt lgkmcnt(5)
  v_mfma_f32_16x16x32_bf16 v[64:67], v[196:199], v[104:107], v[64:67]
  s_nop 0
  v_mul_f32 v32, v32, v128
  v_mfma_f32_16x16x32_bf16 v[72:75], a[20:23], v[104:107], v[72:75]
  v_mul_f32 v33, v33, v129
  v_mul_f32 v34, v34, v130
  v_mfma_f32_16x16x32_bf16 v[80:83], a[100:103], v[104:107], v[80:83]
  v_mul_f32 v35, v35, v131
  v_cvt_pk_bf16_f32 v120, v32, v33
  v_mfma_f32_16x16x32_bf16 v[88:91], a[180:183], v[104:107], v[88:91]
  v_cvt_pk_bf16_f32 v121, v34, v35
  v_mul_f32 v128, s57, v40
  s_waitcnt lgkmcnt(4)
  v_mfma_f32_16x16x32_bf16 v[68:71], v[196:199], v[108:111], v[68:71]
  v_mul_f32 v129, s57, v41
  v_mul_f32 v130, s57, v42
  v_mfma_f32_16x16x32_bf16 v[76:79], a[20:23], v[108:111], v[76:79]
  v_mul_f32 v131, s57, v43
  v_exp_f32 v128, v128
  v_mfma_f32_16x16x32_bf16 v[84:87], a[100:103], v[108:111], v[84:87]
  v_exp_f32 v129, v129
  v_exp_f32 v130, v130
  v_mfma_f32_16x16x32_bf16 v[92:95], a[180:183], v[108:111], v[92:95]
  v_exp_f32 v131, v131
  v_mul_f32 v40, v40, v56
  ds_read_b128 v[104:107], v7 offset:8192
  ds_read_b128 v[108:111], v7 offset:9216
  s_waitcnt lgkmcnt(5)
  v_mfma_f32_16x16x32_bf16 v[64:67], v[200:203], v[112:115], v[64:67]
  v_mul_f32 v41, v41, v57
  v_mul_f32 v42, v42, v58
  v_mfma_f32_16x16x32_bf16 v[72:75], a[24:27], v[112:115], v[72:75]
  v_mul_f32 v43, v43, v59
  v_add_f32 v128, 1.0, v128
  v_mfma_f32_16x16x32_bf16 v[80:83], a[104:107], v[112:115], v[80:83]
  v_add_f32 v129, 1.0, v129
  v_add_f32 v130, 1.0, v130
  v_mfma_f32_16x16x32_bf16 v[88:91], a[184:187], v[112:115], v[88:91]
  v_add_f32 v131, 1.0, v131
  v_rcp_f32 v128, v128
  s_waitcnt lgkmcnt(4)
  v_mfma_f32_16x16x32_bf16 v[68:71], v[200:203], v[116:119], v[68:71]
  v_rcp_f32 v129, v129
  v_rcp_f32 v130, v130
  v_mfma_f32_16x16x32_bf16 v[76:79], a[24:27], v[116:119], v[76:79]
  v_rcp_f32 v131, v131
  s_nop 0
  v_mfma_f32_16x16x32_bf16 v[84:87], a[104:107], v[116:119], v[84:87]
  v_mul_f32 v40, v40, v128
  v_mul_f32 v41, v41, v129
  v_mfma_f32_16x16x32_bf16 v[92:95], a[184:187], v[116:119], v[92:95]
  v_mul_f32 v42, v42, v130
  v_mul_f32 v43, v43, v131
  ds_read_b128 v[112:115], v7 offset:10240
  ds_read_b128 v[116:119], v7 offset:11264
  s_waitcnt lgkmcnt(5)
  v_mfma_f32_16x16x32_bf16 v[64:67], v[204:207], v[96:99], v[64:67]
  v_cvt_pk_bf16_f32 v122, v40, v41
  v_cvt_pk_bf16_f32 v123, v42, v43
  v_mfma_f32_16x16x32_bf16 v[72:75], a[28:31], v[96:99], v[72:75]
  global_store_dwordx4 v8, v[120:123], s[62:63] sc1
  v_mfma_f32_16x16x32_bf16 v[80:83], a[108:111], v[96:99], v[80:83]
  v_mfma_f32_16x16x32_bf16 v[88:91], a[188:191], v[96:99], v[88:91]
  s_waitcnt lgkmcnt(4)
  v_mfma_f32_16x16x32_bf16 v[68:71], v[204:207], v[100:103], v[68:71]
  v_mul_f32 v128, s57, v36
  v_mul_f32 v129, s57, v37
  v_mfma_f32_16x16x32_bf16 v[76:79], a[28:31], v[100:103], v[76:79]
  v_mul_f32 v130, s57, v38
  v_mul_f32 v131, s57, v39
  v_mfma_f32_16x16x32_bf16 v[84:87], a[108:111], v[100:103], v[84:87]
  v_exp_f32 v128, v128
  v_exp_f32 v129, v129
  v_mfma_f32_16x16x32_bf16 v[92:95], a[188:191], v[100:103], v[92:95]
  v_exp_f32 v130, v130
  v_exp_f32 v131, v131
  ds_read_b128 v[96:99], v7 offset:12288
  ds_read_b128 v[100:103], v7 offset:13312
  s_waitcnt lgkmcnt(5)
  v_mfma_f32_16x16x32_bf16 v[64:67], v[208:211], v[104:107], v[64:67]
  v_mul_f32 v36, v36, v52
  v_mul_f32 v37, v37, v53
  v_mfma_f32_16x16x32_bf16 v[72:75], a[32:35], v[104:107], v[72:75]
  v_mul_f32 v38, v38, v54
  v_mul_f32 v39, v39, v55
  v_mfma_f32_16x16x32_bf16 v[80:83], a[112:115], v[104:107], v[80:83]
  v_add_f32 v128, 1.0, v128
  v_add_f32 v129, 1.0, v129
  v_mfma_f32_16x16x32_bf16 v[88:91], a[192:195], v[104:107], v[88:91]
  v_add_f32 v130, 1.0, v130
  v_add_f32 v131, 1.0, v131
  s_waitcnt lgkmcnt(4)
  v_mfma_f32_16x16x32_bf16 v[68:71], v[208:211], v[108:111], v[68:71]
  v_rcp_f32 v128, v128
  v_rcp_f32 v129, v129
  v_mfma_f32_16x16x32_bf16 v[76:79], a[32:35], v[108:111], v[76:79]
  v_rcp_f32 v130, v130
  v_rcp_f32 v131, v131
  v_mfma_f32_16x16x32_bf16 v[84:87], a[112:115], v[108:111], v[84:87]
  s_nop 0
  v_mul_f32 v36, v36, v128
  v_mfma_f32_16x16x32_bf16 v[92:95], a[192:195], v[108:111], v[92:95]
  v_mul_f32 v37, v37, v129
  v_mul_f32 v38, v38, v130
  ds_read_b128 v[104:107], v7 offset:14336
  ds_read_b128 v[108:111], v7 offset:15360
  s_waitcnt lgkmcnt(5)
  v_mfma_f32_16x16x32_bf16 v[64:67], v[212:215], v[112:115], v[64:67]
  v_mul_f32 v39, v39, v131
  v_cvt_pk_bf16_f32 v124, v36, v37
  v_mfma_f32_16x16x32_bf16 v[72:75], a[36:39], v[112:115], v[72:75]
  v_cvt_pk_bf16_f32 v125, v38, v39
  v_mul_f32 v128, s57, v44
  v_mfma_f32_16x16x32_bf16 v[80:83], a[116:119], v[112:115], v[80:83]
  v_mul_f32 v129, s57, v45
  v_mul_f32 v130, s57, v46
  v_mfma_f32_16x16x32_bf16 v[88:91], a[196:199], v[112:115], v[88:91]
  v_mul_f32 v131, s57, v47
  v_exp_f32 v128, v128
  s_waitcnt lgkmcnt(4)
  v_mfma_f32_16x16x32_bf16 v[68:71], v[212:215], v[116:119], v[68:71]
  v_exp_f32 v129, v129
  v_exp_f32 v130, v130
  v_mfma_f32_16x16x32_bf16 v[76:79], a[36:39], v[116:119], v[76:79]
  v_exp_f32 v131, v131
  v_mul_f32 v44, v44, v60
  v_mfma_f32_16x16x32_bf16 v[84:87], a[116:119], v[116:119], v[84:87]
  v_mul_f32 v45, v45, v61
  v_mul_f32 v46, v46, v62
  v_mfma_f32_16x16x32_bf16 v[92:95], a[196:199], v[116:119], v[92:95]
  v_mul_f32 v47, v47, v63
  v_add_f32 v128, 1.0, v128
  ds_read_b128 v[112:115], v7 offset:16384
  ds_read_b128 v[116:119], v7 offset:17408
  s_waitcnt lgkmcnt(5)
  v_mfma_f32_16x16x32_bf16 v[64:67], v[216:219], v[96:99], v[64:67]
  v_add_f32 v129, 1.0, v129
  v_add_f32 v130, 1.0, v130
  v_mfma_f32_16x16x32_bf16 v[72:75], a[40:43], v[96:99], v[72:75]
  v_add_f32 v131, 1.0, v131
  v_rcp_f32 v128, v128
  v_mfma_f32_16x16x32_bf16 v[80:83], a[120:123], v[96:99], v[80:83]
  v_rcp_f32 v129, v129
  v_rcp_f32 v130, v130
  v_mfma_f32_16x16x32_bf16 v[88:91], a[200:203], v[96:99], v[88:91]
  v_rcp_f32 v131, v131
  s_nop 0
  s_waitcnt lgkmcnt(4)
  v_mfma_f32_16x16x32_bf16 v[68:71], v[216:219], v[100:103], v[68:71]
  v_mul_f32 v44, v44, v128
  v_mul_f32 v45, v45, v129
  v_mfma_f32_16x16x32_bf16 v[76:79], a[40:43], v[100:103], v[76:79]
  v_mul_f32 v46, v46, v130
  v_mul_f32 v47, v47, v131
  v_mfma_f32_16x16x32_bf16 v[84:87], a[120:123], v[100:103], v[84:87]
  v_cvt_pk_bf16_f32 v126, v44, v45
  v_cvt_pk_bf16_f32 v127, v46, v47
  v_mfma_f32_16x16x32_bf16 v[92:95], a[200:203], v[100:103], v[92:95]
  global_store_dwordx4 v9, v[124:127], s[62:63] sc1
  ds_read_b128 v[96:99], v7 offset:18432
  ds_read_b128 v[100:103], v7 offset:19456
  s_waitcnt lgkmcnt(5)
  v_mfma_f32_16x16x32_bf16 v[64:67], v[220:223], v[104:107], v[64:67]
  v_mfma_f32_16x16x32_bf16 v[72:75], a[44:47], v[104:107], v[72:75]
  v_mfma_f32_16x16x32_bf16 v[80:83], a[124:127], v[104:107], v[80:83]
  s_mul_i32 s48, s54, 40960
  s_add_u32 s48, s48, s59
  v_mfma_f32_16x16x32_bf16 v[88:91], a[204:207], v[104:107], v[88:91]
  s_add_u32 s50, s4, s48
  s_addc_u32 s51, s5, 0
  s_waitcnt lgkmcnt(4)
  v_mfma_f32_16x16x32_bf16 v[68:71], v[220:223], v[108:111], v[68:71]
  s_add_u32 m0, s86, 0
  s_nop 0
  v_mfma_f32_16x16x32_bf16 v[76:79], a[44:47], v[108:111], v[76:79]
  global_load_lds_dwordx4 v4, s[50:51] offset:0 sc1
  v_mfma_f32_16x16x32_bf16 v[84:87], a[124:127], v[108:111], v[84:87]
  v_mfma_f32_16x16x32_bf16 v[92:95], a[204:207], v[108:111], v[92:95]
  ds_read_b128 v[104:107], v7 offset:20480
  ds_read_b128 v[108:111], v7 offset:21504
  s_waitcnt lgkmcnt(5)
  v_mfma_f32_16x16x32_bf16 v[64:67], v[224:227], v[112:115], v[64:67]
  global_load_lds_dwordx4 v4, s[50:51] offset:1024 sc1
  v_mfma_f32_16x16x32_bf16 v[72:75], a[48:51], v[112:115], v[72:75]
  v_mfma_f32_16x16x32_bf16 v[80:83], a[128:131], v[112:115], v[80:83]
  v_mfma_f32_16x16x32_bf16 v[88:91], a[208:211], v[112:115], v[88:91]
  global_load_lds_dwordx4 v4, s[50:51] offset:2048 sc1
  s_waitcnt lgkmcnt(4)
  v_mfma_f32_16x16x32_bf16 v[68:71], v[224:227], v[116:119], v[68:71]
  v_mfma_f32_16x16x32_bf16 v[76:79], a[48:51], v[116:119], v[76:79]
  v_mfma_f32_16x16x32_bf16 v[84:87], a[128:131], v[116:119], v[84:87]
  global_load_lds_dwordx4 v4, s[50:51] offset:3072 sc1
  v_mfma_f32_16x16x32_bf16 v[92:95], a[208:211], v[116:119], v[92:95]
  ds_read_b128 v[112:115], v7 offset:22528
  ds_read_b128 v[116:119], v7 offset:23552
  s_waitcnt lgkmcnt(5)
  v_mfma_f32_16x16x32_bf16 v[64:67], v[228:231], v[96:99], v[64:67]
  v_mfma_f32_16x16x32_bf16 v[72:75], a[52:55], v[96:99], v[72:75]
  s_add_u32 s50, s50, 4096
  s_addc_u32 s51, s51, 0
  v_mfma_f32_16x16x32_bf16 v[80:83], a[132:135], v[96:99], v[80:83]
  s_add_u32 m0, s86, 4096
  s_nop 0
  v_mfma_f32_16x16x32_bf16 v[88:91], a[212:215], v[96:99], v[88:91]
  global_load_lds_dwordx4 v4, s[50:51] offset:0 sc1
  s_waitcnt lgkmcnt(4)
  v_mfma_f32_16x16x32_bf16 v[68:71], v[228:231], v[100:103], v[68:71]
  v_mfma_f32_16x16x32_bf16 v[76:79], a[52:55], v[100:103], v[76:79]
  v_mfma_f32_16x16x32_bf16 v[84:87], a[132:135], v[100:103], v[84:87]
  global_load_lds_dwordx4 v4, s[50:51] offset:1024 sc1
  v_mfma_f32_16x16x32_bf16 v[92:95], a[212:215], v[100:103], v[92:95]
  ds_read_b128 v[96:99], v7 offset:24576
  ds_read_b128 v[100:103], v7 offset:25600
  s_waitcnt lgkmcnt(5)
  v_mfma_f32_16x16x32_bf16 v[64:67], v[232:235], v[104:107], v[64:67]
  v_mfma_f32_16x16x32_bf16 v[72:75], a[56:59], v[104:107], v[72:75]
  global_load_lds_dwordx4 v4, s[50:51] offset:2048 sc1
  v_mfma_f32_16x16x32_bf16 v[80:83], a[136:139], v[104:107], v[80:83]
  v_mfma_f32_16x16x32_bf16 v[88:91], a[216:219], v[104:107], v[88:91]
  s_waitcnt lgkmcnt(4)
  v_mfma_f32_16x16x32_bf16 v[68:71], v[232:235], v[108:111], v[68:71]
  global_load_lds_dwordx4 v4, s[50:51] offset:3072 sc1
  v_mfma_f32_16x16x32_bf16 v[76:79], a[56:59], v[108:111], v[76:79]
  v_mfma_f32_16x16x32_bf16 v[84:87], a[136:139], v[108:111], v[84:87]
  v_mfma_f32_16x16x32_bf16 v[92:95], a[216:219], v[108:111], v[92:95]
  s_add_u32 s50, s50, 4096
  s_addc_u32 s51, s51, 0
  ds_read_b128 v[104:107], v7 offset:26624
  ds_read_b128 v[108:111], v7 offset:27648
  s_waitcnt lgkmcnt(5)
  v_mfma_f32_16x16x32_bf16 v[64:67], v[236:239], v[112:115], v[64:67]
  s_add_u32 m0, s86, 8192
  s_nop 0
  v_mfma_f32_16x16x32_bf16 v[72:75], a[60:63], v[112:115], v[72:75]
  global_load_lds_dwordx4 v4, s[50:51] offset:0 sc1
  v_mfma_f32_16x16x32_bf16 v[80:83], a[140:143], v[112:115], v[80:83]
  v_mfma_f32_16x16x32_bf16 v[88:91], a[220:223], v[112:115], v[88:91]
  s_waitcnt lgkmcnt(4)
  v_mfma_f32_16x16x32_bf16 v[68:71], v[236:239], v[116:119], v[68:71]
  global_load_lds_dwordx4 v4, s[50:51] offset:1024 sc1
  v_mfma_f32_16x16x32_bf16 v[76:79], a[60:63], v[116:119], v[76:79]
  v_mfma_f32_16x16x32_bf16 v[84:87], a[140:143], v[116:119], v[84:87]
  v_mfma_f32_16x16x32_bf16 v[92:95], a[220:223], v[116:119], v[92:95]
  ds_read_b128 v[112:115], v7 offset:28672
  ds_read_b128 v[116:119], v7 offset:29696
  s_waitcnt lgkmcnt(5)
  v_mfma_f32_16x16x32_bf16 v[64:67], v[240:243], v[96:99], v[64:67]
  v_mfma_f32_16x16x32_bf16 v[72:75], a[64:67], v[96:99], v[72:75]
  v_mfma_f32_16x16x32_bf16 v[80:83], a[144:147], v[96:99], v[80:83]
  v_mfma_f32_16x16x32_bf16 v[88:91], a[224:227], v[96:99], v[88:91]
  s_waitcnt lgkmcnt(4)
  v_mfma_f32_16x16x32_bf16 v[68:71], v[240:243], v[100:103], v[68:71]
  v_mfma_f32_16x16x32_bf16 v[76:79], a[64:67], v[100:103], v[76:79]
  v_mfma_f32_16x16x32_bf16 v[84:87], a[144:147], v[100:103], v[84:87]
  v_mfma_f32_16x16x32_bf16 v[92:95], a[224:227], v[100:103], v[92:95]
  ds_read_b128 v[96:99], v7 offset:30720
  ds_read_b128 v[100:103], v7 offset:31744
  s_waitcnt lgkmcnt(5)
  v_mfma_f32_16x16x32_bf16 v[64:67], v[244:247], v[104:107], v[64:67]
  v_mfma_f32_16x16x32_bf16 v[72:75], a[68:71], v[104:107], v[72:75]
  v_mfma_f32_16x16x32_bf16 v[80:83], a[148:151], v[104:107], v[80:83]
  v_mfma_f32_16x16x32_bf16 v[88:91], a[228:231], v[104:107], v[88:91]
  s_waitcnt lgkmcnt(4)
  v_mfma_f32_16x16x32_bf16 v[68:71], v[244:247], v[108:111], v[68:71]
  v_mfma_f32_16x16x32_bf16 v[76:79], a[68:71], v[108:111], v[76:79]
  v_mfma_f32_16x16x32_bf16 v[84:87], a[148:151], v[108:111], v[84:87]
  v_mfma_f32_16x16x32_bf16 v[92:95], a[228:231], v[108:111], v[92:95]
  ds_read_b128 v[104:107], v7 offset:32768
  ds_read_b128 v[108:111], v7 offset:33792
  s_waitcnt lgkmcnt(5)
  v_mfma_f32_16x16x32_bf16 v[64:67], v[248:251], v[112:115], v[64:67]
  v_mfma_f32_16x16x32_bf16 v[72:75], a[72:75], v[112:115], v[72:75]
  v_mfma_f32_16x16x32_bf16 v[80:83], a[152:155], v[112:115], v[80:83]
  v_mfma_f32_16x16x32_bf16 v[88:91], a[232:235], v[112:115], v[88:91]
  s_waitcnt lgkmcnt(4)
  v_mfma_f32_16x16x32_bf16 v[68:71], v[248:251], v[116:119], v[68:71]
  v_mfma_f32_16x16x32_bf16 v[76:79], a[72:75], v[116:119], v[76:79]
  v_mfma_f32_16x16x32_bf16 v[84:87], a[152:155], v[116:119], v[84:87]
  v_mfma_f32_16x16x32_bf16 v[92:95], a[232:235], v[116:119], v[92:95]
  ds_read_b128 v[112:115], v7 offset:34816
  ds_read_b128 v[116:119], v7 offset:35840
  s_waitcnt lgkmcnt(5)
  v_mfma_f32_16x16x32_bf16 v[64:67], v[252:255], v[96:99], v[64:67]
  v_mfma_f32_16x16x32_bf16 v[72:75], a[76:79], v[96:99], v[72:75]
  v_mfma_f32_16x16x32_bf16 v[80:83], a[156:159], v[96:99], v[80:83]
  v_mfma_f32_16x16x32_bf16 v[88:91], a[236:239], v[96:99], v[88:91]
  s_waitcnt lgkmcnt(4)
  v_mfma_f32_16x16x32_bf16 v[68:71], v[252:255], v[100:103], v[68:71]
  v_mfma_f32_16x16x32_bf16 v[76:79], a[76:79], v[100:103], v[76:79]
  v_mfma_f32_16x16x32_bf16 v[84:87], a[156:159], v[100:103], v[84:87]
  v_mfma_f32_16x16x32_bf16 v[92:95], a[236:239], v[100:103], v[92:95]
  ds_read_b128 v[96:99], v7 offset:36864
  ds_read_b128 v[100:103], v7 offset:37888
  s_waitcnt lgkmcnt(5)
  v_mfma_f32_16x16x32_bf16 v[64:67], a[0:3], v[104:107], v[64:67]
  v_mfma_f32_16x16x32_bf16 v[72:75], a[80:83], v[104:107], v[72:75]
  v_mfma_f32_16x16x32_bf16 v[80:83], a[160:163], v[104:107], v[80:83]
  v_mfma_f32_16x16x32_bf16 v[88:91], a[240:243], v[104:107], v[88:91]
  s_waitcnt lgkmcnt(4)
  v_mfma_f32_16x16x32_bf16 v[68:71], a[0:3], v[108:111], v[68:71]
  v_mfma_f32_16x16x32_bf16 v[76:79], a[80:83], v[108:111], v[76:79]
  v_mfma_f32_16x16x32_bf16 v[84:87], a[160:163], v[108:111], v[84:87]
  v_mfma_f32_16x16x32_bf16 v[92:95], a[240:243], v[108:111], v[92:95]
  ds_read_b128 v[104:107], v7 offset:38912
  ds_read_b128 v[108:111], v7 offset:39936
  s_waitcnt lgkmcnt(5)
  v_mfma_f32_16x16x32_bf16 v[64:67], a[4:7], v[112:115], v[64:67]
  v_mfma_f32_16x16x32_bf16 v[72:75], a[84:87], v[112:115], v[72:75]
  v_mfma_f32_16x16x32_bf16 v[80:83], a[164:167], v[112:115], v[80:83]
  v_mfma_f32_16x16x32_bf16 v[88:91], a[244:247], v[112:115], v[88:91]
  s_waitcnt lgkmcnt(4)
  v_mfma_f32_16x16x32_bf16 v[68:71], a[4:7], v[116:119], v[68:71]
  v_mfma_f32_16x16x32_bf16 v[76:79], a[84:87], v[116:119], v[76:79]
  v_mfma_f32_16x16x32_bf16 v[84:87], a[164:167], v[116:119], v[84:87]
  v_mfma_f32_16x16x32_bf16 v[92:95], a[244:247], v[116:119], v[92:95]
  s_waitcnt lgkmcnt(3)
  v_mfma_f32_16x16x32_bf16 v[64:67], a[8:11], v[96:99], v[64:67]
  v_mfma_f32_16x16x32_bf16 v[72:75], a[88:91], v[96:99], v[72:75]
  v_mfma_f32_16x16x32_bf16 v[80:83], a[168:171], v[96:99], v[80:83]
  v_mfma_f32_16x16x32_bf16 v[88:91], a[248:251], v[96:99], v[88:91]
  s_waitcnt lgkmcnt(2)
  v_mfma_f32_16x16x32_bf16 v[68:71], a[8:11], v[100:103], v[68:71]
  v_mfma_f32_16x16x32_bf16 v[76:79], a[88:91], v[100:103], v[76:79]
  v_mfma_f32_16x16x32_bf16 v[84:87], a[168:171], v[100:103], v[84:87]
  v_mfma_f32_16x16x32_bf16 v[92:95], a[248:251], v[100:103], v[92:95]
  s_waitcnt lgkmcnt(1)
  v_mfma_f32_16x16x32_bf16 v[64:67], a[12:15], v[104:107], v[64:67]
  v_mfma_f32_16x16x32_bf16 v[72:75], a[92:95], v[104:107], v[72:75]
  v_mfma_f32_16x16x32_bf16 v[80:83], a[172:175], v[104:107], v[80:83]
  v_mfma_f32_16x16x32_bf16 v[88:91], a[252:255], v[104:107], v[88:91]
  s_waitcnt lgkmcnt(0)
  v_mfma_f32_16x16x32_bf16 v[68:71], a[12:15], v[108:111], v[68:71]
  v_mfma_f32_16x16x32_bf16 v[76:79], a[92:95], v[108:111], v[76:79]
  v_mfma_f32_16x16x32_bf16 v[84:87], a[172:175], v[108:111], v[84:87]
  v_mfma_f32_16x16x32_bf16 v[92:95], a[252:255], v[108:111], v[92:95]
  s_mov_b32 s47, s46
  s_mov_b32 s46, s44
  s_mov_b32 s44, s52
  s_cmp_ge_u32 s44, 64
  s_cbranch_scc1 FFN1_fin1
  s_waitcnt vmcnt(0)
  s_barrier
  s_cmp_eq_u32 s47, -1
  s_cbranch_scc1 FS_129
  s_cmp_lg_u32 s3, 0
  s_cbranch_scc1 FS_129
  s_lshl_b32 s48, s47, 6
  s_add_u32 s48, s48, s58
  v_mov_b32 v5, s48
  v_mov_b32 v6, 1
  s_mov_b64 exec, 1
  global_store_dword v5, v6, s[4:5] sc1
  s_mov_b64 exec, -1
FS_129:
  s_add_u32 s52, s44, 10
  s_cmp_ge_u32 s52, 64
  s_cselect_b32 s54, s44, s52
  ds_read_b128 v[96:99], v3 offset:0
  ds_read_b128 v[100:103], v3 offset:1024
  ds_read_b128 v[104:107], v3 offset:2048
  ds_read_b128 v[108:111], v3 offset:3072
  s_mul_i32 s60, s46, 98304
  s_add_u32 s60, s60, 0x300000
  s_add_u32 s62, s4, s60
  s_addc_u32 s63, s5, 0
  v_mul_f32 v128, s57, v64
  v_mul_f32 v129, s57, v65
  v_mul_f32 v130, s57, v66
  v_mul_f32 v131, s57, v67
  ds_read_b128 v[112:115], v3 offset:4096
  ds_read_b128 v[116:119], v3 offset:5120
  s_waitcnt lgkmcnt(5)
  v_mfma_f32_16x16x32_bf16 v[32:35], v[192:195], v[96:99], 0
  v_exp_f32 v128, v128
  v_exp_f32 v129, v129
  v_mfma_f32_16x16x32_bf16 v[40:43], a[16:19], v[96:99], 0
  v_exp_f32 v130, v130
  v_exp_f32 v131, v131
  v_mfma_f32_16x16x32_bf16 v[48:51], a[96:99], v[96:99], 0
  v_mul_f32 v64, v64, v80
  v_mul_f32 v65, v65, v81
  v_mfma_f32_16x16x32_bf16 v[56:59], a[176:179], v[96:99], 0
  v_mul_f32 v66, v66, v82
  v_mul_f32 v67, v67, v83
  s_waitcnt lgkmcnt(4)
  v_mfma_f32_16x16x32_bf16 v[36:39], v[192:195], v[100:103], 0
  v_add_f32 v128, 1.0, v128
  v_add_f32 v129, 1.0, v129
  v_mfma_f32_16x16x32_bf16 v[44:47], a[16:19], v[100:103], 0
  v_add_f32 v130, 1.0, v130
  v_add_f32 v131, 1.0, v131
  v_mfma_f32_16x16x32_bf16 v[52:55], a[96:99], v[100:103], 0
  v_rcp_f32 v128, v128
  v_rcp_f32 v129, v129
  v_mfma_f32_16x16x32_bf16 v[60:63], a[176:179], v[100:103], 0
  v_rcp_f32 v130, v130
  v_rcp_f32 v131, v131
  ds_read_b128 v[96:99], v3 offset:6144
  ds_read_b128 v[100:103], v3 offset:7168
  s_waitcnt lgkmcnt(5)
  v_mfma_f32_16x16x32_bf16 v[32:35], v[196:199], v[104:107], v[32:35]
  s_nop 0
  v_mul_f32 v64, v64, v128
  v_mfma_f32_16x16x32_bf16 v[40:43], a[20:23], v[104:107], v[40:43]
  v_mul_f32 v65, v65, v129
  v_mul_f32 v66, v66, v130
  v_mfma_f32_16x16x32_bf16 v[48:51], a[100:103], v[104:107], v[48:51]
  v_mul_f32 v67, v67, v131
  v_cvt_pk_bf16_f32 v120, v64, v65
  v_mfma_f32_16x16x32_bf16 v[56:59], a[180:183], v[104:107], v[56:59]
  v_cvt_pk_bf16_f32 v121, v66, v67
  v_mul_f32 v128, s57, v72
  s_waitcnt lgkmcnt(4)
  v_mfma_f32_16x16x32_bf16 v[36:39], v[196:199], v[108:111], v[36:39]
  v_mul_f32 v129, s57, v73
  v_mul_f32 v130, s57, v74
  v_mfma_f32_16x16x32_bf16 v[44:47], a[20:23], v[108:111], v[44:47]
  v_mul_f32 v131, s57, v75
  v_exp_f32 v128, v128
  v_mfma_f32_16x16x32_bf16 v[52:55], a[100:103], v[108:111], v[52:55]
  v_exp_f32 v129, v129
  v_exp_f32 v130, v130
  v_mfma_f32_16x16x32_bf16 v[60:63], a[180:183], v[108:111], v[60:63]
  v_exp_f32 v131, v131
  v_mul_f32 v72, v72, v88
  ds_read_b128 v[104:107], v3 offset:8192
  ds_read_b128 v[108:111], v3 offset:9216
  s_waitcnt lgkmcnt(5)
  v_mfma_f32_16x16x32_bf16 v[32:35], v[200:203], v[112:115], v[32:35]
  v_mul_f32 v73, v73, v89
  v_mul_f32 v74, v74, v90
  v_mfma_f32_16x16x32_bf16 v[40:43], a[24:27], v[112:115], v[40:43]
  v_mul_f32 v75, v75, v91
  v_add_f32 v128, 1.0, v128
  v_mfma_f32_16x16x32_bf16 v[48:51], a[104:107], v[112:115], v[48:51]
  v_add_f32 v129, 1.0, v129
  v_add_f32 v130, 1.0, v130
  v_mfma_f32_16x16x32_bf16 v[56:59], a[184:187], v[112:115], v[56:59]
  v_add_f32 v131, 1.0, v131
  v_rcp_f32 v128, v128
  s_waitcnt lgkmcnt(4)
  v_mfma_f32_16x16x32_bf16 v[36:39], v[200:203], v[116:119], v[36:39]
  v_rcp_f32 v129, v129
  v_rcp_f32 v130, v130
  v_mfma_f32_16x16x32_bf16 v[44:47], a[24:27], v[116:119], v[44:47]
  v_rcp_f32 v131, v131
  s_nop 0
  v_mfma_f32_16x16x32_bf16 v[52:55], a[104:107], v[116:119], v[52:55]
  v_mul_f32 v72, v72, v128
  v_mul_f32 v73, v73, v129
  v_mfma_f32_16x16x32_bf16 v[60:63], a[184:187], v[116:119], v[60:63]
  v_mul_f32 v74, v74, v130
  v_mul_f32 v75, v75, v131
  ds_read_b128 v[112:115], v3 offset:10240
  ds_read_b128 v[116:119], v3 offset:11264
  s_waitcnt lgkmcnt(5)
  v_mfma_f32_16x16x32_bf16 v[32:35], v[204:207], v[96:99], v[32:35]
  v_cvt_pk_bf16_f32 v122, v72, v73
  v_cvt_pk_bf16_f32 v123, v74, v75
  v_mfma_f32_16x16x32_bf16 v[40:43], a[28:31], v[96:99], v[40:43]
  global_store_dwordx4 v8, v[120:123], s[62:63] sc1
  v_mfma_f32_16x16x32_bf16 v[48:51], a[108:111], v[96:99], v[48:51]
  v_mfma_f32_16x16x32_bf16 v[56:59], a[188:191], v[96:99], v[56:59]
  s_waitcnt lgkmcnt(4)
  v_mfma_f32_16x16x32_bf16 v[36:39], v[204:207], v[100:103], v[36:39]
  v_mul_f32 v128, s57, v68
  v_mul_f32 v129, s57, v69
  v_mfma_f32_16x16x32_bf16 v[44:47], a[28:31], v[100:103], v[44:47]
  v_mul_f32 v130, s57, v70
  v_mul_f32 v131, s57, v71
  v_mfma_f32_16x16x32_bf16 v[52:55], a[108:111], v[100:103], v[52:55]
  v_exp_f32 v128, v128
  v_exp_f32 v129, v129
  v_mfma_f32_16x16x32_bf16 v[60:63], a[188:191], v[100:103], v[60:63]
  v_exp_f32 v130, v130
  v_exp_f32 v131, v131
  ds_read_b128 v[96:99], v3 offset:12288
  ds_read_b128 v[100:103], v3 offset:13312
  s_waitcnt lgkmcnt(5)
  v_mfma_f32_16x16x32_bf16 v[32:35], v[208:211], v[104:107], v[32:35]
  v_mul_f32 v68, v68, v84
  v_mul_f32 v69, v69, v85
  v_mfma_f32_16x16x32_bf16 v[40:43], a[32:35], v[104:107], v[40:43]
  v_mul_f32 v70, v70, v86
  v_mul_f32 v71, v71, v87
  v_mfma_f32_16x16x32_bf16 v[48:51], a[112:115], v[104:107], v[48:51]
  v_add_f32 v128, 1.0, v128
  v_add_f32 v129, 1.0, v129
  v_mfma_f32_16x16x32_bf16 v[56:59], a[192:195], v[104:107], v[56:59]
  v_add_f32 v130, 1.0, v130
  v_add_f32 v131, 1.0, v131
  s_waitcnt lgkmcnt(4)
  v_mfma_f32_16x16x32_bf16 v[36:39], v[208:211], v[108:111], v[36:39]
  v_rcp_f32 v128, v128
  v_rcp_f32 v129, v129
  v_mfma_f32_16x16x32_bf16 v[44:47], a[32:35], v[108:111], v[44:47]
  v_rcp_f32 v130, v130
  v_rcp_f32 v131, v131
  v_mfma_f32_16x16x32_bf16 v[52:55], a[112:115], v[108:111], v[52:55]
  s_nop 0
  v_mul_f32 v68, v68, v128
  v_mfma_f32_16x16x32_bf16 v[60:63], a[192:195], v[108:111], v[60:63]
  v_mul_f32 v69, v69, v129
  v_mul_f32 v70, v70, v130
  ds_read_b128 v[104:107], v3 offset:14336
  ds_read_b128 v[108:111], v3 offset:15360
  s_waitcnt lgkmcnt(5)
  v_mfma_f32_16x16x32_bf16 v[32:35], v[212:215], v[112:115], v[32:35]
  v_mul_f32 v71, v71, v131
  v_cvt_pk_bf16_f32 v124, v68, v69
  v_mfma_f32_16x16x32_bf16 v[40:43], a[36:39], v[112:115], v[40:43]
  v_cvt_pk_bf16_f32 v125, v70, v71
  v_mul_f32 v128, s57, v76
  v_mfma_f32_16x16x32_bf16 v[48:51], a[116:119], v[112:115], v[48:51]
  v_mul_f32 v129, s57, v77
  v_mul_f32 v130, s57, v78
  v_mfma_f32_16x16x32_bf16 v[56:59], a[196:199], v[112:115], v[56:59]
  v_mul_f32 v131, s57, v79
  v_exp_f32 v128, v128
  s_waitcnt lgkmcnt(4)
  v_mfma_f32_16x16x32_bf16 v[36:39], v[212:215], v[116:119], v[36:39]
  v_exp_f32 v129, v129
  v_exp_f32 v130, v130
  v_mfma_f32_16x16x32_bf16 v[44:47], a[36:39], v[116:119], v[44:47]
  v_exp_f32 v131, v131
  v_mul_f32 v76, v76, v92
  v_mfma_f32_16x16x32_bf16 v[52:55], a[116:119], v[116:119], v[52:55]
  v_mul_f32 v77, v77, v93
  v_mul_f32 v78, v78, v94
  v_mfma_f32_16x16x32_bf16 v[60:63], a[196:199], v[116:119], v[60:63]
  v_mul_f32 v79, v79, v95
  v_add_f32 v128, 1.0, v128
  ds_read_b128 v[112:115], v3 offset:16384
  ds_read_b128 v[116:119], v3 offset:17408
  s_waitcnt lgkmcnt(5)
  v_mfma_f32_16x16x32_bf16 v[32:35], v[216:219], v[96:99], v[32:35]
  v_add_f32 v129, 1.0, v129
  v_add_f32 v130, 1.0, v130
  v_mfma_f32_16x16x32_bf16 v[40:43], a[40:43], v[96:99], v[40:43]
  v_add_f32 v131, 1.0, v131
  v_rcp_f32 v128, v128
  v_mfma_f32_16x16x32_bf16 v[48:51], a[120:123], v[96:99], v[48:51]
  v_rcp_f32 v129, v129
  v_rcp_f32 v130, v130
  v_mfma_f32_16x16x32_bf16 v[56:59], a[200:203], v[96:99], v[56:59]
  v_rcp_f32 v131, v131
  s_nop 0
  s_waitcnt lgkmcnt(4)
  v_mfma_f32_16x16x32_bf16 v[36:39], v[216:219], v[100:103], v[36:39]
  v_mul_f32 v76, v76, v128
  v_mul_f32 v77, v77, v129
  v_mfma_f32_16x16x32_bf16 v[44:47], a[40:43], v[100:103], v[44:47]
  v_mul_f32 v78, v78, v130
  v_mul_f32 v79, v79, v131
  v_mfma_f32_16x16x32_bf16 v[52:55], a[120:123], v[100:103], v[52:55]
  v_cvt_pk_bf16_f32 v126, v76, v77
  v_cvt_pk_bf16_f32 v127, v78, v79
  v_mfma_f32_16x16x32_bf16 v[60:63], a[200:203], v[100:103], v[60:63]
  global_store_dwordx4 v9, v[124:127], s[62:63] sc1
  ds_read_b128 v[96:99], v3 offset:18432
  ds_read_b128 v[100:103], v3 offset:19456
  s_waitcnt lgkmcnt(5)
  v_mfma_f32_16x16x32_bf16 v[32:35], v[220:223], v[104:107], v[32:35]
  v_mfma_f32_16x16x32_bf16 v[40:43], a[44:47], v[104:107], v[40:43]
  v_mfma_f32_16x16x32_bf16 v[48:51], a[124:127], v[104:107], v[48:51]
  s_mul_i32 s48, s54, 40960
  s_add_u32 s48, s48, s59
  v_mfma_f32_16x16x32_bf16 v[56:59], a[204:207], v[104:107], v[56:59]
  s_add_u32 s50, s4, s48
  s_addc_u32 s51, s5, 0
  s_waitcnt lgkmcnt(4)
  v_mfma_f32_16x16x32_bf16 v[36:39], v[220:223], v[108:111], v[36:39]
  s_add_u32 m0, s86, 40960
  s_nop 0
  v_mfma_f32_16x16x32_bf16 v[44:47], a[44:47], v[108:111], v[44:47]
  global_load_lds_dwordx4 v4, s[50:51] offset:0 sc1
  v_mfma_f32_16x16x32_bf16 v[52:55], a[124:127], v[108:111], v[52:55]
  v_mfma_f32_16x16x32_bf16 v[60:63], a[204:207], v[108:111], v[60:63]
  ds_read_b128 v[104:107], v3 offset:20480
  ds_read_b128 v[108:111], v3 offset:21504
  s_waitcnt lgkmcnt(5)
  v_mfma_f32_16x16x32_bf16 v[32:35], v[224:227], v[112:115], v[32:35]
  global_load_lds_dwordx4 v4, s[50:51] offset:1024 sc1
  v_mfma_f32_16x16x32_bf16 v[40:43], a[48:51], v[112:115], v[40:43]
  v_mfma_f32_16x16x32_bf16 v[48:51], a[128:131], v[112:115], v[48:51]
  v_mfma_f32_16x16x32_bf16 v[56:59], a[208:211], v[112:115], v[56:59]
  global_load_lds_dwordx4 v4, s[50:51] offset:2048 sc1
  s_waitcnt lgkmcnt(4)
  v_mfma_f32_16x16x32_bf16 v[36:39], v[224:227], v[116:119], v[36:39]
  v_mfma_f32_16x16x32_bf16 v[44:47], a[48:51], v[116:119], v[44:47]
  v_mfma_f32_16x16x32_bf16 v[52:55], a[128:131], v[116:119], v[52:55]
  global_load_lds_dwordx4 v4, s[50:51] offset:3072 sc1
  v_mfma_f32_16x16x32_bf16 v[60:63], a[208:211], v[116:119], v[60:63]
  ds_read_b128 v[112:115], v3 offset:22528
  ds_read_b128 v[116:119], v3 offset:23552
  s_waitcnt lgkmcnt(5)
  v_mfma_f32_16x16x32_bf16 v[32:35], v[228:231], v[96:99], v[32:35]
  v_mfma_f32_16x16x32_bf16 v[40:43], a[52:55], v[96:99], v[40:43]
  s_add_u32 s50, s50, 4096
  s_addc_u32 s51, s51, 0
  v_mfma_f32_16x16x32_bf16 v[48:51], a[132:135], v[96:99], v[48:51]
  s_add_u32 m0, s86, 45056
  s_nop 0
  v_mfma_f32_16x16x32_bf16 v[56:59], a[212:215], v[96:99], v[56:59]
  global_load_lds_dwordx4 v4, s[50:51] offset:0 sc1
  s_waitcnt lgkmcnt(4)
  v_mfma_f32_16x16x32_bf16 v[36:39], v[228:231], v[100:103], v[36:39]
  v_mfma_f32_16x16x32_bf16 v[44:47], a[52:55], v[100:103], v[44:47]
  v_mfma_f32_16x16x32_bf16 v[52:55], a[132:135], v[100:103], v[52:55]
  global_load_lds_dwordx4 v4, s[50:51] offset:1024 sc1
  v_mfma_f32_16x16x32_bf16 v[60:63], a[212:215], v[100:103], v[60:63]
  ds_read_b128 v[96:99], v3 offset:24576
  ds_read_b128 v[100:103], v3 offset:25600
  s_waitcnt lgkmcnt(5)
  v_mfma_f32_16x16x32_bf16 v[32:35], v[232:235], v[104:107], v[32:35]
  v_mfma_f32_16x16x32_bf16 v[40:43], a[56:59], v[104:107], v[40:43]
  global_load_lds_dwordx4 v4, s[50:51] offset:2048 sc1
  v_mfma_f32_16x16x32_bf16 v[48:51], a[136:139], v[104:107], v[48:51]
  v_mfma_f32_16x16x32_bf16 v[56:59], a[216:219], v[104:107], v[56:59]
  s_waitcnt lgkmcnt(4)
  v_mfma_f32_16x16x32_bf16 v[36:39], v[232:235], v[108:111], v[36:39]
  global_load_lds_dwordx4 v4, s[50:51] offset:3072 sc1
  v_mfma_f32_16x16x32_bf16 v[44:47], a[56:59], v[108:111], v[44:47]
  v_mfma_f32_16x16x32_bf16 v[52:55], a[136:139], v[108:111], v[52:55]
  v_mfma_f32_16x16x32_bf16 v[60:63], a[216:219], v[108:111], v[60:63]
  s_add_u32 s50, s50, 4096
  s_addc_u32 s51, s51, 0
  ds_read_b128 v[104:107], v3 offset:26624
  ds_read_b128 v[108:111], v3 offset:27648
  s_waitcnt lgkmcnt(5)
  v_mfma_f32_16x16x32_bf16 v[32:35], v[236:239], v[112:115], v[32:35]
  s_add_u32 m0, s86, 49152
  s_nop 0
  v_mfma_f32_16x16x32_bf16 v[40:43], a[60:63], v[112:115], v[40:43]
  global_load_lds_dwordx4 v4, s[50:51] offset:0 sc1
  v_mfma_f32_16x16x32_bf16 v[48:51], a[140:143], v[112:115], v[48:51]
  v_mfma_f32_16x16x32_bf16 v[56:59], a[220:223], v[112:115], v[56:59]
  s_waitcnt lgkmcnt(4)
  v_mfma_f32_16x16x32_bf16 v[36:39], v[236:239], v[116:119], v[36:39]
  global_load_lds_dwordx4 v4, s[50:51] offset:1024 sc1
  v_mfma_f32_16x16x32_bf16 v[44:47], a[60:63], v[116:119], v[44:47]
  v_mfma_f32_16x16x32_bf16 v[52:55], a[140:143], v[116:119], v[52:55]
  v_mfma_f32_16x16x32_bf16 v[60:63], a[220:223], v[116:119], v[60:63]
  ds_read_b128 v[112:115], v3 offset:28672
  ds_read_b128 v[116:119], v3 offset:29696
  s_waitcnt lgkmcnt(5)
  v_mfma_f32_16x16x32_bf16 v[32:35], v[240:243], v[96:99], v[32:35]
  v_mfma_f32_16x16x32_bf16 v[40:43], a[64:67], v[96:99], v[40:43]
  v_mfma_f32_16x16x32_bf16 v[48:51], a[144:147], v[96:99], v[48:51]
  v_mfma_f32_16x16x32_bf16 v[56:59], a[224:227], v[96:99], v[56:59]
  s_waitcnt lgkmcnt(4)
  v_mfma_f32_16x16x32_bf16 v[36:39], v[240:243], v[100:103], v[36:39]
  v_mfma_f32_16x16x32_bf16 v[44:47], a[64:67], v[100:103], v[44:47]
  v_mfma_f32_16x16x32_bf16 v[52:55], a[144:147], v[100:103], v[52:55]
  v_mfma_f32_16x16x32_bf16 v[60:63], a[224:227], v[100:103], v[60:63]
  ds_read_b128 v[96:99], v3 offset:30720
  ds_read_b128 v[100:103], v3 offset:31744
  s_waitcnt lgkmcnt(5)
  v_mfma_f32_16x16x32_bf16 v[32:35], v[244:247], v[104:107], v[32:35]
  v_mfma_f32_16x16x32_bf16 v[40:43], a[68:71], v[104:107], v[40:43]
  v_mfma_f32_16x16x32_bf16 v[48:51], a[148:151], v[104:107], v[48:51]
  v_mfma_f32_16x16x32_bf16 v[56:59], a[228:231], v[104:107], v[56:59]
  s_waitcnt lgkmcnt(4)
  v_mfma_f32_16x16x32_bf16 v[36:39], v[244:247], v[108:111], v[36:39]
  v_mfma_f32_16x16x32_bf16 v[44:47], a[68:71], v[108:111], v[44:47]
  v_mfma_f32_16x16x32_bf16 v[52:55], a[148:151], v[108:111], v[52:55]
  v_mfma_f32_16x16x32_bf16 v[60:63], a[228:231], v[108:111], v[60:63]
  ds_read_b128 v[104:107], v3 offset:32768
  ds_read_b128 v[108:111], v3 offset:33792
  s_waitcnt lgkmcnt(5)
  v_mfma_f32_16x16x32_bf16 v[32:35], v[248:251], v[112:115], v[32:35]
  v_mfma_f32_16x16x32_bf16 v[40:43], a[72:75], v[112:115], v[40:43]
  v_mfma_f32_16x16x32_bf16 v[48:51], a[152:155], v[112:115], v[48:51]
  v_mfma_f32_16x16x32_bf16 v[56:59], a[232:235], v[112:115], v[56:59]
  s_waitcnt lgkmcnt(4)
  v_mfma_f32_16x16x32_bf16 v[36:39], v[248:251], v[116:119], v[36:39]
  v_mfma_f32_16x16x32_bf16 v[44:47], a[72:75], v[116:119], v[44:47]
  v_mfma_f32_16x16x32_bf16 v[52:55], a[152:155], v[116:119], v[52:55]
  v_mfma_f32_16x16x32_bf16 v[60:63], a[232:235], v[116:119], v[60:63]
  ds_read_b128 v[112:115], v3 offset:34816
  ds_read_b128 v[116:119], v3 offset:35840
  s_waitcnt lgkmcnt(5)
  v_mfma_f32_16x16x32_bf16 v[32:35], v[252:255], v[96:99], v[32:35]
  v_mfma_f32_16x16x32_bf16 v[40:43], a[76:79], v[96:99], v[40:43]
  v_mfma_f32_16x16x32_bf16 v[48:51], a[156:159], v[96:99], v[48:51]
  v_mfma_f32_16x16x32_bf16 v[56:59], a[236:239], v[96:99], v[56:59]
  s_waitcnt lgkmcnt(4)
  v_mfma_f32_16x16x32_bf16 v[36:39], v[252:255], v[100:103], v[36:39]
  v_mfma_f32_16x16x32_bf16 v[44:47], a[76:79], v[100:103], v[44:47]
  v_mfma_f32_16x16x32_bf16 v[52:55], a[156:159], v[100:103], v[52:55]
  v_mfma_f32_16x16x32_bf16 v[60:63], a[236:239], v[100:103], v[60:63]
  ds_read_b128 v[96:99], v3 offset:36864
  ds_read_b128 v[100:103], v3 offset:37888
  s_waitcnt lgkmcnt(5)
  v_mfma_f32_16x16x32_bf16 v[32:35], a[0:3], v[104:107], v[32:35]
  v_mfma_f32_16x16x32_bf16 v[40:43], a[80:83], v[104:107], v[40:43]
  v_mfma_f32_16x16x32_bf16 v[48:51], a[160:163], v[104:107], v[48:51]
  v_mfma_f32_16x16x32_bf16 v[56:59], a[240:243], v[104:107], v[56:59]
  s_waitcnt lgkmcnt(4)
  v_mfma_f32_16x16x32_bf16 v[36:39], a[0:3], v[108:111], v[36:39]
  v_mfma_f32_16x16x32_bf16 v[44:47], a[80:83], v[108:111], v[44:47]
  v_mfma_f32_16x16x32_bf16 v[52:55], a[160:163], v[108:111], v[52:55]
  v_mfma_f32_16x16x32_bf16 v[60:63], a[240:243], v[108:111], v[60:63]
  ds_read_b128 v[104:107], v3 offset:38912
  ds_read_b128 v[108:111], v3 offset:39936
  s_waitcnt lgkmcnt(5)
  v_mfma_f32_16x16x32_bf16 v[32:35], a[4:7], v[112:115], v[32:35]
  v_mfma_f32_16x16x32_bf16 v[40:43], a[84:87], v[112:115], v[40:43]
  v_mfma_f32_16x16x32_bf16 v[48:51], a[164:167], v[112:115], v[48:51]
  v_mfma_f32_16x16x32_bf16 v[56:59], a[244:247], v[112:115], v[56:59]
  s_waitcnt lgkmcnt(4)
  v_mfma_f32_16x16x32_bf16 v[36:39], a[4:7], v[116:119], v[36:39]
  v_mfma_f32_16x16x32_bf16 v[44:47], a[84:87], v[116:119], v[44:47]
  v_mfma_f32_16x16x32_bf16 v[52:55], a[164:167], v[116:119], v[52:55]
  v_mfma_f32_16x16x32_bf16 v[60:63], a[244:247], v[116:119], v[60:63]
  s_waitcnt lgkmcnt(3)
  v_mfma_f32_16x16x32_bf16 v[32:35], a[8:11], v[96:99], v[32:35]
  v_mfma_f32_16x16x32_bf16 v[40:43], a[88:91], v[96:99], v[40:43]
  v_mfma_f32_16x16x32_bf16 v[48:51], a[168:171], v[96:99], v[48:51]
  v_mfma_f32_16x16x32_bf16 v[56:59], a[248:251], v[96:99], v[56:59]
  s_waitcnt lgkmcnt(2)
  v_mfma_f32_16x16x32_bf16 v[36:39], a[8:11], v[100:103], v[36:39]
  v_mfma_f32_16x16x32_bf16 v[44:47], a[88:91], v[100:103], v[44:47]
  v_mfma_f32_16x16x32_bf16 v[52:55], a[168:171], v[100:103], v[52:55]
  v_mfma_f32_16x16x32_bf16 v[60:63], a[248:251], v[100:103], v[60:63]
  s_waitcnt lgkmcnt(1)
  v_mfma_f32_16x16x32_bf16 v[32:35], a[12:15], v[104:107], v[32:35]
  v_mfma_f32_16x16x32_bf16 v[40:43], a[92:95], v[104:107], v[40:43]
  v_mfma_f32_16x16x32_bf16 v[48:51], a[172:175], v[104:107], v[48:51]
  v_mfma_f32_16x16x32_bf16 v[56:59], a[252:255], v[104:107], v[56:59]
  s_waitcnt lgkmcnt(0)
  v_mfma_f32_16x16x32_bf16 v[36:39], a[12:15], v[108:111], v[36:39]
  v_mfma_f32_16x16x32_bf16 v[44:47], a[92:95], v[108:111], v[44:47]
  v_mfma_f32_16x16x32_bf16 v[52:55], a[172:175], v[108:111], v[52:55]
  v_mfma_f32_16x16x32_bf16 v[60:63], a[252:255], v[108:111], v[60:63]
  s_mov_b32 s47, s46
  s_mov_b32 s46, s44
  s_mov_b32 s44, s52
  s_cmp_lt_u32 s44, 64
  s_cbranch_scc1 FFN1_loop
FFN1_fin0:
  s_nop 7
  s_mul_i32 s60, s46, 98304
  s_add_u32 s60, s60, 0x300000
  s_add_u32 s62, s4, s60
  s_addc_u32 s63, s5, 0
  v_mul_f32 v128, s57, v32
  v_mul_f32 v129, s57, v33
  v_mul_f32 v130, s57, v34
  v_mul_f32 v131, s57, v35
  v_exp_f32 v128, v128
  v_exp_f32 v129, v129
  v_exp_f32 v130, v130
  v_exp_f32 v131, v131
  v_mul_f32 v32, v32, v48
  v_mul_f32 v33, v33, v49
  v_mul_f32 v34, v34, v50
  v_mul_f32 v35, v35, v51
  v_add_f32 v128, 1.0, v128
  v_add_f32 v129, 1.0, v129
  v_add_f32 v130, 1.0, v130
  v_add_f32 v131, 1.0, v131
  v_rcp_f32 v128, v128
  v_rcp_f32 v129, v129
  v_rcp_f32 v130, v130
  v_rcp_f32 v131, v131
  s_nop 0
  v_mul_f32 v32, v32, v128
  v_mul_f32 v33, v33, v129
  v_mul_f32 v34, v34, v130
  v_mul_f32 v35, v35, v131
  v_cvt_pk_bf16_f32 v120, v32, v33
  v_cvt_pk_bf16_f32 v121, v34, v35
  v_mul_f32 v128, s57, v40
  v_mul_f32 v129, s57, v41
  v_mul_f32 v130, s57, v42
  v_mul_f32 v131, s57, v43
  v_exp_f32 v128, v128
  v_exp_f32 v129, v129
  v_exp_f32 v130, v130
  v_exp_f32 v131, v131
  v_mul_f32 v40, v40, v56
  v_mul_f32 v41, v41, v57
  v_mul_f32 v42, v42, v58
  v_mul_f32 v43, v43, v59
  v_add_f32 v128, 1.0, v128
  v_add_f32 v129, 1.0, v129
  v_add_f32 v130, 1.0, v130
  v_add_f32 v131, 1.0, v131
  v_rcp_f32 v128, v128
  v_rcp_f32 v129, v129
  v_rcp_f32 v130, v130
  v_rcp_f32 v131, v131
  s_nop 0
  v_mul_f32 v40, v40, v128
  v_mul_f32 v41, v41, v129
  v_mul_f32 v42, v42, v130
  v_mul_f32 v43, v43, v131
  v_cvt_pk_bf16_f32 v122, v40, v41
  v_cvt_pk_bf16_f32 v123, v42, v43
  global_store_dwordx4 v8, v[120:123], s[62:63] sc1
  v_mul_f32 v128, s57, v36
  v_mul_f32 v129, s57, v37
  v_mul_f32 v130, s57, v38
  v_mul_f32 v131, s57, v39
  v_exp_f32 v128, v128
  v_exp_f32 v129, v129
  v_exp_f32 v130, v130
  v_exp_f32 v131, v131
  v_mul_f32 v36, v36, v52
  v_mul_f32 v37, v37, v53
  v_mul_f32 v38, v38, v54
  v_mul_f32 v39, v39, v55
  v_add_f32 v128, 1.0, v128
  v_add_f32 v129, 1.0, v129
  v_add_f32 v130, 1.0, v130
  v_add_f32 v131, 1.0, v131
  v_rcp_f32 v128, v128
  v_rcp_f32 v129, v129
  v_rcp_f32 v130, v130
  v_rcp_f32 v131, v131
  s_nop 0
  v_mul_f32 v36, v36, v128
  v_mul_f32 v37, v37, v129
  v_mul_f32 v38, v38, v130
  v_mul_f32 v39, v39, v131
  v_cvt_pk_bf16_f32 v124, v36, v37
  v_cvt_pk_bf16_f32 v125, v38, v39
  v_mul_f32 v128, s57, v44
  v_mul_f32 v129, s57, v45
  v_mul_f32 v130, s57, v46
  v_mul_f32 v131, s57, v47
  v_exp_f32 v128, v128
  v_exp_f32 v129, v129
  v_exp_f32 v130, v130
  v_exp_f32 v131, v131
  v_mul_f32 v44, v44, v60
  v_mul_f32 v45, v45, v61
  v_mul_f32 v46, v46, v62
  v_mul_f32 v47, v47, v63
  v_add_f32 v128, 1.0, v128
  v_add_f32 v129, 1.0, v129
  v_add_f32 v130, 1.0, v130
  v_add_f32 v131, 1.0, v131
  v_rcp_f32 v128, v128
  v_rcp_f32 v129, v129
  v_rcp_f32 v130, v130
  v_rcp_f32 v131, v131
  s_nop 0
  v_mul_f32 v44, v44, v128
  v_mul_f32 v45, v45, v129
  v_mul_f32 v46, v46, v130
  v_mul_f32 v47, v47, v131
  v_cvt_pk_bf16_f32 v126, v44, v45
  v_cvt_pk_bf16_f32 v127, v46, v47
  global_store_dwordx4 v9, v[124:127], s[62:63] sc1
  s_branch FFN1_tail
FFN1_fin1:
  s_nop 7
  s_mul_i32 s60, s46, 98304
  s_add_u32 s60, s60, 0x300000
  s_add_u32 s62, s4, s60
  s_addc_u32 s63, s5, 0
  v_mul_f32 v128, s57, v64
  v_mul_f32 v129, s57, v65
  v_mul_f32 v130, s57, v66
  v_mul_f32 v131, s57, v67
  v_exp_f32 v128, v128
  v_exp_f32 v129, v129
  v_exp_f32 v130, v130
  v_exp_f32 v131, v131
  v_mul_f32 v64, v64, v80
  v_mul_f32 v65, v65, v81
  v_mul_f32 v66, v66, v82
  v_mul_f32 v67, v67, v83
  v_add_f32 v128, 1.0, v128
  v_add_f32 v129, 1.0, v129
  v_add_f32 v130, 1.0, v130
  v_add_f32 v131, 1.0, v131
  v_rcp_f32 v128, v128
  v_rcp_f32 v129, v129
  v_rcp_f32 v130, v130
  v_rcp_f32 v131, v131
  s_nop 0
  v_mul_f32 v64, v64, v128
  v_mul_f32 v65, v65, v129
  v_mul_f32 v66, v66, v130
  v_mul_f32 v67, v67, v131
  v_cvt_pk_bf16_f32 v120, v64, v65
  v_cvt_pk_bf16_f32 v121, v66, v67
  v_mul_f32 v128, s57, v72
  v_mul_f32 v129, s57, v73
  v_mul_f32 v130, s57, v74
  v_mul_f32 v131, s57, v75
  v_exp_f32 v128, v128
  v_exp_f32 v129, v129
  v_exp_f32 v130, v130
  v_exp_f32 v131, v131
  v_mul_f32 v72, v72, v88
  v_mul_f32 v73, v73, v89
  v_mul_f32 v74, v74, v90
  v_mul_f32 v75, v75, v91
  v_add_f32 v128, 1.0, v128
  v_add_f32 v129, 1.0, v129
  v_add_f32 v130, 1.0, v130
  v_add_f32 v131, 1.0, v131
  v_rcp_f32 v128, v128
  v_rcp_f32 v129, v129
  v_rcp_f32 v130, v130
  v_rcp_f32 v131, v131
  s_nop 0
  v_mul_f32 v72, v72, v128
  v_mul_f32 v73, v73, v129
  v_mul_f32 v74, v74, v130
  v_mul_f32 v75, v75, v131
  v_cvt_pk_bf16_f32 v122, v72, v73
  v_cvt_pk_bf16_f32 v123, v74, v75
  global_store_dwordx4 v8, v[120:123], s[62:63] sc1
  v_mul_f32 v128, s57, v68
  v_mul_f32 v129, s57, v69
  v_mul_f32 v130, s57, v70
  v_mul_f32 v131, s57, v71
  v_exp_f32 v128, v128
  v_exp_f32 v129, v129
  v_exp_f32 v130, v130
  v_exp_f32 v131, v131
  v_mul_f32 v68, v68, v84
  v_mul_f32 v69, v69, v85
  v_mul_f32 v70, v70, v86
  v_mul_f32 v71, v71, v87
  v_add_f32 v128, 1.0, v128
  v_add_f32 v129, 1.0, v129
  v_add_f32 v130, 1.0, v130
  v_add_f32 v131, 1.0, v131
  v_rcp_f32 v128, v128
  v_rcp_f32 v129, v129
  v_rcp_f32 v130, v130
  v_rcp_f32 v131, v131
  s_nop 0
  v_mul_f32 v68, v68, v128
  v_mul_f32 v69, v69, v129
  v_mul_f32 v70, v70, v130
  v_mul_f32 v71, v71, v131
  v_cvt_pk_bf16_f32 v124, v68, v69
  v_cvt_pk_bf16_f32 v125, v70, v71
  v_mul_f32 v128, s57, v76
  v_mul_f32 v129, s57, v77
  v_mul_f32 v130, s57, v78
  v_mul_f32 v131, s57, v79
  v_exp_f32 v128, v128
  v_exp_f32 v129, v129
  v_exp_f32 v130, v130
  v_exp_f32 v131, v131
  v_mul_f32 v76, v76, v92
  v_mul_f32 v77, v77, v93
  v_mul_f32 v78, v78, v94
  v_mul_f32 v79, v79, v95
  v_add_f32 v128, 1.0, v128
  v_add_f32 v129, 1.0, v129
  v_add_f32 v130, 1.0, v130
  v_add_f32 v131, 1.0, v131
  v_rcp_f32 v128, v128
  v_rcp_f32 v129, v129
  v_rcp_f32 v130, v130
  v_rcp_f32 v131, v131
  s_nop 0
  v_mul_f32 v76, v76, v128
  v_mul_f32 v77, v77, v129
  v_mul_f32 v78, v78, v130
  v_mul_f32 v79, v79, v131
  v_cvt_pk_bf16_f32 v126, v76, v77
  v_cvt_pk_bf16_f32 v127, v78, v79
  global_store_dwordx4 v9, v[124:127], s[62:63] sc1
FFN1_tail:
  s_waitcnt vmcnt(0)
  s_barrier
  s_cmp_eq_u32 s47, -1
  s_cbranch_scc1 FS_130
  s_cmp_lg_u32 s3, 0
  s_cbranch_scc1 FS_130
  s_lshl_b32 s48, s47, 6
  s_add_u32 s48, s48, s58
  v_mov_b32 v5, s48
  v_mov_b32 v6, 1
  s_mov_b64 exec, 1
  global_store_dword v5, v6, s[4:5] sc1
  s_mov_b64 exec, -1
FS_130:
  s_cmp_eq_u32 s46, -1
  s_cbranch_scc1 FS_131
  s_cmp_lg_u32 s3, 0
  s_cbranch_scc1 FS_131
  s_lshl_b32 s48, s46, 6
  s_add_u32 s48, s48, s58
  v_mov_b32 v5, s48
  v_mov_b32 v6, 1
  s_mov_b64 exec, 1
  global_store_dword v5, v6, s[4:5] sc1
  s_mov_b64 exec, -1
FS_131:
FFN1_end:
  s_cmp_ge_u32 s40, 125
  s_cbranch_scc1 FFN2_end
  s_load_dwordx2 s[8:9], s[0:1], 80
  s_load_dwordx2 s[10:11], s[0:1], 0
  s_mul_i32 s44, s40, 13108
  s_lshr_b32 s44, s44, 16
  s_mul_i32 s48, s44, 5
  s_sub_u32 s42, s40, s48
  v_add_u32 v20, 0, v0
  v_lshrrev_b32 v21, 4, v20
  v_and_b32 v22, 15, v20
  v_and_b32 v23, 7, v21
  v_lshlrev_b32 v23, 1, v23
  v_xor_b32 v22, v22, v23
  s_mov_b32 s90, 1280
  v_mul_lo_u32 v21, v21, s90
  v_lshl_add_u32 v8, v22, 4, v21
  v_add_u32 v20, 256, v0
  v_lshrrev_b32 v21, 4, v20
  v_and_b32 v22, 15, v20
  v_and_b32 v23, 7, v21
  v_lshlrev_b32 v23, 1, v23
  v_xor_b32 v22, v22, v23
  s_mov_b32 s90, 1280
  v_mul_lo_u32 v21, v21, s90
  v_lshl_add_u32 v9, v22, 4, v21
  s_mov_b32 s91, 256
  s_lshl_b32 s56, s3, 1
  v_lshrrev_b32 v20, 2, v1
  v_and_b32 v21, 7, v20
  v_xor_b32 v21, s56, v21
  v_lshlrev_b32 v21, 5, v21
  v_mad_u32_u24 v21, v20, s91, v21
  v_and_b32 v20, 3, v1
  v_lshl_add_u32 v12, v20, 3, v21
  s_add_u32 s56, s56, 1
  v_lshrrev_b32 v20, 2, v1
  v_and_b32 v21, 7, v20
  v_xor_b32 v21, s56, v21
  v_lshlrev_b32 v21, 5, v21
  v_mad_u32_u24 v21, v20, s91, v21
  v_and_b32 v20, 3, v1
  v_lshl_add_u32 v13, v20, 3, v21
  s_waitcnt lgkmcnt(0)
  s_lshl_b32 s48, s42, 8
  s_add_u32 s8, s8, s48
  s_addc_u32 s9, s9, 0
  s_lshl_b32 s92, s3, 10
  s_add_u32 m0, s92, 0
  s_nop 0
  global_load_lds_dwordx4 v8, s[8:9]
  s_add_u32 m0, s92, 4096
  s_nop 0
  global_load_lds_dwordx4 v9, s[8:9]
  s_add_u32 s8, s8, 40960
  s_addc_u32 s9, s9, 0
  s_add_u32 m0, s92, 8192
  s_nop 0
  global_load_lds_dwordx4 v8, s[8:9]
  s_add_u32 m0, s92, 12288
  s_nop 0
  global_load_lds_dwordx4 v9, s[8:9]
  s_add_u32 s8, s8, 40960
  s_addc_u32 s9, s9, 0
  s_add_u32 m0, s92, 16384
  s_nop 0
  global_load_lds_dwordx4 v8, s[8:9]
  s_add_u32 m0, s92, 20480
  s_nop 0
  global_load_lds_dwordx4 v9, s[8:9]
  s_add_u32 s8, s8, 40960
  s_addc_u32 s9, s9, 0
  s_add_u32 m0, s92, 24576
  s_nop 0
  global_load_lds_dwordx4 v8, s[8:9]
  s_add_u32 m0, s92, 28672
  s_nop 0
  global_load_lds_dwordx4 v9, s[8:9]
  s_add_u32 s8, s8, 40960
  s_addc_u32 s9, s9, 0
  s_add_u32 m0, s92, 32768
  s_nop 0
  global_load_lds_dwordx4 v8, s[8:9]
  s_add_u32 m0, s92, 36864
  s_nop 0
  global_load_lds_dwordx4 v9, s[8:9]
  s_add_u32 s8, s8, 40960
  s_addc_u32 s9, s9, 0
  s_add_u32 m0, s92, 40960
  s_nop 0
  global_load_lds_dwordx4 v8, s[8:9]
  s_add_u32 m0, s92, 45056
  s_nop 0
  global_load_lds_dwordx4 v9, s[8:9]
  s_add_u32 s8, s8, 40960
  s_addc_u32 s9, s9, 0
  s_add_u32 m0, s92, 49152
  s_nop 0
  global_load_lds_dwordx4 v8, s[8:9]
  s_add_u32 m0, s92, 53248
  s_nop 0
  global_load_lds_dwordx4 v9, s[8:9]
  s_add_u32 s8, s8, 40960
  s_addc_u32 s9, s9, 0
  s_add_u32 m0, s92, 57344
  s_nop 0
  global_load_lds_dwordx4 v8, s[8:9]
  s_add_u32 m0, s92, 61440
  s_nop 0
  global_load_lds_dwordx4 v9, s[8:9]
  s_add_u32 s8, s8, 40960
  s_addc_u32 s9, s9, 0
  s_add_u32 m0, s92, 65536
  s_nop 0
  global_load_lds_dwordx4 v8, s[8:9]
  s_add_u32 m0, s92, 69632
  s_nop 0
  global_load_lds_dwordx4 v9, s[8:9]
  s_add_u32 s8, s8, 40960
  s_addc_u32 s9, s9, 0
  s_add_u32 m0, s92, 73728
  s_nop 0
  global_load_lds_dwordx4 v8, s[8:9]
  s_add_u32 m0, s92, 77824
  s_nop 0
  global_load_lds_dwordx4 v9, s[8:9]
  s_add_u32 s8, s8, 40960
  s_addc_u32 s9, s9, 0
  s_add_u32 m0, s92, 81920
  s_nop 0
  global_load_lds_dwordx4 v8, s[8:9]
  s_add_u32 m0, s92, 86016
  s_nop 0
  global_load_lds_dwordx4 v9, s[8:9]
  s_add_u32 s8, s8, 40960
  s_addc_u32 s9, s9, 0
  s_add_u32 m0, s92, 90112
  s_nop 0
  global_load_lds_dwordx4 v8, s[8:9]
  s_add_u32 m0, s92, 94208
  s_nop 0
  global_load_lds_dwordx4 v9, s[8:9]
  s_add_u32 s8, s8, 40960
  s_addc_u32 s9, s9, 0
  s_add_u32 m0, s92, 98304
  s_nop 0
  global_load_lds_dwordx4 v8, s[8:9]
  s_add_u32 m0, s92, 102400
  s_nop 0
  global_load_lds_dwordx4 v9, s[8:9]
  s_add_u32 s8, s8, 40960
  s_addc_u32 s9, s9, 0
  s_add_u32 m0, s92, 106496
  s_nop 0
  global_load_lds_dwordx4 v8, s[8:9]
  s_add_u32 m0, s92, 110592
  s_nop 0
  global_load_lds_dwordx4 v9, s[8:9]
  s_add_u32 s8, s8, 40960
  s_addc_u32 s9, s9, 0
  s_add_u32 m0, s92, 114688
  s_nop 0
  global_load_lds_dwordx4 v8, s[8:9]
  s_add_u32 m0, s92, 118784
  s_nop 0
  global_load_lds_dwordx4 v9, s[8:9]
  s_add_u32 s8, s8, 40960
  s_addc_u32 s9, s9, 0
  s_add_u32 m0, s92, 122880
  s_nop 0
  global_load_lds_dwordx4 v8, s[8:9]
  s_add_u32 m0, s92, 126976
  s_nop 0
  global_load_lds_dwordx4 v9, s[8:9]
  s_add_u32 s8, s8, 40960
  s_addc_u32 s9, s9, 0
  s_add_u32 m0, s92, 131072
  s_nop 0
  global_load_lds_dwordx4 v8, s[8:9]
  s_add_u32 m0, s92, 135168
  s_nop 0
  global_load_lds_dwordx4 v9, s[8:9]
  s_add_u32 s8, s8, 40960
  s_addc_u32 s9, s9, 0
  s_add_u32 m0, s92, 139264
  s_nop 0
  global_load_lds_dwordx4 v8, s[8:9]
  s_add_u32 m0, s92, 143360
  s_nop 0
  global_load_lds_dwordx4 v9, s[8:9]
  s_add_u32 s8, s8, 40960
  s_addc_u32 s9, s9, 0
  s_add_u32 m0, s92, 147456
  s_nop 0
  global_load_lds_dwordx4 v8, s[8:9]
  s_add_u32 m0, s92, 151552
  s_nop 0
  global_load_lds_dwordx4 v9, s[8:9]
  s_add_u32 s8, s8, 40960
  s_addc_u32 s9, s9, 0
  s_add_u32 m0, s92, 155648
  s_nop 0
  global_load_lds_dwordx4 v8, s[8:9]
  s_add_u32 m0, s92, 159744
  s_nop 0
  global_load_lds_dwordx4 v9, s[8:9]
  s_add_u32 s8, s8, 40960
  s_addc_u32 s9, s9, 0
  s_waitcnt vmcnt(36)
  s_waitcnt lgkmcnt(0)
  s_barrier
  v_add_u32 v16, 0, v12
  ds_read_b64_tr_b16 v[128:129], v16
  ds_read_b64_tr_b16 v[130:131], v16 offset:4096
  v_add_u32 v17, 0, v13
  ds_read_b64_tr_b16 a[64:65], v17
  ds_read_b64_tr_b16 a[66:67], v17 offset:4096
  v_add_u32 v18, 8192, v12
  ds_read_b64_tr_b16 v[132:133], v18
  ds_read_b64_tr_b16 v[134:135], v18 offset:4096
  v_add_u32 v19, 8192, v13
  ds_read_b64_tr_b16 a[68:69], v19
  ds_read_b64_tr_b16 a[70:71], v19 offset:4096
  s_waitcnt vmcnt(32)
  s_waitcnt lgkmcnt(0)
  s_barrier
  s_add_u32 m0, s92, 0
  s_nop 0
  global_load_lds_dwordx4 v8, s[8:9]
  s_add_u32 m0, s92, 4096
  s_nop 0
  global_load_lds_dwordx4 v9, s[8:9]
  s_add_u32 s8, s8, 40960
  s_addc_u32 s9, s9, 0
  s_add_u32 m0, s92, 8192
  s_nop 0
  global_load_lds_dwordx4 v8, s[8:9]
  s_add_u32 m0, s92, 12288
  s_nop 0
  global_load_lds_dwordx4 v9, s[8:9]
  s_add_u32 s8, s8, 40960
  s_addc_u32 s9, s9, 0
  v_add_u32 v16, 16384, v12
  ds_read_b64_tr_b16 v[136:137], v16
  ds_read_b64_tr_b16 v[138:139], v16 offset:4096
  v_add_u32 v17, 16384, v13
  ds_read_b64_tr_b16 a[72:73], v17
  ds_read_b64_tr_b16 a[74:75], v17 offset:4096
  v_add_u32 v18, 24576, v12
  ds_read_b64_tr_b16 v[140:141], v18
  ds_read_b64_tr_b16 v[142:143], v18 offset:4096
  v_add_u32 v19, 24576, v13
  ds_read_b64_tr_b16 a[76:77], v19
  ds_read_b64_tr_b16 a[78:79], v19 offset:4096
  s_waitcnt vmcnt(32)
  s_waitcnt lgkmcnt(0)
  s_barrier
  s_add_u32 m0, s92, 16384
  s_nop 0
  global_load_lds_dwordx4 v8, s[8:9]
  s_add_u32 m0, s92, 20480
  s_nop 0
  global_load_lds_dwordx4 v9, s[8:9]
  s_add_u32 s8, s8, 40960
  s_addc_u32 s9, s9, 0
  s_add_u32 m0, s92, 24576
  s_nop 0
  global_load_lds_dwordx4 v8, s[8:9]
  s_add_u32 m0, s92, 28672
  s_nop 0
  global_load_lds_dwordx4 v9, s[8:9]
  s_add_u32 s8, s8, 40960
  s_addc_u32 s9, s9, 0
  v_add_u32 v16, 32768, v12
  ds_read_b64_tr_b16 v[144:145], v16
  ds_read_b64_tr_b16 v[146:147], v16 offset:4096
  v_add_u32 v17, 32768, v13
  ds_read_b64_tr_b16 a[80:81], v17
  ds_read_b64_tr_b16 a[82:83], v17 offset:4096
  v_add_u32 v18, 40960, v12
  ds_read_b64_tr_b16 v[148:149], v18
  ds_read_b64_tr_b16 v[150:151], v18 offset:4096
  v_add_u32 v19, 40960, v13
  ds_read_b64_tr_b16 a[84:85], v19
  ds_read_b64_tr_b16 a[86:87], v19 offset:4096
  s_waitcnt vmcnt(32)
  s_waitcnt lgkmcnt(0)
  s_barrier
  s_add_u32 m0, s92, 32768
  s_nop 0
  global_load_lds_dwordx4 v8, s[8:9]
  s_add_u32 m0, s92, 36864
  s_nop 0
  global_load_lds_dwordx4 v9, s[8:9]
  s_add_u32 s8, s8, 40960
  s_addc_u32 s9, s9, 0
  s_add_u32 m0, s92, 40960
  s_nop 0
  global_load_lds_dwordx4 v8, s[8:9]
  s_add_u32 m0, s92, 45056
  s_nop 0
  global_load_lds_dwordx4 v9, s[8:9]
  s_add_u32 s8, s8, 40960
  s_addc_u32 s9, s9, 0
  v_add_u32 v16, 49152, v12
  ds_read_b64_tr_b16 v[152:153], v16
  ds_read_b64_tr_b16 v[154:155], v16 offset:4096
  v_add_u32 v17, 49152, v13
  ds_read_b64_tr_b16 a[88:89], v17
  ds_read_b64_tr_b16 a[90:91], v17 offset:4096
  v_add_u32 v18, 57344, v12
  ds_read_b64_tr_b16 v[156:157], v18
  ds_read_b64_tr_b16 v[158:159], v18 offset:4096
  v_add_u32 v19, 57344, v13
  ds_read_b64_tr_b16 a[92:93], v19
  ds_read_b64_tr_b16 a[94:95], v19 offset:4096
  s_waitcnt vmcnt(32)
  s_waitcnt lgkmcnt(0)
  s_barrier
  s_add_u32 m0, s92, 49152
  s_nop 0
  global_load_lds_dwordx4 v8, s[8:9]
  s_add_u32 m0, s92, 53248
  s_nop 0
  global_load_lds_dwordx4 v9, s[8:9]
  s_add_u32 s8, s8, 40960
  s_addc_u32 s9, s9, 0
  s_add_u32 m0, s92, 57344
  s_nop 0
  global_load_lds_dwordx4 v8, s[8:9]
  s_add_u32 m0, s92, 61440
  s_nop 0
  global_load_lds_dwordx4 v9, s[8:9]
  s_add_u32 s8, s8, 40960
  s_addc_u32 s9, s9, 0
  v_add_u32 v16, 65536, v12
  ds_read_b64_tr_b16 v[160:161], v16
  ds_read_b64_tr_b16 v[162:163], v16 offset:4096
  v_add_u32 v17, 65536, v13
  ds_read_b64_tr_b16 a[96:97], v17
  ds_read_b64_tr_b16 a[98:99], v17 offset:4096
  v_add_u32 v18, 73728, v12
  ds_read_b64_tr_b16 v[164:165], v18
  ds_read_b64_tr_b16 v[166:167], v18 offset:4096
  v_add_u32 v19, 73728, v13
  ds_read_b64_tr_b16 a[100:101], v19
  ds_read_b64_tr_b16 a[102:103], v19 offset:4096
  s_waitcnt vmcnt(32)
  s_waitcnt lgkmcnt(0)
  s_barrier
  s_add_u32 m0, s92, 65536
  s_nop 0
  global_load_lds_dwordx4 v8, s[8:9]
  s_add_u32 m0, s92, 69632
  s_nop 0
  global_load_lds_dwordx4 v9, s[8:9]
  s_add_u32 s8, s8, 40960
  s_addc_u32 s9, s9, 0
  s_add_u32 m0, s92, 73728
  s_nop 0
  global_load_lds_dwordx4 v8, s[8:9]
  s_add_u32 m0, s92, 77824
  s_nop 0
  global_load_lds_dwordx4 v9, s[8:9]
  s_add_u32 s8, s8, 40960
  s_addc_u32 s9, s9, 0
  v_add_u32 v16, 81920, v12
  ds_read_b64_tr_b16 v[168:169], v16
  ds_read_b64_tr_b16 v[170:171], v16 offset:4096
  v_add_u32 v17, 81920, v13
  ds_read_b64_tr_b16 a[104:105], v17
  ds_read_b64_tr_b16 a[106:107], v17 offset:4096
  v_add_u32 v18, 90112, v12
  ds_read_b64_tr_b16 v[172:173], v18
  ds_read_b64_tr_b16 v[174:175], v18 offset:4096
  v_add_u32 v19, 90112, v13
  ds_read_b64_tr_b16 a[108:109], v19
  ds_read_b64_tr_b16 a[110:111], v19 offset:4096
  s_waitcnt vmcnt(32)
  s_waitcnt lgkmcnt(0)
  s_barrier
  s_add_u32 m0, s92, 81920
  s_nop 0
  global_load_lds_dwordx4 v8, s[8:9]
  s_add_u32 m0, s92, 86016
  s_nop 0
  global_load_lds_dwordx4 v9, s[8:9]
  s_add_u32 s8, s8, 40960
  s_addc_u32 s9, s9, 0
  s_add_u32 m0, s92, 90112
  s_nop 0
  global_load_lds_dwordx4 v8, s[8:9]
  s_add_u32 m0, s92, 94208
  s_nop 0
  global_load_lds_dwordx4 v9, s[8:9]
  s_add_u32 s8, s8, 40960
  s_addc_u32 s9, s9, 0
  v_add_u32 v16, 98304, v12
  ds_read_b64_tr_b16 v[176:177], v16
  ds_read_b64_tr_b16 v[178:179], v16 offset:4096
  v_add_u32 v17, 98304, v13
  ds_read_b64_tr_b16 a[112:113], v17
  ds_read_b64_tr_b16 a[114:115], v17 offset:4096
  v_add_u32 v18, 106496, v12
  ds_read_b64_tr_b16 v[180:181], v18
  ds_read_b64_tr_b16 v[182:183], v18 offset:4096
  v_add_u32 v19, 106496, v13
  ds_read_b64_tr_b16 a[116:117], v19
  ds_read_b64_tr_b16 a[118:119], v19 offset:4096
  s_waitcnt vmcnt(32)
  s_waitcnt lgkmcnt(0)
  s_barrier
  s_add_u32 m0, s92, 98304
  s_nop 0
  global_load_lds_dwordx4 v8, s[8:9]
  s_add_u32 m0, s92, 102400
  s_nop 0
  global_load_lds_dwordx4 v9, s[8:9]
  s_add_u32 s8, s8, 40960
  s_addc_u32 s9, s9, 0
  s_add_u32 m0, s92, 106496
  s_nop 0
  global_load_lds_dwordx4 v8, s[8:9]
  s_add_u32 m0, s92, 110592
  s_nop 0
  global_load_lds_dwordx4 v9, s[8:9]
  s_add_u32 s8, s8, 40960
  s_addc_u32 s9, s9, 0
  v_add_u32 v16, 114688, v12
  ds_read_b64_tr_b16 v[184:185], v16
  ds_read_b64_tr_b16 v[186:187], v16 offset:4096
  v_add_u32 v17, 114688, v13
  ds_read_b64_tr_b16 a[120:121], v17
  ds_read_b64_tr_b16 a[122:123], v17 offset:4096
  v_add_u32 v18, 122880, v12
  ds_read_b64_tr_b16 v[188:189], v18
  ds_read_b64_tr_b16 v[190:191], v18 offset:4096
  v_add_u32 v19, 122880, v13
  ds_read_b64_tr_b16 a[124:125], v19
  ds_read_b64_tr_b16 a[126:127], v19 offset:4096
  s_waitcnt vmcnt(32)
  s_waitcnt lgkmcnt(0)
  s_barrier
  s_add_u32 m0, s92, 114688
  s_nop 0
  global_load_lds_dwordx4 v8, s[8:9]
  s_add_u32 m0, s92, 118784
  s_nop 0
  global_load_lds_dwordx4 v9, s[8:9]
  s_add_u32 s8, s8, 40960
  s_addc_u32 s9, s9, 0
  s_add_u32 m0, s92, 122880
  s_nop 0
  global_load_lds_dwordx4 v8, s[8:9]
  s_add_u32 m0, s92, 126976
  s_nop 0
  global_load_lds_dwordx4 v9, s[8:9]
  s_add_u32 s8, s8, 40960
  s_addc_u32 s9, s9, 0
  v_add_u32 v16, 131072, v12
  ds_read_b64_tr_b16 v[192:193], v16
  ds_read_b64_tr_b16 v[194:195], v16 offset:4096
  v_add_u32 v17, 131072, v13
  ds_read_b64_tr_b16 a[128:129], v17
  ds_read_b64_tr_b16 a[130:131], v17 offset:4096
  v_add_u32 v18, 139264, v12
  ds_read_b64_tr_b16 v[196:197], v18
  ds_read_b64_tr_b16 v[198:199], v18 offset:4096
  v_add_u32 v19, 139264, v13
  ds_read_b64_tr_b16 a[132:133], v19
  ds_read_b64_tr_b16 a[134:135], v19 offset:4096
  s_waitcnt vmcnt(32)
  s_waitcnt lgkmcnt(0)
  s_barrier
  s_add_u32 m0, s92, 131072
  s_nop 0
  global_load_lds_dwordx4 v8, s[8:9]
  s_add_u32 m0, s92, 135168
  s_nop 0
  global_load_lds_dwordx4 v9, s[8:9]
  s_add_u32 s8, s8, 40960
  s_addc_u32 s9, s9, 0
  s_add_u32 m0, s92, 139264
  s_nop 0
  global_load_lds_dwordx4 v8, s[8:9]
  s_add_u32 m0, s92, 143360
  s_nop 0
  global_load_lds_dwordx4 v9, s[8:9]
  s_add_u32 s8, s8, 40960
  s_addc_u32 s9, s9, 0
  v_add_u32 v16, 147456, v12
  ds_read_b64_tr_b16 v[200:201], v16
  ds_read_b64_tr_b16 v[202:203], v16 offset:4096
  v_add_u32 v17, 147456, v13
  ds_read_b64_tr_b16 a[136:137], v17
  ds_read_b64_tr_b16 a[138:139], v17 offset:4096
  v_add_u32 v18, 155648, v12
  ds_read_b64_tr_b16 v[204:205], v18
  ds_read_b64_tr_b16 v[206:207], v18 offset:4096
  v_add_u32 v19, 155648, v13
  ds_read_b64_tr_b16 a[140:141], v19
  ds_read_b64_tr_b16 a[142:143], v19 offset:4096
  s_waitcnt vmcnt(32)
  s_waitcnt lgkmcnt(0)
  s_barrier
  s_add_u32 m0, s92, 147456
  s_nop 0
  global_load_lds_dwordx4 v8, s[8:9]
  s_add_u32 m0, s92, 151552
  s_nop 0
  global_load_lds_dwordx4 v9, s[8:9]
  s_add_u32 s8, s8, 40960
  s_addc_u32 s9, s9, 0
  s_add_u32 m0, s92, 155648
  s_nop 0
  global_load_lds_dwordx4 v8, s[8:9]
  s_add_u32 m0, s92, 159744
  s_nop 0
  global_load_lds_dwordx4 v9, s[8:9]
  s_add_u32 s8, s8, 40960
  s_addc_u32 s9, s9, 0
  v_add_u32 v16, 0, v12
  ds_read_b64_tr_b16 v[208:209], v16
  ds_read_b64_tr_b16 v[210:211], v16 offset:4096
  v_add_u32 v17, 0, v13
  ds_read_b64_tr_b16 a[144:145], v17
  ds_read_b64_tr_b16 a[146:147], v17 offset:4096
  v_add_u32 v18, 8192, v12
  ds_read_b64_tr_b16 v[212:213], v18
  ds_read_b64_tr_b16 v[214:215], v18 offset:4096
  v_add_u32 v19, 8192, v13
  ds_read_b64_tr_b16 a[148:149], v19
  ds_read_b64_tr_b16 a[150:151], v19 offset:4096
  s_waitcnt vmcnt(32)
  s_waitcnt lgkmcnt(0)
  s_barrier
  s_add_u32 m0, s92, 0
  s_nop 0
  global_load_lds_dwordx4 v8, s[8:9]
  s_add_u32 m0, s92, 4096
  s_nop 0
  global_load_lds_dwordx4 v9, s[8:9]
  s_add_u32 s8, s8, 40960
  s_addc_u32 s9, s9, 0
  s_add_u32 m0, s92, 8192
  s_nop 0
  global_load_lds_dwordx4 v8, s[8:9]
  s_add_u32 m0, s92, 12288
  s_nop 0
  global_load_lds_dwordx4 v9, s[8:9]
  s_add_u32 s8, s8, 40960
  s_addc_u32 s9, s9, 0
  v_add_u32 v16, 16384, v12
  ds_read_b64_tr_b16 v[216:217], v16
  ds_read_b64_tr_b16 v[218:219], v16 offset:4096
  v_add_u32 v17, 16384, v13
  ds_read_b64_tr_b16 a[152:153], v17
  ds_read_b64_tr_b16 a[154:155], v17 offset:4096
  v_add_u32 v18, 24576, v12
  ds_read_b64_tr_b16 v[220:221], v18
  ds_read_b64_tr_b16 v[222:223], v18 offset:4096
  v_add_u32 v19, 24576, v13
  ds_read_b64_tr_b16 a[156:157], v19
  ds_read_b64_tr_b16 a[158:159], v19 offset:4096
  s_waitcnt vmcnt(32)
  s_waitcnt lgkmcnt(0)
  s_barrier
  s_add_u32 m0, s92, 16384
  s_nop 0
  global_load_lds_dwordx4 v8, s[8:9]
  s_add_u32 m0, s92, 20480
  s_nop 0
  global_load_lds_dwordx4 v9, s[8:9]
  s_add_u32 s8, s8, 40960
  s_addc_u32 s9, s9, 0
  s_add_u32 m0, s92, 24576
  s_nop 0
  global_load_lds_dwordx4 v8, s[8:9]
  s_add_u32 m0, s92, 28672
  s_nop 0
  global_load_lds_dwordx4 v9, s[8:9]
  s_add_u32 s8, s8, 40960
  s_addc_u32 s9, s9, 0
  v_add_u32 v16, 32768, v12
  ds_read_b64_tr_b16 v[224:225], v16
  ds_read_b64_tr_b16 v[226:227], v16 offset:4096
  v_add_u32 v17, 32768, v13
  ds_read_b64_tr_b16 a[160:161], v17
  ds_read_b64_tr_b16 a[162:163], v17 offset:4096
  v_add_u32 v18, 40960, v12
  ds_read_b64_tr_b16 v[228:229], v18
  ds_read_b64_tr_b16 v[230:231], v18 offset:4096
  v_add_u32 v19, 40960, v13
  ds_read_b64_tr_b16 a[164:165], v19
  ds_read_b64_tr_b16 a[166:167], v19 offset:4096
  s_waitcnt vmcnt(32)
  s_waitcnt lgkmcnt(0)
  s_barrier
  s_add_u32 m0, s92, 32768
  s_nop 0
  global_load_lds_dwordx4 v8, s[8:9]
  s_add_u32 m0, s92, 36864
  s_nop 0
  global_load_lds_dwordx4 v9, s[8:9]
  s_add_u32 s8, s8, 40960
  s_addc_u32 s9, s9, 0
  s_add_u32 m0, s92, 40960
  s_nop 0
  global_load_lds_dwordx4 v8, s[8:9]
  s_add_u32 m0, s92, 45056
  s_nop 0
  global_load_lds_dwordx4 v9, s[8:9]
  s_add_u32 s8, s8, 40960
  s_addc_u32 s9, s9, 0
  v_add_u32 v16, 49152, v12
  ds_read_b64_tr_b16 v[232:233], v16
  ds_read_b64_tr_b16 v[234:235], v16 offset:4096
  v_add_u32 v17, 49152, v13
  ds_read_b64_tr_b16 a[168:169], v17
  ds_read_b64_tr_b16 a[170:171], v17 offset:4096
  v_add_u32 v18, 57344, v12
  ds_read_b64_tr_b16 v[236:237], v18
  ds_read_b64_tr_b16 v[238:239], v18 offset:4096
  v_add_u32 v19, 57344, v13
  ds_read_b64_tr_b16 a[172:173], v19
  ds_read_b64_tr_b16 a[174:175], v19 offset:4096
  s_waitcnt vmcnt(32)
  s_waitcnt lgkmcnt(0)
  s_barrier
  s_add_u32 m0, s92, 49152
  s_nop 0
  global_load_lds_dwordx4 v8, s[8:9]
  s_add_u32 m0, s92, 53248
  s_nop 0
  global_load_lds_dwordx4 v9, s[8:9]
  s_add_u32 s8, s8, 40960
  s_addc_u32 s9, s9, 0
  s_add_u32 m0, s92, 57344
  s_nop 0
  global_load_lds_dwordx4 v8, s[8:9]
  s_add_u32 m0, s92, 61440
  s_nop 0
  global_load_lds_dwordx4 v9, s[8:9]
  s_add_u32 s8, s8, 40960
  s_addc_u32 s9, s9, 0
  v_add_u32 v16, 65536, v12
  ds_read_b64_tr_b16 v[240:241], v16
  ds_read_b64_tr_b16 v[242:243], v16 offset:4096
  v_add_u32 v17, 65536, v13
  ds_read_b64_tr_b16 a[176:177], v17
  ds_read_b64_tr_b16 a[178:179], v17 offset:4096
  v_add_u32 v18, 73728, v12
  ds_read_b64_tr_b16 v[244:245], v18
  ds_read_b64_tr_b16 v[246:247], v18 offset:4096
  v_add_u32 v19, 73728, v13
  ds_read_b64_tr_b16 a[180:181], v19
  ds_read_b64_tr_b16 a[182:183], v19 offset:4096
  s_waitcnt vmcnt(32)
  s_waitcnt lgkmcnt(0)
  s_barrier
  v_add_u32 v16, 81920, v12
  ds_read_b64_tr_b16 v[248:249], v16
  ds_read_b64_tr_b16 v[250:251], v16 offset:4096
  v_add_u32 v17, 81920, v13
  ds_read_b64_tr_b16 a[184:185], v17
  ds_read_b64_tr_b16 a[186:187], v17 offset:4096
  v_add_u32 v18, 90112, v12
  ds_read_b64_tr_b16 v[252:253], v18
  ds_read_b64_tr_b16 v[254:255], v18 offset:4096
  v_add_u32 v19, 90112, v13
  ds_read_b64_tr_b16 a[188:189], v19
  ds_read_b64_tr_b16 a[190:191], v19 offset:4096
  s_waitcnt vmcnt(28)
  s_waitcnt lgkmcnt(0)
  s_barrier
  v_add_u32 v16, 98304, v12
  ds_read_b64_tr_b16 a[0:1], v16
  ds_read_b64_tr_b16 a[2:3], v16 offset:4096
  v_add_u32 v17, 98304, v13
  ds_read_b64_tr_b16 a[192:193], v17
  ds_read_b64_tr_b16 a[194:195], v17 offset:4096
  v_add_u32 v18, 106496, v12
  ds_read_b64_tr_b16 a[4:5], v18
  ds_read_b64_tr_b16 a[6:7], v18 offset:4096
  v_add_u32 v19, 106496, v13
  ds_read_b64_tr_b16 a[196:197], v19
  ds_read_b64_tr_b16 a[198:199], v19 offset:4096
  s_waitcnt vmcnt(24)
  s_waitcnt lgkmcnt(0)
  s_barrier
  v_add_u32 v16, 114688, v12
  ds_read_b64_tr_b16 a[8:9], v16
  ds_read_b64_tr_b16 a[10:11], v16 offset:4096
  v_add_u32 v17, 114688, v13
  ds_read_b64_tr_b16 a[200:201], v17
  ds_read_b64_tr_b16 a[202:203], v17 offset:4096
  v_add_u32 v18, 122880, v12
  ds_read_b64_tr_b16 a[12:13], v18
  ds_read_b64_tr_b16 a[14:15], v18 offset:4096
  v_add_u32 v19, 122880, v13
  ds_read_b64_tr_b16 a[204:205], v19
  ds_read_b64_tr_b16 a[206:207], v19 offset:4096
  s_waitcnt vmcnt(20)
  s_waitcnt lgkmcnt(0)
  s_barrier
  v_add_u32 v16, 131072, v12
  ds_read_b64_tr_b16 a[16:17], v16
  ds_read_b64_tr_b16 a[18:19], v16 offset:4096
  v_add_u32 v17, 131072, v13
  ds_read_b64_tr_b16 a[208:209], v17
  ds_read_b64_tr_b16 a[210:211], v17 offset:4096
  v_add_u32 v18, 139264, v12
  ds_read_b64_tr_b16 a[20:21], v18
  ds_read_b64_tr_b16 a[22:23], v18 offset:4096
  v_add_u32 v19, 139264, v13
  ds_read_b64_tr_b16 a[212:213], v19
  ds_read_b64_tr_b16 a[214:215], v19 offset:4096
  s_waitcnt vmcnt(16)
  s_waitcnt lgkmcnt(0)
  s_barrier
  v_add_u32 v16, 147456, v12
  ds_read_b64_tr_b16 a[24:25], v16
  ds_read_b64_tr_b16 a[26:27], v16 offset:4096
  v_add_u32 v17, 147456, v13
  ds_read_b64_tr_b16 a[216:217], v17
  ds_read_b64_tr_b16 a[218:219], v17 offset:4096
  v_add_u32 v18, 155648, v12
  ds_read_b64_tr_b16 a[28:29], v18
  ds_read_b64_tr_b16 a[30:31], v18 offset:4096
  v_add_u32 v19, 155648, v13
  ds_read_b64_tr_b16 a[220:221], v19
  ds_read_b64_tr_b16 a[222:223], v19 offset:4096
  s_waitcnt vmcnt(12)
  s_waitcnt lgkmcnt(0)
  s_barrier
  v_add_u32 v16, 0, v12
  ds_read_b64_tr_b16 a[32:33], v16
  ds_read_b64_tr_b16 a[34:35], v16 offset:4096
  v_add_u32 v17, 0, v13
  ds_read_b64_tr_b16 a[224:225], v17
  ds_read_b64_tr_b16 a[226:227], v17 offset:4096
  v_add_u32 v18, 8192, v12
  ds_read_b64_tr_b16 a[36:37], v18
  ds_read_b64_tr_b16 a[38:39], v18 offset:4096
  v_add_u32 v19, 8192, v13
  ds_read_b64_tr_b16 a[228:229], v19
  ds_read_b64_tr_b16 a[230:231], v19 offset:4096
  s_waitcnt vmcnt(8)
  s_waitcnt lgkmcnt(0)
  s_barrier
  v_add_u32 v16, 16384, v12
  ds_read_b64_tr_b16 a[40:41], v16
  ds_read_b64_tr_b16 a[42:43], v16 offset:4096
  v_add_u32 v17, 16384, v13
  ds_read_b64_tr_b16 a[232:233], v17
  ds_read_b64_tr_b16 a[234:235], v17 offset:4096
  v_add_u32 v18, 24576, v12
  ds_read_b64_tr_b16 a[44:45], v18
  ds_read_b64_tr_b16 a[46:47], v18 offset:4096
  v_add_u32 v19, 24576, v13
  ds_read_b64_tr_b16 a[236:237], v19
  ds_read_b64_tr_b16 a[238:239], v19 offset:4096
  s_waitcnt vmcnt(4)
  s_waitcnt lgkmcnt(0)
  s_barrier
  v_add_u32 v16, 32768, v12
  ds_read_b64_tr_b16 a[48:49], v16
  ds_read_b64_tr_b16 a[50:51], v16 offset:4096
  v_add_u32 v17, 32768, v13
  ds_read_b64_tr_b16 a[240:241], v17
  ds_read_b64_tr_b16 a[242:243], v17 offset:4096
  v_add_u32 v18, 40960, v12
  ds_read_b64_tr_b16 a[52:53], v18
  ds_read_b64_tr_b16 a[54:55], v18 offset:4096
  v_add_u32 v19, 40960, v13
  ds_read_b64_tr_b16 a[244:245], v19
  ds_read_b64_tr_b16 a[246:247], v19 offset:4096
  s_waitcnt vmcnt(0)
  s_waitcnt lgkmcnt(0)
  s_barrier
  v_add_u32 v16, 49152, v12
  ds_read_b64_tr_b16 a[56:57], v16
  ds_read_b64_tr_b16 a[58:59], v16 offset:4096
  v_add_u32 v17, 49152, v13
  ds_read_b64_tr_b16 a[248:249], v17
  ds_read_b64_tr_b16 a[250:251], v17 offset:4096
  v_add_u32 v18, 57344, v12
  ds_read_b64_tr_b16 a[60:61], v18
  ds_read_b64_tr_b16 a[62:63], v18 offset:4096
  v_add_u32 v19, 57344, v13
  ds_read_b64_tr_b16 a[252:253], v19
  ds_read_b64_tr_b16 a[254:255], v19 offset:4096
  s_waitcnt lgkmcnt(0)
  s_barrier
  s_lshl_b32 s48, s42, 8
  s_lshl_b32 s49, s3, 6
  s_add_u32 s48, s48, s49
  v_and_b32 v8, 15, v1
  v_mul_u32_u24 v8, 1280, v8
  v_lshrrev_b32 v9, 4, v1
  v_lshl_add_u32 v8, v9, 3, v8
  v_add_u32 v8, s48, v8
  s_lshl_b32 s48, s48, 5
  v_lshlrev_b32 v9, 4, v1
  v_add_u32 v9, s48, v9
  s_mov_b32 s59, 0x300000
  s_lshl_b32 s58, s42, 2
  s_add_u32 s58, s58, 0x136c000
  v_lshlrev_b32 v3, 4, v1
  v_add_u32 v7, 49152, v3
  s_mul_i32 s86, s3, 12288
  v_add_u32 v4, s86, v3
  s_mov_b32 s46, -1
  s_mov_b32 s47, -1
  s_cmp_ge_u32 s44, 128
  s_cbranch_scc1 FFN2_end
  s_lshr_b32 s48, s44, 1
  s_lshl_b32 s48, s48, 6
  s_add_u32 s48, s48, 0x1368000
  v_min_u32 v5, 11, v1
  v_lshlrev_b32 v5, 2, v5
  v_add_u32 v5, s48, v5
WA_132:
  global_load_dword v6, v5, s[4:5] sc1
  s_waitcnt vmcnt(0)
  v_cmp_ne_u32 vcc, 1, v6
  s_cbranch_vccz WB_133
  s_sleep 8
  s_add_u32 s66, s66, 1
  s_cmp_lt_u32 s66, 0x200000
  s_cbranch_scc1 WA_132
  s_endpgm
WB_133:
  s_mul_i32 s48, s44, 49152
  s_add_u32 s48, s48, s59
  s_add_u32 s50, s4, s48
  s_addc_u32 s51, s5, 0
  s_add_u32 m0, s86, 0
  s_nop 0
  global_load_lds_dwordx4 v4, s[50:51] offset:0 sc1
  global_load_lds_dwordx4 v4, s[50:51] offset:1024 sc1
  global_load_lds_dwordx4 v4, s[50:51] offset:2048 sc1
  global_load_lds_dwordx4 v4, s[50:51] offset:3072 sc1
  s_add_u32 s50, s50, 4096
  s_addc_u32 s51, s51, 0
  s_add_u32 m0, s86, 4096
  s_nop 0
  global_load_lds_dwordx4 v4, s[50:51] offset:0 sc1
  global_load_lds_dwordx4 v4, s[50:51] offset:1024 sc1
  global_load_lds_dwordx4 v4, s[50:51] offset:2048 sc1
  global_load_lds_dwordx4 v4, s[50:51] offset:3072 sc1
  s_add_u32 s50, s50, 4096
  s_addc_u32 s51, s51, 0
  s_add_u32 m0, s86, 8192
  s_nop 0
  global_load_lds_dwordx4 v4, s[50:51] offset:0 sc1
  global_load_lds_dwordx4 v4, s[50:51] offset:1024 sc1
  global_load_lds_dwordx4 v4, s[50:51] offset:2048 sc1
  global_load_lds_dwordx4 v4, s[50:51] offset:3072 sc1
  s_waitcnt vmcnt(0)
  s_barrier
  s_add_u32 s52, s44, 25
  s_cmp_ge_u32 s52, 128
  s_cselect_b32 s54, s44, s52
  s_lshr_b32 s48, s54, 1
  s_lshl_b32 s48, s48, 6
  s_add_u32 s48, s48, 0x1368000
  v_min_u32 v5, 11, v1
  v_lshlrev_b32 v5, 2, v5
  v_add_u32 v5, s48, v5
WA_134:
  global_load_dword v6, v5, s[4:5] sc1
  s_waitcnt vmcnt(0)
  v_cmp_ne_u32 vcc, 1, v6
  s_cbranch_vccz WB_135
  s_sleep 8
  s_add_u32 s66, s66, 1
  s_cmp_lt_u32 s66, 0x200000
  s_cbranch_scc1 WA_134
  s_endpgm
WB_135:
  ds_read_b128 v[64:67], v3 offset:0
  ds_read_b128 v[68:71], v3 offset:1024
  ds_read_b128 v[72:75], v3 offset:2048
  s_waitcnt lgkmcnt(2)
  v_mfma_f32_16x16x32_bf16 v[32:35], v[128:131], v[64:67], 0
  s_mul_i32 s48, s54, 49152
  s_add_u32 s48, s48, s59
  v_mfma_f32_16x16x32_bf16 v[36:39], a[64:67], v[64:67], 0
  s_add_u32 s50, s4, s48
  s_addc_u32 s51, s5, 0
  ds_read_b128 v[64:67], v3 offset:3072
  s_waitcnt lgkmcnt(2)
  v_mfma_f32_16x16x32_bf16 v[32:35], v[132:135], v[68:71], v[32:35]
  s_add_u32 m0, s86, 49152
  s_nop 0
  v_mfma_f32_16x16x32_bf16 v[36:39], a[68:71], v[68:71], v[36:39]
  global_load_lds_dwordx4 v4, s[50:51] offset:0 sc1
  ds_read_b128 v[68:71], v3 offset:4096
  s_waitcnt lgkmcnt(2)
  v_mfma_f32_16x16x32_bf16 v[32:35], v[136:139], v[72:75], v[32:35]
  v_mfma_f32_16x16x32_bf16 v[36:39], a[72:75], v[72:75], v[36:39]
  ds_read_b128 v[72:75], v3 offset:5120
  s_waitcnt lgkmcnt(2)
  v_mfma_f32_16x16x32_bf16 v[32:35], v[140:143], v[64:67], v[32:35]
  global_load_lds_dwordx4 v4, s[50:51] offset:1024 sc1
  v_mfma_f32_16x16x32_bf16 v[36:39], a[76:79], v[64:67], v[36:39]
  ds_read_b128 v[64:67], v3 offset:6144
  s_waitcnt lgkmcnt(2)
  v_mfma_f32_16x16x32_bf16 v[32:35], v[144:147], v[68:71], v[32:35]
  v_mfma_f32_16x16x32_bf16 v[36:39], a[80:83], v[68:71], v[36:39]
  global_load_lds_dwordx4 v4, s[50:51] offset:2048 sc1
  ds_read_b128 v[68:71], v3 offset:7168
  s_waitcnt lgkmcnt(2)
  v_mfma_f32_16x16x32_bf16 v[32:35], v[148:151], v[72:75], v[32:35]
  v_mfma_f32_16x16x32_bf16 v[36:39], a[84:87], v[72:75], v[36:39]
  ds_read_b128 v[72:75], v3 offset:8192
  s_waitcnt lgkmcnt(2)
  v_mfma_f32_16x16x32_bf16 v[32:35], v[152:155], v[64:67], v[32:35]
  global_load_lds_dwordx4 v4, s[50:51] offset:3072 sc1
  v_mfma_f32_16x16x32_bf16 v[36:39], a[88:91], v[64:67], v[36:39]
  ds_read_b128 v[64:67], v3 offset:9216
  s_waitcnt lgkmcnt(2)
  v_mfma_f32_16x16x32_bf16 v[32:35], v[156:159], v[68:71], v[32:35]
  v_mfma_f32_16x16x32_bf16 v[36:39], a[92:95], v[68:71], v[36:39]
  s_add_u32 s50, s50, 4096
  s_addc_u32 s51, s51, 0
  ds_read_b128 v[68:71], v3 offset:10240
  s_waitcnt lgkmcnt(2)
  v_mfma_f32_16x16x32_bf16 v[32:35], v[160:163], v[72:75], v[32:35]
  s_add_u32 m0, s86, 53248
  s_nop 0
  v_mfma_f32_16x16x32_bf16 v[36:39], a[96:99], v[72:75], v[36:39]
  global_load_lds_dwordx4 v4, s[50:51] offset:0 sc1
  ds_read_b128 v[72:75], v3 offset:11264
  s_waitcnt lgkmcnt(2)
  v_mfma_f32_16x16x32_bf16 v[32:35], v[164:167], v[64:67], v[32:35]
  v_mfma_f32_16x16x32_bf16 v[36:39], a[100:103], v[64:67], v[36:39]
  ds_read_b128 v[64:67], v3 offset:12288
  s_waitcnt lgkmcnt(2)
  v_mfma_f32_16x16x32_bf16 v[32:35], v[168:171], v[68:71], v[32:35]
  global_load_lds_dwordx4 v4, s[50:51] offset:1024 sc1
  v_mfma_f32_16x16x32_bf16 v[36:39], a[104:107], v[68:71], v[36:39]
  ds_read_b128 v[68:71], v3 offset:13312
  s_waitcnt lgkmcnt(2)
  v_mfma_f32_16x16x32_bf16 v[32:35], v[172:175], v[72:75], v[32:35]
  v_mfma_f32_16x16x32_bf16 v[36:39], a[108:111], v[72:75], v[36:39]
  global_load_lds_dwordx4 v4, s[50:51] offset:2048 sc1
  ds_read_b128 v[72:75], v3 offset:14336
  s_waitcnt lgkmcnt(2)
  v_mfma_f32_16x16x32_bf16 v[32:35], v[176:179], v[64:67], v[32:35]
  v_mfma_f32_16x16x32_bf16 v[36:39], a[112:115], v[64:67], v[36:39]
  ds_read_b128 v[64:67], v3 offset:15360
  s_waitcnt lgkmcnt(2)
  v_mfma_f32_16x16x32_bf16 v[32:35], v[180:183], v[68:71], v[32:35]
  global_load_lds_dwordx4 v4, s[50:51] offset:3072 sc1
  v_mfma_f32_16x16x32_bf16 v[36:39], a[116:119], v[68:71], v[36:39]
  ds_read_b128 v[68:71], v3 offset:16384
  s_waitcnt lgkmcnt(2)
  v_mfma_f32_16x16x32_bf16 v[32:35], v[184:187], v[72:75], v[32:35]
  v_mfma_f32_16x16x32_bf16 v[36:39], a[120:123], v[72:75], v[36:39]
  s_add_u32 s50, s50, 4096
  s_addc_u32 s51, s51, 0
  ds_read_b128 v[72:75], v3 offset:17408
  s_waitcnt lgkmcnt(2)
  v_mfma_f32_16x16x32_bf16 v[32:35], v[188:191], v[64:67], v[32:35]
  s_add_u32 m0, s86, 57344
  s_nop 0
  v_mfma_f32_16x16x32_bf16 v[36:39], a[124:127], v[64:67], v[36:39]
  global_load_lds_dwordx4 v4, s[50:51] offset:0 sc1
  ds_read_b128 v[64:67], v3 offset:18432
  s_waitcnt lgkmcnt(2)
  v_mfma_f32_16x16x32_bf16 v[32:35], v[192:195], v[68:71], v[32:35]
  v_mfma_f32_16x16x32_bf16 v[36:39], a[128:131], v[68:71], v[36:39]
  ds_read_b128 v[68:71], v3 offset:19456
  s_waitcnt lgkmcnt(2)
  v_mfma_f32_16x16x32_bf16 v[32:35], v[196:199], v[72:75], v[32:35]
  global_load_lds_dwordx4 v4, s[50:51] offset:1024 sc1
  v_mfma_f32_16x16x32_bf16 v[36:39], a[132:135], v[72:75], v[36:39]
  ds_read_b128 v[72:75], v3 offset:20480
  s_waitcnt lgkmcnt(2)
  v_mfma_f32_16x16x32_bf16 v[32:35], v[200:203], v[64:67], v[32:35]
  v_mfma_f32_16x16x32_bf16 v[36:39], a[136:139], v[64:67], v[36:39]
  global_load_lds_dwordx4 v4, s[50:51] offset:2048 sc1
  ds_read_b128 v[64:67], v3 offset:21504
  s_waitcnt lgkmcnt(2)
  v_mfma_f32_16x16x32_bf16 v[32:35], v[204:207], v[68:71], v[32:35]
  v_mfma_f32_16x16x32_bf16 v[36:39], a[140:143], v[68:71], v[36:39]
  ds_read_b128 v[68:71], v3 offset:22528
  s_waitcnt lgkmcnt(2)
  v_mfma_f32_16x16x32_bf16 v[32:35], v[208:211], v[72:75], v[32:35]
  global_load_lds_dwordx4 v4, s[50:51] offset:3072 sc1
  v_mfma_f32_16x16x32_bf16 v[36:39], a[144:147], v[72:75], v[36:39]
  ds_read_b128 v[72:75], v3 offset:23552
  s_waitcnt lgkmcnt(2)
  v_mfma_f32_16x16x32_bf16 v[32:35], v[212:215], v[64:67], v[32:35]
  v_mfma_f32_16x16x32_bf16 v[36:39], a[148:151], v[64:67], v[36:39]
  ds_read_b128 v[64:67], v3 offset:24576
  s_waitcnt lgkmcnt(2)
  v_mfma_f32_16x16x32_bf16 v[32:35], v[216:219], v[68:71], v[32:35]
  v_mfma_f32_16x16x32_bf16 v[36:39], a[152:155], v[68:71], v[36:39]
  ds_read_b128 v[68:71], v3 offset:25600
  s_waitcnt lgkmcnt(2)
  v_mfma_f32_16x16x32_bf16 v[32:35], v[220:223], v[72:75], v[32:35]
  v_mfma_f32_16x16x32_bf16 v[36:39], a[156:159], v[72:75], v[36:39]
  ds_read_b128 v[72:75], v3 offset:26624
  s_waitcnt lgkmcnt(2)
  v_mfma_f32_16x16x32_bf16 v[32:35], v[224:227], v[64:67], v[32:35]
  v_mfma_f32_16x16x32_bf16 v[36:39], a[160:163], v[64:67], v[36:39]
  ds_read_b128 v[64:67], v3 offset:27648
  s_waitcnt lgkmcnt(2)
  v_mfma_f32_16x16x32_bf16 v[32:35], v[228:231], v[68:71], v[32:35]
  v_mfma_f32_16x16x32_bf16 v[36:39], a[164:167], v[68:71], v[36:39]
  ds_read_b128 v[68:71], v3 offset:28672
  s_waitcnt lgkmcnt(2)
  v_mfma_f32_16x16x32_bf16 v[32:35], v[232:235], v[72:75], v[32:35]
  v_mfma_f32_16x16x32_bf16 v[36:39], a[168:171], v[72:75], v[36:39]
  ds_read_b128 v[72:75], v3 offset:29696
  s_waitcnt lgkmcnt(2)
  v_mfma_f32_16x16x32_bf16 v[32:35], v[236:239], v[64:67], v[32:35]
  v_mfma_f32_16x16x32_bf16 v[36:39], a[172:175], v[64:67], v[36:39]
  ds_read_b128 v[64:67], v3 offset:30720
  s_waitcnt lgkmcnt(2)
  v_mfma_f32_16x16x32_bf16 v[32:35], v[240:243], v[68:71], v[32:35]
  v_mfma_f32_16x16x32_bf16 v[36:39], a[176:179], v[68:71], v[36:39]
  ds_read_b128 v[68:71], v3 offset:31744
  s_waitcnt lgkmcnt(2)
  v_mfma_f32_16x16x32_bf16 v[32:35], v[244:247], v[72:75], v[32:35]
  v_mfma_f32_16x16x32_bf16 v[36:39], a[180:183], v[72:75], v[36:39]
  ds_read_b128 v[72:75], v3 offset:32768
  s_waitcnt lgkmcnt(2)
  v_mfma_f32_16x16x32_bf16 v[32:35], v[248:251], v[64:67], v[32:35]
  v_mfma_f32_16x16x32_bf16 v[36:39], a[184:187], v[64:67], v[36:39]
  ds_read_b128 v[64:67], v3 offset:33792
  s_waitcnt lgkmcnt(2)
  v_mfma_f32_16x16x32_bf16 v[32:35], v[252:255], v[68:71], v[32:35]
  v_mfma_f32_16x16x32_bf16 v[36:39], a[188:191], v[68:71], v[36:39]
  ds_read_b128 v[68:71], v3 offset:34816
  s_waitcnt lgkmcnt(2)
  v_mfma_f32_16x16x32_bf16 v[32:35], a[0:3], v[72:75], v[32:35]
  v_mfma_f32_16x16x32_bf16 v[36:39], a[192:195], v[72:75], v[36:39]
  ds_read_b128 v[72:75], v3 offset:35840
  s_waitcnt lgkmcnt(2)
  v_mfma_f32_16x16x32_bf16 v[32:35], a[4:7], v[64:67], v[32:35]
  v_mfma_f32_16x16x32_bf16 v[36:39], a[196:199], v[64:67], v[36:39]
  ds_read_b128 v[64:67], v3 offset:36864
  s_waitcnt lgkmcnt(2)
  v_mfma_f32_16x16x32_bf16 v[32:35], a[8:11], v[68:71], v[32:35]
  v_mfma_f32_16x16x32_bf16 v[36:39], a[200:203], v[68:71], v[36:39]
  ds_read_b128 v[68:71], v3 offset:37888
  s_waitcnt lgkmcnt(2)
  v_mfma_f32_16x16x32_bf16 v[32:35], a[12:15], v[72:75], v[32:35]
  v_mfma_f32_16x16x32_bf16 v[36:39], a[204:207], v[72:75], v[36:39]
  ds_read_b128 v[72:75], v3 offset:38912
  s_waitcnt lgkmcnt(2)
  v_mfma_f32_16x16x32_bf16 v[32:35], a[16:19], v[64:67], v[32:35]
  v_mfma_f32_16x16x32_bf16 v[36:39], a[208:211], v[64:67], v[36:39]
  ds_read_b128 v[64:67], v3 offset:39936
  s_waitcnt lgkmcnt(2)
  v_mfma_f32_16x16x32_bf16 v[32:35], a[20:23], v[68:71], v[32:35]
  v_mfma_f32_16x16x32_bf16 v[36:39], a[212:215], v[68:71], v[36:39]
  ds_read_b128 v[68:71], v3 offset:40960
  s_waitcnt lgkmcnt(2)
  v_mfma_f32_16x16x32_bf16 v[32:35], a[24:27], v[72:75], v[32:35]
  v_mfma_f32_16x16x32_bf16 v[36:39], a[216:219], v[72:75], v[36:39]
  ds_read_b128 v[72:75], v3 offset:41984
  s_waitcnt lgkmcnt(2)
  v_mfma_f32_16x16x32_bf16 v[32:35], a[28:31], v[64:67], v[32:35]
  v_mfma_f32_16x16x32_bf16 v[36:39], a[220:223], v[64:67], v[36:39]
  ds_read_b128 v[64:67], v3 offset:43008
  s_waitcnt lgkmcnt(2)
  v_mfma_f32_16x16x32_bf16 v[32:35], a[32:35], v[68:71], v[32:35]
  v_mfma_f32_16x16x32_bf16 v[36:39], a[224:227], v[68:71], v[36:39]
  ds_read_b128 v[68:71], v3 offset:44032
  s_waitcnt lgkmcnt(2)
  v_mfma_f32_16x16x32_bf16 v[32:35], a[36:39], v[72:75], v[32:35]
  v_mfma_f32_16x16x32_bf16 v[36:39], a[228:231], v[72:75], v[36:39]
  ds_read_b128 v[72:75], v3 offset:45056
  s_waitcnt lgkmcnt(2)
  v_mfma_f32_16x16x32_bf16 v[32:35], a[40:43], v[64:67], v[32:35]
  v_mfma_f32_16x16x32_bf16 v[36:39], a[232:235], v[64:67], v[36:39]
  ds_read_b128 v[64:67], v3 offset:46080
  s_waitcnt lgkmcnt(2)
  v_mfma_f32_16x16x32_bf16 v[32:35], a[44:47], v[68:71], v[32:35]
  v_mfma_f32_16x16x32_bf16 v[36:39], a[236:239], v[68:71], v[36:39]
  ds_read_b128 v[68:71], v3 offset:47104
  s_waitcnt lgkmcnt(2)
  v_mfma_f32_16x16x32_bf16 v[32:35], a[48:51], v[72:75], v[32:35]
  v_mfma_f32_16x16x32_bf16 v[36:39], a[240:243], v[72:75], v[36:39]
  ds_read_b128 v[72:75], v3 offset:48128
  s_waitcnt lgkmcnt(2)
  v_mfma_f32_16x16x32_bf16 v[32:35], a[52:55], v[64:67], v[32:35]
  v_mfma_f32_16x16x32_bf16 v[36:39], a[244:247], v[64:67], v[36:39]
  s_waitcnt lgkmcnt(1)
  v_mfma_f32_16x16x32_bf16 v[32:35], a[56:59], v[68:71], v[32:35]
  v_mfma_f32_16x16x32_bf16 v[36:39], a[248:251], v[68:71], v[36:39]
  s_waitcnt lgkmcnt(0)
  v_mfma_f32_16x16x32_bf16 v[32:35], a[60:63], v[72:75], v[32:35]
  v_mfma_f32_16x16x32_bf16 v[36:39], a[252:255], v[72:75], v[36:39]
  s_mov_b32 s47, s46
  s_mov_b32 s46, s44
  s_mov_b32 s44, s52
  s_cmp_ge_u32 s44, 128
  s_cbranch_scc1 FFN2_fin0
FFN2_loop:
  s_waitcnt vmcnt(0)
  s_barrier
  s_cmp_eq_u32 s47, -1
  s_cbranch_scc1 FS_136
  s_cmp_lg_u32 s3, 0
  s_cbranch_scc1 FS_136
  s_lshl_b32 s48, s47, 5
  s_add_u32 s48, s48, s58
  v_mov_b32 v5, s48
  v_mov_b32 v6, 1
  s_mov_b64 exec, 1
  global_store_dword v5, v6, s[4:5] sc1
  s_mov_b64 exec, -1
FS_136:
  s_add_u32 s52, s44, 25
  s_cmp_ge_u32 s52, 128
  s_cselect_b32 s54, s44, s52
  s_lshr_b32 s48, s54, 1
  s_lshl_b32 s48, s48, 6
  s_add_u32 s48, s48, 0x1368000
  v_min_u32 v5, 11, v1
  v_lshlrev_b32 v5, 2, v5
  v_add_u32 v5, s48, v5
WA_137:
  global_load_dword v6, v5, s[4:5] sc1
  s_waitcnt vmcnt(0)
  v_cmp_ne_u32 vcc, 1, v6
  s_cbranch_vccz WB_138
  s_sleep 8
  s_add_u32 s66, s66, 1
  s_cmp_lt_u32 s66, 0x200000
  s_cbranch_scc1 WA_137
  s_endpgm
WB_138:
  ds_read_b128 v[64:67], v7 offset:0
  ds_read_b128 v[68:71], v7 offset:1024
  s_mul_i32 s60, s46, 20480
  s_add_u32 s62, s10, s60
  s_addc_u32 s63, s11, 0
  global_load_dwordx2 v[96:97], v8, s[62:63]
  ds_read_b128 v[72:75], v7 offset:2048
  s_waitcnt lgkmcnt(2)
  v_mfma_f32_16x16x32_bf16 v[40:43], v[128:131], v[64:67], 0
  v_mfma_f32_16x16x32_bf16 v[44:47], a[64:67], v[64:67], 0
  ds_read_b128 v[64:67], v7 offset:3072
  s_waitcnt lgkmcnt(2)
  v_mfma_f32_16x16x32_bf16 v[40:43], v[132:135], v[68:71], v[40:43]
  v_mfma_f32_16x16x32_bf16 v[44:47], a[68:71], v[68:71], v[44:47]
  global_load_dwordx2 v[98:99], v8, s[62:63] offset:32
  ds_read_b128 v[68:71], v7 offset:4096
  s_waitcnt lgkmcnt(2)
  v_mfma_f32_16x16x32_bf16 v[40:43], v[136:139], v[72:75], v[40:43]
  v_mfma_f32_16x16x32_bf16 v[44:47], a[72:75], v[72:75], v[44:47]
  ds_read_b128 v[72:75], v7 offset:5120
  s_waitcnt lgkmcnt(2)
  v_mfma_f32_16x16x32_bf16 v[40:43], v[140:143], v[64:67], v[40:43]
  s_mul_i32 s60, s46, 40960
  s_add_u32 s60, s60, 0xa00000
  v_mfma_f32_16x16x32_bf16 v[44:47], a[76:79], v[64:67], v[44:47]
  s_add_u32 s62, s4, s60
  s_addc_u32 s63, s5, 0
  ds_read_b128 v[64:67], v7 offset:6144
  s_waitcnt lgkmcnt(2)
  v_mfma_f32_16x16x32_bf16 v[40:43], v[144:147], v[68:71], v[40:43]
  v_mfma_f32_16x16x32_bf16 v[44:47], a[80:83], v[68:71], v[44:47]
  ds_read_b128 v[68:71], v7 offset:7168
  s_waitcnt lgkmcnt(2)
  v_mfma_f32_16x16x32_bf16 v[40:43], v[148:151], v[72:75], v[40:43]
  v_mfma_f32_16x16x32_bf16 v[44:47], a[84:87], v[72:75], v[44:47]
  ds_read_b128 v[72:75], v7 offset:8192
  s_waitcnt lgkmcnt(2)
  v_mfma_f32_16x16x32_bf16 v[40:43], v[152:155], v[64:67], v[40:43]
  v_mfma_f32_16x16x32_bf16 v[44:47], a[88:91], v[64:67], v[44:47]
  ds_read_b128 v[64:67], v7 offset:9216
  s_waitcnt lgkmcnt(2)
  v_mfma_f32_16x16x32_bf16 v[40:43], v[156:159], v[68:71], v[40:43]
  v_mfma_f32_16x16x32_bf16 v[44:47], a[92:95], v[68:71], v[44:47]
  ds_read_b128 v[68:71], v7 offset:10240
  s_waitcnt lgkmcnt(2)
  v_mfma_f32_16x16x32_bf16 v[40:43], v[160:163], v[72:75], v[40:43]
  v_mfma_f32_16x16x32_bf16 v[44:47], a[96:99], v[72:75], v[44:47]
  ds_read_b128 v[72:75], v7 offset:11264
  s_waitcnt lgkmcnt(2)
  v_mfma_f32_16x16x32_bf16 v[40:43], v[164:167], v[64:67], v[40:43]
  v_mfma_f32_16x16x32_bf16 v[44:47], a[100:103], v[64:67], v[44:47]
  ds_read_b128 v[64:67], v7 offset:12288
  s_waitcnt lgkmcnt(2)
  v_mfma_f32_16x16x32_bf16 v[40:43], v[168:171], v[68:71], v[40:43]
  v_mfma_f32_16x16x32_bf16 v[44:47], a[104:107], v[68:71], v[44:47]
  ds_read_b128 v[68:71], v7 offset:13312
  s_waitcnt lgkmcnt(2)
  v_mfma_f32_16x16x32_bf16 v[40:43], v[172:175], v[72:75], v[40:43]
  v_mfma_f32_16x16x32_bf16 v[44:47], a[108:111], v[72:75], v[44:47]
  ds_read_b128 v[72:75], v7 offset:14336
  s_waitcnt lgkmcnt(2)
  v_mfma_f32_16x16x32_bf16 v[40:43], v[176:179], v[64:67], v[40:43]
  s_waitcnt vmcnt(0)
  v_lshlrev_b32 v100, 16, v96
  v_mfma_f32_16x16x32_bf16 v[44:47], a[112:115], v[64:67], v[44:47]
  v_and_b32 v101, 0xffff0000, v96
  v_add_f32 v32, v32, v100
  ds_read_b128 v[64:67], v7 offset:15360
  s_waitcnt lgkmcnt(2)
  v_mfma_f32_16x16x32_bf16 v[40:43], v[180:183], v[68:71], v[40:43]
  v_add_f32 v33, v33, v101
  v_lshlrev_b32 v100, 16, v97
  v_mfma_f32_16x16x32_bf16 v[44:47], a[116:119], v[68:71], v[44:47]
  v_and_b32 v101, 0xffff0000, v97
  v_add_f32 v34, v34, v100
  ds_read_b128 v[68:71], v7 offset:16384
  s_waitcnt lgkmcnt(2)
  v_mfma_f32_16x16x32_bf16 v[40:43], v[184:187], v[72:75], v[40:43]
  v_add_f32 v35, v35, v101
  global_store_dwordx4 v9, v[32:35], s[62:63] offset:0 sc1
  v_mfma_f32_16x16x32_bf16 v[44:47], a[120:123], v[72:75], v[44:47]
  ds_read_b128 v[72:75], v7 offset:17408
  s_waitcnt lgkmcnt(2)
  v_mfma_f32_16x16x32_bf16 v[40:43], v[188:191], v[64:67], v[40:43]
  v_mfma_f32_16x16x32_bf16 v[44:47], a[124:127], v[64:67], v[44:47]
  ds_read_b128 v[64:67], v7 offset:18432
  s_waitcnt lgkmcnt(2)
  v_mfma_f32_16x16x32_bf16 v[40:43], v[192:195], v[68:71], v[40:43]
  v_lshlrev_b32 v100, 16, v98
  v_and_b32 v101, 0xffff0000, v98
  v_mfma_f32_16x16x32_bf16 v[44:47], a[128:131], v[68:71], v[44:47]
  v_add_f32 v36, v36, v100
  v_add_f32 v37, v37, v101
  ds_read_b128 v[68:71], v7 offset:19456
  s_waitcnt lgkmcnt(2)
  v_mfma_f32_16x16x32_bf16 v[40:43], v[196:199], v[72:75], v[40:43]
  v_lshlrev_b32 v100, 16, v99
  v_and_b32 v101, 0xffff0000, v99
  v_mfma_f32_16x16x32_bf16 v[44:47], a[132:135], v[72:75], v[44:47]
  v_add_f32 v38, v38, v100
  v_add_f32 v39, v39, v101
  ds_read_b128 v[72:75], v7 offset:20480
  s_waitcnt lgkmcnt(2)
  v_mfma_f32_16x16x32_bf16 v[40:43], v[200:203], v[64:67], v[40:43]
  global_store_dwordx4 v9, v[36:39], s[62:63] offset:1024 sc1
  v_mfma_f32_16x16x32_bf16 v[44:47], a[136:139], v[64:67], v[44:47]
  ds_read_b128 v[64:67], v7 offset:21504
  s_waitcnt lgkmcnt(2)
  v_mfma_f32_16x16x32_bf16 v[40:43], v[204:207], v[68:71], v[40:43]
  v_mfma_f32_16x16x32_bf16 v[44:47], a[140:143], v[68:71], v[44:47]
  s_mul_i32 s48, s54, 49152
  s_add_u32 s48, s48, s59
  ds_read_b128 v[68:71], v7 offset:22528
  s_waitcnt lgkmcnt(2)
  v_mfma_f32_16x16x32_bf16 v[40:43], v[208:211], v[72:75], v[40:43]
  s_add_u32 s50, s4, s48
  s_addc_u32 s51, s5, 0
  v_mfma_f32_16x16x32_bf16 v[44:47], a[144:147], v[72:75], v[44:47]
  s_add_u32 m0, s86, 0
  s_nop 0
  ds_read_b128 v[72:75], v7 offset:23552
  s_waitcnt lgkmcnt(2)
  v_mfma_f32_16x16x32_bf16 v[40:43], v[212:215], v[64:67], v[40:43]
  global_load_lds_dwordx4 v4, s[50:51] offset:0 sc1
  v_mfma_f32_16x16x32_bf16 v[44:47], a[148:151], v[64:67], v[44:47]
  ds_read_b128 v[64:67], v7 offset:24576
  s_waitcnt lgkmcnt(2)
  v_mfma_f32_16x16x32_bf16 v[40:43], v[216:219], v[68:71], v[40:43]
  v_mfma_f32_16x16x32_bf16 v[44:47], a[152:155], v[68:71], v[44:47]
  global_load_lds_dwordx4 v4, s[50:51] offset:1024 sc1
  ds_read_b128 v[68:71], v7 offset:25600
  s_waitcnt lgkmcnt(2)
  v_mfma_f32_16x16x32_bf16 v[40:43], v[220:223], v[72:75], v[40:43]
  v_mfma_f32_16x16x32_bf16 v[44:47], a[156:159], v[72:75], v[44:47]
  ds_read_b128 v[72:75], v7 offset:26624
  s_waitcnt lgkmcnt(2)
  v_mfma_f32_16x16x32_bf16 v[40:43], v[224:227], v[64:67], v[40:43]
  global_load_lds_dwordx4 v4, s[50:51] offset:2048 sc1
  v_mfma_f32_16x16x32_bf16 v[44:47], a[160:163], v[64:67], v[44:47]
  ds_read_b128 v[64:67], v7 offset:27648
  s_waitcnt lgkmcnt(2)
  v_mfma_f32_16x16x32_bf16 v[40:43], v[228:231], v[68:71], v[40:43]
  v_mfma_f32_16x16x32_bf16 v[44:47], a[164:167], v[68:71], v[44:47]
  global_load_lds_dwordx4 v4, s[50:51] offset:3072 sc1
  ds_read_b128 v[68:71], v7 offset:28672
  s_waitcnt lgkmcnt(2)
  v_mfma_f32_16x16x32_bf16 v[40:43], v[232:235], v[72:75], v[40:43]
  v_mfma_f32_16x16x32_bf16 v[44:47], a[168:171], v[72:75], v[44:47]
  ds_read_b128 v[72:75], v7 offset:29696
  s_waitcnt lgkmcnt(2)
  v_mfma_f32_16x16x32_bf16 v[40:43], v[236:239], v[64:67], v[40:43]
  s_add_u32 s50, s50, 4096
  s_addc_u32 s51, s51, 0
  v_mfma_f32_16x16x32_bf16 v[44:47], a[172:175], v[64:67], v[44:47]
  s_add_u32 m0, s86, 4096
  s_nop 0
  ds_read_b128 v[64:67], v7 offset:30720
  s_waitcnt lgkmcnt(2)
  v_mfma_f32_16x16x32_bf16 v[40:43], v[240:243], v[68:71], v[40:43]
  global_load_lds_dwordx4 v4, s[50:51] offset:0 sc1
  v_mfma_f32_16x16x32_bf16 v[44:47], a[176:179], v[68:71], v[44:47]
  ds_read_b128 v[68:71], v7 offset:31744
  s_waitcnt lgkmcnt(2)
  v_mfma_f32_16x16x32_bf16 v[40:43], v[244:247], v[72:75], v[40:43]
  v_mfma_f32_16x16x32_bf16 v[44:47], a[180:183], v[72:75], v[44:47]
  global_load_lds_dwordx4 v4, s[50:51] offset:1024 sc1
  ds_read_b128 v[72:75], v7 offset:32768
  s_waitcnt lgkmcnt(2)
  v_mfma_f32_16x16x32_bf16 v[40:43], v[248:251], v[64:67], v[40:43]
  v_mfma_f32_16x16x32_bf16 v[44:47], a[184:187], v[64:67], v[44:47]
  ds_read_b128 v[64:67], v7 offset:33792
  s_waitcnt lgkmcnt(2)
  v_mfma_f32_16x16x32_bf16 v[40:43], v[252:255], v[68:71], v[40:43]
  global_load_lds_dwordx4 v4, s[50:51] offset:2048 sc1
  v_mfma_f32_16x16x32_bf16 v[44:47], a[188:191], v[68:71], v[44:47]
  ds_read_b128 v[68:71], v7 offset:34816
  s_waitcnt lgkmcnt(2)
  v_mfma_f32_16x16x32_bf16 v[40:43], a[0:3], v[72:75], v[40:43]
  v_mfma_f32_16x16x32_bf16 v[44:47], a[192:195], v[72:75], v[44:47]
  global_load_lds_dwordx4 v4, s[50:51] offset:3072 sc1
  ds_read_b128 v[72:75], v7 offset:35840
  s_waitcnt lgkmcnt(2)
  v_mfma_f32_16x16x32_bf16 v[40:43], a[4:7], v[64:67], v[40:43]
  v_mfma_f32_16x16x32_bf16 v[44:47], a[196:199], v[64:67], v[44:47]
  ds_read_b128 v[64:67], v7 offset:36864
  s_waitcnt lgkmcnt(2)
  v_mfma_f32_16x16x32_bf16 v[40:43], a[8:11], v[68:71], v[40:43]
  s_add_u32 s50, s50, 4096
  s_addc_u32 s51, s51, 0
  v_mfma_f32_16x16x32_bf16 v[44:47], a[200:203], v[68:71], v[44:47]
  s_add_u32 m0, s86, 8192
  s_nop 0
  ds_read_b128 v[68:71], v7 offset:37888
  s_waitcnt lgkmcnt(2)
  v_mfma_f32_16x16x32_bf16 v[40:43], a[12:15], v[72:75], v[40:43]
  global_load_lds_dwordx4 v4, s[50:51] offset:0 sc1
  v_mfma_f32_16x16x32_bf16 v[44:47], a[204:207], v[72:75], v[44:47]
  ds_read_b128 v[72:75], v7 offset:38912
  s_waitcnt lgkmcnt(2)
  v_mfma_f32_16x16x32_bf16 v[40:43], a[16:19], v[64:67], v[40:43]
  v_mfma_f32_16x16x32_bf16 v[44:47], a[208:211], v[64:67], v[44:47]
  global_load_lds_dwordx4 v4, s[50:51] offset:1024 sc1
  ds_read_b128 v[64:67], v7 offset:39936
  s_waitcnt lgkmcnt(2)
  v_mfma_f32_16x16x32_bf16 v[40:43], a[20:23], v[68:71], v[40:43]
  v_mfma_f32_16x16x32_bf16 v[44:47], a[212:215], v[68:71], v[44:47]
  ds_read_b128 v[68:71], v7 offset:40960
  s_waitcnt lgkmcnt(2)
  v_mfma_f32_16x16x32_bf16 v[40:43], a[24:27], v[72:75], v[40:43]
  global_load_lds_dwordx4 v4, s[50:51] offset:2048 sc1
  v_mfma_f32_16x16x32_bf16 v[44:47], a[216:219], v[72:75], v[44:47]
  ds_read_b128 v[72:75], v7 offset:41984
  s_waitcnt lgkmcnt(2)
  v_mfma_f32_16x16x32_bf16 v[40:43], a[28:31], v[64:67], v[40:43]
  v_mfma_f32_16x16x32_bf16 v[44:47], a[220:223], v[64:67], v[44:47]
  global_load_lds_dwordx4 v4, s[50:51] offset:3072 sc1
  ds_read_b128 v[64:67], v7 offset:43008
  s_waitcnt lgkmcnt(2)
  v_mfma_f32_16x16x32_bf16 v[40:43], a[32:35], v[68:71], v[40:43]
  v_mfma_f32_16x16x32_bf16 v[44:47], a[224:227], v[68:71], v[44:47]
  ds_read_b128 v[68:71], v7 offset:44032
  s_waitcnt lgkmcnt(2)
  v_mfma_f32_16x16x32_bf16 v[40:43], a[36:39], v[72:75], v[40:43]
  v_mfma_f32_16x16x32_bf16 v[44:47], a[228:231], v[72:75], v[44:47]
  ds_read_b128 v[72:75], v7 offset:45056
  s_waitcnt lgkmcnt(2)
  v_mfma_f32_16x16x32_bf16 v[40:43], a[40:43], v[64:67], v[40:43]
  v_mfma_f32_16x16x32_bf16 v[44:47], a[232:235], v[64:67], v[44:47]
  ds_read_b128 v[64:67], v7 offset:46080
  s_waitcnt lgkmcnt(2)
  v_mfma_f32_16x16x32_bf16 v[40:43], a[44:47], v[68:71], v[40:43]
  v_mfma_f32_16x16x32_bf16 v[44:47], a[236:239], v[68:71], v[44:47]
  ds_read_b128 v[68:71], v7 offset:47104
  s_waitcnt lgkmcnt(2)
  v_mfma_f32_16x16x32_bf16 v[40:43], a[48:51], v[72:75], v[40:43]
  v_mfma_f32_16x16x32_bf16 v[44:47], a[240:243], v[72:75], v[44:47]
  ds_read_b128 v[72:75], v7 offset:48128
  s_waitcnt lgkmcnt(2)
  v_mfma_f32_16x16x32_bf16 v[40:43], a[52:55], v[64:67], v[40:43]
  v_mfma_f32_16x16x32_bf16 v[44:47], a[244:247], v[64:67], v[44:47]
  s_waitcnt lgkmcnt(1)
  v_mfma_f32_16x16x32_bf16 v[40:43], a[56:59], v[68:71], v[40:43]
  v_mfma_f32_16x16x32_bf16 v[44:47], a[248:251], v[68:71], v[44:47]
  s_waitcnt lgkmcnt(0)
  v_mfma_f32_16x16x32_bf16 v[40:43], a[60:63], v[72:75], v[40:43]
  v_mfma_f32_16x16x32_bf16 v[44:47], a[252:255], v[72:75], v[44:47]
  s_mov_b32 s47, s46
  s_mov_b32 s46, s44
  s_mov_b32 s44, s52
  s_cmp_ge_u32 s44, 128
  s_cbranch_scc1 FFN2_fin1
  s_waitcnt vmcnt(0)
  s_barrier
  s_cmp_eq_u32 s47, -1
  s_cbranch_scc1 FS_139
  s_cmp_lg_u32 s3, 0
  s_cbranch_scc1 FS_139
  s_lshl_b32 s48, s47, 5
  s_add_u32 s48, s48, s58
  v_mov_b32 v5, s48
  v_mov_b32 v6, 1
  s_mov_b64 exec, 1
  global_store_dword v5, v6, s[4:5] sc1
  s_mov_b64 exec, -1
FS_139:
  s_add_u32 s52, s44, 25
  s_cmp_ge_u32 s52, 128
  s_cselect_b32 s54, s44, s52
  s_lshr_b32 s48, s54, 1
  s_lshl_b32 s48, s48, 6
  s_add_u32 s48, s48, 0x1368000
  v_min_u32 v5, 11, v1
  v_lshlrev_b32 v5, 2, v5
  v_add_u32 v5, s48, v5
WA_140:
  global_load_dword v6, v5, s[4:5] sc1
  s_waitcnt vmcnt(0)
  v_cmp_ne_u32 vcc, 1, v6
  s_cbranch_vccz WB_141
  s_sleep 8
  s_add_u32 s66, s66, 1
  s_cmp_lt_u32 s66, 0x200000
  s_cbranch_scc1 WA_140
  s_endpgm
WB_141:
  ds_read_b128 v[64:67], v3 offset:0
  ds_read_b128 v[68:71], v3 offset:1024
  s_mul_i32 s60, s46, 20480
  s_add_u32 s62, s10, s60
  s_addc_u32 s63, s11, 0
  global_load_dwordx2 v[96:97], v8, s[62:63]
  ds_read_b128 v[72:75], v3 offset:2048
  s_waitcnt lgkmcnt(2)
  v_mfma_f32_16x16x32_bf16 v[32:35], v[128:131], v[64:67], 0
  v_mfma_f32_16x16x32_bf16 v[36:39], a[64:67], v[64:67], 0
  ds_read_b128 v[64:67], v3 offset:3072
  s_waitcnt lgkmcnt(2)
  v_mfma_f32_16x16x32_bf16 v[32:35], v[132:135], v[68:71], v[32:35]
  v_mfma_f32_16x16x32_bf16 v[36:39], a[68:71], v[68:71], v[36:39]
  global_load_dwordx2 v[98:99], v8, s[62:63] offset:32
  ds_read_b128 v[68:71], v3 offset:4096
  s_waitcnt lgkmcnt(2)
  v_mfma_f32_16x16x32_bf16 v[32:35], v[136:139], v[72:75], v[32:35]
  v_mfma_f32_16x16x32_bf16 v[36:39], a[72:75], v[72:75], v[36:39]
  ds_read_b128 v[72:75], v3 offset:5120
  s_waitcnt lgkmcnt(2)
  v_mfma_f32_16x16x32_bf16 v[32:35], v[140:143], v[64:67], v[32:35]
  s_mul_i32 s60, s46, 40960
  s_add_u32 s60, s60, 0xa00000
  v_mfma_f32_16x16x32_bf16 v[36:39], a[76:79], v[64:67], v[36:39]
  s_add_u32 s62, s4, s60
  s_addc_u32 s63, s5, 0
  ds_read_b128 v[64:67], v3 offset:6144
  s_waitcnt lgkmcnt(2)
  v_mfma_f32_16x16x32_bf16 v[32:35], v[144:147], v[68:71], v[32:35]
  v_mfma_f32_16x16x32_bf16 v[36:39], a[80:83], v[68:71], v[36:39]
  ds_read_b128 v[68:71], v3 offset:7168
  s_waitcnt lgkmcnt(2)
  v_mfma_f32_16x16x32_bf16 v[32:35], v[148:151], v[72:75], v[32:35]
  v_mfma_f32_16x16x32_bf16 v[36:39], a[84:87], v[72:75], v[36:39]
  ds_read_b128 v[72:75], v3 offset:8192
  s_waitcnt lgkmcnt(2)
  v_mfma_f32_16x16x32_bf16 v[32:35], v[152:155], v[64:67], v[32:35]
  v_mfma_f32_16x16x32_bf16 v[36:39], a[88:91], v[64:67], v[36:39]
  ds_read_b128 v[64:67], v3 offset:9216
  s_waitcnt lgkmcnt(2)
  v_mfma_f32_16x16x32_bf16 v[32:35], v[156:159], v[68:71], v[32:35]
  v_mfma_f32_16x16x32_bf16 v[36:39], a[92:95], v[68:71], v[36:39]
  ds_read_b128 v[68:71], v3 offset:10240
  s_waitcnt lgkmcnt(2)
  v_mfma_f32_16x16x32_bf16 v[32:35], v[160:163], v[72:75], v[32:35]
  v_mfma_f32_16x16x32_bf16 v[36:39], a[96:99], v[72:75], v[36:39]
  ds_read_b128 v[72:75], v3 offset:11264
  s_waitcnt lgkmcnt(2)
  v_mfma_f32_16x16x32_bf16 v[32:35], v[164:167], v[64:67], v[32:35]
  v_mfma_f32_16x16x32_bf16 v[36:39], a[100:103], v[64:67], v[36:39]
  ds_read_b128 v[64:67], v3 offset:12288
  s_waitcnt lgkmcnt(2)
  v_mfma_f32_16x16x32_bf16 v[32:35], v[168:171], v[68:71], v[32:35]
  v_mfma_f32_16x16x32_bf16 v[36:39], a[104:107], v[68:71], v[36:39]
  ds_read_b128 v[68:71], v3 offset:13312
  s_waitcnt lgkmcnt(2)
  v_mfma_f32_16x16x32_bf16 v[32:35], v[172:175], v[72:75], v[32:35]
  v_mfma_f32_16x16x32_bf16 v[36:39], a[108:111], v[72:75], v[36:39]
  ds_read_b128 v[72:75], v3 offset:14336
  s_waitcnt lgkmcnt(2)
  v_mfma_f32_16x16x32_bf16 v[32:35], v[176:179], v[64:67], v[32:35]
  s_waitcnt vmcnt(0)
  v_lshlrev_b32 v100, 16, v96
  v_mfma_f32_16x16x32_bf16 v[36:39], a[112:115], v[64:67], v[36:39]
  v_and_b32 v101, 0xffff0000, v96
  v_add_f32 v40, v40, v100
  ds_read_b128 v[64:67], v3 offset:15360
  s_waitcnt lgkmcnt(2)
  v_mfma_f32_16x16x32_bf16 v[32:35], v[180:183], v[68:71], v[32:35]
  v_add_f32 v41, v41, v101
  v_lshlrev_b32 v100, 16, v97
  v_mfma_f32_16x16x32_bf16 v[36:39], a[116:119], v[68:71], v[36:39]
  v_and_b32 v101, 0xffff0000, v97
  v_add_f32 v42, v42, v100
  ds_read_b128 v[68:71], v3 offset:16384
  s_waitcnt lgkmcnt(2)
  v_mfma_f32_16x16x32_bf16 v[32:35], v[184:187], v[72:75], v[32:35]
  v_add_f32 v43, v43, v101
  global_store_dwordx4 v9, v[40:43], s[62:63] offset:0 sc1
  v_mfma_f32_16x16x32_bf16 v[36:39], a[120:123], v[72:75], v[36:39]
  ds_read_b128 v[72:75], v3 offset:17408
  s_waitcnt lgkmcnt(2)
  v_mfma_f32_16x16x32_bf16 v[32:35], v[188:191], v[64:67], v[32:35]
  v_mfma_f32_16x16x32_bf16 v[36:39], a[124:127], v[64:67], v[36:39]
  ds_read_b128 v[64:67], v3 offset:18432
  s_waitcnt lgkmcnt(2)
  v_mfma_f32_16x16x32_bf16 v[32:35], v[192:195], v[68:71], v[32:35]
  v_lshlrev_b32 v100, 16, v98
  v_and_b32 v101, 0xffff0000, v98
  v_mfma_f32_16x16x32_bf16 v[36:39], a[128:131], v[68:71], v[36:39]
  v_add_f32 v44, v44, v100
  v_add_f32 v45, v45, v101
  ds_read_b128 v[68:71], v3 offset:19456
  s_waitcnt lgkmcnt(2)
  v_mfma_f32_16x16x32_bf16 v[32:35], v[196:199], v[72:75], v[32:35]
  v_lshlrev_b32 v100, 16, v99
  v_and_b32 v101, 0xffff0000, v99
  v_mfma_f32_16x16x32_bf16 v[36:39], a[132:135], v[72:75], v[36:39]
  v_add_f32 v46, v46, v100
  v_add_f32 v47, v47, v101
  ds_read_b128 v[72:75], v3 offset:20480
  s_waitcnt lgkmcnt(2)
  v_mfma_f32_16x16x32_bf16 v[32:35], v[200:203], v[64:67], v[32:35]
  global_store_dwordx4 v9, v[44:47], s[62:63] offset:1024 sc1
  v_mfma_f32_16x16x32_bf16 v[36:39], a[136:139], v[64:67], v[36:39]
  ds_read_b128 v[64:67], v3 offset:21504
  s_waitcnt lgkmcnt(2)
  v_mfma_f32_16x16x32_bf16 v[32:35], v[204:207], v[68:71], v[32:35]
  v_mfma_f32_16x16x32_bf16 v[36:39], a[140:143], v[68:71], v[36:39]
  s_mul_i32 s48, s54, 49152
  s_add_u32 s48, s48, s59
  ds_read_b128 v[68:71], v3 offset:22528
  s_waitcnt lgkmcnt(2)
  v_mfma_f32_16x16x32_bf16 v[32:35], v[208:211], v[72:75], v[32:35]
  s_add_u32 s50, s4, s48
  s_addc_u32 s51, s5, 0
  v_mfma_f32_16x16x32_bf16 v[36:39], a[144:147], v[72:75], v[36:39]
  s_add_u32 m0, s86, 49152
  s_nop 0
  ds_read_b128 v[72:75], v3 offset:23552
  s_waitcnt lgkmcnt(2)
  v_mfma_f32_16x16x32_bf16 v[32:35], v[212:215], v[64:67], v[32:35]
  global_load_lds_dwordx4 v4, s[50:51] offset:0 sc1
  v_mfma_f32_16x16x32_bf16 v[36:39], a[148:151], v[64:67], v[36:39]
  ds_read_b128 v[64:67], v3 offset:24576
  s_waitcnt lgkmcnt(2)
  v_mfma_f32_16x16x32_bf16 v[32:35], v[216:219], v[68:71], v[32:35]
  v_mfma_f32_16x16x32_bf16 v[36:39], a[152:155], v[68:71], v[36:39]
  global_load_lds_dwordx4 v4, s[50:51] offset:1024 sc1
  ds_read_b128 v[68:71], v3 offset:25600
  s_waitcnt lgkmcnt(2)
  v_mfma_f32_16x16x32_bf16 v[32:35], v[220:223], v[72:75], v[32:35]
  v_mfma_f32_16x16x32_bf16 v[36:39], a[156:159], v[72:75], v[36:39]
  ds_read_b128 v[72:75], v3 offset:26624
  s_waitcnt lgkmcnt(2)
  v_mfma_f32_16x16x32_bf16 v[32:35], v[224:227], v[64:67], v[32:35]
  global_load_lds_dwordx4 v4, s[50:51] offset:2048 sc1
  v_mfma_f32_16x16x32_bf16 v[36:39], a[160:163], v[64:67], v[36:39]
  ds_read_b128 v[64:67], v3 offset:27648
  s_waitcnt lgkmcnt(2)
  v_mfma_f32_16x16x32_bf16 v[32:35], v[228:231], v[68:71], v[32:35]
  v_mfma_f32_16x16x32_bf16 v[36:39], a[164:167], v[68:71], v[36:39]
  global_load_lds_dwordx4 v4, s[50:51] offset:3072 sc1
  ds_read_b128 v[68:71], v3 offset:28672
  s_waitcnt lgkmcnt(2)
  v_mfma_f32_16x16x32_bf16 v[32:35], v[232:235], v[72:75], v[32:35]
  v_mfma_f32_16x16x32_bf16 v[36:39], a[168:171], v[72:75], v[36:39]
  ds_read_b128 v[72:75], v3 offset:29696
  s_waitcnt lgkmcnt(2)
  v_mfma_f32_16x16x32_bf16 v[32:35], v[236:239], v[64:67], v[32:35]
  s_add_u32 s50, s50, 4096
  s_addc_u32 s51, s51, 0
  v_mfma_f32_16x16x32_bf16 v[36:39], a[172:175], v[64:67], v[36:39]
  s_add_u32 m0, s86, 53248
  s_nop 0
  ds_read_b128 v[64:67], v3 offset:30720
  s_waitcnt lgkmcnt(2)
  v_mfma_f32_16x16x32_bf16 v[32:35], v[240:243], v[68:71], v[32:35]
  global_load_lds_dwordx4 v4, s[50:51] offset:0 sc1
  v_mfma_f32_16x16x32_bf16 v[36:39], a[176:179], v[68:71], v[36:39]
  ds_read_b128 v[68:71], v3 offset:31744
  s_waitcnt lgkmcnt(2)
  v_mfma_f32_16x16x32_bf16 v[32:35], v[244:247], v[72:75], v[32:35]
  v_mfma_f32_16x16x32_bf16 v[36:39], a[180:183], v[72:75], v[36:39]
  global_load_lds_dwordx4 v4, s[50:51] offset:1024 sc1
  ds_read_b128 v[72:75], v3 offset:32768
  s_waitcnt lgkmcnt(2)
  v_mfma_f32_16x16x32_bf16 v[32:35], v[248:251], v[64:67], v[32:35]
  v_mfma_f32_16x16x32_bf16 v[36:39], a[184:187], v[64:67], v[36:39]
  ds_read_b128 v[64:67], v3 offset:33792
  s_waitcnt lgkmcnt(2)
  v_mfma_f32_16x16x32_bf16 v[32:35], v[252:255], v[68:71], v[32:35]
  global_load_lds_dwordx4 v4, s[50:51] offset:2048 sc1
  v_mfma_f32_16x16x32_bf16 v[36:39], a[188:191], v[68:71], v[36:39]
  ds_read_b128 v[68:71], v3 offset:34816
  s_waitcnt lgkmcnt(2)
  v_mfma_f32_16x16x32_bf16 v[32:35], a[0:3], v[72:75], v[32:35]
  v_mfma_f32_16x16x32_bf16 v[36:39], a[192:195], v[72:75], v[36:39]
  global_load_lds_dwordx4 v4, s[50:51] offset:3072 sc1
  ds_read_b128 v[72:75], v3 offset:35840
  s_waitcnt lgkmcnt(2)
  v_mfma_f32_16x16x32_bf16 v[32:35], a[4:7], v[64:67], v[32:35]
  v_mfma_f32_16x16x32_bf16 v[36:39], a[196:199], v[64:67], v[36:39]
  ds_read_b128 v[64:67], v3 offset:36864
  s_waitcnt lgkmcnt(2)
  v_mfma_f32_16x16x32_bf16 v[32:35], a[8:11], v[68:71], v[32:35]
  s_add_u32 s50, s50, 4096
  s_addc_u32 s51, s51, 0
  v_mfma_f32_16x16x32_bf16 v[36:39], a[200:203], v[68:71], v[36:39]
  s_add_u32 m0, s86, 57344
  s_nop 0
  ds_read_b128 v[68:71], v3 offset:37888
  s_waitcnt lgkmcnt(2)
  v_mfma_f32_16x16x32_bf16 v[32:35], a[12:15], v[72:75], v[32:35]
  global_load_lds_dwordx4 v4, s[50:51] offset:0 sc1
  v_mfma_f32_16x16x32_bf16 v[36:39], a[204:207], v[72:75], v[36:39]
  ds_read_b128 v[72:75], v3 offset:38912
  s_waitcnt lgkmcnt(2)
  v_mfma_f32_16x16x32_bf16 v[32:35], a[16:19], v[64:67], v[32:35]
  v_mfma_f32_16x16x32_bf16 v[36:39], a[208:211], v[64:67], v[36:39]
  global_load_lds_dwordx4 v4, s[50:51] offset:1024 sc1
  ds_read_b128 v[64:67], v3 offset:39936
  s_waitcnt lgkmcnt(2)
  v_mfma_f32_16x16x32_bf16 v[32:35], a[20:23], v[68:71], v[32:35]
  v_mfma_f32_16x16x32_bf16 v[36:39], a[212:215], v[68:71], v[36:39]
  ds_read_b128 v[68:71], v3 offset:40960
  s_waitcnt lgkmcnt(2)
  v_mfma_f32_16x16x32_bf16 v[32:35], a[24:27], v[72:75], v[32:35]
  global_load_lds_dwordx4 v4, s[50:51] offset:2048 sc1
  v_mfma_f32_16x16x32_bf16 v[36:39], a[216:219], v[72:75], v[36:39]
  ds_read_b128 v[72:75], v3 offset:41984
  s_waitcnt lgkmcnt(2)
  v_mfma_f32_16x16x32_bf16 v[32:35], a[28:31], v[64:67], v[32:35]
  v_mfma_f32_16x16x32_bf16 v[36:39], a[220:223], v[64:67], v[36:39]
  global_load_lds_dwordx4 v4, s[50:51] offset:3072 sc1
  ds_read_b128 v[64:67], v3 offset:43008
  s_waitcnt lgkmcnt(2)
  v_mfma_f32_16x16x32_bf16 v[32:35], a[32:35], v[68:71], v[32:35]
  v_mfma_f32_16x16x32_bf16 v[36:39], a[224:227], v[68:71], v[36:39]
  ds_read_b128 v[68:71], v3 offset:44032
  s_waitcnt lgkmcnt(2)
  v_mfma_f32_16x16x32_bf16 v[32:35], a[36:39], v[72:75], v[32:35]
  v_mfma_f32_16x16x32_bf16 v[36:39], a[228:231], v[72:75], v[36:39]
  ds_read_b128 v[72:75], v3 offset:45056
  s_waitcnt lgkmcnt(2)
  v_mfma_f32_16x16x32_bf16 v[32:35], a[40:43], v[64:67], v[32:35]
  v_mfma_f32_16x16x32_bf16 v[36:39], a[232:235], v[64:67], v[36:39]
  ds_read_b128 v[64:67], v3 offset:46080
  s_waitcnt lgkmcnt(2)
  v_mfma_f32_16x16x32_bf16 v[32:35], a[44:47], v[68:71], v[32:35]
  v_mfma_f32_16x16x32_bf16 v[36:39], a[236:239], v[68:71], v[36:39]
  ds_read_b128 v[68:71], v3 offset:47104
  s_waitcnt lgkmcnt(2)
  v_mfma_f32_16x16x32_bf16 v[32:35], a[48:51], v[72:75], v[32:35]
  v_mfma_f32_16x16x32_bf16 v[36:39], a[240:243], v[72:75], v[36:39]
  ds_read_b128 v[72:75], v3 offset:48128
  s_waitcnt lgkmcnt(2)
  v_mfma_f32_16x16x32_bf16 v[32:35], a[52:55], v[64:67], v[32:35]
  v_mfma_f32_16x16x32_bf16 v[36:39], a[244:247], v[64:67], v[36:39]
  s_waitcnt lgkmcnt(1)
  v_mfma_f32_16x16x32_bf16 v[32:35], a[56:59], v[68:71], v[32:35]
  v_mfma_f32_16x16x32_bf16 v[36:39], a[248:251], v[68:71], v[36:39]
  s_waitcnt lgkmcnt(0)
  v_mfma_f32_16x16x32_bf16 v[32:35], a[60:63], v[72:75], v[32:35]
  v_mfma_f32_16x16x32_bf16 v[36:39], a[252:255], v[72:75], v[36:39]
  s_mov_b32 s47, s46
  s_mov_b32 s46, s44
  s_mov_b32 s44, s52
  s_cmp_lt_u32 s44, 128
  s_cbranch_scc1 FFN2_loop
FFN2_fin0:
  s_nop 7
  s_mul_i32 s60, s46, 20480
  s_add_u32 s62, s10, s60
  s_addc_u32 s63, s11, 0
  global_load_dwordx2 v[96:97], v8, s[62:63]
  global_load_dwordx2 v[98:99], v8, s[62:63] offset:32
  s_mul_i32 s60, s46, 40960
  s_add_u32 s60, s60, 0xa00000
  s_add_u32 s62, s4, s60
  s_addc_u32 s63, s5, 0
  s_waitcnt vmcnt(0)
  v_lshlrev_b32 v100, 16, v96
  v_and_b32 v101, 0xffff0000, v96
  v_add_f32 v32, v32, v100
  v_add_f32 v33, v33, v101
  v_lshlrev_b32 v100, 16, v97
  v_and_b32 v101, 0xffff0000, v97
  v_add_f32 v34, v34, v100
  v_add_f32 v35, v35, v101
  global_store_dwordx4 v9, v[32:35], s[62:63] offset:0 sc1
  v_lshlrev_b32 v100, 16, v98
  v_and_b32 v101, 0xffff0000, v98
  v_add_f32 v36, v36, v100
  v_add_f32 v37, v37, v101
  v_lshlrev_b32 v100, 16, v99
  v_and_b32 v101, 0xffff0000, v99
  v_add_f32 v38, v38, v100
  v_add_f32 v39, v39, v101
  global_store_dwordx4 v9, v[36:39], s[62:63] offset:1024 sc1
  s_branch FFN2_tail
FFN2_fin1:
  s_nop 7
  s_mul_i32 s60, s46, 20480
  s_add_u32 s62, s10, s60
  s_addc_u32 s63, s11, 0
  global_load_dwordx2 v[96:97], v8, s[62:63]
  global_load_dwordx2 v[98:99], v8, s[62:63] offset:32
  s_mul_i32 s60, s46, 40960
  s_add_u32 s60, s60, 0xa00000
  s_add_u32 s62, s4, s60
  s_addc_u32 s63, s5, 0
  s_waitcnt vmcnt(0)
  v_lshlrev_b32 v100, 16, v96
  v_and_b32 v101, 0xffff0000, v96
  v_add_f32 v40, v40, v100
  v_add_f32 v41, v41, v101
  v_lshlrev_b32 v100, 16, v97
  v_and_b32 v101, 0xffff0000, v97
  v_add_f32 v42, v42, v100
  v_add_f32 v43, v43, v101
  global_store_dwordx4 v9, v[40:43], s[62:63] offset:0 sc1
  v_lshlrev_b32 v100, 16, v98
  v_and_b32 v101, 0xffff0000, v98
  v_add_f32 v44, v44, v100
  v_add_f32 v45, v45, v101
  v_lshlrev_b32 v100, 16, v99
  v_and_b32 v101, 0xffff0000, v99
  v_add_f32 v46, v46, v100
  v_add_f32 v47, v47, v101
  global_store_dwordx4 v9, v[44:47], s[62:63] offset:1024 sc1
FFN2_tail:
  s_waitcnt vmcnt(0)
  s_barrier
  s_cmp_eq_u32 s47, -1
  s_cbranch_scc1 FS_142
  s_cmp_lg_u32 s3, 0
  s_cbranch_scc1 FS_142
  s_lshl_b32 s48, s47, 5
  s_add_u32 s48, s48, s58
  v_mov_b32 v5, s48
  v_mov_b32 v6, 1
  s_mov_b64 exec, 1
  global_store_dword v5, v6, s[4:5] sc1
  s_mov_b64 exec, -1
FS_142:
  s_cmp_eq_u32 s46, -1
  s_cbranch_scc1 FS_143
  s_cmp_lg_u32 s3, 0
  s_cbranch_scc1 FS_143
  s_lshl_b32 s48, s46, 5
  s_add_u32 s48, s48, s58
  v_mov_b32 v5, s48
  v_mov_b32 v6, 1
  s_mov_b64 exec, 1
  global_store_dword v5, v6, s[4:5] sc1
  s_mov_b64 exec, -1
FS_143:
FFN2_end:
  s_load_dwordx2 s[8:9], s[0:1], 88
  s_lshl_b32 s48, s40, 5
  s_add_u32 s48, s48, 0x136c000
  v_min_u32 v8, 4, v1
  v_lshlrev_b32 v8, 2, v8
  v_add_u32 v8, s48, v8
FIN_wb:
  global_load_dword v12, v8, s[4:5] offset:0 sc1
  s_waitcnt vmcnt(0)
  v_cmp_ne_u32 vcc, 1, v12
  s_cbranch_vccz FIN_wbd
  s_sleep 4
  s_add_u32 s66, s66, 1
  s_cmp_lt_u32 s66, 0x200000
  s_cbranch_scc1 FIN_wb
  s_endpgm
FIN_wbd:
  s_mul_i32 s48, s40, 40960
  s_mul_i32 s49, s3, 10240
  s_add_u32 s48, s48, s49
  s_lshr_b32 s49, s48, 1
  s_add_u32 s48, s48, 0xa00000
  s_add_u32 s49, s49, 0x6e00000
  s_add_u32 s12, s4, s48
  s_addc_u32 s13, s5, 0
  s_add_u32 s14, s4, s49
  s_addc_u32 s15, s5, 0
  v_lshlrev_b32 v3, 4, v1
  v_lshlrev_b32 v4, 3, v1
  v_add_u32 v5, 4096, v4
  global_load_dwordx4 v[24:27], v3, s[12:13] offset:0 sc1
  global_load_dwordx4 v[28:31], v3, s[12:13] offset:1024 sc1
  global_load_dwordx4 v[32:35], v3, s[12:13] offset:2048 sc1
  global_load_dwordx4 v[36:39], v3, s[12:13] offset:3072 sc1
  s_add_u32 s12, s12, 4096
  s_addc_u32 s13, s13, 0
  global_load_dwordx4 v[40:43], v3, s[12:13] offset:0 sc1
  global_load_dwordx4 v[44:47], v3, s[12:13] offset:1024 sc1
  global_load_dwordx4 v[48:51], v3, s[12:13] offset:2048 sc1
  global_load_dwordx4 v[52:55], v3, s[12:13] offset:3072 sc1
  s_add_u32 s12, s12, 4096
  s_addc_u32 s13, s13, 0
  global_load_dwordx4 v[56:59], v3, s[12:13] offset:0 sc1
  global_load_dwordx4 v[60:63], v3, s[12:13] offset:1024 sc1
  s_cmp_ge_u32 s40, 124
  s_cbranch_scc1 FIN_last
  s_lshr_b32 s48, s40, 1
  s_lshl_b32 s48, s48, 4
  s_add_u32 s48, s48, 0x136e000
  v_min_u32 v8, 3, v1
  v_lshlrev_b32 v8, 2, v8
  v_add_u32 v8, s48, v8
FIN_wo:
  global_load_dword v12, v8, s[4:5] offset:0 sc1
  s_waitcnt vmcnt(0)
  v_cmp_ne_u32 vcc, 1, v12
  s_cbranch_vccz FIN_wod
  s_sleep 4
  s_add_u32 s66, s66, 1
  s_cmp_lt_u32 s66, 0x200000
  s_cbranch_scc1 FIN_wo
  s_endpgm
FIN_wod:
  s_branch FIN_ld
FIN_last:
  s_sub_u32 s14, s14, 0xa00000
  s_subb_u32 s15, s15, 0
  s_lshr_b32 s48, s40, 1
  s_lshl_b32 s48, s48, 10
  s_add_u32 s48, s48, 0x1370000
  v_min_u32 v8, 39, v1
  v_lshlrev_b32 v8, 2, v8
  v_add_u32 v8, s48, v8
FIN_wl:
  global_load_dword v12, v8, s[4:5] offset:0 sc1
  global_load_dword v13, v8, s[4:5] offset:256 sc1
  global_load_dword v14, v8, s[4:5] offset:512 sc1
  global_load_dword v15, v8, s[4:5] offset:768 sc1
  s_waitcnt vmcnt(0)
  v_and_b32 v12, v12, v13
  v_and_b32 v12, v12, v14
  v_and_b32 v12, v12, v15
  v_cmp_ne_u32 vcc, 1, v12
  s_cbranch_vccz FIN_wld
  s_sleep 4
  s_add_u32 s66, s66, 1
  s_cmp_lt_u32 s66, 0x200000
  s_cbranch_scc1 FIN_wl
  s_endpgm
FIN_wld:
FIN_ld:
  global_load_dwordx2 v[64:65], v4, s[14:15] offset:0 sc1
  global_load_dwordx2 v[66:67], v4, s[14:15] offset:512 sc1
  global_load_dwordx2 v[68:69], v4, s[14:15] offset:1024 sc1
  global_load_dwordx2 v[70:71], v4, s[14:15] offset:1536 sc1
  global_load_dwordx2 v[72:73], v4, s[14:15] offset:2048 sc1
  global_load_dwordx2 v[74:75], v4, s[14:15] offset:2560 sc1
  global_load_dwordx2 v[76:77], v4, s[14:15] offset:3072 sc1
  global_load_dwordx2 v[78:79], v4, s[14:15] offset:3584 sc1
  global_load_dwordx2 v[80:81], v5, s[14:15] offset:0 sc1
  global_load_dwordx2 v[82:83], v5, s[14:15] offset:512 sc1
  s_add_u32 s14, s14, 2621440
  s_addc_u32 s15, s15, 0
  global_load_dwordx2 v[84:85], v4, s[14:15] offset:0 sc1
  global_load_dwordx2 v[86:87], v4, s[14:15] offset:512 sc1
  global_load_dwordx2 v[88:89], v4, s[14:15] offset:1024 sc1
  global_load_dwordx2 v[90:91], v4, s[14:15] offset:1536 sc1
  global_load_dwordx2 v[92:93], v4, s[14:15] offset:2048 sc1
  global_load_dwordx2 v[94:95], v4, s[14:15] offset:2560 sc1
  global_load_dwordx2 v[96:97], v4, s[14:15] offset:3072 sc1
  global_load_dwordx2 v[98:99], v4, s[14:15] offset:3584 sc1
  global_load_dwordx2 v[100:101], v5, s[14:15] offset:0 sc1
  global_load_dwordx2 v[102:103], v5, s[14:15] offset:512 sc1
  s_add_u32 s14, s14, 2621440
  s_addc_u32 s15, s15, 0
  global_load_dwordx2 v[104:105], v4, s[14:15] offset:0 sc1
  global_load_dwordx2 v[106:107], v4, s[14:15] offset:512 sc1
  global_load_dwordx2 v[108:109], v4, s[14:15] offset:1024 sc1
  global_load_dwordx2 v[110:111], v4, s[14:15] offset:1536 sc1
  global_load_dwordx2 v[112:113], v4, s[14:15] offset:2048 sc1
  global_load_dwordx2 v[114:115], v4, s[14:15] offset:2560 sc1
  global_load_dwordx2 v[116:117], v4, s[14:15] offset:3072 sc1
  global_load_dwordx2 v[118:119], v4, s[14:15] offset:3584 sc1
  global_load_dwordx2 v[120:121], v5, s[14:15] offset:0 sc1
  global_load_dwordx2 v[122:123], v5, s[14:15] offset:512 sc1
  s_add_u32 s14, s14, 2621440
  s_addc_u32 s15, s15, 0
  global_load_dwordx2 v[124:125], v4, s[14:15] offset:0 sc1
  global_load_dwordx2 v[126:127], v4, s[14:15] offset:512 sc1
  global_load_dwordx2 v[128:129], v4, s[14:15] offset:1024 sc1
  global_load_dwordx2 v[130:131], v4, s[14:15] offset:1536 sc1
  global_load_dwordx2 v[132:133], v4, s[14:15] offset:2048 sc1
  global_load_dwordx2 v[134:135], v4, s[14:15] offset:2560 sc1
  global_load_dwordx2 v[136:137], v4, s[14:15] offset:3072 sc1
  global_load_dwordx2 v[138:139], v4, s[14:15] offset:3584 sc1
  global_load_dwordx2 v[140:141], v5, s[14:15] offset:0 sc1
  global_load_dwordx2 v[142:143], v5, s[14:15] offset:512 sc1
  s_mul_i32 s48, s40, 20480
  s_mul_i32 s49, s3, 320
  s_add_u32 s48, s48, s49
  s_add_u32 s8, s8, s48
  s_addc_u32 s9, s9, 0
  v_and_b32 v6, 15, v1
  v_mul_u32_u24 v6, 1280, v6
  v_lshrrev_b32 v7, 4, v1
  v_lshl_add_u32 v6, v7, 3, v6
  s_waitcnt vmcnt(30)
  v_lshlrev_b32 v16, 16, v64
  v_and_b32 v17, 0xffff0000, v64
  v_pk_add_f32 v[24:25], v[24:25], v[16:17]
  v_lshlrev_b32 v16, 16, v65
  v_and_b32 v17, 0xffff0000, v65
  v_pk_add_f32 v[26:27], v[26:27], v[16:17]
  v_lshlrev_b32 v16, 16, v66
  v_and_b32 v17, 0xffff0000, v66
  v_pk_add_f32 v[28:29], v[28:29], v[16:17]
  v_lshlrev_b32 v16, 16, v67
  v_and_b32 v17, 0xffff0000, v67
  v_pk_add_f32 v[30:31], v[30:31], v[16:17]
  v_lshlrev_b32 v16, 16, v68
  v_and_b32 v17, 0xffff0000, v68
  v_pk_add_f32 v[32:33], v[32:33], v[16:17]
  v_lshlrev_b32 v16, 16, v69
  v_and_b32 v17, 0xffff0000, v69
  v_pk_add_f32 v[34:35], v[34:35], v[16:17]
  v_lshlrev_b32 v16, 16, v70
  v_and_b32 v17, 0xffff0000, v70
  v_pk_add_f32 v[36:37], v[36:37], v[16:17]
  v_lshlrev_b32 v16, 16, v71
  v_and_b32 v17, 0xffff0000, v71
  v_pk_add_f32 v[38:39], v[38:39], v[16:17]
  v_lshlrev_b32 v16, 16, v72
  v_and_b32 v17, 0xffff0000, v72
  v_pk_add_f32 v[40:41], v[40:41], v[16:17]
  v_lshlrev_b32 v16, 16, v73
  v_and_b32 v17, 0xffff0000, v73
  v_pk_add_f32 v[42:43], v[42:43], v[16:17]
  v_lshlrev_b32 v16, 16, v74
  v_and_b32 v17, 0xffff0000, v74
  v_pk_add_f32 v[44:45], v[44:45], v[16:17]
  v_lshlrev_b32 v16, 16, v75
  v_and_b32 v17, 0xffff0000, v75
  v_pk_add_f32 v[46:47], v[46:47], v[16:17]
  v_lshlrev_b32 v16, 16, v76
  v_and_b32 v17, 0xffff0000, v76
  v_pk_add_f32 v[48:49], v[48:49], v[16:17]
  v_lshlrev_b32 v16, 16, v77
  v_and_b32 v17, 0xffff0000, v77
  v_pk_add_f32 v[50:51], v[50:51], v[16:17]
  v_lshlrev_b32 v16, 16, v78
  v_and_b32 v17, 0xffff0000, v78
  v_pk_add_f32 v[52:53], v[52:53], v[16:17]
  v_lshlrev_b32 v16, 16, v79
  v_and_b32 v17, 0xffff0000, v79
  v_pk_add_f32 v[54:55], v[54:55], v[16:17]
  v_lshlrev_b32 v16, 16, v80
  v_and_b32 v17, 0xffff0000, v80
  v_pk_add_f32 v[56:57], v[56:57], v[16:17]
  v_lshlrev_b32 v16, 16, v81
  v_and_b32 v17, 0xffff0000, v81
  v_pk_add_f32 v[58:59], v[58:59], v[16:17]
  v_lshlrev_b32 v16, 16, v82
  v_and_b32 v17, 0xffff0000, v82
  v_pk_add_f32 v[60:61], v[60:61], v[16:17]
  v_lshlrev_b32 v16, 16, v83
  v_and_b32 v17, 0xffff0000, v83
  v_pk_add_f32 v[62:63], v[62:63], v[16:17]
  s_waitcnt vmcnt(20)
  v_lshlrev_b32 v16, 16, v84
  v_and_b32 v17, 0xffff0000, v84
  v_pk_add_f32 v[24:25], v[24:25], v[16:17]
  v_lshlrev_b32 v16, 16, v85
  v_and_b32 v17, 0xffff0000, v85
  v_pk_add_f32 v[26:27], v[26:27], v[16:17]
  v_lshlrev_b32 v16, 16, v86
  v_and_b32 v17, 0xffff0000, v86
  v_pk_add_f32 v[28:29], v[28:29], v[16:17]
  v_lshlrev_b32 v16, 16, v87
  v_and_b32 v17, 0xffff0000, v87
  v_pk_add_f32 v[30:31], v[30:31], v[16:17]
  v_lshlrev_b32 v16, 16, v88
  v_and_b32 v17, 0xffff0000, v88
  v_pk_add_f32 v[32:33], v[32:33], v[16:17]
  v_lshlrev_b32 v16, 16, v89
  v_and_b32 v17, 0xffff0000, v89
  v_pk_add_f32 v[34:35], v[34:35], v[16:17]
  v_lshlrev_b32 v16, 16, v90
  v_and_b32 v17, 0xffff0000, v90
  v_pk_add_f32 v[36:37], v[36:37], v[16:17]
  v_lshlrev_b32 v16, 16, v91
  v_and_b32 v17, 0xffff0000, v91
  v_pk_add_f32 v[38:39], v[38:39], v[16:17]
  v_lshlrev_b32 v16, 16, v92
  v_and_b32 v17, 0xffff0000, v92
  v_pk_add_f32 v[40:41], v[40:41], v[16:17]
  v_lshlrev_b32 v16, 16, v93
  v_and_b32 v17, 0xffff0000, v93
  v_pk_add_f32 v[42:43], v[42:43], v[16:17]
  v_lshlrev_b32 v16, 16, v94
  v_and_b32 v17, 0xffff0000, v94
  v_pk_add_f32 v[44:45], v[44:45], v[16:17]
  v_lshlrev_b32 v16, 16, v95
  v_and_b32 v17, 0xffff0000, v95
  v_pk_add_f32 v[46:47], v[46:47], v[16:17]
  v_lshlrev_b32 v16, 16, v96
  v_and_b32 v17, 0xffff0000, v96
  v_pk_add_f32 v[48:49], v[48:49], v[16:17]
  v_lshlrev_b32 v16, 16, v97
  v_and_b32 v17, 0xffff0000, v97
  v_pk_add_f32 v[50:51], v[50:51], v[16:17]
  v_lshlrev_b32 v16, 16, v98
  v_and_b32 v17, 0xffff0000, v98
  v_pk_add_f32 v[52:53], v[52:53], v[16:17]
  v_lshlrev_b32 v16, 16, v99
  v_and_b32 v17, 0xffff0000, v99
  v_pk_add_f32 v[54:55], v[54:55], v[16:17]
  v_lshlrev_b32 v16, 16, v100
  v_and_b32 v17, 0xffff0000, v100
  v_pk_add_f32 v[56:57], v[56:57], v[16:17]
  v_lshlrev_b32 v16, 16, v101
  v_and_b32 v17, 0xffff0000, v101
  v_pk_add_f32 v[58:59], v[58:59], v[16:17]
  v_lshlrev_b32 v16, 16, v102
  v_and_b32 v17, 0xffff0000, v102
  v_pk_add_f32 v[60:61], v[60:61], v[16:17]
  v_lshlrev_b32 v16, 16, v103
  v_and_b32 v17, 0xffff0000, v103
  v_pk_add_f32 v[62:63], v[62:63], v[16:17]
  s_waitcnt vmcnt(10)
  v_lshlrev_b32 v16, 16, v104
  v_and_b32 v17, 0xffff0000, v104
  v_pk_add_f32 v[24:25], v[24:25], v[16:17]
  v_lshlrev_b32 v16, 16, v105
  v_and_b32 v17, 0xffff0000, v105
  v_pk_add_f32 v[26:27], v[26:27], v[16:17]
  v_lshlrev_b32 v16, 16, v106
  v_and_b32 v17, 0xffff0000, v106
  v_pk_add_f32 v[28:29], v[28:29], v[16:17]
  v_lshlrev_b32 v16, 16, v107
  v_and_b32 v17, 0xffff0000, v107
  v_pk_add_f32 v[30:31], v[30:31], v[16:17]
  v_lshlrev_b32 v16, 16, v108
  v_and_b32 v17, 0xffff0000, v108
  v_pk_add_f32 v[32:33], v[32:33], v[16:17]
  v_lshlrev_b32 v16, 16, v109
  v_and_b32 v17, 0xffff0000, v109
  v_pk_add_f32 v[34:35], v[34:35], v[16:17]
  v_lshlrev_b32 v16, 16, v110
  v_and_b32 v17, 0xffff0000, v110
  v_pk_add_f32 v[36:37], v[36:37], v[16:17]
  v_lshlrev_b32 v16, 16, v111
  v_and_b32 v17, 0xffff0000, v111
  v_pk_add_f32 v[38:39], v[38:39], v[16:17]
  v_lshlrev_b32 v16, 16, v112
  v_and_b32 v17, 0xffff0000, v112
  v_pk_add_f32 v[40:41], v[40:41], v[16:17]
  v_lshlrev_b32 v16, 16, v113
  v_and_b32 v17, 0xffff0000, v113
  v_pk_add_f32 v[42:43], v[42:43], v[16:17]
  v_lshlrev_b32 v16, 16, v114
  v_and_b32 v17, 0xffff0000, v114
  v_pk_add_f32 v[44:45], v[44:45], v[16:17]
  v_lshlrev_b32 v16, 16, v115
  v_and_b32 v17, 0xffff0000, v115
  v_pk_add_f32 v[46:47], v[46:47], v[16:17]
  v_lshlrev_b32 v16, 16, v116
  v_and_b32 v17, 0xffff0000, v116
  v_pk_add_f32 v[48:49], v[48:49], v[16:17]
  v_lshlrev_b32 v16, 16, v117
  v_and_b32 v17, 0xffff0000, v117
  v_pk_add_f32 v[50:51], v[50:51], v[16:17]
  v_lshlrev_b32 v16, 16, v118
  v_and_b32 v17, 0xffff0000, v118
  v_pk_add_f32 v[52:53], v[52:53], v[16:17]
  v_lshlrev_b32 v16, 16, v119
  v_and_b32 v17, 0xffff0000, v119
  v_pk_add_f32 v[54:55], v[54:55], v[16:17]
  v_lshlrev_b32 v16, 16, v120
  v_and_b32 v17, 0xffff0000, v120
  v_pk_add_f32 v[56:57], v[56:57], v[16:17]
  v_lshlrev_b32 v16, 16, v121
  v_and_b32 v17, 0xffff0000, v121
  v_pk_add_f32 v[58:59], v[58:59], v[16:17]
  v_lshlrev_b32 v16, 16, v122
  v_and_b32 v17, 0xffff0000, v122
  v_pk_add_f32 v[60:61], v[60:61], v[16:17]
  v_lshlrev_b32 v16, 16, v123
  v_and_b32 v17, 0xffff0000, v123
  v_pk_add_f32 v[62:63], v[62:63], v[16:17]
  s_waitcnt vmcnt(0)
  v_lshlrev_b32 v16, 16, v124
  v_and_b32 v17, 0xffff0000, v124
  v_pk_add_f32 v[24:25], v[24:25], v[16:17]
  v_lshlrev_b32 v16, 16, v125
  v_and_b32 v17, 0xffff0000, v125
  v_pk_add_f32 v[26:27], v[26:27], v[16:17]
  v_lshlrev_b32 v16, 16, v126
  v_and_b32 v17, 0xffff0000, v126
  v_pk_add_f32 v[28:29], v[28:29], v[16:17]
  v_lshlrev_b32 v16, 16, v127
  v_and_b32 v17, 0xffff0000, v127
  v_pk_add_f32 v[30:31], v[30:31], v[16:17]
  v_lshlrev_b32 v16, 16, v128
  v_and_b32 v17, 0xffff0000, v128
  v_pk_add_f32 v[32:33], v[32:33], v[16:17]
  v_lshlrev_b32 v16, 16, v129
  v_and_b32 v17, 0xffff0000, v129
  v_pk_add_f32 v[34:35], v[34:35], v[16:17]
  v_lshlrev_b32 v16, 16, v130
  v_and_b32 v17, 0xffff0000, v130
  v_pk_add_f32 v[36:37], v[36:37], v[16:17]
  v_lshlrev_b32 v16, 16, v131
  v_and_b32 v17, 0xffff0000, v131
  v_pk_add_f32 v[38:39], v[38:39], v[16:17]
  v_lshlrev_b32 v16, 16, v132
  v_and_b32 v17, 0xffff0000, v132
  v_pk_add_f32 v[40:41], v[40:41], v[16:17]
  v_lshlrev_b32 v16, 16, v133
  v_and_b32 v17, 0xffff0000, v133
  v_pk_add_f32 v[42:43], v[42:43], v[16:17]
  v_lshlrev_b32 v16, 16, v134
  v_and_b32 v17, 0xffff0000, v134
  v_pk_add_f32 v[44:45], v[44:45], v[16:17]
  v_lshlrev_b32 v16, 16, v135
  v_and_b32 v17, 0xffff0000, v135
  v_pk_add_f32 v[46:47], v[46:47], v[16:17]
  v_lshlrev_b32 v16, 16, v136
  v_and_b32 v17, 0xffff0000, v136
  v_pk_add_f32 v[48:49], v[48:49], v[16:17]
  v_lshlrev_b32 v16, 16, v137
  v_and_b32 v17, 0xffff0000, v137
  v_pk_add_f32 v[50:51], v[50:51], v[16:17]
  v_lshlrev_b32 v16, 16, v138
  v_and_b32 v17, 0xffff0000, v138
  v_pk_add_f32 v[52:53], v[52:53], v[16:17]
  v_lshlrev_b32 v16, 16, v139
  v_and_b32 v17, 0xffff0000, v139
  v_pk_add_f32 v[54:55], v[54:55], v[16:17]
  v_lshlrev_b32 v16, 16, v140
  v_and_b32 v17, 0xffff0000, v140
  v_pk_add_f32 v[56:57], v[56:57], v[16:17]
  v_lshlrev_b32 v16, 16, v141
  v_and_b32 v17, 0xffff0000, v141
  v_pk_add_f32 v[58:59], v[58:59], v[16:17]
  v_lshlrev_b32 v16, 16, v142
  v_and_b32 v17, 0xffff0000, v142
  v_pk_add_f32 v[60:61], v[60:61], v[16:17]
  v_lshlrev_b32 v16, 16, v143
  v_and_b32 v17, 0xffff0000, v143
  v_pk_add_f32 v[62:63], v[62:63], v[16:17]
  v_cvt_pk_bf16_f32 v24, v24, v25
  v_cvt_pk_bf16_f32 v25, v26, v27
  global_store_dwordx2 v6, v[24:25], s[8:9] offset:0
  v_cvt_pk_bf16_f32 v28, v28, v29
  v_cvt_pk_bf16_f32 v29, v30, v31
  global_store_dwordx2 v6, v[28:29], s[8:9] offset:32
  v_cvt_pk_bf16_f32 v32, v32, v33
  v_cvt_pk_bf16_f32 v33, v34, v35
  global_store_dwordx2 v6, v[32:33], s[8:9] offset:64
  v_cvt_pk_bf16_f32 v36, v36, v37
  v_cvt_pk_bf16_f32 v37, v38, v39
  global_store_dwordx2 v6, v[36:37], s[8:9] offset:96
  v_cvt_pk_bf16_f32 v40, v40, v41
  v_cvt_pk_bf16_f32 v41, v42, v43
  global_store_dwordx2 v6, v[40:41], s[8:9] offset:128
  v_cvt_pk_bf16_f32 v44, v44, v45
  v_cvt_pk_bf16_f32 v45, v46, v47
  global_store_dwordx2 v6, v[44:45], s[8:9] offset:160
  v_cvt_pk_bf16_f32 v48, v48, v49
  v_cvt_pk_bf16_f32 v49, v50, v51
  global_store_dwordx2 v6, v[48:49], s[8:9] offset:192
  v_cvt_pk_bf16_f32 v52, v52, v53
  v_cvt_pk_bf16_f32 v53, v54, v55
  global_store_dwordx2 v6, v[52:53], s[8:9] offset:224
  v_cvt_pk_bf16_f32 v56, v56, v57
  v_cvt_pk_bf16_f32 v57, v58, v59
  global_store_dwordx2 v6, v[56:57], s[8:9] offset:256
  v_cvt_pk_bf16_f32 v60, v60, v61
  v_cvt_pk_bf16_f32 v61, v62, v63
  global_store_dwordx2 v6, v[60:61], s[8:9] offset:288
  s_endpgm
K2_last:
.section .rodata,"a"
.p2align 6
.amdhsa_kernel parallel_sum__memory_aug_recurrent_mem_tr__swiglu_ffn__prompt_kernel
  .amdhsa_next_free_vgpr 512
  .amdhsa_next_free_sgpr 102
  .amdhsa_accum_offset 256
  .amdhsa_group_segment_fixed_size 0
  .amdhsa_kernarg_size 112
  .amdhsa_user_sgpr_count 2
  .amdhsa_user_sgpr_kernarg_segment_ptr 1
  .amdhsa_system_sgpr_workgroup_id_x 1
.end_amdhsa_kernel
```
